```python
import torch

def _softmax(x, axis=-1):
    return torch.softmax(x, dim=axis)
def _gelu(x):
    return torch.nn.functional.gelu(x, approximate="tanh")
def _silu(x):
    return torch.nn.functional.silu(x)
def _sigmoid(x):
    return torch.sigmoid(x)
def _layernorm(x, axis=-1, eps=1e-5):
    m = x.mean(dim=axis, keepdim=True)
    v = x.var(dim=axis, keepdim=True, unbiased=False)
    return (x - m) / torch.sqrt(v + eps)
def _scatter_add(tgt, idx, src, axis=0):
    return tgt.clone().index_add_(axis, idx, src)
def _segment_sum(src, seg, n):
    out = torch.zeros((n,) + src.shape[1:], dtype=src.dtype)
    return out.index_add_(0, seg, src)
def _pad(x, pw):
    flat = tuple(v for pair in reversed(pw) for v in pair)
    return torch.nn.functional.pad(x, flat)

kernel_name = 'parallel_sum__compressed_kv_cla__moe_arch_mod__prompt'

def setup_inputs():

    _w = (lambda a: (lambda t: t.to(torch.bfloat16) if t.is_floating_point() else t)(torch.as_tensor(a)))
    def _A_setup():
        B, H, Sq, Sk, D, M = 1, 32, 2048, 2048, 128, 512
        Dc = 4 * D
        return {
            "x": _w((lambda *s: torch.randn(*s, dtype=torch.bfloat16) * 0.05)(B, Sq, M)),
            "c_kv": _w((lambda *s: torch.randn(*s, dtype=torch.bfloat16) * 1.6)(B, Sk, Dc)),
            "w_q": _w((lambda *s: torch.randn(*s, dtype=torch.bfloat16) * 0.8)(M, H, D) * (M ** -0.5)),
            "w_uk": _w((lambda *s: torch.randn(*s, dtype=torch.bfloat16) * 0.8)(Dc, H, D) * (Dc ** -0.5)),
            "w_uv": _w((lambda *s: torch.randn(*s, dtype=torch.bfloat16) * 1.6)(Dc, H, D) * (Dc ** -0.5)),
            "w_o": _w((lambda *s: torch.randn(*s, dtype=torch.bfloat16) * 1.6)(H, D, M) * ((H * D) ** -0.5)),
        }
    _A_in = _A_setup()

    def _B_setup():
        B, S, D, F, C = 1, 2048, 512, 1376, 8
        return {
            "x": _w((lambda *s: torch.randn(*s, dtype=torch.bfloat16) * 0.05)(B, S, D)),
            "w_r": _w((lambda *s: torch.randn(*s, dtype=torch.bfloat16) * 0.05)(D)),
            "w_gate": _w((lambda *s: torch.randn(*s, dtype=torch.bfloat16) * 0.05)(D, F)),
            "w_up": _w((lambda *s: torch.randn(*s, dtype=torch.bfloat16) * 0.05)(D, F)),
            "w_down": _w((lambda *s: torch.randn(*s, dtype=torch.bfloat16) * 0.05)(F, D)),
        }
    _B_in = _B_setup()

    return {
        "A_x": _A_in["x"],
        "A_c_kv": _A_in["c_kv"],
        "A_w_q": _A_in["w_q"],
        "A_w_uk": _A_in["w_uk"],
        "A_w_uv": _A_in["w_uv"],
        "A_w_o": _A_in["w_o"],
        "B_x": _B_in["x"],
        "B_w_r": _B_in["w_r"],
        "B_w_gate": _B_in["w_gate"],
        "B_w_up": _B_in["w_up"],
        "B_w_down": _B_in["w_down"],
    }

def reference(A_x, A_c_kv, A_w_q, A_w_uk, A_w_uv, A_w_o, B_x, B_w_r, B_w_gate, B_w_up, B_w_down):
    def _A_ref(x, c_kv, w_q, w_uk, w_uv, w_o):
        B, Sq, M = x.shape[0], x.shape[1], x.shape[2]
        Sk = c_kv.shape[1]
        H, D = w_q.shape[1], w_q.shape[2]
        q = torch.einsum("bqm,mhd->bhqd", x, w_q)
        k = torch.einsum("bkc,chd->bhkd", c_kv, w_uk)
        v = torch.einsum("bkc,chd->bhkd", c_kv, w_uv)
        scores = torch.einsum("bhqd,bhkd->bhqk", q, k) * (D ** -0.5)
        off = Sk - Sq
        qi = torch.arange(Sq)[:, None]
        kj = torch.arange(Sk)[None, :]
        cmask = kj <= (qi + off)
        scores = torch.where(cmask[None, None], scores, -1e9)
        p = _softmax(scores, axis=-1)
        ctx = torch.einsum("bhqk,bhkd->bhqd", p, v)
        return torch.einsum("bhqd,hdm->bqm", ctx, w_o)

    def _B_ref(x, w_r, w_gate, w_up, w_down):
        B, S, D = x.shape
        C = 8
        r = x @ w_r
        idx = torch.argsort(-r, axis=-1)[:, :C]
        idx_e = (lambda x, n, axis: torch.repeat_interleave(x, n, dim=axis))(idx.reshape(B, C, 1), D, axis=2)
        x_sel = (lambda x, i, axis: torch.take_along_dim(x, i, dim=axis))(x, idx_e, axis=1)
        g = _silu(x_sel @ w_gate)
        u = x_sel @ w_up
        y = (g * u) @ w_down
        r_sel = _sigmoid((lambda x, i, axis: torch.take_along_dim(x, i, dim=axis))(r, idx, axis=1))
        y = y * r_sel.reshape(B, C, 1)
        b_off = (torch.arange(B) * S).reshape(B, 1)
        flat_idx = (idx + b_off).reshape(B * C)
        zero = (x * 0.0).reshape(B * S, D)
        upd = _scatter_add(zero, flat_idx, y.reshape(B * C, D), axis=0)
        return x + upd.reshape(B, S, D)

    x = A_x
    xn = _layernorm(x, axis=-1)
    return x + _A_ref(xn, A_c_kv, A_w_q, A_w_uk, A_w_uv, A_w_o) + _B_ref(xn, B_w_r, B_w_gate, B_w_up, B_w_down)
```

```asm
; @launch grid=(256,1,1) block=(256,1,1) lds=163840
.amdgcn_target "amdgcn-amd-amdhsa--gfx950"
.text
.globl parallel_sum__compressed_kv_cla__moe_arch_mod__prompt_kernel
.p2align 8
.type parallel_sum__compressed_kv_cla__moe_arch_mod__prompt_kernel,@function
parallel_sum__compressed_kv_cla__moe_arch_mod__prompt_kernel:
    s_cmp_ge_u32 s2, 256
    s_cbranch_scc1 F_end
    s_load_dwordx16 s[4:19], s[0:1], 0
    s_load_dwordx8 s[20:27], s[0:1], 64
    s_load_dwordx4 s[28:31], s[0:1], 96
    s_cmp_ge_u32 s2, 24
    s_cbranch_scc1 F_nopf
    s_lshr_b32 s56, s2, 3
    s_lshl_b32 s56, s56, 15
    v_lshl_add_u32 v250, v0, 7, s56
    v_min_u32 v250, F_end-F_pc, v250
    s_getpc_b64 s[56:57]
F_pc:
    v_mov_b32 v251, s57
    v_add_co_u32 v250, vcc, s56, v250
    s_nop 1
    v_addc_co_u32 v251, vcc, 0, v251, vcc
    global_load_dword v255, v[250:251], off
F_nopf:
    v_and_b32 v249, 63, v0
    v_lshrrev_b32 v250, 6, v0
    v_lshlrev_b32 v248, 4, v249
    v_readfirstlane_b32 s52, v250
    s_and_b32 s61, s2, 7
    s_lshr_b32 s57, s2, 3
    s_and_b32 s54, s57, 7
    s_lshr_b32 s57, s57, 3
    s_lshl_b32 s53, s61, 2
    s_add_u32 s53, s53, s57
    v_lshrrev_b32 v250, 3, v249
    v_lshlrev_b32 v250, 10, v250
    v_and_b32 v251, 7, v249
    v_lshrrev_b32 v252, 4, v249
    v_xor_b32 v251, v251, v252
    v_lshl_add_u32 v240, v251, 4, v250
    v_xor_b32 v253, 64, v240
    v_add_u32 v241, 7168, v253
    v_add_u32 v242, 14336, v240
    v_add_u32 v243, 21504, v253
    v_bfe_u32 v250, v249, 1, 3
    v_xor_b32 v250, v250, v252
    v_lshlrev_b32 v250, 5, v250
    v_and_b32 v251, 1, v249
    v_lshl_add_u32 v250, v251, 4, v250
    v_lshl_add_u32 v244, v252, 13, v250
    v_add_u32 v245, 31744, v244
    v_xor_b32 v253, 128, v244
    v_add_u32 v246, 63488, v253
    v_add_u32 v247, 95232, v253
    s_lshl_b32 s63, s52, 13
    s_lshl_b32 s55, s52, 12
    s_lshl_b32 s62, s54, 18
    s_lshl_b32 s56, s52, 16
    s_add_u32 s62, s62, s56
    s_lshl_b32 s59, s52, 17
    s_lshl_b32 s56, s53, 8
    s_add_u32 s59, s59, s56
    s_waitcnt lgkmcnt(0)
    s_mov_b32 s36, s10
    s_and_b32 s37, s11, 0xffff
    s_mov_b32 s38, 0x400000
    s_mov_b32 s39, 0x20000
    s_mov_b32 s40, s6
    s_and_b32 s41, s7, 0xffff
    s_mov_b32 s42, 0x200000
    s_mov_b32 s43, 0x20000
    s_add_u32 s60, s61, 0
    s_and_b32 s60, s60, 7
    s_lshl_b32 s60, s60, 19
    s_add_u32 m0, s55, 98304
    s_add_u32 s57, s59, s60
    buffer_load_dwordx4 v244, s[36:39], s57 offen offset:0 lds
    buffer_load_dwordx4 v245, s[36:39], s57 offen offset:1024 lds
    buffer_load_dwordx4 v246, s[36:39], s57 offen offset:2048 lds
    buffer_load_dwordx4 v247, s[36:39], s57 offen offset:3072 lds
    s_add_u32 s60, s61, 0
    s_and_b32 s60, s60, 7
    s_lshl_b32 s60, s60, 7
    s_add_u32 m0, s63, 0
    s_add_u32 s56, s62, s60
    buffer_load_dwordx4 v240, s[40:43], s56 offen offset:0 lds
    buffer_load_dwordx4 v241, s[40:43], s56 offen offset:1024 lds
    buffer_load_dwordx4 v242, s[40:43], s56 offen offset:2048 lds
    buffer_load_dwordx4 v243, s[40:43], s56 offen offset:3072 lds
    s_add_u32 m0, s63, 4096
    s_add_u32 s56, s56, 32768
    buffer_load_dwordx4 v240, s[40:43], s56 offen offset:0 lds
    buffer_load_dwordx4 v241, s[40:43], s56 offen offset:1024 lds
    buffer_load_dwordx4 v242, s[40:43], s56 offen offset:2048 lds
    buffer_load_dwordx4 v243, s[40:43], s56 offen offset:3072 lds
    s_add_u32 s60, s61, 1
    s_and_b32 s60, s60, 7
    s_lshl_b32 s60, s60, 19
    s_add_u32 m0, s55, 114688
    s_add_u32 s57, s59, s60
    buffer_load_dwordx4 v244, s[36:39], s57 offen offset:0 lds
    buffer_load_dwordx4 v245, s[36:39], s57 offen offset:1024 lds
    buffer_load_dwordx4 v246, s[36:39], s57 offen offset:2048 lds
    buffer_load_dwordx4 v247, s[36:39], s57 offen offset:3072 lds
    s_add_u32 s60, s61, 1
    s_and_b32 s60, s60, 7
    s_lshl_b32 s60, s60, 7
    s_add_u32 m0, s63, 32768
    s_add_u32 s56, s62, s60
    buffer_load_dwordx4 v240, s[40:43], s56 offen offset:0 lds
    buffer_load_dwordx4 v241, s[40:43], s56 offen offset:1024 lds
    buffer_load_dwordx4 v242, s[40:43], s56 offen offset:2048 lds
    buffer_load_dwordx4 v243, s[40:43], s56 offen offset:3072 lds
    s_add_u32 m0, s63, 36864
    s_add_u32 s56, s56, 32768
    buffer_load_dwordx4 v240, s[40:43], s56 offen offset:0 lds
    buffer_load_dwordx4 v241, s[40:43], s56 offen offset:1024 lds
    buffer_load_dwordx4 v242, s[40:43], s56 offen offset:2048 lds
    buffer_load_dwordx4 v243, s[40:43], s56 offen offset:3072 lds
    s_mov_b32 s48, s18
    s_and_b32 s49, s19, 0xffff
    s_mov_b32 s50, 0x400
    s_mov_b32 s51, 0x20000
    buffer_load_dwordx4 v[136:139], v248, s[48:51], 0 offen
    s_mov_b32 s44, s12
    s_and_b32 s45, s13, 0xffff
    s_mov_b32 s46, 0x400000
    s_mov_b32 s47, 0x20000
    s_mov_b32 s32, s30
    s_and_b32 s33, s31, 0xffff
    s_mov_b32 s34, 0x10000000
    s_mov_b32 s35, 0x20000
    v_bfe_u32 v250, v249, 1, 4
    v_lshlrev_b32 v250, 13, v250
    v_and_b32 v251, 1, v249
    v_lshl_add_u32 v235, v251, 7, v250
    s_lshl_b32 s68, s54, 19
    s_add_u32 s68, s68, s59
    s_mov_b32 s48, s4
    s_and_b32 s49, s5, 0xffff
    s_mov_b32 s50, 0x200000
    s_lshl_b32 s56, s2, 13
    s_lshl_b32 s57, s52, 11
    s_add_u32 s56, s56, s57
    buffer_load_dwordx4 v[128:131], v248, s[48:51], s56 offen
    buffer_load_dwordx4 v[132:135], v248, s[48:51], s56 offen offset:1024
    buffer_load_dword v255, v235, s[36:39], s68 offen
    v_and_b32 v235, 0xffff, v235
    v_and_b32 v234, 15, v249
    v_lshlrev_b32 v234, 7, v234
    v_lshrrev_b32 v252, 4, v249
    v_bfe_u32 v250, v249, 2, 2
    v_lshl_add_u32 v251, v252, 3, v250
    v_lshlrev_b32 v251, 8, v251
    v_and_b32 v253, 3, v249
    v_lshl_add_u32 v251, v253, 3, v251
    v_and_b32 v253, 1, v252
    v_lshl_add_u32 v250, v253, 2, v250
    v_lshl_add_u32 v224, v250, 5, v251
    v_add_u32 v224, 98304, v224
    v_xor_b32 v225, 32, v224
    v_xor_b32 v226, 64, v224
    v_xor_b32 v227, 96, v224
    v_xor_b32 v228, 128, v224
    v_xor_b32 v229, 160, v224
    v_xor_b32 v230, 192, v224
    v_xor_b32 v231, 224, v224
    v_and_b32 v250, 15, v249
    v_lshrrev_b32 v251, 1, v250
    v_xor_b32 v251, v251, v252
    v_lshlrev_b32 v251, 4, v251
    v_lshl_add_u32 v236, v250, 7, v251
    v_add_u32 v236, s63, v236
    v_xor_b32 v237, 64, v236
    v_add_u32 v238, 0x10000, v236
    v_add_u32 v239, 0x10000, v237
    s_mul_i32 s64, s53, 537600
    s_mul_i32 s56, s54, 65536
    s_add_u32 s64, s64, s56
    s_mul_i32 s56, s52, 16384
    s_add_u32 s64, s64, s56
    s_add_u32 s18, s64, 0x1009000
    s_add_u32 s64, s64, 0x5800000
    s_mov_b32 s67, 0x3e0293ee
    s_sub_u32 s56, s54, 2
    s_cmp_lt_u32 s56, 4
    s_cselect_b32 s56, 0x40000000, 0
    s_add_u32 s18, s18, s56
    s_lshl_b32 s56, s54, 1
    s_sub_u32 s57, 30, s56
    s_add_u32 s58, s57, s52
    s_add_u32 s56, s56, s52
    s_sub_u32 s56, s56, 2
    s_cmp_lt_u32 s52, 2
    s_cselect_b32 s74, s58, s56
    s_mul_i32 s73, s74, 70656
    s_add_u32 s73, s73, 0xb00000
    s_lshl_b32 s95, s2, 9
    s_add_u32 s95, s95, 0x3a0000
    s_lshr_b32 s56, s2, 3
    s_lshl_b32 s56, s56, 7
    s_add_u32 s56, s56, 0x3c0000
    s_cmp_lt_u32 s52, 2
    s_cselect_b32 s56, s95, s56
    s_cselect_b32 s57, 7, 12
    s_lshl_b32 s58, s2, 5
    s_add_u32 s58, s58, 0x200000
    s_cmp_eq_u32 s52, 1
    s_cselect_b32 s56, s58, s56
    s_cselect_b32 s57, 2, s57
    v_and_b32 v250, 3, v249
    v_lshlrev_b32 v250, s57, v250
    buffer_load_dword v255, v250, s[32:35], s56 offen sc1
    s_lshl_b32 s95, s2, 9
    s_add_u32 s95, s95, 0x3a0000
    s_or_b32 s56, s2, s52
    s_cmp_lg_u32 s56, 0
    s_cbranch_scc1 F_notag
    s_memrealtime s[16:17]
    s_mov_b32 s48, s28
    s_and_b32 s49, s29, 0xffff
    s_mov_b32 s50, 0x100
    s_mov_b32 s51, 0x20000
    v_lshlrev_b32 v250, 12, v249
    s_waitcnt lgkmcnt(0)
    s_or_b32 s16, s16, 1
    v_mov_b32 v251, s16
    buffer_store_dword v251, v250, s[48:51], 0 offen sc1
F_notag:
    s_waitcnt vmcnt(17)
    s_barrier
    ds_read_b128 a[160:163], v236 offset:0
    ds_read_b128 a[176:179], v237 offset:0
    ds_read_b64_tr_b16 v[192:193], v224 offset:0
    ds_read_b64_tr_b16 v[194:195], v224 offset:1024
    ds_read_b64_tr_b16 v[196:197], v224 offset:8192
    ds_read_b64_tr_b16 v[198:199], v224 offset:9216
    ds_read_b128 a[164:167], v236 offset:2048
    ds_read_b128 a[180:183], v237 offset:2048
    ds_read_b128 a[168:171], v236 offset:4096
    ds_read_b128 a[184:187], v237 offset:4096
    ds_read_b128 a[172:175], v236 offset:6144
    ds_read_b128 a[188:191], v237 offset:6144
    ds_read_b64_tr_b16 v[200:201], v225 offset:0
    ds_read_b64_tr_b16 v[202:203], v225 offset:1024
    ds_read_b64_tr_b16 v[204:205], v225 offset:8192
    ds_read_b64_tr_b16 v[206:207], v225 offset:9216
    ds_read_b64_tr_b16 v[208:209], v226 offset:0
    ds_read_b64_tr_b16 v[210:211], v226 offset:1024
    ds_read_b64_tr_b16 v[212:213], v226 offset:8192
    ds_read_b64_tr_b16 v[214:215], v226 offset:9216
    s_waitcnt lgkmcnt(4)
    v_mfma_f32_16x16x32_bf16 v[0:3], v[192:195], a[160:163], 0
    s_add_u32 s60, s61, 2
    v_mfma_f32_16x16x32_bf16 v[0:3], v[196:199], a[176:179], v[0:3]
    s_and_b32 s60, s60, 7
    v_mfma_f32_16x16x32_bf16 v[4:7], v[192:195], a[164:167], 0
    s_lshl_b32 s60, s60, 19
    v_mfma_f32_16x16x32_bf16 v[4:7], v[196:199], a[180:183], v[4:7]
    s_add_u32 m0, s55, 131072
    v_mfma_f32_16x16x32_bf16 v[8:11], v[192:195], a[168:171], 0
    s_add_u32 s57, s59, s60
    ds_read_b64_tr_b16 v[216:217], v227 offset:0
    buffer_load_dwordx4 v244, s[36:39], s57 offen offset:0 lds
    v_mfma_f32_16x16x32_bf16 v[8:11], v[196:199], a[184:187], v[8:11]
    ds_read_b64_tr_b16 v[218:219], v227 offset:1024
    buffer_load_dwordx4 v245, s[36:39], s57 offen offset:1024 lds
    v_mfma_f32_16x16x32_bf16 v[12:15], v[192:195], a[172:175], 0
    ds_read_b64_tr_b16 v[220:221], v227 offset:8192
    v_mfma_f32_16x16x32_bf16 v[12:15], v[196:199], a[188:191], v[12:15]
    ds_read_b64_tr_b16 v[222:223], v227 offset:9216
    v_mfma_f32_16x16x32_bf16 v[16:19], v[200:203], a[160:163], 0
    buffer_load_dwordx4 v246, s[36:39], s57 offen offset:2048 lds
    v_mfma_f32_16x16x32_bf16 v[16:19], v[204:207], a[176:179], v[16:19]
    v_mfma_f32_16x16x32_bf16 v[20:23], v[200:203], a[164:167], 0
    buffer_load_dwordx4 v247, s[36:39], s57 offen offset:3072 lds
    v_mfma_f32_16x16x32_bf16 v[20:23], v[204:207], a[180:183], v[20:23]
    v_mfma_f32_16x16x32_bf16 v[24:27], v[200:203], a[168:171], 0
    s_add_u32 s60, s61, 2
    ds_read_b64_tr_b16 v[192:193], v228 offset:0
    v_mfma_f32_16x16x32_bf16 v[24:27], v[204:207], a[184:187], v[24:27]
    s_and_b32 s60, s60, 7
    ds_read_b64_tr_b16 v[194:195], v228 offset:1024
    v_mfma_f32_16x16x32_bf16 v[28:31], v[200:203], a[172:175], 0
    s_lshl_b32 s60, s60, 7
    ds_read_b64_tr_b16 v[196:197], v228 offset:8192
    v_mfma_f32_16x16x32_bf16 v[28:31], v[204:207], a[188:191], v[28:31]
    s_waitcnt lgkmcnt(5)
    s_add_u32 m0, s63, 65536
    ds_read_b64_tr_b16 v[198:199], v228 offset:9216
    v_mfma_f32_16x16x32_bf16 v[32:35], v[208:211], a[160:163], 0
    s_add_u32 s56, s62, s60
    buffer_load_dwordx4 v240, s[40:43], s56 offen offset:0 lds
    v_mfma_f32_16x16x32_bf16 v[32:35], v[212:215], a[176:179], v[32:35]
    buffer_load_dwordx4 v241, s[40:43], s56 offen offset:1024 lds
    v_mfma_f32_16x16x32_bf16 v[36:39], v[208:211], a[164:167], 0
    v_mfma_f32_16x16x32_bf16 v[36:39], v[212:215], a[180:183], v[36:39]
    v_mfma_f32_16x16x32_bf16 v[40:43], v[208:211], a[168:171], 0
    ds_read_b64_tr_b16 v[200:201], v229 offset:0
    v_mfma_f32_16x16x32_bf16 v[40:43], v[212:215], a[184:187], v[40:43]
    ds_read_b64_tr_b16 v[202:203], v229 offset:1024
    buffer_load_dwordx4 v242, s[40:43], s56 offen offset:2048 lds
    v_mfma_f32_16x16x32_bf16 v[44:47], v[208:211], a[172:175], 0
    ds_read_b64_tr_b16 v[204:205], v229 offset:8192
    v_mfma_f32_16x16x32_bf16 v[44:47], v[212:215], a[188:191], v[44:47]
    ds_read_b64_tr_b16 v[206:207], v229 offset:9216
    v_mfma_f32_16x16x32_bf16 v[48:51], v[216:219], a[160:163], 0
    s_waitcnt lgkmcnt(4)
    buffer_load_dwordx4 v243, s[40:43], s56 offen offset:3072 lds
    v_mfma_f32_16x16x32_bf16 v[48:51], v[220:223], a[176:179], v[48:51]
    v_mfma_f32_16x16x32_bf16 v[52:55], v[216:219], a[164:167], 0
    v_mfma_f32_16x16x32_bf16 v[52:55], v[220:223], a[180:183], v[52:55]
    s_add_u32 m0, s63, 69632
    v_mfma_f32_16x16x32_bf16 v[56:59], v[216:219], a[168:171], 0
    s_add_u32 s56, s56, 32768
    ds_read_b64_tr_b16 v[208:209], v230 offset:0
    buffer_load_dwordx4 v240, s[40:43], s56 offen offset:0 lds
    v_mfma_f32_16x16x32_bf16 v[56:59], v[220:223], a[184:187], v[56:59]
    ds_read_b64_tr_b16 v[210:211], v230 offset:1024
    v_mfma_f32_16x16x32_bf16 v[60:63], v[216:219], a[172:175], 0
    ds_read_b64_tr_b16 v[212:213], v230 offset:8192
    v_mfma_f32_16x16x32_bf16 v[60:63], v[220:223], a[188:191], v[60:63]
    ds_read_b64_tr_b16 v[214:215], v230 offset:9216
    v_mfma_f32_16x16x32_bf16 v[64:67], v[192:195], a[160:163], 0
    buffer_load_dwordx4 v241, s[40:43], s56 offen offset:1024 lds
    v_mfma_f32_16x16x32_bf16 v[64:67], v[196:199], a[176:179], v[64:67]
    v_mfma_f32_16x16x32_bf16 v[68:71], v[192:195], a[164:167], 0
    v_mfma_f32_16x16x32_bf16 v[68:71], v[196:199], a[180:183], v[68:71]
    buffer_load_dwordx4 v242, s[40:43], s56 offen offset:2048 lds
    v_mfma_f32_16x16x32_bf16 v[72:75], v[192:195], a[168:171], 0
    ds_read_b64_tr_b16 v[216:217], v231 offset:0
    v_mfma_f32_16x16x32_bf16 v[72:75], v[196:199], a[184:187], v[72:75]
    ds_read_b64_tr_b16 v[218:219], v231 offset:1024
    v_mfma_f32_16x16x32_bf16 v[76:79], v[192:195], a[172:175], 0
    ds_read_b64_tr_b16 v[220:221], v231 offset:8192
    buffer_load_dwordx4 v243, s[40:43], s56 offen offset:3072 lds
    v_mfma_f32_16x16x32_bf16 v[76:79], v[196:199], a[188:191], v[76:79]
    s_waitcnt lgkmcnt(5)
    ds_read_b64_tr_b16 v[222:223], v231 offset:9216
    v_mfma_f32_16x16x32_bf16 v[80:83], v[200:203], a[160:163], 0
    v_mfma_f32_16x16x32_bf16 v[80:83], v[204:207], a[176:179], v[80:83]
    v_mfma_f32_16x16x32_bf16 v[84:87], v[200:203], a[164:167], 0
    v_mfma_f32_16x16x32_bf16 v[84:87], v[204:207], a[180:183], v[84:87]
    v_mfma_f32_16x16x32_bf16 v[88:91], v[200:203], a[168:171], 0
    v_mfma_f32_16x16x32_bf16 v[88:91], v[204:207], a[184:187], v[88:91]
    v_mfma_f32_16x16x32_bf16 v[92:95], v[200:203], a[172:175], 0
    v_mfma_f32_16x16x32_bf16 v[92:95], v[204:207], a[188:191], v[92:95]
    v_mfma_f32_16x16x32_bf16 v[96:99], v[208:211], a[160:163], 0
    s_waitcnt vmcnt(17)
    s_waitcnt lgkmcnt(0)
    s_barrier
    ds_read_b128 a[128:131], v236 offset:32768
    v_mfma_f32_16x16x32_bf16 v[96:99], v[212:215], a[176:179], v[96:99]
    s_add_u32 s60, s61, 3
    ds_read_b128 a[144:147], v237 offset:32768
    v_mfma_f32_16x16x32_bf16 v[100:103], v[208:211], a[164:167], 0
    s_and_b32 s60, s60, 7
    s_waitcnt vmcnt(14)
    ds_read_b64_tr_b16 v[192:193], v224 offset:16384
    v_mfma_f32_16x16x32_bf16 v[100:103], v[212:215], a[180:183], v[100:103]
    s_lshl_b32 s60, s60, 19
    ds_read_b64_tr_b16 v[194:195], v224 offset:17408
    v_lshlrev_b32 v140, 16, v128
    v_mfma_f32_16x16x32_bf16 v[104:107], v[208:211], a[168:171], 0
    s_add_u32 m0, s55, 98304
    ds_read_b64_tr_b16 v[196:197], v224 offset:24576
    v_and_b32 v141, 0xffff0000, v128
    v_mfma_f32_16x16x32_bf16 v[104:107], v[212:215], a[184:187], v[104:107]
    s_add_u32 s57, s59, s60
    ds_read_b64_tr_b16 v[198:199], v224 offset:25600
    buffer_load_dwordx4 v244, s[36:39], s57 offen offset:0 lds
    v_mfma_f32_16x16x32_bf16 v[108:111], v[208:211], a[172:175], 0
    ds_read_b128 a[132:135], v236 offset:34816
    buffer_load_dwordx4 v245, s[36:39], s57 offen offset:1024 lds
    v_mfma_f32_16x16x32_bf16 v[108:111], v[212:215], a[188:191], v[108:111]
    ds_read_b128 a[148:151], v237 offset:34816
    v_lshlrev_b32 v142, 16, v129
    v_mfma_f32_16x16x32_bf16 v[112:115], v[216:219], a[160:163], 0
    ds_read_b128 a[136:139], v236 offset:36864
    v_and_b32 v143, 0xffff0000, v129
    v_mfma_f32_16x16x32_bf16 v[112:115], v[220:223], a[176:179], v[112:115]
    ds_read_b128 a[152:155], v237 offset:36864
    v_lshlrev_b32 v144, 16, v130
    v_mfma_f32_16x16x32_bf16 v[116:119], v[216:219], a[164:167], 0
    ds_read_b128 a[140:143], v236 offset:38912
    buffer_load_dwordx4 v246, s[36:39], s57 offen offset:2048 lds
    v_mfma_f32_16x16x32_bf16 v[116:119], v[220:223], a[180:183], v[116:119]
    ds_read_b128 a[156:159], v237 offset:38912
    v_and_b32 v145, 0xffff0000, v130
    v_mfma_f32_16x16x32_bf16 v[120:123], v[216:219], a[168:171], 0
    ds_read_b64_tr_b16 v[200:201], v225 offset:16384
    v_lshlrev_b32 v146, 16, v131
    v_mfma_f32_16x16x32_bf16 v[120:123], v[220:223], a[184:187], v[120:123]
    ds_read_b64_tr_b16 v[202:203], v225 offset:17408
    v_and_b32 v147, 0xffff0000, v131
    v_mfma_f32_16x16x32_bf16 v[124:127], v[216:219], a[172:175], 0
    ds_read_b64_tr_b16 v[204:205], v225 offset:24576
    v_lshlrev_b32 v148, 16, v132
    v_mfma_f32_16x16x32_bf16 v[124:127], v[220:223], a[188:191], v[124:127]
    s_waitcnt lgkmcnt(8)
    ds_read_b64_tr_b16 v[206:207], v225 offset:25600
    buffer_load_dwordx4 v247, s[36:39], s57 offen offset:3072 lds
    v_mfma_f32_16x16x32_bf16 v[0:3], v[192:195], a[128:131], v[0:3]
    s_add_u32 s60, s61, 3
    ds_read_b64_tr_b16 v[208:209], v226 offset:16384
    v_and_b32 v149, 0xffff0000, v132
    v_mfma_f32_16x16x32_bf16 v[0:3], v[196:199], a[144:147], v[0:3]
    s_and_b32 s60, s60, 7
    ds_read_b64_tr_b16 v[210:211], v226 offset:17408
    v_lshlrev_b32 v150, 16, v133
    v_mfma_f32_16x16x32_bf16 v[4:7], v[192:195], a[132:135], v[4:7]
    s_waitcnt lgkmcnt(8)
    s_lshl_b32 s60, s60, 7
    ds_read_b64_tr_b16 v[212:213], v226 offset:24576
    v_mfma_f32_16x16x32_bf16 v[4:7], v[196:199], a[148:151], v[4:7]
    s_add_u32 m0, s63, 0
    ds_read_b64_tr_b16 v[214:215], v226 offset:25600
    v_and_b32 v151, 0xffff0000, v133
    v_mfma_f32_16x16x32_bf16 v[8:11], v[192:195], a[136:139], v[8:11]
    s_add_u32 s56, s62, s60
    ds_read_b64_tr_b16 v[216:217], v227 offset:16384
    buffer_load_dwordx4 v240, s[40:43], s56 offen offset:0 lds
    v_mfma_f32_16x16x32_bf16 v[8:11], v[196:199], a[152:155], v[8:11]
    s_waitcnt lgkmcnt(9)
    ds_read_b64_tr_b16 v[218:219], v227 offset:17408
    v_lshlrev_b32 v152, 16, v134
    v_mfma_f32_16x16x32_bf16 v[12:15], v[192:195], a[140:143], v[12:15]
    ds_read_b64_tr_b16 v[220:221], v227 offset:24576
    v_and_b32 v153, 0xffff0000, v134
    v_mfma_f32_16x16x32_bf16 v[12:15], v[196:199], a[156:159], v[12:15]
    s_waitcnt lgkmcnt(9)
    ds_read_b64_tr_b16 v[222:223], v227 offset:25600
    v_lshlrev_b32 v154, 16, v135
    v_mfma_f32_16x16x32_bf16 v[16:19], v[200:203], a[128:131], v[16:19]
    s_waitcnt lgkmcnt(8)
    buffer_load_dwordx4 v241, s[40:43], s56 offen offset:1024 lds
    v_and_b32 v155, 0xffff0000, v135
    v_mfma_f32_16x16x32_bf16 v[16:19], v[204:207], a[144:147], v[16:19]
    v_add_f32 v172, v140, v141
    v_add_f32 v173, v148, v149
    v_mfma_f32_16x16x32_bf16 v[20:23], v[200:203], a[132:135], v[20:23]
    v_add_f32 v172, v172, v142
    v_add_f32 v173, v173, v150
    v_mfma_f32_16x16x32_bf16 v[20:23], v[204:207], a[148:151], v[20:23]
    v_add_f32 v172, v172, v143
    v_add_f32 v173, v173, v151
    v_mfma_f32_16x16x32_bf16 v[24:27], v[200:203], a[136:139], v[24:27]
    ds_read_b64_tr_b16 v[192:193], v228 offset:16384
    v_add_f32 v172, v172, v144
    v_mfma_f32_16x16x32_bf16 v[24:27], v[204:207], a[152:155], v[24:27]
    ds_read_b64_tr_b16 v[194:195], v228 offset:17408
    buffer_load_dwordx4 v242, s[40:43], s56 offen offset:2048 lds
    v_mfma_f32_16x16x32_bf16 v[28:31], v[200:203], a[140:143], v[28:31]
    ds_read_b64_tr_b16 v[196:197], v228 offset:24576
    v_add_f32 v173, v173, v152
    v_mfma_f32_16x16x32_bf16 v[28:31], v[204:207], a[156:159], v[28:31]
    s_waitcnt lgkmcnt(5)
    ds_read_b64_tr_b16 v[198:199], v228 offset:25600
    v_add_f32 v172, v172, v145
    v_mfma_f32_16x16x32_bf16 v[32:35], v[208:211], a[128:131], v[32:35]
    v_add_f32 v173, v173, v153
    v_add_f32 v172, v172, v146
    v_mfma_f32_16x16x32_bf16 v[32:35], v[212:215], a[144:147], v[32:35]
    buffer_load_dwordx4 v243, s[40:43], s56 offen offset:3072 lds
    v_add_f32 v173, v173, v154
    v_mfma_f32_16x16x32_bf16 v[36:39], v[208:211], a[132:135], v[36:39]
    v_add_f32 v172, v172, v147
    v_add_f32 v173, v173, v155
    v_mfma_f32_16x16x32_bf16 v[36:39], v[212:215], a[148:151], v[36:39]
    v_mfma_f32_16x16x32_bf16 v[40:43], v[208:211], a[136:139], v[40:43]
    ds_read_b64_tr_b16 v[200:201], v229 offset:16384
    v_add_f32_dpp v172, v172, v172 quad_perm:[1,0,3,2] row_mask:0xf bank_mask:0xf
    v_mfma_f32_16x16x32_bf16 v[40:43], v[212:215], a[152:155], v[40:43]
    s_add_u32 m0, s63, 4096
    ds_read_b64_tr_b16 v[202:203], v229 offset:17408
    v_add_f32_dpp v173, v173, v173 quad_perm:[1,0,3,2] row_mask:0xf bank_mask:0xf
    v_mfma_f32_16x16x32_bf16 v[44:47], v[208:211], a[140:143], v[44:47]
    s_add_u32 s56, s56, 32768
    ds_read_b64_tr_b16 v[204:205], v229 offset:24576
    buffer_load_dwordx4 v240, s[40:43], s56 offen offset:0 lds
    v_mfma_f32_16x16x32_bf16 v[44:47], v[212:215], a[156:159], v[44:47]
    ds_read_b64_tr_b16 v[206:207], v229 offset:25600
    v_add_f32_dpp v172, v172, v172 quad_perm:[2,3,0,1] row_mask:0xf bank_mask:0xf
    v_mfma_f32_16x16x32_bf16 v[48:51], v[216:219], a[128:131], v[48:51]
    s_waitcnt lgkmcnt(4)
    v_add_f32_dpp v173, v173, v173 quad_perm:[2,3,0,1] row_mask:0xf bank_mask:0xf
    v_mfma_f32_16x16x32_bf16 v[48:51], v[220:223], a[144:147], v[48:51]
    v_mfma_f32_16x16x32_bf16 v[52:55], v[216:219], a[132:135], v[52:55]
    v_add_f32_dpp v172, v172, v172 row_half_mirror row_mask:0xf bank_mask:0xf
    v_add_f32_dpp v173, v173, v173 row_half_mirror row_mask:0xf bank_mask:0xf
    v_mfma_f32_16x16x32_bf16 v[52:55], v[220:223], a[148:151], v[52:55]
    buffer_load_dwordx4 v241, s[40:43], s56 offen offset:1024 lds
    v_mfma_f32_16x16x32_bf16 v[56:59], v[216:219], a[136:139], v[56:59]
    ds_read_b64_tr_b16 v[208:209], v230 offset:16384
    v_add_f32_dpp v172, v172, v172 row_mirror row_mask:0xf bank_mask:0xf
    v_mfma_f32_16x16x32_bf16 v[56:59], v[220:223], a[152:155], v[56:59]
    ds_read_b64_tr_b16 v[210:211], v230 offset:17408
    v_add_f32_dpp v173, v173, v173 row_mirror row_mask:0xf bank_mask:0xf
    v_mfma_f32_16x16x32_bf16 v[60:63], v[216:219], a[140:143], v[60:63]
    ds_read_b64_tr_b16 v[212:213], v230 offset:24576
    v_mov_b32 v174, v172
    v_mfma_f32_16x16x32_bf16 v[60:63], v[220:223], a[156:159], v[60:63]
    ds_read_b64_tr_b16 v[214:215], v230 offset:25600
    v_mov_b32 v175, v173
    v_mfma_f32_16x16x32_bf16 v[64:67], v[192:195], a[128:131], v[64:67]
    buffer_load_dwordx4 v242, s[40:43], s56 offen offset:2048 lds
    v_mfma_f32_16x16x32_bf16 v[64:67], v[196:199], a[144:147], v[64:67]
    v_permlane16_swap_b32 v172, v174
    v_permlane16_swap_b32 v173, v175
    v_mfma_f32_16x16x32_bf16 v[68:71], v[192:195], a[132:135], v[68:71]
    v_add_f32 v172, v172, v174
    v_add_f32 v173, v173, v175
    v_mfma_f32_16x16x32_bf16 v[68:71], v[196:199], a[148:151], v[68:71]
    v_mov_b32 v174, v172
    v_mov_b32 v175, v173
    v_mfma_f32_16x16x32_bf16 v[72:75], v[192:195], a[136:139], v[72:75]
    ds_read_b64_tr_b16 v[216:217], v231 offset:16384
    buffer_load_dwordx4 v243, s[40:43], s56 offen offset:3072 lds
    v_mfma_f32_16x16x32_bf16 v[72:75], v[196:199], a[152:155], v[72:75]
    ds_read_b64_tr_b16 v[218:219], v231 offset:17408
    v_permlane32_swap_b32 v172, v174
    v_mfma_f32_16x16x32_bf16 v[76:79], v[192:195], a[140:143], v[76:79]
    s_mov_b32 s48, s12
    ds_read_b64_tr_b16 v[220:221], v231 offset:24576
    v_permlane32_swap_b32 v173, v175
    v_mfma_f32_16x16x32_bf16 v[76:79], v[196:199], a[156:159], v[76:79]
    s_waitcnt lgkmcnt(5)
    s_and_b32 s49, s13, 0xffff
    ds_read_b64_tr_b16 v[222:223], v231 offset:25600
    v_mfma_f32_16x16x32_bf16 v[80:83], v[200:203], a[128:131], v[80:83]
    s_mov_b32 s50, 0x400000
    v_add_f32 v172, v172, v174
    v_add_f32 v173, v173, v175
    v_mfma_f32_16x16x32_bf16 v[80:83], v[204:207], a[144:147], v[80:83]
    s_add_u32 s57, s68, 0
    buffer_load_dword v255, v235, s[48:51], s57 offen
    v_mul_f32 v176, 0x3b000000, v172
    v_mfma_f32_16x16x32_bf16 v[84:87], v[200:203], a[132:135], v[84:87]
    v_mul_f32 v177, 0x3b000000, v173
    v_sub_f32 v156, v140, v176
    v_mfma_f32_16x16x32_bf16 v[84:87], v[204:207], a[148:151], v[84:87]
    v_sub_f32 v164, v148, v177
    v_sub_f32 v157, v141, v176
    v_mfma_f32_16x16x32_bf16 v[88:91], v[200:203], a[136:139], v[88:91]
    v_sub_f32 v165, v149, v177
    v_sub_f32 v158, v142, v176
    v_mfma_f32_16x16x32_bf16 v[88:91], v[204:207], a[152:155], v[88:91]
    v_sub_f32 v166, v150, v177
    v_sub_f32 v159, v143, v176
    v_mfma_f32_16x16x32_bf16 v[92:95], v[200:203], a[140:143], v[92:95]
    v_sub_f32 v167, v151, v177
    v_sub_f32 v160, v144, v176
    v_mfma_f32_16x16x32_bf16 v[92:95], v[204:207], a[156:159], v[92:95]
    v_sub_f32 v168, v152, v177
    v_sub_f32 v161, v145, v176
    v_mfma_f32_16x16x32_bf16 v[96:99], v[208:211], a[128:131], v[96:99]
    s_waitcnt vmcnt(13)
    s_waitcnt lgkmcnt(0)
    s_barrier
    ds_read_b128 a[0:3], v238 offset:0
    v_sub_f32 v169, v153, v177
    v_mfma_f32_16x16x32_bf16 v[96:99], v[212:215], a[144:147], v[96:99]
    s_add_u32 s60, s61, 4
    ds_read_b128 a[16:19], v239 offset:0
    v_sub_f32 v162, v146, v176
    v_mfma_f32_16x16x32_bf16 v[100:103], v[208:211], a[132:135], v[100:103]
    s_and_b32 s60, s60, 7
    ds_read_b64_tr_b16 v[192:193], v224 offset:32768
    v_sub_f32 v170, v154, v177
    v_mfma_f32_16x16x32_bf16 v[100:103], v[212:215], a[148:151], v[100:103]
    s_lshl_b32 s60, s60, 19
    ds_read_b64_tr_b16 v[194:195], v224 offset:33792
    v_sub_f32 v163, v147, v176
    v_mfma_f32_16x16x32_bf16 v[104:107], v[208:211], a[136:139], v[104:107]
    s_add_u32 m0, s55, 114688
    ds_read_b64_tr_b16 v[196:197], v224 offset:40960
    v_sub_f32 v171, v155, v177
    v_mfma_f32_16x16x32_bf16 v[104:107], v[212:215], a[152:155], v[104:107]
    s_add_u32 s57, s59, s60
    ds_read_b64_tr_b16 v[198:199], v224 offset:41984
    buffer_load_dwordx4 v244, s[36:39], s57 offen offset:0 lds
    v_mfma_f32_16x16x32_bf16 v[108:111], v[208:211], a[140:143], v[108:111]
    ds_read_b128 a[4:7], v238 offset:2048
    buffer_load_dwordx4 v245, s[36:39], s57 offen offset:1024 lds
    v_mfma_f32_16x16x32_bf16 v[108:111], v[212:215], a[156:159], v[108:111]
    ds_read_b128 a[20:23], v239 offset:2048
    v_mul_f32 v172, v156, v156
    v_mfma_f32_16x16x32_bf16 v[112:115], v[216:219], a[128:131], v[112:115]
    ds_read_b128 a[8:11], v238 offset:4096
    v_mul_f32 v173, v164, v164
    v_mfma_f32_16x16x32_bf16 v[112:115], v[220:223], a[144:147], v[112:115]
    ds_read_b128 a[24:27], v239 offset:4096
    v_fmac_f32 v172, v157, v157
    v_mfma_f32_16x16x32_bf16 v[116:119], v[216:219], a[132:135], v[116:119]
    ds_read_b128 a[12:15], v238 offset:6144
    buffer_load_dwordx4 v246, s[36:39], s57 offen offset:2048 lds
    v_mfma_f32_16x16x32_bf16 v[116:119], v[220:223], a[148:151], v[116:119]
    ds_read_b128 a[28:31], v239 offset:6144
    v_fmac_f32 v173, v165, v165
    v_mfma_f32_16x16x32_bf16 v[120:123], v[216:219], a[136:139], v[120:123]
    ds_read_b64_tr_b16 v[200:201], v225 offset:32768
    v_fmac_f32 v172, v158, v158
    v_mfma_f32_16x16x32_bf16 v[120:123], v[220:223], a[152:155], v[120:123]
    ds_read_b64_tr_b16 v[202:203], v225 offset:33792
    v_fmac_f32 v173, v166, v166
    v_mfma_f32_16x16x32_bf16 v[124:127], v[216:219], a[140:143], v[124:127]
    ds_read_b64_tr_b16 v[204:205], v225 offset:40960
    v_fmac_f32 v172, v159, v159
    v_mfma_f32_16x16x32_bf16 v[124:127], v[220:223], a[156:159], v[124:127]
    s_waitcnt lgkmcnt(8)
    ds_read_b64_tr_b16 v[206:207], v225 offset:41984
    buffer_load_dwordx4 v247, s[36:39], s57 offen offset:3072 lds
    v_mfma_f32_16x16x32_bf16 v[0:3], v[192:195], a[0:3], v[0:3]
    s_add_u32 s60, s61, 4
    ds_read_b64_tr_b16 v[208:209], v226 offset:32768
    v_fmac_f32 v173, v167, v167
    v_mfma_f32_16x16x32_bf16 v[0:3], v[196:199], a[16:19], v[0:3]
    s_and_b32 s60, s60, 7
    ds_read_b64_tr_b16 v[210:211], v226 offset:33792
    v_fmac_f32 v172, v160, v160
    v_mfma_f32_16x16x32_bf16 v[4:7], v[192:195], a[4:7], v[4:7]
    s_waitcnt lgkmcnt(8)
    s_lshl_b32 s60, s60, 7
    ds_read_b64_tr_b16 v[212:213], v226 offset:40960
    v_mfma_f32_16x16x32_bf16 v[4:7], v[196:199], a[20:23], v[4:7]
    s_add_u32 m0, s63, 32768
    ds_read_b64_tr_b16 v[214:215], v226 offset:41984
    v_fmac_f32 v173, v168, v168
    v_mfma_f32_16x16x32_bf16 v[8:11], v[192:195], a[8:11], v[8:11]
    s_add_u32 s56, s62, s60
    ds_read_b64_tr_b16 v[216:217], v227 offset:32768
    buffer_load_dwordx4 v240, s[40:43], s56 offen offset:0 lds
    v_mfma_f32_16x16x32_bf16 v[8:11], v[196:199], a[24:27], v[8:11]
    s_waitcnt lgkmcnt(9)
    ds_read_b64_tr_b16 v[218:219], v227 offset:33792
    v_fmac_f32 v172, v161, v161
    v_mfma_f32_16x16x32_bf16 v[12:15], v[192:195], a[12:15], v[12:15]
    ds_read_b64_tr_b16 v[220:221], v227 offset:40960
    v_fmac_f32 v173, v169, v169
    v_mfma_f32_16x16x32_bf16 v[12:15], v[196:199], a[28:31], v[12:15]
    s_waitcnt lgkmcnt(9)
    ds_read_b64_tr_b16 v[222:223], v227 offset:41984
    v_fmac_f32 v172, v162, v162
    v_mfma_f32_16x16x32_bf16 v[16:19], v[200:203], a[0:3], v[16:19]
    s_waitcnt lgkmcnt(8)
    buffer_load_dwordx4 v241, s[40:43], s56 offen offset:1024 lds
    v_fmac_f32 v173, v170, v170
    v_mfma_f32_16x16x32_bf16 v[16:19], v[204:207], a[16:19], v[16:19]
    v_fmac_f32 v172, v163, v163
    v_fmac_f32 v173, v171, v171
    v_mfma_f32_16x16x32_bf16 v[20:23], v[200:203], a[4:7], v[20:23]
    v_mfma_f32_16x16x32_bf16 v[20:23], v[204:207], a[20:23], v[20:23]
    v_add_f32_dpp v172, v172, v172 quad_perm:[1,0,3,2] row_mask:0xf bank_mask:0xf
    v_add_f32_dpp v173, v173, v173 quad_perm:[1,0,3,2] row_mask:0xf bank_mask:0xf
    v_mfma_f32_16x16x32_bf16 v[24:27], v[200:203], a[8:11], v[24:27]
    ds_read_b64_tr_b16 v[192:193], v228 offset:32768
    v_mfma_f32_16x16x32_bf16 v[24:27], v[204:207], a[24:27], v[24:27]
    ds_read_b64_tr_b16 v[194:195], v228 offset:33792
    buffer_load_dwordx4 v242, s[40:43], s56 offen offset:2048 lds
    v_mfma_f32_16x16x32_bf16 v[28:31], v[200:203], a[12:15], v[28:31]
    ds_read_b64_tr_b16 v[196:197], v228 offset:40960
    v_add_f32_dpp v172, v172, v172 quad_perm:[2,3,0,1] row_mask:0xf bank_mask:0xf
    v_mfma_f32_16x16x32_bf16 v[28:31], v[204:207], a[28:31], v[28:31]
    s_waitcnt lgkmcnt(5)
    ds_read_b64_tr_b16 v[198:199], v228 offset:41984
    v_add_f32_dpp v173, v173, v173 quad_perm:[2,3,0,1] row_mask:0xf bank_mask:0xf
    v_mfma_f32_16x16x32_bf16 v[32:35], v[208:211], a[0:3], v[32:35]
    v_mfma_f32_16x16x32_bf16 v[32:35], v[212:215], a[16:19], v[32:35]
    buffer_load_dwordx4 v243, s[40:43], s56 offen offset:3072 lds
    v_add_f32_dpp v172, v172, v172 row_half_mirror row_mask:0xf bank_mask:0xf
    v_mfma_f32_16x16x32_bf16 v[36:39], v[208:211], a[4:7], v[36:39]
    v_add_f32_dpp v173, v173, v173 row_half_mirror row_mask:0xf bank_mask:0xf
    v_mfma_f32_16x16x32_bf16 v[36:39], v[212:215], a[20:23], v[36:39]
    v_mfma_f32_16x16x32_bf16 v[40:43], v[208:211], a[8:11], v[40:43]
    ds_read_b64_tr_b16 v[200:201], v229 offset:32768
    v_add_f32_dpp v172, v172, v172 row_mirror row_mask:0xf bank_mask:0xf
    v_mfma_f32_16x16x32_bf16 v[40:43], v[212:215], a[24:27], v[40:43]
    s_add_u32 m0, s63, 36864
    ds_read_b64_tr_b16 v[202:203], v229 offset:33792
    v_add_f32_dpp v173, v173, v173 row_mirror row_mask:0xf bank_mask:0xf
    v_mfma_f32_16x16x32_bf16 v[44:47], v[208:211], a[12:15], v[44:47]
    s_add_u32 s56, s56, 32768
    ds_read_b64_tr_b16 v[204:205], v229 offset:40960
    buffer_load_dwordx4 v240, s[40:43], s56 offen offset:0 lds
    v_mfma_f32_16x16x32_bf16 v[44:47], v[212:215], a[28:31], v[44:47]
    ds_read_b64_tr_b16 v[206:207], v229 offset:41984
    v_mov_b32 v174, v172
    v_mfma_f32_16x16x32_bf16 v[48:51], v[216:219], a[0:3], v[48:51]
    s_waitcnt lgkmcnt(4)
    v_mov_b32 v175, v173
    v_mfma_f32_16x16x32_bf16 v[48:51], v[220:223], a[16:19], v[48:51]
    v_mfma_f32_16x16x32_bf16 v[52:55], v[216:219], a[4:7], v[52:55]
    v_permlane16_swap_b32 v172, v174
    v_permlane16_swap_b32 v173, v175
    v_mfma_f32_16x16x32_bf16 v[52:55], v[220:223], a[20:23], v[52:55]
    buffer_load_dwordx4 v241, s[40:43], s56 offen offset:1024 lds
    v_add_f32 v172, v172, v174
    v_mfma_f32_16x16x32_bf16 v[56:59], v[216:219], a[8:11], v[56:59]
    ds_read_b64_tr_b16 v[208:209], v230 offset:32768
    v_add_f32 v173, v173, v175
    v_mfma_f32_16x16x32_bf16 v[56:59], v[220:223], a[24:27], v[56:59]
    ds_read_b64_tr_b16 v[210:211], v230 offset:33792
    v_mov_b32 v174, v172
    v_mfma_f32_16x16x32_bf16 v[60:63], v[216:219], a[12:15], v[60:63]
    ds_read_b64_tr_b16 v[212:213], v230 offset:40960
    v_mov_b32 v175, v173
    v_mfma_f32_16x16x32_bf16 v[60:63], v[220:223], a[28:31], v[60:63]
    ds_read_b64_tr_b16 v[214:215], v230 offset:41984
    v_mfma_f32_16x16x32_bf16 v[64:67], v[192:195], a[0:3], v[64:67]
    buffer_load_dwordx4 v242, s[40:43], s56 offen offset:2048 lds
    v_permlane32_swap_b32 v172, v174
    v_mfma_f32_16x16x32_bf16 v[64:67], v[196:199], a[16:19], v[64:67]
    v_permlane32_swap_b32 v173, v175
    v_add_f32 v172, v172, v174
    v_mfma_f32_16x16x32_bf16 v[68:71], v[192:195], a[4:7], v[68:71]
    v_add_f32 v173, v173, v175
    v_mul_f32 v172, 0x3b000000, v172
    v_mfma_f32_16x16x32_bf16 v[68:71], v[196:199], a[20:23], v[68:71]
    v_mul_f32 v173, 0x3b000000, v173
    v_cvt_pk_bf16_f32 v174, v172, v176
    v_mfma_f32_16x16x32_bf16 v[72:75], v[192:195], a[8:11], v[72:75]
    ds_read_b64_tr_b16 v[216:217], v231 offset:32768
    buffer_load_dwordx4 v243, s[40:43], s56 offen offset:3072 lds
    v_mfma_f32_16x16x32_bf16 v[72:75], v[196:199], a[24:27], v[72:75]
    ds_read_b64_tr_b16 v[218:219], v231 offset:33792
    v_cvt_pk_bf16_f32 v175, v173, v177
    v_mfma_f32_16x16x32_bf16 v[76:79], v[192:195], a[12:15], v[76:79]
    s_mov_b32 s48, s12
    ds_read_b64_tr_b16 v[220:221], v231 offset:40960
    v_and_b32 v178, 0xffff0000, v174
    v_mfma_f32_16x16x32_bf16 v[76:79], v[196:199], a[28:31], v[76:79]
    s_waitcnt lgkmcnt(5)
    s_and_b32 s49, s13, 0xffff
    ds_read_b64_tr_b16 v[222:223], v231 offset:41984
    v_mfma_f32_16x16x32_bf16 v[80:83], v[200:203], a[0:3], v[80:83]
    s_mov_b32 s50, 0x400000
    v_and_b32 v179, 0xffff0000, v175
    v_lshlrev_b32 v172, 16, v174
    v_mfma_f32_16x16x32_bf16 v[80:83], v[204:207], a[16:19], v[80:83]
    s_add_u32 s57, s68, 65536
    buffer_load_dword v255, v235, s[48:51], s57 offen
    v_lshlrev_b32 v173, 16, v175
    v_mfma_f32_16x16x32_bf16 v[84:87], v[200:203], a[4:7], v[84:87]
    v_add_f32 v172, 0x3727c5ac, v172
    v_add_f32 v173, 0x3727c5ac, v173
    v_mfma_f32_16x16x32_bf16 v[84:87], v[204:207], a[20:23], v[84:87]
    v_cvt_pk_bf16_f32 v172, v172, v172
    v_cvt_pk_bf16_f32 v173, v173, v173
    v_mfma_f32_16x16x32_bf16 v[88:91], v[200:203], a[8:11], v[88:91]
    v_lshlrev_b32 v172, 16, v172
    v_lshlrev_b32 v173, 16, v173
    v_mfma_f32_16x16x32_bf16 v[88:91], v[204:207], a[24:27], v[88:91]
    v_sqrt_f32 v172, v172
    v_mfma_f32_16x16x32_bf16 v[92:95], v[200:203], a[12:15], v[92:95]
    v_sqrt_f32 v173, v173
    v_mfma_f32_16x16x32_bf16 v[92:95], v[204:207], a[28:31], v[92:95]
    v_cvt_pk_bf16_f32 v172, v172, v172
    v_cvt_pk_bf16_f32 v173, v173, v173
    v_mfma_f32_16x16x32_bf16 v[96:99], v[208:211], a[0:3], v[96:99]
    s_waitcnt vmcnt(14)
    s_waitcnt lgkmcnt(0)
    s_barrier
    ds_read_b128 a[32:35], v236 offset:0
    v_lshlrev_b32 v172, 16, v172
    v_mfma_f32_16x16x32_bf16 v[96:99], v[212:215], a[16:19], v[96:99]
    s_add_u32 s60, s61, 5
    ds_read_b128 a[48:51], v237 offset:0
    v_lshlrev_b32 v173, 16, v173
    v_mfma_f32_16x16x32_bf16 v[100:103], v[208:211], a[4:7], v[100:103]
    s_and_b32 s60, s60, 7
    ds_read_b64_tr_b16 v[192:193], v224 offset:0
    v_mfma_f32_16x16x32_bf16 v[100:103], v[212:215], a[20:23], v[100:103]
    s_lshl_b32 s60, s60, 19
    ds_read_b64_tr_b16 v[194:195], v224 offset:1024
    v_mfma_f32_16x16x32_bf16 v[104:107], v[208:211], a[8:11], v[104:107]
    s_add_u32 m0, s55, 131072
    ds_read_b64_tr_b16 v[196:197], v224 offset:8192
    v_mfma_f32_16x16x32_bf16 v[104:107], v[212:215], a[24:27], v[104:107]
    s_add_u32 s57, s59, s60
    ds_read_b64_tr_b16 v[198:199], v224 offset:9216
    buffer_load_dwordx4 v244, s[36:39], s57 offen offset:0 lds
    v_mfma_f32_16x16x32_bf16 v[108:111], v[208:211], a[12:15], v[108:111]
    ds_read_b128 a[36:39], v236 offset:2048
    buffer_load_dwordx4 v245, s[36:39], s57 offen offset:1024 lds
    v_mfma_f32_16x16x32_bf16 v[108:111], v[212:215], a[28:31], v[108:111]
    ds_read_b128 a[52:55], v237 offset:2048
    v_mfma_f32_16x16x32_bf16 v[112:115], v[216:219], a[0:3], v[112:115]
    ds_read_b128 a[40:43], v236 offset:4096
    v_mfma_f32_16x16x32_bf16 v[112:115], v[220:223], a[16:19], v[112:115]
    ds_read_b128 a[56:59], v237 offset:4096
    v_mfma_f32_16x16x32_bf16 v[116:119], v[216:219], a[4:7], v[116:119]
    ds_read_b128 a[44:47], v236 offset:6144
    buffer_load_dwordx4 v246, s[36:39], s57 offen offset:2048 lds
    v_mfma_f32_16x16x32_bf16 v[116:119], v[220:223], a[20:23], v[116:119]
    ds_read_b128 a[60:63], v237 offset:6144
    v_mfma_f32_16x16x32_bf16 v[120:123], v[216:219], a[8:11], v[120:123]
    ds_read_b64_tr_b16 v[200:201], v225 offset:0
    v_mfma_f32_16x16x32_bf16 v[120:123], v[220:223], a[24:27], v[120:123]
    ds_read_b64_tr_b16 v[202:203], v225 offset:1024
    v_mfma_f32_16x16x32_bf16 v[124:127], v[216:219], a[12:15], v[124:127]
    ds_read_b64_tr_b16 v[204:205], v225 offset:8192
    v_mfma_f32_16x16x32_bf16 v[124:127], v[220:223], a[28:31], v[124:127]
    s_waitcnt lgkmcnt(8)
    ds_read_b64_tr_b16 v[206:207], v225 offset:9216
    buffer_load_dwordx4 v247, s[36:39], s57 offen offset:3072 lds
    v_mfma_f32_16x16x32_bf16 v[0:3], v[192:195], a[32:35], v[0:3]
    s_add_u32 s60, s61, 5
    ds_read_b64_tr_b16 v[208:209], v226 offset:0
    v_mfma_f32_16x16x32_bf16 v[0:3], v[196:199], a[48:51], v[0:3]
    s_and_b32 s60, s60, 7
    ds_read_b64_tr_b16 v[210:211], v226 offset:1024
    v_mfma_f32_16x16x32_bf16 v[4:7], v[192:195], a[36:39], v[4:7]
    s_waitcnt lgkmcnt(8)
    s_lshl_b32 s60, s60, 7
    ds_read_b64_tr_b16 v[212:213], v226 offset:8192
    v_mfma_f32_16x16x32_bf16 v[4:7], v[196:199], a[52:55], v[4:7]
    s_add_u32 m0, s63, 65536
    ds_read_b64_tr_b16 v[214:215], v226 offset:9216
    v_mfma_f32_16x16x32_bf16 v[8:11], v[192:195], a[40:43], v[8:11]
    s_add_u32 s56, s62, s60
    ds_read_b64_tr_b16 v[216:217], v227 offset:0
    buffer_load_dwordx4 v240, s[40:43], s56 offen offset:0 lds
    v_mfma_f32_16x16x32_bf16 v[8:11], v[196:199], a[56:59], v[8:11]
    s_waitcnt lgkmcnt(9)
    ds_read_b64_tr_b16 v[218:219], v227 offset:1024
    v_mfma_f32_16x16x32_bf16 v[12:15], v[192:195], a[44:47], v[12:15]
    ds_read_b64_tr_b16 v[220:221], v227 offset:8192
    v_mfma_f32_16x16x32_bf16 v[12:15], v[196:199], a[60:63], v[12:15]
    s_waitcnt lgkmcnt(9)
    ds_read_b64_tr_b16 v[222:223], v227 offset:9216
    v_mfma_f32_16x16x32_bf16 v[16:19], v[200:203], a[32:35], v[16:19]
    s_waitcnt lgkmcnt(8)
    buffer_load_dwordx4 v241, s[40:43], s56 offen offset:1024 lds
    v_mfma_f32_16x16x32_bf16 v[16:19], v[204:207], a[48:51], v[16:19]
    v_rcp_f32 v174, v172
    v_mfma_f32_16x16x32_bf16 v[20:23], v[200:203], a[36:39], v[20:23]
    v_rcp_f32 v175, v173
    v_mfma_f32_16x16x32_bf16 v[20:23], v[204:207], a[52:55], v[20:23]
    v_sub_f32 v156, v140, v178
    v_sub_f32 v164, v148, v179
    v_mfma_f32_16x16x32_bf16 v[24:27], v[200:203], a[40:43], v[24:27]
    ds_read_b64_tr_b16 v[192:193], v228 offset:0
    v_sub_f32 v157, v141, v178
    v_mfma_f32_16x16x32_bf16 v[24:27], v[204:207], a[56:59], v[24:27]
    ds_read_b64_tr_b16 v[194:195], v228 offset:1024
    buffer_load_dwordx4 v242, s[40:43], s56 offen offset:2048 lds
    v_mfma_f32_16x16x32_bf16 v[28:31], v[200:203], a[44:47], v[28:31]
    ds_read_b64_tr_b16 v[196:197], v228 offset:8192
    v_sub_f32 v165, v149, v179
    v_mfma_f32_16x16x32_bf16 v[28:31], v[204:207], a[60:63], v[28:31]
    s_waitcnt lgkmcnt(5)
    ds_read_b64_tr_b16 v[198:199], v228 offset:9216
    v_sub_f32 v158, v142, v178
    v_mfma_f32_16x16x32_bf16 v[32:35], v[208:211], a[32:35], v[32:35]
    v_sub_f32 v166, v150, v179
    v_sub_f32 v159, v143, v178
    v_mfma_f32_16x16x32_bf16 v[32:35], v[212:215], a[48:51], v[32:35]
    buffer_load_dwordx4 v243, s[40:43], s56 offen offset:3072 lds
    v_sub_f32 v167, v151, v179
    v_mfma_f32_16x16x32_bf16 v[36:39], v[208:211], a[36:39], v[36:39]
    v_sub_f32 v160, v144, v178
    v_sub_f32 v168, v152, v179
    v_mfma_f32_16x16x32_bf16 v[36:39], v[212:215], a[52:55], v[36:39]
    v_sub_f32 v161, v145, v178
    v_sub_f32 v169, v153, v179
    v_mfma_f32_16x16x32_bf16 v[40:43], v[208:211], a[40:43], v[40:43]
    ds_read_b64_tr_b16 v[200:201], v229 offset:0
    v_sub_f32 v162, v146, v178
    v_mfma_f32_16x16x32_bf16 v[40:43], v[212:215], a[56:59], v[40:43]
    s_add_u32 m0, s63, 69632
    ds_read_b64_tr_b16 v[202:203], v229 offset:1024
    v_sub_f32 v170, v154, v179
    v_mfma_f32_16x16x32_bf16 v[44:47], v[208:211], a[44:47], v[44:47]
    s_add_u32 s56, s56, 32768
    ds_read_b64_tr_b16 v[204:205], v229 offset:8192
    buffer_load_dwordx4 v240, s[40:43], s56 offen offset:0 lds
    v_mfma_f32_16x16x32_bf16 v[44:47], v[212:215], a[60:63], v[44:47]
    ds_read_b64_tr_b16 v[206:207], v229 offset:9216
    v_sub_f32 v163, v147, v178
    v_mfma_f32_16x16x32_bf16 v[48:51], v[216:219], a[32:35], v[48:51]
    s_waitcnt lgkmcnt(4)
    v_sub_f32 v171, v155, v179
    v_cvt_pk_bf16_f32 v140, v156, v157
    v_mfma_f32_16x16x32_bf16 v[48:51], v[220:223], a[48:51], v[48:51]
    v_cvt_pk_bf16_f32 v148, v164, v165
    v_cvt_pk_bf16_f32 v141, v158, v159
    v_mfma_f32_16x16x32_bf16 v[52:55], v[216:219], a[36:39], v[52:55]
    v_cvt_pk_bf16_f32 v149, v166, v167
    v_cvt_pk_bf16_f32 v142, v160, v161
    v_mfma_f32_16x16x32_bf16 v[52:55], v[220:223], a[52:55], v[52:55]
    buffer_load_dwordx4 v241, s[40:43], s56 offen offset:1024 lds
    v_cvt_pk_bf16_f32 v150, v168, v169
    v_mfma_f32_16x16x32_bf16 v[56:59], v[216:219], a[40:43], v[56:59]
    ds_read_b64_tr_b16 v[208:209], v230 offset:0
    v_cvt_pk_bf16_f32 v143, v162, v163
    v_mfma_f32_16x16x32_bf16 v[56:59], v[220:223], a[56:59], v[56:59]
    ds_read_b64_tr_b16 v[210:211], v230 offset:1024
    v_cvt_pk_bf16_f32 v151, v170, v171
    v_mfma_f32_16x16x32_bf16 v[60:63], v[216:219], a[44:47], v[60:63]
    ds_read_b64_tr_b16 v[212:213], v230 offset:8192
    v_lshlrev_b32 v156, 16, v140
    v_mfma_f32_16x16x32_bf16 v[60:63], v[220:223], a[60:63], v[60:63]
    ds_read_b64_tr_b16 v[214:215], v230 offset:9216
    v_and_b32 v157, 0xffff0000, v140
    v_mfma_f32_16x16x32_bf16 v[64:67], v[192:195], a[32:35], v[64:67]
    buffer_load_dwordx4 v242, s[40:43], s56 offen offset:2048 lds
    v_lshlrev_b32 v164, 16, v148
    v_mfma_f32_16x16x32_bf16 v[64:67], v[196:199], a[48:51], v[64:67]
    v_and_b32 v165, 0xffff0000, v148
    v_lshlrev_b32 v158, 16, v141
    v_mfma_f32_16x16x32_bf16 v[68:71], v[192:195], a[36:39], v[68:71]
    v_and_b32 v159, 0xffff0000, v141
    v_lshlrev_b32 v166, 16, v149
    v_mfma_f32_16x16x32_bf16 v[68:71], v[196:199], a[52:55], v[68:71]
    v_and_b32 v167, 0xffff0000, v149
    v_lshlrev_b32 v160, 16, v142
    v_mfma_f32_16x16x32_bf16 v[72:75], v[192:195], a[40:43], v[72:75]
    ds_read_b64_tr_b16 v[216:217], v231 offset:0
    buffer_load_dwordx4 v243, s[40:43], s56 offen offset:3072 lds
    v_mfma_f32_16x16x32_bf16 v[72:75], v[196:199], a[56:59], v[72:75]
    ds_read_b64_tr_b16 v[218:219], v231 offset:1024
    v_and_b32 v161, 0xffff0000, v142
    v_mfma_f32_16x16x32_bf16 v[76:79], v[192:195], a[44:47], v[76:79]
    s_mov_b32 s48, s8
    ds_read_b64_tr_b16 v[220:221], v231 offset:8192
    v_lshlrev_b32 v168, 16, v150
    v_mfma_f32_16x16x32_bf16 v[76:79], v[196:199], a[60:63], v[76:79]
    s_waitcnt lgkmcnt(5)
    s_and_b32 s49, s9, 0xffff
    ds_read_b64_tr_b16 v[222:223], v231 offset:9216
    v_mfma_f32_16x16x32_bf16 v[80:83], v[200:203], a[32:35], v[80:83]
    s_mov_b32 s50, 0x400000
    v_and_b32 v169, 0xffff0000, v150
    v_lshlrev_b32 v162, 16, v143
    v_mfma_f32_16x16x32_bf16 v[80:83], v[204:207], a[48:51], v[80:83]
    s_add_u32 s57, s68, 0
    buffer_load_dword v255, v235, s[48:51], s57 offen
    v_and_b32 v163, 0xffff0000, v143
    v_mfma_f32_16x16x32_bf16 v[84:87], v[200:203], a[36:39], v[84:87]
    v_lshlrev_b32 v170, 16, v151
    v_and_b32 v171, 0xffff0000, v151
    v_mfma_f32_16x16x32_bf16 v[84:87], v[204:207], a[52:55], v[84:87]
    v_mul_f32 v140, v156, v174
    v_mul_f32 v148, v164, v175
    v_mfma_f32_16x16x32_bf16 v[88:91], v[200:203], a[40:43], v[88:91]
    v_mul_f32 v141, v157, v174
    v_mul_f32 v149, v165, v175
    v_mfma_f32_16x16x32_bf16 v[88:91], v[204:207], a[56:59], v[88:91]
    v_mul_f32 v142, v158, v174
    v_mul_f32 v150, v166, v175
    v_mfma_f32_16x16x32_bf16 v[92:95], v[200:203], a[44:47], v[92:95]
    v_mul_f32 v143, v159, v174
    v_mul_f32 v151, v167, v175
    v_mfma_f32_16x16x32_bf16 v[92:95], v[204:207], a[60:63], v[92:95]
    v_mul_f32 v144, v160, v174
    v_mul_f32 v152, v168, v175
    v_mfma_f32_16x16x32_bf16 v[96:99], v[208:211], a[32:35], v[96:99]
    s_waitcnt vmcnt(14)
    s_waitcnt lgkmcnt(0)
    s_barrier
    ds_read_b128 a[64:67], v236 offset:32768
    v_mul_f32 v145, v161, v174
    v_mfma_f32_16x16x32_bf16 v[96:99], v[212:215], a[48:51], v[96:99]
    s_add_u32 s60, s61, 6
    ds_read_b128 a[80:83], v237 offset:32768
    v_mul_f32 v153, v169, v175
    v_mfma_f32_16x16x32_bf16 v[100:103], v[208:211], a[36:39], v[100:103]
    s_and_b32 s60, s60, 7
    ds_read_b64_tr_b16 v[192:193], v224 offset:16384
    v_mul_f32 v146, v162, v174
    v_mfma_f32_16x16x32_bf16 v[100:103], v[212:215], a[52:55], v[100:103]
    s_lshl_b32 s60, s60, 19
    ds_read_b64_tr_b16 v[194:195], v224 offset:17408
    v_mul_f32 v154, v170, v175
    v_mfma_f32_16x16x32_bf16 v[104:107], v[208:211], a[40:43], v[104:107]
    s_add_u32 m0, s55, 98304
    ds_read_b64_tr_b16 v[196:197], v224 offset:24576
    v_mul_f32 v147, v163, v174
    v_mfma_f32_16x16x32_bf16 v[104:107], v[212:215], a[56:59], v[104:107]
    s_add_u32 s57, s59, s60
    ds_read_b64_tr_b16 v[198:199], v224 offset:25600
    buffer_load_dwordx4 v244, s[36:39], s57 offen offset:0 lds
    v_mfma_f32_16x16x32_bf16 v[108:111], v[208:211], a[44:47], v[108:111]
    ds_read_b128 a[68:71], v236 offset:34816
    buffer_load_dwordx4 v245, s[36:39], s57 offen offset:1024 lds
    v_mfma_f32_16x16x32_bf16 v[108:111], v[212:215], a[60:63], v[108:111]
    ds_read_b128 a[84:87], v237 offset:34816
    v_mul_f32 v155, v171, v175
    v_mfma_f32_16x16x32_bf16 v[112:115], v[216:219], a[32:35], v[112:115]
    ds_read_b128 a[72:75], v236 offset:36864
    v_fma_f32 v156, -v140, v172, v156
    v_mfma_f32_16x16x32_bf16 v[112:115], v[220:223], a[48:51], v[112:115]
    ds_read_b128 a[88:91], v237 offset:36864
    v_fma_f32 v164, -v148, v173, v164
    v_mfma_f32_16x16x32_bf16 v[116:119], v[216:219], a[36:39], v[116:119]
    ds_read_b128 a[76:79], v236 offset:38912
    buffer_load_dwordx4 v246, s[36:39], s57 offen offset:2048 lds
    v_mfma_f32_16x16x32_bf16 v[116:119], v[220:223], a[52:55], v[116:119]
    ds_read_b128 a[92:95], v237 offset:38912
    v_fma_f32 v157, -v141, v172, v157
    v_mfma_f32_16x16x32_bf16 v[120:123], v[216:219], a[40:43], v[120:123]
    ds_read_b64_tr_b16 v[200:201], v225 offset:16384
    v_fma_f32 v165, -v149, v173, v165
    v_mfma_f32_16x16x32_bf16 v[120:123], v[220:223], a[56:59], v[120:123]
    ds_read_b64_tr_b16 v[202:203], v225 offset:17408
    v_fma_f32 v158, -v142, v172, v158
    v_mfma_f32_16x16x32_bf16 v[124:127], v[216:219], a[44:47], v[124:127]
    ds_read_b64_tr_b16 v[204:205], v225 offset:24576
    v_fma_f32 v166, -v150, v173, v166
    v_mfma_f32_16x16x32_bf16 v[124:127], v[220:223], a[60:63], v[124:127]
    s_waitcnt lgkmcnt(8)
    ds_read_b64_tr_b16 v[206:207], v225 offset:25600
    buffer_load_dwordx4 v247, s[36:39], s57 offen offset:3072 lds
    v_mfma_f32_16x16x32_bf16 v[0:3], v[192:195], a[64:67], v[0:3]
    s_add_u32 s60, s61, 6
    ds_read_b64_tr_b16 v[208:209], v226 offset:16384
    v_fma_f32 v159, -v143, v172, v159
    v_mfma_f32_16x16x32_bf16 v[0:3], v[196:199], a[80:83], v[0:3]
    s_and_b32 s60, s60, 7
    ds_read_b64_tr_b16 v[210:211], v226 offset:17408
    v_fma_f32 v167, -v151, v173, v167
    v_mfma_f32_16x16x32_bf16 v[4:7], v[192:195], a[68:71], v[4:7]
    s_waitcnt lgkmcnt(8)
    s_lshl_b32 s60, s60, 7
    ds_read_b64_tr_b16 v[212:213], v226 offset:24576
    v_mfma_f32_16x16x32_bf16 v[4:7], v[196:199], a[84:87], v[4:7]
    s_add_u32 m0, s63, 0
    ds_read_b64_tr_b16 v[214:215], v226 offset:25600
    v_fma_f32 v160, -v144, v172, v160
    v_mfma_f32_16x16x32_bf16 v[8:11], v[192:195], a[72:75], v[8:11]
    s_add_u32 s56, s62, s60
    ds_read_b64_tr_b16 v[216:217], v227 offset:16384
    buffer_load_dwordx4 v240, s[40:43], s56 offen offset:0 lds
    v_mfma_f32_16x16x32_bf16 v[8:11], v[196:199], a[88:91], v[8:11]
    s_waitcnt lgkmcnt(9)
    ds_read_b64_tr_b16 v[218:219], v227 offset:17408
    v_fma_f32 v168, -v152, v173, v168
    v_mfma_f32_16x16x32_bf16 v[12:15], v[192:195], a[76:79], v[12:15]
    ds_read_b64_tr_b16 v[220:221], v227 offset:24576
    v_fma_f32 v161, -v145, v172, v161
    v_mfma_f32_16x16x32_bf16 v[12:15], v[196:199], a[92:95], v[12:15]
    s_waitcnt lgkmcnt(9)
    ds_read_b64_tr_b16 v[222:223], v227 offset:25600
    v_fma_f32 v169, -v153, v173, v169
    v_mfma_f32_16x16x32_bf16 v[16:19], v[200:203], a[64:67], v[16:19]
    s_waitcnt lgkmcnt(8)
    buffer_load_dwordx4 v241, s[40:43], s56 offen offset:1024 lds
    v_fma_f32 v162, -v146, v172, v162
    v_mfma_f32_16x16x32_bf16 v[16:19], v[204:207], a[80:83], v[16:19]
    v_fma_f32 v170, -v154, v173, v170
    v_fma_f32 v163, -v147, v172, v163
    v_mfma_f32_16x16x32_bf16 v[20:23], v[200:203], a[68:71], v[20:23]
    v_fma_f32 v171, -v155, v173, v171
    v_fmac_f32 v140, v156, v174
    v_mfma_f32_16x16x32_bf16 v[20:23], v[204:207], a[84:87], v[20:23]
    v_fmac_f32 v148, v164, v175
    v_fmac_f32 v141, v157, v174
    v_mfma_f32_16x16x32_bf16 v[24:27], v[200:203], a[72:75], v[24:27]
    ds_read_b64_tr_b16 v[192:193], v228 offset:16384
    v_fmac_f32 v149, v165, v175
    v_mfma_f32_16x16x32_bf16 v[24:27], v[204:207], a[88:91], v[24:27]
    ds_read_b64_tr_b16 v[194:195], v228 offset:17408
    buffer_load_dwordx4 v242, s[40:43], s56 offen offset:2048 lds
    v_mfma_f32_16x16x32_bf16 v[28:31], v[200:203], a[76:79], v[28:31]
    ds_read_b64_tr_b16 v[196:197], v228 offset:24576
    v_fmac_f32 v142, v158, v174
    v_mfma_f32_16x16x32_bf16 v[28:31], v[204:207], a[92:95], v[28:31]
    s_waitcnt lgkmcnt(5)
    ds_read_b64_tr_b16 v[198:199], v228 offset:25600
    v_fmac_f32 v150, v166, v175
    v_mfma_f32_16x16x32_bf16 v[32:35], v[208:211], a[64:67], v[32:35]
    v_fmac_f32 v143, v159, v174
    v_fmac_f32 v151, v167, v175
    v_mfma_f32_16x16x32_bf16 v[32:35], v[212:215], a[80:83], v[32:35]
    buffer_load_dwordx4 v243, s[40:43], s56 offen offset:3072 lds
    v_fmac_f32 v144, v160, v174
    v_mfma_f32_16x16x32_bf16 v[36:39], v[208:211], a[68:71], v[36:39]
    v_fmac_f32 v152, v168, v175
    v_fmac_f32 v145, v161, v174
    v_mfma_f32_16x16x32_bf16 v[36:39], v[212:215], a[84:87], v[36:39]
    v_fmac_f32 v153, v169, v175
    v_fmac_f32 v146, v162, v174
    v_mfma_f32_16x16x32_bf16 v[40:43], v[208:211], a[72:75], v[40:43]
    ds_read_b64_tr_b16 v[200:201], v229 offset:16384
    v_fmac_f32 v154, v170, v175
    v_mfma_f32_16x16x32_bf16 v[40:43], v[212:215], a[88:91], v[40:43]
    s_add_u32 m0, s63, 4096
    ds_read_b64_tr_b16 v[202:203], v229 offset:17408
    v_fmac_f32 v147, v163, v174
    v_mfma_f32_16x16x32_bf16 v[44:47], v[208:211], a[76:79], v[44:47]
    s_add_u32 s56, s56, 32768
    ds_read_b64_tr_b16 v[204:205], v229 offset:24576
    buffer_load_dwordx4 v240, s[40:43], s56 offen offset:0 lds
    v_mfma_f32_16x16x32_bf16 v[44:47], v[212:215], a[92:95], v[44:47]
    ds_read_b64_tr_b16 v[206:207], v229 offset:25600
    v_fmac_f32 v155, v171, v175
    v_mfma_f32_16x16x32_bf16 v[48:51], v[216:219], a[64:67], v[48:51]
    s_waitcnt lgkmcnt(4)
    v_cvt_pk_bf16_f32 v128, v140, v141
    v_cvt_pk_bf16_f32 v132, v148, v149
    v_mfma_f32_16x16x32_bf16 v[48:51], v[220:223], a[80:83], v[48:51]
    v_cvt_pk_bf16_f32 v129, v142, v143
    v_cvt_pk_bf16_f32 v133, v150, v151
    v_mfma_f32_16x16x32_bf16 v[52:55], v[216:219], a[68:71], v[52:55]
    v_cvt_pk_bf16_f32 v130, v144, v145
    v_cvt_pk_bf16_f32 v134, v152, v153
    v_mfma_f32_16x16x32_bf16 v[52:55], v[220:223], a[84:87], v[52:55]
    buffer_load_dwordx4 v241, s[40:43], s56 offen offset:1024 lds
    v_cvt_pk_bf16_f32 v131, v146, v147
    v_mfma_f32_16x16x32_bf16 v[56:59], v[216:219], a[72:75], v[56:59]
    ds_read_b64_tr_b16 v[208:209], v230 offset:16384
    v_cvt_pk_bf16_f32 v135, v154, v155
    v_mfma_f32_16x16x32_bf16 v[56:59], v[220:223], a[88:91], v[56:59]
    s_lshl_b32 s69, s52, 5
    s_add_u32 s69, s69, 147456
    ds_read_b64_tr_b16 v[210:211], v230 offset:17408
    v_mfma_f32_16x16x32_bf16 v[60:63], v[216:219], a[76:79], v[60:63]
    ds_read_b64_tr_b16 v[212:213], v230 offset:24576
    v_mul_u32_u24 v180, 144, v249
    v_mfma_f32_16x16x32_bf16 v[60:63], v[220:223], a[92:95], v[60:63]
    ds_read_b64_tr_b16 v[214:215], v230 offset:25600
    v_add_u32 v180, s69, v180
    v_mfma_f32_16x16x32_bf16 v[64:67], v[192:195], a[64:67], v[64:67]
    buffer_load_dwordx4 v242, s[40:43], s56 offen offset:2048 lds
    ds_write_b128 v180, v[128:131]
    v_mfma_f32_16x16x32_bf16 v[64:67], v[196:199], a[80:83], v[64:67]
    ds_write_b128 v180, v[132:135] offset:16
    v_mfma_f32_16x16x32_bf16 v[68:71], v[192:195], a[68:71], v[68:71]
    v_lshlrev_b32 v140, 16, v136
    v_and_b32 v141, 0xffff0000, v136
    v_mfma_f32_16x16x32_bf16 v[68:71], v[196:199], a[84:87], v[68:71]
    v_lshlrev_b32 v142, 16, v137
    v_and_b32 v143, 0xffff0000, v137
    v_mfma_f32_16x16x32_bf16 v[72:75], v[192:195], a[72:75], v[72:75]
    ds_read_b64_tr_b16 v[216:217], v231 offset:16384
    buffer_load_dwordx4 v243, s[40:43], s56 offen offset:3072 lds
    v_mfma_f32_16x16x32_bf16 v[72:75], v[196:199], a[88:91], v[72:75]
    ds_read_b64_tr_b16 v[218:219], v231 offset:17408
    v_lshlrev_b32 v144, 16, v138
    v_mfma_f32_16x16x32_bf16 v[76:79], v[192:195], a[76:79], v[76:79]
    s_mov_b32 s48, s8
    ds_read_b64_tr_b16 v[220:221], v231 offset:24576
    v_and_b32 v145, 0xffff0000, v138
    v_mfma_f32_16x16x32_bf16 v[76:79], v[196:199], a[92:95], v[76:79]
    s_waitcnt lgkmcnt(7)
    s_and_b32 s49, s9, 0xffff
    ds_read_b64_tr_b16 v[222:223], v231 offset:25600
    v_mfma_f32_16x16x32_bf16 v[80:83], v[200:203], a[64:67], v[80:83]
    s_mov_b32 s50, 0x400000
    v_lshlrev_b32 v146, 16, v139
    v_and_b32 v147, 0xffff0000, v139
    v_mfma_f32_16x16x32_bf16 v[80:83], v[204:207], a[80:83], v[80:83]
    s_add_u32 s57, s68, 65536
    buffer_load_dword v255, v235, s[48:51], s57 offen
    v_lshlrev_b32 v156, 16, v128
    v_mfma_f32_16x16x32_bf16 v[84:87], v[200:203], a[68:71], v[84:87]
    v_and_b32 v157, 0xffff0000, v128
    v_lshlrev_b32 v164, 16, v132
    v_mfma_f32_16x16x32_bf16 v[84:87], v[204:207], a[84:87], v[84:87]
    v_and_b32 v165, 0xffff0000, v132
    v_lshlrev_b32 v158, 16, v129
    v_mfma_f32_16x16x32_bf16 v[88:91], v[200:203], a[72:75], v[88:91]
    v_and_b32 v159, 0xffff0000, v129
    v_lshlrev_b32 v166, 16, v133
    v_mfma_f32_16x16x32_bf16 v[88:91], v[204:207], a[88:91], v[88:91]
    v_and_b32 v167, 0xffff0000, v133
    v_lshlrev_b32 v160, 16, v130
    v_mfma_f32_16x16x32_bf16 v[92:95], v[200:203], a[76:79], v[92:95]
    v_and_b32 v161, 0xffff0000, v130
    v_lshlrev_b32 v168, 16, v134
    v_mfma_f32_16x16x32_bf16 v[92:95], v[204:207], a[92:95], v[92:95]
    v_and_b32 v169, 0xffff0000, v134
    v_lshlrev_b32 v162, 16, v131
    v_mfma_f32_16x16x32_bf16 v[96:99], v[208:211], a[64:67], v[96:99]
    s_waitcnt vmcnt(14)
    s_waitcnt lgkmcnt(0)
    s_barrier
    ds_read_b128 a[192:195], v238 offset:0
    v_and_b32 v163, 0xffff0000, v131
    v_mfma_f32_16x16x32_bf16 v[96:99], v[212:215], a[80:83], v[96:99]
    s_add_u32 s60, s61, 7
    ds_read_b128 a[208:211], v239 offset:0
    v_lshlrev_b32 v170, 16, v135
    v_mfma_f32_16x16x32_bf16 v[100:103], v[208:211], a[68:71], v[100:103]
    s_and_b32 s60, s60, 7
    ds_read_b64_tr_b16 v[192:193], v224 offset:32768
    v_and_b32 v171, 0xffff0000, v135
    v_mfma_f32_16x16x32_bf16 v[100:103], v[212:215], a[84:87], v[100:103]
    s_lshl_b32 s60, s60, 19
    ds_read_b64_tr_b16 v[194:195], v224 offset:33792
    v_mul_f32 v172, v156, v140
    v_mfma_f32_16x16x32_bf16 v[104:107], v[208:211], a[72:75], v[104:107]
    s_add_u32 m0, s55, 114688
    s_mov_b32 s48, s28
    ds_read_b64_tr_b16 v[196:197], v224 offset:40960
    v_mfma_f32_16x16x32_bf16 v[104:107], v[212:215], a[88:91], v[104:107]
    s_add_u32 s57, s59, s60
    ds_read_b64_tr_b16 v[198:199], v224 offset:41984
    buffer_load_dwordx4 v244, s[36:39], s57 offen offset:0 lds
    v_mfma_f32_16x16x32_bf16 v[108:111], v[208:211], a[76:79], v[108:111]
    s_and_b32 s49, s29, 0xffff
    ds_read_b128 a[196:199], v238 offset:2048
    buffer_load_dwordx4 v245, s[36:39], s57 offen offset:1024 lds
    v_mfma_f32_16x16x32_bf16 v[108:111], v[212:215], a[92:95], v[108:111]
    s_mov_b32 s50, 0x100
    s_mov_b32 s51, 0x20000
    ds_read_b128 a[212:215], v239 offset:2048
    v_mfma_f32_16x16x32_bf16 v[112:115], v[216:219], a[64:67], v[112:115]
    ds_read_b128 a[200:203], v238 offset:4096
    v_mov_b32 v253, 0
    v_mfma_f32_16x16x32_bf16 v[112:115], v[220:223], a[80:83], v[112:115]
    ds_read_b128 a[216:219], v239 offset:4096
    buffer_load_dword v252, v253, s[48:51], 0 offen sc1
    v_mfma_f32_16x16x32_bf16 v[116:119], v[216:219], a[68:71], v[116:119]
    ds_read_b128 a[204:207], v238 offset:6144
    v_mul_f32 v173, v164, v140
    v_mfma_f32_16x16x32_bf16 v[116:119], v[220:223], a[84:87], v[116:119]
    ds_read_b128 a[220:223], v239 offset:6144
    buffer_load_dwordx4 v246, s[36:39], s57 offen offset:2048 lds
    v_mfma_f32_16x16x32_bf16 v[120:123], v[216:219], a[72:75], v[120:123]
    ds_read_b64_tr_b16 v[200:201], v225 offset:32768
    v_fmac_f32 v172, v157, v141
    v_mfma_f32_16x16x32_bf16 v[120:123], v[220:223], a[88:91], v[120:123]
    ds_read_b64_tr_b16 v[202:203], v225 offset:33792
    v_fmac_f32 v173, v165, v141
    v_mfma_f32_16x16x32_bf16 v[124:127], v[216:219], a[76:79], v[124:127]
    ds_read_b64_tr_b16 v[204:205], v225 offset:40960
    v_fmac_f32 v172, v158, v142
    v_mfma_f32_16x16x32_bf16 v[124:127], v[220:223], a[92:95], v[124:127]
    s_waitcnt lgkmcnt(8)
    ds_read_b64_tr_b16 v[206:207], v225 offset:41984
    v_fmac_f32 v173, v166, v142
    v_mfma_f32_16x16x32_bf16 v[0:3], v[192:195], a[192:195], v[0:3]
    ds_read_b64_tr_b16 v[208:209], v226 offset:32768
    buffer_load_dwordx4 v247, s[36:39], s57 offen offset:3072 lds
    v_mfma_f32_16x16x32_bf16 v[0:3], v[196:199], a[208:211], v[0:3]
    s_add_u32 s60, s61, 7
    ds_read_b64_tr_b16 v[210:211], v226 offset:33792
    v_fmac_f32 v172, v159, v143
    v_mfma_f32_16x16x32_bf16 v[4:7], v[192:195], a[196:199], v[4:7]
    s_waitcnt lgkmcnt(8)
    s_and_b32 s60, s60, 7
    ds_read_b64_tr_b16 v[212:213], v226 offset:40960
    v_mfma_f32_16x16x32_bf16 v[4:7], v[196:199], a[212:215], v[4:7]
    s_lshl_b32 s60, s60, 7
    ds_read_b64_tr_b16 v[214:215], v226 offset:41984
    v_fmac_f32 v173, v167, v143
    v_mfma_f32_16x16x32_bf16 v[8:11], v[192:195], a[200:203], v[8:11]
    s_add_u32 m0, s63, 32768
    ds_read_b64_tr_b16 v[216:217], v227 offset:32768
    v_fmac_f32 v172, v160, v144
    v_mfma_f32_16x16x32_bf16 v[8:11], v[196:199], a[216:219], v[8:11]
    s_waitcnt lgkmcnt(9)
    s_add_u32 s56, s62, s60
    ds_read_b64_tr_b16 v[218:219], v227 offset:33792
    buffer_load_dwordx4 v240, s[40:43], s56 offen offset:0 lds
    v_mfma_f32_16x16x32_bf16 v[12:15], v[192:195], a[204:207], v[12:15]
    ds_read_b64_tr_b16 v[220:221], v227 offset:40960
    v_fmac_f32 v173, v168, v144
    v_mfma_f32_16x16x32_bf16 v[12:15], v[196:199], a[220:223], v[12:15]
    s_waitcnt lgkmcnt(9)
    ds_read_b64_tr_b16 v[222:223], v227 offset:41984
    v_fmac_f32 v172, v161, v145
    v_mfma_f32_16x16x32_bf16 v[16:19], v[200:203], a[192:195], v[16:19]
    s_waitcnt lgkmcnt(8)
    v_fmac_f32 v173, v169, v145
    v_fmac_f32 v172, v162, v146
    v_mfma_f32_16x16x32_bf16 v[16:19], v[204:207], a[208:211], v[16:19]
    v_fmac_f32 v173, v170, v146
    v_fmac_f32 v172, v163, v147
    v_mfma_f32_16x16x32_bf16 v[20:23], v[200:203], a[196:199], v[20:23]
    buffer_load_dwordx4 v241, s[40:43], s56 offen offset:1024 lds
    v_fmac_f32 v173, v171, v147
    v_mfma_f32_16x16x32_bf16 v[20:23], v[204:207], a[212:215], v[20:23]
    v_lshrrev_b32 v181, 3, v249
    v_and_b32 v182, 7, v249
    v_mfma_f32_16x16x32_bf16 v[24:27], v[200:203], a[200:203], v[24:27]
    ds_read_b64_tr_b16 v[192:193], v228 offset:32768
    v_add_f32_dpp v172, v172, v172 quad_perm:[1,0,3,2] row_mask:0xf bank_mask:0xf
    v_mfma_f32_16x16x32_bf16 v[24:27], v[204:207], a[216:219], v[24:27]
    ds_read_b64_tr_b16 v[194:195], v228 offset:33792
    v_add_f32_dpp v173, v173, v173 quad_perm:[1,0,3,2] row_mask:0xf bank_mask:0xf
    v_mfma_f32_16x16x32_bf16 v[28:31], v[200:203], a[204:207], v[28:31]
    ds_read_b64_tr_b16 v[196:197], v228 offset:40960
    v_mul_u32_u24 v183, 144, v181
    v_mfma_f32_16x16x32_bf16 v[28:31], v[204:207], a[220:223], v[28:31]
    s_waitcnt lgkmcnt(5)
    ds_read_b64_tr_b16 v[198:199], v228 offset:41984
    v_add_f32_dpp v172, v172, v172 quad_perm:[2,3,0,1] row_mask:0xf bank_mask:0xf
    v_mfma_f32_16x16x32_bf16 v[32:35], v[208:211], a[192:195], v[32:35]
    buffer_load_dwordx4 v242, s[40:43], s56 offen offset:2048 lds
    v_add_f32_dpp v173, v173, v173 quad_perm:[2,3,0,1] row_mask:0xf bank_mask:0xf
    v_mfma_f32_16x16x32_bf16 v[32:35], v[212:215], a[208:211], v[32:35]
    v_lshl_add_u32 v183, v182, 4, v183
    v_mfma_f32_16x16x32_bf16 v[36:39], v[208:211], a[196:199], v[36:39]
    s_mul_i32 s19, s52, 2304
    v_add_f32_dpp v172, v172, v172 row_half_mirror row_mask:0xf bank_mask:0xf
    v_add_f32_dpp v173, v173, v173 row_half_mirror row_mask:0xf bank_mask:0xf
    v_mfma_f32_16x16x32_bf16 v[36:39], v[212:215], a[212:215], v[36:39]
    s_add_u32 s19, s19, 147456
    v_add_u32 v183, s19, v183
    v_mfma_f32_16x16x32_bf16 v[40:43], v[208:211], a[200:203], v[40:43]
    ds_read_b64_tr_b16 v[200:201], v229 offset:32768
    buffer_load_dwordx4 v243, s[40:43], s56 offen offset:3072 lds
    v_mfma_f32_16x16x32_bf16 v[40:43], v[212:215], a[216:219], v[40:43]
    ds_read_b64_tr_b16 v[202:203], v229 offset:33792
    v_add_f32_dpp v172, v172, v172 row_mirror row_mask:0xf bank_mask:0xf
    v_mfma_f32_16x16x32_bf16 v[44:47], v[208:211], a[204:207], v[44:47]
    ds_read_b64_tr_b16 v[204:205], v229 offset:40960
    v_add_f32_dpp v173, v173, v173 row_mirror row_mask:0xf bank_mask:0xf
    v_mfma_f32_16x16x32_bf16 v[44:47], v[212:215], a[220:223], v[44:47]
    ds_read_b64_tr_b16 v[206:207], v229 offset:41984
    v_mov_b32 v174, v172
    v_mfma_f32_16x16x32_bf16 v[48:51], v[216:219], a[192:195], v[48:51]
    s_waitcnt lgkmcnt(4)
    s_add_u32 m0, s63, 36864
    v_mov_b32 v175, v173
    v_mfma_f32_16x16x32_bf16 v[48:51], v[220:223], a[208:211], v[48:51]
    s_add_u32 s56, s56, 32768
    buffer_load_dwordx4 v240, s[40:43], s56 offen offset:0 lds
    ds_read_b128 v[184:187], v183
    v_mfma_f32_16x16x32_bf16 v[52:55], v[216:219], a[196:199], v[52:55]
    v_permlane16_swap_b32 v172, v174
    v_permlane16_swap_b32 v173, v175
    v_mfma_f32_16x16x32_bf16 v[52:55], v[220:223], a[212:215], v[52:55]
    v_add_f32 v172, v172, v174
    v_add_f32 v173, v173, v175
    v_mfma_f32_16x16x32_bf16 v[56:59], v[216:219], a[200:203], v[56:59]
    ds_read_b64_tr_b16 v[208:209], v230 offset:32768
    v_mov_b32 v174, v172
    v_mfma_f32_16x16x32_bf16 v[56:59], v[220:223], a[216:219], v[56:59]
    ds_read_b64_tr_b16 v[210:211], v230 offset:33792
    v_mov_b32 v175, v173
    v_mfma_f32_16x16x32_bf16 v[60:63], v[216:219], a[204:207], v[60:63]
    ds_read_b64_tr_b16 v[212:213], v230 offset:40960
    buffer_load_dwordx4 v241, s[40:43], s56 offen offset:1024 lds
    v_mfma_f32_16x16x32_bf16 v[60:63], v[220:223], a[220:223], v[60:63]
    ds_read_b64_tr_b16 v[214:215], v230 offset:41984
    v_permlane32_swap_b32 v172, v174
    v_mfma_f32_16x16x32_bf16 v[64:67], v[192:195], a[192:195], v[64:67]
    v_permlane32_swap_b32 v173, v175
    v_add_f32 v172, v172, v174
    v_mfma_f32_16x16x32_bf16 v[64:67], v[196:199], a[208:211], v[64:67]
    v_add_f32 v173, v173, v175
    v_cvt_pk_bf16_f32 v174, v172, v173
    v_mfma_f32_16x16x32_bf16 v[68:71], v[192:195], a[196:199], v[68:71]
    v_lshlrev_b32 v176, 16, v174
    v_and_b32 v177, 0xffff0000, v174
    v_mfma_f32_16x16x32_bf16 v[68:71], v[196:199], a[212:215], v[68:71]
    s_lshl_b32 s69, s2, 3
    s_lshl_b32 s70, s52, 1
    buffer_load_dwordx4 v242, s[40:43], s56 offen offset:2048 lds
    v_mfma_f32_16x16x32_bf16 v[72:75], v[192:195], a[200:203], v[72:75]
    s_add_u32 s69, s69, s70
    s_sub_u32 s71, 2047, s69
    ds_read_b64_tr_b16 v[216:217], v231 offset:32768
    v_mfma_f32_16x16x32_bf16 v[72:75], v[196:199], a[216:219], v[72:75]
    s_sub_u32 s72, 2046, s69
    ds_read_b64_tr_b16 v[218:219], v231 offset:33792
    v_add_f32 v176, 0, v176
    v_mfma_f32_16x16x32_bf16 v[76:79], v[192:195], a[204:207], v[76:79]
    ds_read_b64_tr_b16 v[220:221], v231 offset:40960
    v_add_f32 v177, 0, v177
    v_mfma_f32_16x16x32_bf16 v[76:79], v[196:199], a[220:223], v[76:79]
    s_waitcnt lgkmcnt(5)
    ds_read_b64_tr_b16 v[222:223], v231 offset:41984
    v_ashrrev_i32 v172, 31, v176
    v_mfma_f32_16x16x32_bf16 v[80:83], v[200:203], a[192:195], v[80:83]
    buffer_load_dwordx4 v243, s[40:43], s56 offen offset:3072 lds
    v_ashrrev_i32 v173, 31, v177
    v_mfma_f32_16x16x32_bf16 v[80:83], v[204:207], a[208:211], v[80:83]
    v_or_b32 v172, 0x80000000, v172
    v_or_b32 v173, 0x80000000, v173
    v_mfma_f32_16x16x32_bf16 v[84:87], v[200:203], a[196:199], v[84:87]
    v_xor_b32 v176, v176, v172
    v_xor_b32 v177, v177, v173
    v_mfma_f32_16x16x32_bf16 v[84:87], v[204:207], a[212:215], v[84:87]
    v_and_b32 v176, 0xffff0000, v176
    v_and_b32 v177, 0xffff0000, v177
    v_mfma_f32_16x16x32_bf16 v[88:91], v[200:203], a[200:203], v[88:91]
    v_or_b32 v176, s71, v176
    v_or_b32 v177, s72, v177
    v_mfma_f32_16x16x32_bf16 v[88:91], v[204:207], a[216:219], v[88:91]
    v_min_u32 v180, 1, v249
    v_lshlrev_b32 v180, 30, v180
    v_mfma_f32_16x16x32_bf16 v[92:95], v[200:203], a[204:207], v[92:95]
    s_lshl_b32 s69, s69, 2
    s_add_u32 s69, s69, 0x200000
    buffer_store_dwordx2 v[176:177], v180, s[32:35], s69 offen sc1
    v_mfma_f32_16x16x32_bf16 v[92:95], v[204:207], a[220:223], v[92:95]
    ds_read_b128 v[188:191], v183 offset:1152
    v_lshrrev_b32 v183, 2, v181
    v_mfma_f32_16x16x32_bf16 v[96:99], v[208:211], a[192:195], v[96:99]
    s_waitcnt vmcnt(15)
    s_waitcnt lgkmcnt(0)
    s_barrier
    ds_read_b128 a[224:227], v236 offset:0
    v_lshlrev_b32 v183, 12, v183
    v_mfma_f32_16x16x32_bf16 v[96:99], v[212:215], a[208:211], v[96:99]
    s_add_u32 s60, s61, 1
    ds_read_b128 a[240:243], v237 offset:0
    v_and_b32 v181, 3, v181
    v_mfma_f32_16x16x32_bf16 v[100:103], v[208:211], a[196:199], v[100:103]
    s_and_b32 s60, s60, 7
    ds_read_b64_tr_b16 v[192:193], v224 offset:0
    v_lshl_add_u32 v183, v181, 8, v183
    v_mfma_f32_16x16x32_bf16 v[100:103], v[212:215], a[212:215], v[100:103]
    s_lshl_b32 s60, s60, 19
    ds_read_b64_tr_b16 v[194:195], v224 offset:1024
    v_lshl_add_u32 v183, v182, 4, v183
    v_mfma_f32_16x16x32_bf16 v[104:107], v[208:211], a[200:203], v[104:107]
    s_add_u32 m0, s55, 131072
    s_lshr_b32 s19, s2, 3
    ds_read_b64_tr_b16 v[196:197], v224 offset:8192
    v_mfma_f32_16x16x32_bf16 v[104:107], v[212:215], a[216:219], v[104:107]
    s_add_u32 s57, s59, s60
    ds_read_b64_tr_b16 v[198:199], v224 offset:9216
    buffer_load_dwordx4 v244, s[44:47], s57 offen offset:0 lds
    v_mfma_f32_16x16x32_bf16 v[108:111], v[208:211], a[204:207], v[108:111]
    s_mul_i32 s19, s19, 70656
    ds_read_b128 a[228:231], v236 offset:2048
    buffer_load_dwordx4 v245, s[44:47], s57 offen offset:1024 lds
    v_mfma_f32_16x16x32_bf16 v[108:111], v[212:215], a[220:223], v[108:111]
    s_add_u32 s19, s19, 0xb00000
    s_bfe_u32 s58, s2, 0x20001
    ds_read_b128 a[244:247], v237 offset:2048
    v_mfma_f32_16x16x32_bf16 v[112:115], v[216:219], a[192:195], v[112:115]
    s_lshl_b32 s58, s58, 10
    s_add_u32 s19, s19, s58
    ds_read_b128 a[232:235], v236 offset:4096
    v_mfma_f32_16x16x32_bf16 v[112:115], v[220:223], a[208:211], v[112:115]
    s_and_b32 s58, s2, 1
    s_lshl_b32 s58, s58, 7
    ds_read_b128 a[248:251], v237 offset:4096
    v_mfma_f32_16x16x32_bf16 v[116:119], v[216:219], a[196:199], v[116:119]
    s_add_u32 s19, s19, s58
    s_lshl_b32 s58, s52, 14
    ds_read_b128 a[236:239], v236 offset:6144
    v_mfma_f32_16x16x32_bf16 v[116:119], v[220:223], a[212:215], v[116:119]
    s_add_u32 s19, s19, s58
    ds_read_b128 a[252:255], v237 offset:6144
    buffer_load_dwordx4 v246, s[44:47], s57 offen offset:2048 lds
    v_mfma_f32_16x16x32_bf16 v[120:123], v[216:219], a[200:203], v[120:123]
    s_add_u32 s58, s19, 8192
    ds_read_b64_tr_b16 v[200:201], v225 offset:0
    v_mfma_f32_16x16x32_bf16 v[120:123], v[220:223], a[216:219], v[120:123]
    ds_read_b64_tr_b16 v[202:203], v225 offset:1024
    buffer_store_dwordx4 v[184:187], v183, s[32:35], s19 offen sc1
    v_mfma_f32_16x16x32_bf16 v[124:127], v[216:219], a[204:207], v[124:127]
    ds_read_b64_tr_b16 v[204:205], v225 offset:8192
    v_mfma_f32_16x16x32_bf16 v[124:127], v[220:223], a[220:223], v[124:127]
    s_waitcnt lgkmcnt(8)
    ds_read_b64_tr_b16 v[206:207], v225 offset:9216
    buffer_store_dwordx4 v[188:191], v183, s[32:35], s58 offen sc1
    v_mfma_f32_16x16x32_bf16 v[0:3], v[192:195], a[224:227], v[0:3]
    ds_read_b64_tr_b16 v[208:209], v226 offset:0
    buffer_load_dwordx4 v247, s[44:47], s57 offen offset:3072 lds
    v_mfma_f32_16x16x32_bf16 v[0:3], v[196:199], a[240:243], v[0:3]
    s_add_u32 s60, s61, 2
    ds_read_b64_tr_b16 v[210:211], v226 offset:1024
    v_mfma_f32_16x16x32_bf16 v[4:7], v[192:195], a[228:231], v[4:7]
    s_waitcnt lgkmcnt(8)
    s_and_b32 s60, s60, 7
    ds_read_b64_tr_b16 v[212:213], v226 offset:8192
    v_mfma_f32_16x16x32_bf16 v[4:7], v[196:199], a[244:247], v[4:7]
    s_lshl_b32 s60, s60, 19
    ds_read_b64_tr_b16 v[214:215], v226 offset:9216
    v_mfma_f32_16x16x32_bf16 v[8:11], v[192:195], a[232:235], v[8:11]
    s_add_u32 m0, s55, 65536
    ds_read_b64_tr_b16 v[216:217], v227 offset:0
    v_mfma_f32_16x16x32_bf16 v[8:11], v[196:199], a[248:251], v[8:11]
    s_waitcnt lgkmcnt(9)
    s_add_u32 s57, s59, s60
    ds_read_b64_tr_b16 v[218:219], v227 offset:1024
    buffer_load_dwordx4 v244, s[44:47], s57 offen offset:0 lds
    v_mfma_f32_16x16x32_bf16 v[12:15], v[192:195], a[236:239], v[12:15]
    ds_read_b64_tr_b16 v[220:221], v227 offset:8192
    v_mfma_f32_16x16x32_bf16 v[12:15], v[196:199], a[252:255], v[12:15]
    s_waitcnt lgkmcnt(9)
    ds_read_b64_tr_b16 v[222:223], v227 offset:9216
    v_mfma_f32_16x16x32_bf16 v[16:19], v[200:203], a[224:227], v[16:19]
    s_waitcnt lgkmcnt(8)
    v_mfma_f32_16x16x32_bf16 v[16:19], v[204:207], a[240:243], v[16:19]
    v_mfma_f32_16x16x32_bf16 v[20:23], v[200:203], a[228:231], v[20:23]
    buffer_load_dwordx4 v245, s[44:47], s57 offen offset:1024 lds
    s_waitcnt vmcnt(19)
    s_mov_b32 s16, 100000
F_pl1:
    v_cmp_eq_u32 vcc, 0, v252
    s_nop 4
    s_cbranch_vccz F_pd1
    s_sleep 16
    buffer_load_dword v252, v253, s[48:51], 0 offen sc1
    s_sub_u32 s16, s16, 1
    s_waitcnt vmcnt(0)
    s_cbranch_scc0 F_pl1
F_pd1:
    v_mfma_f32_16x16x32_bf16 v[20:23], v[204:207], a[244:247], v[20:23]
    v_readfirstlane_b32 s94, v252
    v_mfma_f32_16x16x32_bf16 v[24:27], v[200:203], a[232:235], v[24:27]
    ds_read_b64_tr_b16 v[192:193], v228 offset:0
    v_mfma_f32_16x16x32_bf16 v[24:27], v[204:207], a[248:251], v[24:27]
    ds_read_b64_tr_b16 v[194:195], v228 offset:1024
    v_mfma_f32_16x16x32_bf16 v[28:31], v[200:203], a[236:239], v[28:31]
    ds_read_b64_tr_b16 v[196:197], v228 offset:8192
    v_mfma_f32_16x16x32_bf16 v[28:31], v[204:207], a[252:255], v[28:31]
    s_waitcnt lgkmcnt(5)
    ds_read_b64_tr_b16 v[198:199], v228 offset:9216
    v_mfma_f32_16x16x32_bf16 v[32:35], v[208:211], a[224:227], v[32:35]
    buffer_load_dwordx4 v246, s[44:47], s57 offen offset:2048 lds
    v_mfma_f32_16x16x32_bf16 v[32:35], v[212:215], a[240:243], v[32:35]
    v_mfma_f32_16x16x32_bf16 v[36:39], v[208:211], a[228:231], v[36:39]
    v_mfma_f32_16x16x32_bf16 v[36:39], v[212:215], a[244:247], v[36:39]
    v_mfma_f32_16x16x32_bf16 v[40:43], v[208:211], a[232:235], v[40:43]
    ds_read_b64_tr_b16 v[200:201], v229 offset:0
    buffer_load_dwordx4 v247, s[44:47], s57 offen offset:3072 lds
    v_mfma_f32_16x16x32_bf16 v[40:43], v[212:215], a[248:251], v[40:43]
    s_add_u32 s60, s61, 3
    ds_read_b64_tr_b16 v[202:203], v229 offset:1024
    v_mfma_f32_16x16x32_bf16 v[44:47], v[208:211], a[236:239], v[44:47]
    s_and_b32 s60, s60, 7
    ds_read_b64_tr_b16 v[204:205], v229 offset:8192
    v_mfma_f32_16x16x32_bf16 v[44:47], v[212:215], a[252:255], v[44:47]
    s_lshl_b32 s60, s60, 19
    ds_read_b64_tr_b16 v[206:207], v229 offset:9216
    v_mfma_f32_16x16x32_bf16 v[48:51], v[216:219], a[224:227], v[48:51]
    s_waitcnt lgkmcnt(4)
    s_add_u32 m0, s55, 81920
    v_mfma_f32_16x16x32_bf16 v[48:51], v[220:223], a[240:243], v[48:51]
    s_add_u32 s57, s59, s60
    buffer_load_dwordx4 v244, s[44:47], s57 offen offset:0 lds
    v_mfma_f32_16x16x32_bf16 v[52:55], v[216:219], a[228:231], v[52:55]
    v_mfma_f32_16x16x32_bf16 v[52:55], v[220:223], a[244:247], v[52:55]
    v_mfma_f32_16x16x32_bf16 v[56:59], v[216:219], a[232:235], v[56:59]
    ds_read_b64_tr_b16 v[208:209], v230 offset:0
    v_mfma_f32_16x16x32_bf16 v[56:59], v[220:223], a[248:251], v[56:59]
    ds_read_b64_tr_b16 v[210:211], v230 offset:1024
    v_mfma_f32_16x16x32_bf16 v[60:63], v[216:219], a[236:239], v[60:63]
    ds_read_b64_tr_b16 v[212:213], v230 offset:8192
    buffer_load_dwordx4 v245, s[44:47], s57 offen offset:1024 lds
    v_mfma_f32_16x16x32_bf16 v[60:63], v[220:223], a[252:255], v[60:63]
    ds_read_b64_tr_b16 v[214:215], v230 offset:9216
    v_mfma_f32_16x16x32_bf16 v[64:67], v[192:195], a[224:227], v[64:67]
    v_mfma_f32_16x16x32_bf16 v[64:67], v[196:199], a[240:243], v[64:67]
    v_mfma_f32_16x16x32_bf16 v[68:71], v[192:195], a[228:231], v[68:71]
    v_mfma_f32_16x16x32_bf16 v[68:71], v[196:199], a[244:247], v[68:71]
    buffer_load_dwordx4 v246, s[44:47], s57 offen offset:2048 lds
    v_mfma_f32_16x16x32_bf16 v[72:75], v[192:195], a[232:235], v[72:75]
    ds_read_b64_tr_b16 v[216:217], v231 offset:0
    v_mfma_f32_16x16x32_bf16 v[72:75], v[196:199], a[248:251], v[72:75]
    ds_read_b64_tr_b16 v[218:219], v231 offset:1024
    v_mfma_f32_16x16x32_bf16 v[76:79], v[192:195], a[236:239], v[76:79]
    ds_read_b64_tr_b16 v[220:221], v231 offset:8192
    v_mfma_f32_16x16x32_bf16 v[76:79], v[196:199], a[252:255], v[76:79]
    s_waitcnt lgkmcnt(5)
    ds_read_b64_tr_b16 v[222:223], v231 offset:9216
    v_mfma_f32_16x16x32_bf16 v[80:83], v[200:203], a[224:227], v[80:83]
    buffer_load_dwordx4 v247, s[44:47], s57 offen offset:3072 lds
    v_mfma_f32_16x16x32_bf16 v[80:83], v[204:207], a[240:243], v[80:83]
    s_mov_b32 s36, s8
    s_and_b32 s37, s9, 0xffff
    s_mov_b32 s38, 0x400000
    s_mov_b32 s39, 0x20000
    v_mfma_f32_16x16x32_bf16 v[84:87], v[200:203], a[228:231], v[84:87]
    v_mfma_f32_16x16x32_bf16 v[84:87], v[204:207], a[244:247], v[84:87]
    v_mfma_f32_16x16x32_bf16 v[88:91], v[200:203], a[232:235], v[88:91]
    v_mfma_f32_16x16x32_bf16 v[88:91], v[204:207], a[248:251], v[88:91]
    v_mfma_f32_16x16x32_bf16 v[92:95], v[200:203], a[236:239], v[92:95]
    v_mfma_f32_16x16x32_bf16 v[92:95], v[204:207], a[252:255], v[92:95]
    v_mfma_f32_16x16x32_bf16 v[96:99], v[208:211], a[224:227], v[96:99]
    s_waitcnt vmcnt(9)
    s_waitcnt lgkmcnt(0)
    s_barrier
    ds_read_b128 a[96:99], v236 offset:32768
    v_mfma_f32_16x16x32_bf16 v[96:99], v[212:215], a[240:243], v[96:99]
    ds_read_b128 a[112:115], v237 offset:32768
    v_mov_b32 v253, s94
    s_lshr_b32 s58, s2, 3
    s_mul_i32 s58, s58, 96
    s_lshl_b32 s16, s2, 2
    s_add_u32 s58, s58, s16
    s_add_u32 s58, s58, 0x3c0000
    s_cmp_eq_u32 s52, 0
    s_cselect_b32 s58, s58, 0x7fff0000
    v_min_u32 v252, 1, v249
    v_lshlrev_b32 v252, 30, v252
    buffer_store_dword v253, v252, s[32:35], s58 offen sc1
    v_mfma_f32_16x16x32_bf16 v[100:103], v[208:211], a[228:231], v[100:103]
    s_add_u32 s60, s61, 0
    ds_read_b64_tr_b16 v[192:193], v224 offset:16384
    v_mfma_f32_16x16x32_bf16 v[100:103], v[212:215], a[244:247], v[100:103]
    s_and_b32 s60, s60, 7
    ds_read_b64_tr_b16 v[194:195], v224 offset:17408
    v_mfma_f32_16x16x32_bf16 v[104:107], v[208:211], a[232:235], v[104:107]
    s_lshl_b32 s60, s60, 19
    ds_read_b64_tr_b16 v[196:197], v224 offset:24576
    v_mfma_f32_16x16x32_bf16 v[104:107], v[212:215], a[248:251], v[104:107]
    s_add_u32 m0, s55, 147456
    ds_read_b64_tr_b16 v[198:199], v224 offset:25600
    v_mfma_f32_16x16x32_bf16 v[108:111], v[208:211], a[236:239], v[108:111]
    s_add_u32 s57, s59, s60
    ds_read_b128 a[100:103], v236 offset:34816
    buffer_load_dwordx4 v244, s[44:47], s57 offen offset:0 lds
    v_mfma_f32_16x16x32_bf16 v[108:111], v[212:215], a[252:255], v[108:111]
    ds_read_b128 a[116:119], v237 offset:34816
    v_mfma_f32_16x16x32_bf16 v[112:115], v[216:219], a[224:227], v[112:115]
    ds_read_b128 a[104:107], v236 offset:36864
    buffer_load_dwordx4 v245, s[44:47], s57 offen offset:1024 lds
    v_mfma_f32_16x16x32_bf16 v[112:115], v[220:223], a[240:243], v[112:115]
    ds_read_b128 a[120:123], v237 offset:36864
    v_mfma_f32_16x16x32_bf16 v[116:119], v[216:219], a[228:231], v[116:119]
    ds_read_b128 a[108:111], v236 offset:38912
    v_mfma_f32_16x16x32_bf16 v[116:119], v[220:223], a[244:247], v[116:119]
    ds_read_b128 a[124:127], v237 offset:38912
    buffer_load_dwordx4 v246, s[44:47], s57 offen offset:2048 lds
    v_mfma_f32_16x16x32_bf16 v[120:123], v[216:219], a[232:235], v[120:123]
    ds_read_b64_tr_b16 v[200:201], v225 offset:16384
    v_mfma_f32_16x16x32_bf16 v[120:123], v[220:223], a[248:251], v[120:123]
    ds_read_b64_tr_b16 v[202:203], v225 offset:17408
    v_mfma_f32_16x16x32_bf16 v[124:127], v[216:219], a[236:239], v[124:127]
    ds_read_b64_tr_b16 v[204:205], v225 offset:24576
    v_mfma_f32_16x16x32_bf16 v[124:127], v[220:223], a[252:255], v[124:127]
    s_waitcnt lgkmcnt(8)
    ds_read_b64_tr_b16 v[206:207], v225 offset:25600
    buffer_load_dwordx4 v247, s[44:47], s57 offen offset:3072 lds
    v_mfma_f32_16x16x32_bf16 v[0:3], v[192:195], a[96:99], v[0:3]
    s_add_u32 s60, s61, 4
    ds_read_b64_tr_b16 v[208:209], v226 offset:16384
    v_mfma_f32_16x16x32_bf16 v[0:3], v[196:199], a[112:115], v[0:3]
    s_and_b32 s60, s60, 7
    ds_read_b64_tr_b16 v[210:211], v226 offset:17408
    v_mfma_f32_16x16x32_bf16 v[4:7], v[192:195], a[100:103], v[4:7]
    s_waitcnt lgkmcnt(8)
    s_lshl_b32 s60, s60, 19
    ds_read_b64_tr_b16 v[212:213], v226 offset:24576
    v_mfma_f32_16x16x32_bf16 v[4:7], v[196:199], a[116:119], v[4:7]
    s_add_u32 m0, s55, 98304
    ds_read_b64_tr_b16 v[214:215], v226 offset:25600
    v_mfma_f32_16x16x32_bf16 v[8:11], v[192:195], a[104:107], v[8:11]
    s_add_u32 s57, s59, s60
    ds_read_b64_tr_b16 v[216:217], v227 offset:16384
    buffer_load_dwordx4 v244, s[44:47], s57 offen offset:0 lds
    v_mfma_f32_16x16x32_bf16 v[8:11], v[196:199], a[120:123], v[8:11]
    s_waitcnt lgkmcnt(9)
    ds_read_b64_tr_b16 v[218:219], v227 offset:17408
    v_mfma_f32_16x16x32_bf16 v[12:15], v[192:195], a[108:111], v[12:15]
    ds_read_b64_tr_b16 v[220:221], v227 offset:24576
    buffer_load_dwordx4 v245, s[44:47], s57 offen offset:1024 lds
    v_mfma_f32_16x16x32_bf16 v[12:15], v[196:199], a[124:127], v[12:15]
    s_waitcnt lgkmcnt(9)
    ds_read_b64_tr_b16 v[222:223], v227 offset:25600
    v_mfma_f32_16x16x32_bf16 v[16:19], v[200:203], a[96:99], v[16:19]
    s_waitcnt lgkmcnt(8)
    v_mfma_f32_16x16x32_bf16 v[16:19], v[204:207], a[112:115], v[16:19]
    v_mfma_f32_16x16x32_bf16 v[20:23], v[200:203], a[100:103], v[20:23]
    buffer_load_dwordx4 v246, s[44:47], s57 offen offset:2048 lds
    v_mfma_f32_16x16x32_bf16 v[20:23], v[204:207], a[116:119], v[20:23]
    v_mfma_f32_16x16x32_bf16 v[24:27], v[200:203], a[104:107], v[24:27]
    ds_read_b64_tr_b16 v[192:193], v228 offset:16384
    v_mfma_f32_16x16x32_bf16 v[24:27], v[204:207], a[120:123], v[24:27]
    ds_read_b64_tr_b16 v[194:195], v228 offset:17408
    buffer_load_dwordx4 v247, s[44:47], s57 offen offset:3072 lds
    v_mfma_f32_16x16x32_bf16 v[28:31], v[200:203], a[108:111], v[28:31]
    s_add_u32 s60, s61, 5
    ds_read_b64_tr_b16 v[196:197], v228 offset:24576
    v_mfma_f32_16x16x32_bf16 v[28:31], v[204:207], a[124:127], v[28:31]
    s_waitcnt lgkmcnt(5)
    s_and_b32 s60, s60, 7
    ds_read_b64_tr_b16 v[198:199], v228 offset:25600
    v_mfma_f32_16x16x32_bf16 v[32:35], v[208:211], a[96:99], v[32:35]
    s_lshl_b32 s60, s60, 19
    v_mfma_f32_16x16x32_bf16 v[32:35], v[212:215], a[112:115], v[32:35]
    s_add_u32 m0, s55, 0
    v_mfma_f32_16x16x32_bf16 v[36:39], v[208:211], a[100:103], v[36:39]
    s_add_u32 s57, s59, s60
    buffer_load_dwordx4 v244, s[44:47], s57 offen offset:0 lds
    v_mfma_f32_16x16x32_bf16 v[36:39], v[212:215], a[116:119], v[36:39]
    v_mfma_f32_16x16x32_bf16 v[40:43], v[208:211], a[104:107], v[40:43]
    ds_read_b64_tr_b16 v[200:201], v229 offset:16384
    buffer_load_dwordx4 v245, s[44:47], s57 offen offset:1024 lds
    v_mfma_f32_16x16x32_bf16 v[40:43], v[212:215], a[120:123], v[40:43]
    ds_read_b64_tr_b16 v[202:203], v229 offset:17408
    v_mfma_f32_16x16x32_bf16 v[44:47], v[208:211], a[108:111], v[44:47]
    ds_read_b64_tr_b16 v[204:205], v229 offset:24576
    v_mfma_f32_16x16x32_bf16 v[44:47], v[212:215], a[124:127], v[44:47]
    ds_read_b64_tr_b16 v[206:207], v229 offset:25600
    v_mfma_f32_16x16x32_bf16 v[48:51], v[216:219], a[96:99], v[48:51]
    s_waitcnt lgkmcnt(4)
    buffer_load_dwordx4 v246, s[44:47], s57 offen offset:2048 lds
    v_mfma_f32_16x16x32_bf16 v[48:51], v[220:223], a[112:115], v[48:51]
    v_mfma_f32_16x16x32_bf16 v[52:55], v[216:219], a[100:103], v[52:55]
    v_mfma_f32_16x16x32_bf16 v[52:55], v[220:223], a[116:119], v[52:55]
    v_mfma_f32_16x16x32_bf16 v[56:59], v[216:219], a[104:107], v[56:59]
    ds_read_b64_tr_b16 v[208:209], v230 offset:16384
    buffer_load_dwordx4 v247, s[44:47], s57 offen offset:3072 lds
    v_mfma_f32_16x16x32_bf16 v[56:59], v[220:223], a[120:123], v[56:59]
    s_add_u32 s60, s61, 6
    ds_read_b64_tr_b16 v[210:211], v230 offset:17408
    v_mfma_f32_16x16x32_bf16 v[60:63], v[216:219], a[108:111], v[60:63]
    s_and_b32 s60, s60, 7
    ds_read_b64_tr_b16 v[212:213], v230 offset:24576
    v_mfma_f32_16x16x32_bf16 v[60:63], v[220:223], a[124:127], v[60:63]
    s_lshl_b32 s60, s60, 19
    ds_read_b64_tr_b16 v[214:215], v230 offset:25600
    v_mfma_f32_16x16x32_bf16 v[64:67], v[192:195], a[96:99], v[64:67]
    s_add_u32 m0, s55, 16384
    v_mfma_f32_16x16x32_bf16 v[64:67], v[196:199], a[112:115], v[64:67]
    s_add_u32 s57, s59, s60
    buffer_load_dwordx4 v244, s[44:47], s57 offen offset:0 lds
    v_mfma_f32_16x16x32_bf16 v[68:71], v[192:195], a[100:103], v[68:71]
    v_mfma_f32_16x16x32_bf16 v[68:71], v[196:199], a[116:119], v[68:71]
    buffer_load_dwordx4 v245, s[44:47], s57 offen offset:1024 lds
    v_mfma_f32_16x16x32_bf16 v[72:75], v[192:195], a[104:107], v[72:75]
    ds_read_b64_tr_b16 v[216:217], v231 offset:16384
    v_mfma_f32_16x16x32_bf16 v[72:75], v[196:199], a[120:123], v[72:75]
    ds_read_b64_tr_b16 v[218:219], v231 offset:17408
    v_mfma_f32_16x16x32_bf16 v[76:79], v[192:195], a[108:111], v[76:79]
    ds_read_b64_tr_b16 v[220:221], v231 offset:24576
    buffer_load_dwordx4 v246, s[44:47], s57 offen offset:2048 lds
    v_mfma_f32_16x16x32_bf16 v[76:79], v[196:199], a[124:127], v[76:79]
    s_waitcnt lgkmcnt(5)
    ds_read_b64_tr_b16 v[222:223], v231 offset:25600
    v_mfma_f32_16x16x32_bf16 v[80:83], v[200:203], a[96:99], v[80:83]
    v_mfma_f32_16x16x32_bf16 v[80:83], v[204:207], a[112:115], v[80:83]
    v_mfma_f32_16x16x32_bf16 v[84:87], v[200:203], a[100:103], v[84:87]
    buffer_load_dwordx4 v247, s[44:47], s57 offen offset:3072 lds
    v_mfma_f32_16x16x32_bf16 v[84:87], v[204:207], a[116:119], v[84:87]
    v_mfma_f32_16x16x32_bf16 v[88:91], v[200:203], a[104:107], v[88:91]
    v_mfma_f32_16x16x32_bf16 v[88:91], v[204:207], a[120:123], v[88:91]
    v_mfma_f32_16x16x32_bf16 v[92:95], v[200:203], a[108:111], v[92:95]
    v_mfma_f32_16x16x32_bf16 v[92:95], v[204:207], a[124:127], v[92:95]
    v_mfma_f32_16x16x32_bf16 v[96:99], v[208:211], a[96:99], v[96:99]
    s_waitcnt vmcnt(17)
    s_waitcnt lgkmcnt(0)
    s_barrier
    v_subrev_u32 v224, 98304, v224
    v_subrev_u32 v225, 98304, v225
    v_subrev_u32 v226, 98304, v226
    v_subrev_u32 v227, 98304, v227
    v_add_u32 v228, 0x10000, v224
    v_add_u32 v229, 0x10000, v225
    v_add_u32 v230, 0x10000, v226
    v_add_u32 v231, 0x10000, v227
    v_add_u32 v232, 0x20000, v224
    v_add_u32 v233, 0x20000, v225
    v_add_u32 v234, 0x20000, v226
    v_add_u32 v235, 0x20000, v227
    ds_read_b64_tr_b16 v[192:193], v232 offset:0
    v_mfma_f32_16x16x32_bf16 v[96:99], v[212:215], a[112:115], v[96:99]
    s_add_u32 s60, s61, 7
    ds_read_b64_tr_b16 v[194:195], v232 offset:1024
    v_mfma_f32_16x16x32_bf16 v[100:103], v[208:211], a[100:103], v[100:103]
    s_and_b32 s60, s60, 7
    ds_read_b64_tr_b16 v[196:197], v232 offset:8192
    v_mfma_f32_16x16x32_bf16 v[100:103], v[212:215], a[116:119], v[100:103]
    s_lshl_b32 s60, s60, 19
    ds_read_b64_tr_b16 v[198:199], v232 offset:9216
    v_mfma_f32_16x16x32_bf16 v[104:107], v[208:211], a[104:107], v[104:107]
    s_add_u32 m0, s55, 114688
    ds_read_b64_tr_b16 v[200:201], v233 offset:0
    v_mfma_f32_16x16x32_bf16 v[104:107], v[212:215], a[120:123], v[104:107]
    s_add_u32 s57, s59, s60
    ds_read_b64_tr_b16 v[202:203], v233 offset:1024
    buffer_load_dwordx4 v244, s[44:47], s57 offen offset:0 lds
    v_mfma_f32_16x16x32_bf16 v[108:111], v[208:211], a[108:111], v[108:111]
    ds_read_b64_tr_b16 v[204:205], v233 offset:8192
    buffer_load_dwordx4 v245, s[44:47], s57 offen offset:1024 lds
    v_mfma_f32_16x16x32_bf16 v[108:111], v[212:215], a[124:127], v[108:111]
    ds_read_b64_tr_b16 v[206:207], v233 offset:9216
    v_mfma_f32_16x16x32_bf16 v[112:115], v[216:219], a[96:99], v[112:115]
    v_mfma_f32_16x16x32_bf16 v[112:115], v[220:223], a[112:115], v[112:115]
    v_mfma_f32_16x16x32_bf16 v[116:119], v[216:219], a[100:103], v[116:119]
    v_mfma_f32_16x16x32_bf16 v[116:119], v[220:223], a[116:119], v[116:119]
    v_mfma_f32_16x16x32_bf16 v[120:123], v[216:219], a[104:107], v[120:123]
    ds_read_b64_tr_b16 v[208:209], v234 offset:0
    buffer_load_dwordx4 v246, s[44:47], s57 offen offset:2048 lds
    v_mfma_f32_16x16x32_bf16 v[120:123], v[220:223], a[120:123], v[120:123]
    ds_read_b64_tr_b16 v[210:211], v234 offset:1024
    v_mfma_f32_16x16x32_bf16 v[124:127], v[216:219], a[108:111], v[124:127]
    ds_read_b64_tr_b16 v[212:213], v234 offset:8192
    v_mfma_f32_16x16x32_bf16 v[124:127], v[220:223], a[124:127], v[124:127]
    s_waitcnt lgkmcnt(5)
    ds_read_b64_tr_b16 v[214:215], v234 offset:9216
    v_mfma_f32_16x16x32_bf16 v[128:131], a[128:131], v[192:195], 0
    v_mfma_f32_16x16x32_bf16 v[128:131], a[144:147], v[196:199], v[128:131]
    v_mfma_f32_16x16x32_bf16 v[132:135], a[132:135], v[192:195], 0
    buffer_load_dwordx4 v247, s[44:47], s57 offen offset:3072 lds
    v_mfma_f32_16x16x32_bf16 v[132:135], a[148:151], v[196:199], v[132:135]
    v_mfma_f32_16x16x32_bf16 v[136:139], a[136:139], v[192:195], 0
    ds_read_b64_tr_b16 v[216:217], v235 offset:0
    v_mfma_f32_16x16x32_bf16 v[136:139], a[152:155], v[196:199], v[136:139]
    ds_read_b64_tr_b16 v[218:219], v235 offset:1024
    v_mfma_f32_16x16x32_bf16 v[140:143], a[140:143], v[192:195], 0
    ds_read_b64_tr_b16 v[220:221], v235 offset:8192
    v_mfma_f32_16x16x32_bf16 v[140:143], a[156:159], v[196:199], v[140:143]
    ds_read_b64_tr_b16 v[222:223], v235 offset:9216
    v_mfma_f32_16x16x32_bf16 v[144:147], a[128:131], v[200:203], 0
    s_waitcnt lgkmcnt(4)
    s_getpc_b64 s[100:101]
F_cp1:
    s_lshr_b32 s16, s2, 3
    s_lshl_b32 s16, s16, 9
    s_add_u32 s16, s16, F_mA2-F_cp1
    v_and_b32 v250, 0, v249
    v_lshl_add_u32 v250, v250, 14, s16
    s_lshl_b32 s16, s52, 7
    v_add_u32 v250, s16, v250
    v_min_u32 v250, F_end-F_cp1, v250
    v_mov_b32 v251, s101
    v_add_co_u32 v250, vcc, s100, v250
    s_nop 1
    v_addc_co_u32 v251, vcc, 0, v251, vcc
    global_load_dword v255, v[250:251], off
    v_mfma_f32_16x16x32_bf16 v[144:147], a[144:147], v[204:207], v[144:147]
    v_mfma_f32_16x16x32_bf16 v[148:151], a[132:135], v[200:203], 0
    v_mul_f32 v64, s67, v64
    v_mul_f32 v65, s67, v65
    v_mfma_f32_16x16x32_bf16 v[148:151], a[148:151], v[204:207], v[148:151]
    v_mul_f32 v66, s67, v66
    v_mul_f32 v67, s67, v67
    v_mfma_f32_16x16x32_bf16 v[152:155], a[136:139], v[200:203], 0
    ds_read_b64_tr_b16 v[192:193], v228 offset:0
    v_mul_f32 v80, s67, v80
    v_mfma_f32_16x16x32_bf16 v[152:155], a[152:155], v[204:207], v[152:155]
    ds_read_b64_tr_b16 v[194:195], v228 offset:1024
    v_mul_f32 v81, s67, v81
    v_mfma_f32_16x16x32_bf16 v[156:159], a[140:143], v[200:203], 0
    ds_read_b64_tr_b16 v[196:197], v228 offset:8192
    v_mul_f32 v82, s67, v82
    v_mfma_f32_16x16x32_bf16 v[156:159], a[156:159], v[204:207], v[156:159]
    ds_read_b64_tr_b16 v[198:199], v228 offset:9216
    v_mul_f32 v83, s67, v83
    v_mfma_f32_16x16x32_bf16 v[160:163], a[128:131], v[208:211], 0
    v_cvt_pk_bf16_f32 v64, v64, v65
    v_cvt_pk_bf16_f32 v65, v66, v67
    v_mfma_f32_16x16x32_bf16 v[160:163], a[144:147], v[212:215], v[160:163]
    v_cvt_pk_bf16_f32 v66, v80, v81
    v_cvt_pk_bf16_f32 v67, v82, v83
    v_mfma_f32_16x16x32_bf16 v[164:167], a[132:135], v[208:211], 0
    v_mul_f32 v68, s67, v68
    v_mul_f32 v69, s67, v69
    v_mfma_f32_16x16x32_bf16 v[164:167], a[148:151], v[212:215], v[164:167]
    v_mul_f32 v70, s67, v70
    v_mul_f32 v71, s67, v71
    v_mfma_f32_16x16x32_bf16 v[168:171], a[136:139], v[208:211], 0
    ds_read_b64_tr_b16 v[200:201], v229 offset:0
    v_mul_f32 v84, s67, v84
    v_mfma_f32_16x16x32_bf16 v[168:171], a[152:155], v[212:215], v[168:171]
    ds_read_b64_tr_b16 v[202:203], v229 offset:1024
    v_mul_f32 v85, s67, v85
    v_mfma_f32_16x16x32_bf16 v[172:175], a[140:143], v[208:211], 0
    ds_read_b64_tr_b16 v[204:205], v229 offset:8192
    v_mul_f32 v86, s67, v86
    v_mfma_f32_16x16x32_bf16 v[172:175], a[156:159], v[212:215], v[172:175]
    s_waitcnt lgkmcnt(5)
    ds_read_b64_tr_b16 v[206:207], v229 offset:9216
    v_mul_f32 v87, s67, v87
    v_mfma_f32_16x16x32_bf16 v[176:179], a[128:131], v[216:219], 0
    v_cvt_pk_bf16_f32 v68, v68, v69
    v_cvt_pk_bf16_f32 v69, v70, v71
    v_mfma_f32_16x16x32_bf16 v[176:179], a[144:147], v[220:223], v[176:179]
    v_cvt_pk_bf16_f32 v70, v84, v85
    v_cvt_pk_bf16_f32 v71, v86, v87
    v_mfma_f32_16x16x32_bf16 v[180:183], a[132:135], v[216:219], 0
    v_mul_f32 v72, s67, v72
    v_mul_f32 v73, s67, v73
    v_mfma_f32_16x16x32_bf16 v[180:183], a[148:151], v[220:223], v[180:183]
    v_mul_f32 v74, s67, v74
    v_mul_f32 v75, s67, v75
    v_mfma_f32_16x16x32_bf16 v[184:187], a[136:139], v[216:219], 0
    ds_read_b64_tr_b16 v[208:209], v230 offset:0
    v_mul_f32 v88, s67, v88
    v_mfma_f32_16x16x32_bf16 v[184:187], a[152:155], v[220:223], v[184:187]
    ds_read_b64_tr_b16 v[210:211], v230 offset:1024
    v_mul_f32 v89, s67, v89
    v_mfma_f32_16x16x32_bf16 v[188:191], a[140:143], v[216:219], 0
    s_add_u32 s19, s64, 0
    ds_read_b64_tr_b16 v[212:213], v230 offset:8192
    buffer_store_dwordx4 v[64:67], v248, s[32:35], s19 offen offset:2048 sc1
    v_mul_f32 v90, s67, v90
    v_mfma_f32_16x16x32_bf16 v[188:191], a[156:159], v[220:223], v[188:191]
    ds_read_b64_tr_b16 v[214:215], v230 offset:9216
    v_mul_f32 v91, s67, v91
    v_mfma_f32_16x16x32_bf16 v[128:131], a[0:3], v[192:195], v[128:131]
    s_waitcnt lgkmcnt(4)
    v_cvt_pk_bf16_f32 v72, v72, v73
    v_cvt_pk_bf16_f32 v73, v74, v75
    v_mfma_f32_16x16x32_bf16 v[128:131], a[16:19], v[196:199], v[128:131]
    v_cvt_pk_bf16_f32 v74, v88, v89
    v_cvt_pk_bf16_f32 v75, v90, v91
    v_mfma_f32_16x16x32_bf16 v[132:135], a[4:7], v[192:195], v[132:135]
    v_mul_f32 v76, s67, v76
    v_mul_f32 v77, s67, v77
    v_mfma_f32_16x16x32_bf16 v[132:135], a[20:23], v[196:199], v[132:135]
    v_mul_f32 v78, s67, v78
    v_mul_f32 v79, s67, v79
    v_mfma_f32_16x16x32_bf16 v[136:139], a[8:11], v[192:195], v[136:139]
    ds_read_b64_tr_b16 v[216:217], v231 offset:0
    v_mul_f32 v92, s67, v92
    v_mfma_f32_16x16x32_bf16 v[136:139], a[24:27], v[196:199], v[136:139]
    ds_read_b64_tr_b16 v[218:219], v231 offset:1024
    v_mul_f32 v93, s67, v93
    v_mfma_f32_16x16x32_bf16 v[140:143], a[12:15], v[192:195], v[140:143]
    ds_read_b64_tr_b16 v[220:221], v231 offset:8192
    v_mul_f32 v94, s67, v94
    v_mfma_f32_16x16x32_bf16 v[140:143], a[28:31], v[196:199], v[140:143]
    ds_read_b64_tr_b16 v[222:223], v231 offset:9216
    v_mul_f32 v95, s67, v95
    v_mfma_f32_16x16x32_bf16 v[144:147], a[0:3], v[200:203], v[144:147]
    v_cvt_pk_bf16_f32 v76, v76, v77
    v_cvt_pk_bf16_f32 v77, v78, v79
    v_mfma_f32_16x16x32_bf16 v[144:147], a[16:19], v[204:207], v[144:147]
    v_cvt_pk_bf16_f32 v78, v92, v93
    v_cvt_pk_bf16_f32 v79, v94, v95
    v_mfma_f32_16x16x32_bf16 v[148:151], a[4:7], v[200:203], v[148:151]
    v_mul_f32 v96, s67, v96
    v_mul_f32 v97, s67, v97
    v_mfma_f32_16x16x32_bf16 v[148:151], a[20:23], v[204:207], v[148:151]
    v_mul_f32 v98, s67, v98
    v_mul_f32 v99, s67, v99
    v_mfma_f32_16x16x32_bf16 v[152:155], a[8:11], v[200:203], v[152:155]
    s_add_u32 s19, s64, 4096
    ds_read_b64_tr_b16 v[192:193], v228 offset:16384
    buffer_store_dwordx4 v[68:71], v248, s[32:35], s19 offen offset:2048 sc1
    v_mul_f32 v112, s67, v112
    v_mfma_f32_16x16x32_bf16 v[152:155], a[24:27], v[204:207], v[152:155]
    ds_read_b64_tr_b16 v[194:195], v228 offset:17408
    v_mul_f32 v113, s67, v113
    v_mfma_f32_16x16x32_bf16 v[156:159], a[12:15], v[200:203], v[156:159]
    ds_read_b64_tr_b16 v[196:197], v228 offset:24576
    v_mul_f32 v114, s67, v114
    v_mfma_f32_16x16x32_bf16 v[156:159], a[28:31], v[204:207], v[156:159]
    s_waitcnt lgkmcnt(5)
    ds_read_b64_tr_b16 v[198:199], v228 offset:25600
    v_mul_f32 v115, s67, v115
    v_mfma_f32_16x16x32_bf16 v[160:163], a[0:3], v[208:211], v[160:163]
    v_cvt_pk_bf16_f32 v96, v96, v97
    v_cvt_pk_bf16_f32 v97, v98, v99
    v_mfma_f32_16x16x32_bf16 v[160:163], a[16:19], v[212:215], v[160:163]
    v_cvt_pk_bf16_f32 v98, v112, v113
    v_cvt_pk_bf16_f32 v99, v114, v115
    v_mfma_f32_16x16x32_bf16 v[164:167], a[4:7], v[208:211], v[164:167]
    v_mul_f32 v100, s67, v100
    v_mul_f32 v101, s67, v101
    v_mfma_f32_16x16x32_bf16 v[164:167], a[20:23], v[212:215], v[164:167]
    v_mul_f32 v102, s67, v102
    v_mul_f32 v103, s67, v103
    v_mfma_f32_16x16x32_bf16 v[168:171], a[8:11], v[208:211], v[168:171]
    ds_read_b64_tr_b16 v[200:201], v229 offset:16384
    v_mul_f32 v116, s67, v116
    v_mfma_f32_16x16x32_bf16 v[168:171], a[24:27], v[212:215], v[168:171]
    ds_read_b64_tr_b16 v[202:203], v229 offset:17408
    v_mul_f32 v117, s67, v117
    v_mfma_f32_16x16x32_bf16 v[172:175], a[12:15], v[208:211], v[172:175]
    ds_read_b64_tr_b16 v[204:205], v229 offset:24576
    v_mul_f32 v118, s67, v118
    v_mfma_f32_16x16x32_bf16 v[172:175], a[28:31], v[212:215], v[172:175]
    ds_read_b64_tr_b16 v[206:207], v229 offset:25600
    v_mul_f32 v119, s67, v119
    v_mfma_f32_16x16x32_bf16 v[176:179], a[0:3], v[216:219], v[176:179]
    s_waitcnt lgkmcnt(4)
    v_cvt_pk_bf16_f32 v100, v100, v101
    v_cvt_pk_bf16_f32 v101, v102, v103
    v_mfma_f32_16x16x32_bf16 v[176:179], a[16:19], v[220:223], v[176:179]
    v_cvt_pk_bf16_f32 v102, v116, v117
    v_cvt_pk_bf16_f32 v103, v118, v119
    v_mfma_f32_16x16x32_bf16 v[180:183], a[4:7], v[216:219], v[180:183]
    v_mul_f32 v104, s67, v104
    v_mul_f32 v105, s67, v105
    v_mfma_f32_16x16x32_bf16 v[180:183], a[20:23], v[220:223], v[180:183]
    s_add_u32 s19, s64, 8192
    buffer_store_dwordx4 v[72:75], v248, s[32:35], s19 offen offset:2048 sc1
    v_mul_f32 v106, s67, v106
    v_mul_f32 v107, s67, v107
    v_mfma_f32_16x16x32_bf16 v[184:187], a[8:11], v[216:219], v[184:187]
    ds_read_b64_tr_b16 v[208:209], v230 offset:16384
    v_mul_f32 v120, s67, v120
    v_mfma_f32_16x16x32_bf16 v[184:187], a[24:27], v[220:223], v[184:187]
    ds_read_b64_tr_b16 v[210:211], v230 offset:17408
    v_mul_f32 v121, s67, v121
    v_mfma_f32_16x16x32_bf16 v[188:191], a[12:15], v[216:219], v[188:191]
    ds_read_b64_tr_b16 v[212:213], v230 offset:24576
    v_mul_f32 v122, s67, v122
    v_mfma_f32_16x16x32_bf16 v[188:191], a[28:31], v[220:223], v[188:191]
    ds_read_b64_tr_b16 v[214:215], v230 offset:25600
    v_mul_f32 v123, s67, v123
    v_mfma_f32_16x16x32_bf16 v[128:131], a[32:35], v[192:195], v[128:131]
    v_cvt_pk_bf16_f32 v104, v104, v105
    v_cvt_pk_bf16_f32 v105, v106, v107
    v_mfma_f32_16x16x32_bf16 v[128:131], a[48:51], v[196:199], v[128:131]
    v_cvt_pk_bf16_f32 v106, v120, v121
    v_cvt_pk_bf16_f32 v107, v122, v123
    v_mfma_f32_16x16x32_bf16 v[132:135], a[36:39], v[192:195], v[132:135]
    v_mul_f32 v108, s67, v108
    v_mul_f32 v109, s67, v109
    v_mfma_f32_16x16x32_bf16 v[132:135], a[52:55], v[196:199], v[132:135]
    v_mul_f32 v110, s67, v110
    v_mul_f32 v111, s67, v111
    v_mfma_f32_16x16x32_bf16 v[136:139], a[40:43], v[192:195], v[136:139]
    ds_read_b64_tr_b16 v[216:217], v231 offset:16384
    v_mul_f32 v124, s67, v124
    v_mfma_f32_16x16x32_bf16 v[136:139], a[56:59], v[196:199], v[136:139]
    ds_read_b64_tr_b16 v[218:219], v231 offset:17408
    v_mul_f32 v125, s67, v125
    v_mfma_f32_16x16x32_bf16 v[140:143], a[44:47], v[192:195], v[140:143]
    ds_read_b64_tr_b16 v[220:221], v231 offset:24576
    v_mul_f32 v126, s67, v126
    v_mfma_f32_16x16x32_bf16 v[140:143], a[60:63], v[196:199], v[140:143]
    s_waitcnt lgkmcnt(5)
    ds_read_b64_tr_b16 v[222:223], v231 offset:25600
    v_mul_f32 v127, s67, v127
    v_mfma_f32_16x16x32_bf16 v[144:147], a[32:35], v[200:203], v[144:147]
    v_cvt_pk_bf16_f32 v108, v108, v109
    v_cvt_pk_bf16_f32 v109, v110, v111
    v_mfma_f32_16x16x32_bf16 v[144:147], a[48:51], v[204:207], v[144:147]
    v_cvt_pk_bf16_f32 v110, v124, v125
    v_cvt_pk_bf16_f32 v111, v126, v127
    v_mfma_f32_16x16x32_bf16 v[148:151], a[36:39], v[200:203], v[148:151]
    s_add_u32 s19, s64, 12288
    buffer_store_dwordx4 v[76:79], v248, s[32:35], s19 offen offset:2048 sc1
    v_mul_f32 v0, s67, v0
    v_mul_f32 v1, s67, v1
    v_mfma_f32_16x16x32_bf16 v[148:151], a[52:55], v[204:207], v[148:151]
    v_mul_f32 v2, s67, v2
    v_mul_f32 v3, s67, v3
    v_mfma_f32_16x16x32_bf16 v[152:155], a[40:43], v[200:203], v[152:155]
    v_mul_f32 v16, s67, v16
    v_mul_f32 v17, s67, v17
    v_mfma_f32_16x16x32_bf16 v[152:155], a[56:59], v[204:207], v[152:155]
    v_mul_f32 v18, s67, v18
    v_mul_f32 v19, s67, v19
    v_mfma_f32_16x16x32_bf16 v[156:159], a[44:47], v[200:203], v[156:159]
    v_cvt_pk_bf16_f32 v80, v0, v1
    v_cvt_pk_bf16_f32 v81, v2, v3
    v_mfma_f32_16x16x32_bf16 v[156:159], a[60:63], v[204:207], v[156:159]
    v_cvt_pk_bf16_f32 v82, v16, v17
    v_cvt_pk_bf16_f32 v83, v18, v19
    v_mfma_f32_16x16x32_bf16 v[160:163], a[32:35], v[208:211], v[160:163]
    s_waitcnt vmcnt(9)
    s_waitcnt lgkmcnt(0)
    s_barrier
    ds_read_b64_tr_b16 v[192:193], v232 offset:16384
    v_mul_f32 v4, s67, v4
    v_mfma_f32_16x16x32_bf16 v[160:163], a[48:51], v[212:215], v[160:163]
    ds_read_b64_tr_b16 v[194:195], v232 offset:17408
    v_mul_f32 v5, s67, v5
    v_mfma_f32_16x16x32_bf16 v[164:167], a[36:39], v[208:211], v[164:167]
    ds_read_b64_tr_b16 v[196:197], v232 offset:24576
    v_mul_f32 v6, s67, v6
    v_mfma_f32_16x16x32_bf16 v[164:167], a[52:55], v[212:215], v[164:167]
    ds_read_b64_tr_b16 v[198:199], v232 offset:25600
    v_mul_f32 v7, s67, v7
    v_mfma_f32_16x16x32_bf16 v[168:171], a[40:43], v[208:211], v[168:171]
    ds_read_b64_tr_b16 v[200:201], v233 offset:16384
    v_mul_f32 v20, s67, v20
    v_mfma_f32_16x16x32_bf16 v[168:171], a[56:59], v[212:215], v[168:171]
    ds_read_b64_tr_b16 v[202:203], v233 offset:17408
    v_mul_f32 v21, s67, v21
    v_mfma_f32_16x16x32_bf16 v[172:175], a[44:47], v[208:211], v[172:175]
    ds_read_b64_tr_b16 v[204:205], v233 offset:24576
    v_mul_f32 v22, s67, v22
    v_mfma_f32_16x16x32_bf16 v[172:175], a[60:63], v[212:215], v[172:175]
    ds_read_b64_tr_b16 v[206:207], v233 offset:25600
    v_mul_f32 v23, s67, v23
    v_mfma_f32_16x16x32_bf16 v[176:179], a[32:35], v[216:219], v[176:179]
    v_cvt_pk_bf16_f32 v84, v4, v5
    v_cvt_pk_bf16_f32 v85, v6, v7
    v_mfma_f32_16x16x32_bf16 v[176:179], a[48:51], v[220:223], v[176:179]
    s_add_u32 s19, s64, 0
    buffer_store_dwordx4 v[96:99], v248, s[32:35], s19 offen offset:3072 sc1
    v_cvt_pk_bf16_f32 v86, v20, v21
    v_cvt_pk_bf16_f32 v87, v22, v23
    v_mfma_f32_16x16x32_bf16 v[180:183], a[36:39], v[216:219], v[180:183]
    v_mul_f32 v8, s67, v8
    v_mul_f32 v9, s67, v9
    v_mfma_f32_16x16x32_bf16 v[180:183], a[52:55], v[220:223], v[180:183]
    v_mul_f32 v10, s67, v10
    v_mul_f32 v11, s67, v11
    v_mfma_f32_16x16x32_bf16 v[184:187], a[40:43], v[216:219], v[184:187]
    ds_read_b64_tr_b16 v[208:209], v234 offset:16384
    v_mul_f32 v24, s67, v24
    v_mfma_f32_16x16x32_bf16 v[184:187], a[56:59], v[220:223], v[184:187]
    ds_read_b64_tr_b16 v[210:211], v234 offset:17408
    v_mul_f32 v25, s67, v25
    v_mfma_f32_16x16x32_bf16 v[188:191], a[44:47], v[216:219], v[188:191]
    ds_read_b64_tr_b16 v[212:213], v234 offset:24576
    v_mul_f32 v26, s67, v26
    v_mfma_f32_16x16x32_bf16 v[188:191], a[60:63], v[220:223], v[188:191]
    s_waitcnt lgkmcnt(5)
    ds_read_b64_tr_b16 v[214:215], v234 offset:25600
    v_mul_f32 v27, s67, v27
    v_mfma_f32_16x16x32_bf16 v[128:131], a[160:163], v[192:195], v[128:131]
    v_cvt_pk_bf16_f32 v88, v8, v9
    v_cvt_pk_bf16_f32 v89, v10, v11
    v_mfma_f32_16x16x32_bf16 v[128:131], a[176:179], v[196:199], v[128:131]
    v_cvt_pk_bf16_f32 v90, v24, v25
    v_cvt_pk_bf16_f32 v91, v26, v27
    v_mfma_f32_16x16x32_bf16 v[132:135], a[164:167], v[192:195], v[132:135]
    v_mul_f32 v12, s67, v12
    v_mul_f32 v13, s67, v13
    v_mfma_f32_16x16x32_bf16 v[132:135], a[180:183], v[196:199], v[132:135]
    v_mul_f32 v14, s67, v14
    v_mul_f32 v15, s67, v15
    v_mfma_f32_16x16x32_bf16 v[136:139], a[168:171], v[192:195], v[136:139]
    ds_read_b64_tr_b16 v[216:217], v235 offset:16384
    v_mul_f32 v28, s67, v28
    v_mfma_f32_16x16x32_bf16 v[136:139], a[184:187], v[196:199], v[136:139]
    ds_read_b64_tr_b16 v[218:219], v235 offset:17408
    v_mul_f32 v29, s67, v29
    v_mfma_f32_16x16x32_bf16 v[140:143], a[172:175], v[192:195], v[140:143]
    ds_read_b64_tr_b16 v[220:221], v235 offset:24576
    v_mul_f32 v30, s67, v30
    v_mfma_f32_16x16x32_bf16 v[140:143], a[188:191], v[196:199], v[140:143]
    s_add_u32 s19, s64, 4096
    ds_read_b64_tr_b16 v[222:223], v235 offset:25600
    buffer_store_dwordx4 v[100:103], v248, s[32:35], s19 offen offset:3072 sc1
    v_mul_f32 v31, s67, v31
    v_mfma_f32_16x16x32_bf16 v[144:147], a[160:163], v[200:203], v[144:147]
    s_waitcnt lgkmcnt(4)
    v_cvt_pk_bf16_f32 v92, v12, v13
    v_cvt_pk_bf16_f32 v93, v14, v15
    v_mfma_f32_16x16x32_bf16 v[144:147], a[176:179], v[204:207], v[144:147]
    v_cvt_pk_bf16_f32 v94, v28, v29
    v_cvt_pk_bf16_f32 v95, v30, v31
    v_mfma_f32_16x16x32_bf16 v[148:151], a[164:167], v[200:203], v[148:151]
    v_mul_f32 v32, s67, v32
    v_mul_f32 v33, s67, v33
    v_mfma_f32_16x16x32_bf16 v[148:151], a[180:183], v[204:207], v[148:151]
    v_mul_f32 v34, s67, v34
    v_mul_f32 v35, s67, v35
    v_mfma_f32_16x16x32_bf16 v[152:155], a[168:171], v[200:203], v[152:155]
    ds_read_b64_tr_b16 v[192:193], v228 offset:32768
    v_mul_f32 v48, s67, v48
    v_mfma_f32_16x16x32_bf16 v[152:155], a[184:187], v[204:207], v[152:155]
    ds_read_b64_tr_b16 v[194:195], v228 offset:33792
    v_mul_f32 v49, s67, v49
    v_mfma_f32_16x16x32_bf16 v[156:159], a[172:175], v[200:203], v[156:159]
    ds_read_b64_tr_b16 v[196:197], v228 offset:40960
    v_mul_f32 v50, s67, v50
    v_mfma_f32_16x16x32_bf16 v[156:159], a[188:191], v[204:207], v[156:159]
    ds_read_b64_tr_b16 v[198:199], v228 offset:41984
    v_mul_f32 v51, s67, v51
    v_mfma_f32_16x16x32_bf16 v[160:163], a[160:163], v[208:211], v[160:163]
    v_cvt_pk_bf16_f32 v112, v32, v33
    v_cvt_pk_bf16_f32 v113, v34, v35
    v_mfma_f32_16x16x32_bf16 v[160:163], a[176:179], v[212:215], v[160:163]
    v_cvt_pk_bf16_f32 v114, v48, v49
    v_cvt_pk_bf16_f32 v115, v50, v51
    v_mfma_f32_16x16x32_bf16 v[164:167], a[164:167], v[208:211], v[164:167]
    v_mul_f32 v36, s67, v36
    v_mul_f32 v37, s67, v37
    v_mfma_f32_16x16x32_bf16 v[164:167], a[180:183], v[212:215], v[164:167]
    v_mul_f32 v38, s67, v38
    v_mul_f32 v39, s67, v39
    v_mfma_f32_16x16x32_bf16 v[168:171], a[168:171], v[208:211], v[168:171]
    ds_read_b64_tr_b16 v[200:201], v229 offset:32768
    v_mul_f32 v52, s67, v52
    v_mfma_f32_16x16x32_bf16 v[168:171], a[184:187], v[212:215], v[168:171]
    ds_read_b64_tr_b16 v[202:203], v229 offset:33792
    v_mul_f32 v53, s67, v53
    v_mfma_f32_16x16x32_bf16 v[172:175], a[172:175], v[208:211], v[172:175]
    s_add_u32 s19, s64, 8192
    ds_read_b64_tr_b16 v[204:205], v229 offset:40960
    buffer_store_dwordx4 v[104:107], v248, s[32:35], s19 offen offset:3072 sc1
    v_mul_f32 v54, s67, v54
    v_mfma_f32_16x16x32_bf16 v[172:175], a[188:191], v[212:215], v[172:175]
    s_waitcnt lgkmcnt(5)
    ds_read_b64_tr_b16 v[206:207], v229 offset:41984
    v_mul_f32 v55, s67, v55
    v_mfma_f32_16x16x32_bf16 v[176:179], a[160:163], v[216:219], v[176:179]
    v_cvt_pk_bf16_f32 v116, v36, v37
    v_cvt_pk_bf16_f32 v117, v38, v39
    v_mfma_f32_16x16x32_bf16 v[176:179], a[176:179], v[220:223], v[176:179]
    v_cvt_pk_bf16_f32 v118, v52, v53
    v_cvt_pk_bf16_f32 v119, v54, v55
    v_mfma_f32_16x16x32_bf16 v[180:183], a[164:167], v[216:219], v[180:183]
    v_mul_f32 v40, s67, v40
    v_mul_f32 v41, s67, v41
    v_mfma_f32_16x16x32_bf16 v[180:183], a[180:183], v[220:223], v[180:183]
    v_mul_f32 v42, s67, v42
    v_mul_f32 v43, s67, v43
    v_mfma_f32_16x16x32_bf16 v[184:187], a[168:171], v[216:219], v[184:187]
    ds_read_b64_tr_b16 v[208:209], v230 offset:32768
    v_mul_f32 v56, s67, v56
    v_mfma_f32_16x16x32_bf16 v[184:187], a[184:187], v[220:223], v[184:187]
    ds_read_b64_tr_b16 v[210:211], v230 offset:33792
    v_mul_f32 v57, s67, v57
    v_mfma_f32_16x16x32_bf16 v[188:191], a[172:175], v[216:219], v[188:191]
    ds_read_b64_tr_b16 v[212:213], v230 offset:40960
    v_mul_f32 v58, s67, v58
    v_mfma_f32_16x16x32_bf16 v[188:191], a[188:191], v[220:223], v[188:191]
    ds_read_b64_tr_b16 v[214:215], v230 offset:41984
    v_mul_f32 v59, s67, v59
    v_mfma_f32_16x16x32_bf16 v[128:131], a[64:67], v[192:195], v[128:131]
    s_waitcnt lgkmcnt(4)
    v_cvt_pk_bf16_f32 v120, v40, v41
    v_cvt_pk_bf16_f32 v121, v42, v43
    v_mfma_f32_16x16x32_bf16 v[128:131], a[80:83], v[196:199], v[128:131]
    v_cvt_pk_bf16_f32 v122, v56, v57
    v_cvt_pk_bf16_f32 v123, v58, v59
    v_mfma_f32_16x16x32_bf16 v[132:135], a[68:71], v[192:195], v[132:135]
    v_mul_f32 v44, s67, v44
    v_mul_f32 v45, s67, v45
    v_mfma_f32_16x16x32_bf16 v[132:135], a[84:87], v[196:199], v[132:135]
    v_mul_f32 v46, s67, v46
    v_mul_f32 v47, s67, v47
    v_mfma_f32_16x16x32_bf16 v[136:139], a[72:75], v[192:195], v[136:139]
    ds_read_b64_tr_b16 v[216:217], v231 offset:32768
    v_mul_f32 v60, s67, v60
    v_mfma_f32_16x16x32_bf16 v[136:139], a[88:91], v[196:199], v[136:139]
    s_add_u32 s19, s64, 12288
    ds_read_b64_tr_b16 v[218:219], v231 offset:33792
    buffer_store_dwordx4 v[108:111], v248, s[32:35], s19 offen offset:3072 sc1
    v_mul_f32 v61, s67, v61
    v_mfma_f32_16x16x32_bf16 v[140:143], a[76:79], v[192:195], v[140:143]
    ds_read_b64_tr_b16 v[220:221], v231 offset:40960
    v_mul_f32 v62, s67, v62
    v_mfma_f32_16x16x32_bf16 v[140:143], a[92:95], v[196:199], v[140:143]
    ds_read_b64_tr_b16 v[222:223], v231 offset:41984
    v_mul_f32 v63, s67, v63
    v_mfma_f32_16x16x32_bf16 v[144:147], a[64:67], v[200:203], v[144:147]
    v_cvt_pk_bf16_f32 v124, v44, v45
    v_cvt_pk_bf16_f32 v125, v46, v47
    v_mfma_f32_16x16x32_bf16 v[144:147], a[80:83], v[204:207], v[144:147]
    v_cvt_pk_bf16_f32 v126, v60, v61
    v_cvt_pk_bf16_f32 v127, v62, v63
    v_mfma_f32_16x16x32_bf16 v[148:151], a[68:71], v[200:203], v[148:151]
    v_mfma_f32_16x16x32_bf16 v[148:151], a[84:87], v[204:207], v[148:151]
    v_mfma_f32_16x16x32_bf16 v[152:155], a[72:75], v[200:203], v[152:155]
    ds_read_b64_tr_b16 v[192:193], v224 offset:0
    v_mfma_f32_16x16x32_bf16 v[152:155], a[88:91], v[204:207], v[152:155]
    ds_read_b64_tr_b16 v[194:195], v224 offset:1024
    v_mfma_f32_16x16x32_bf16 v[156:159], a[76:79], v[200:203], v[156:159]
    ds_read_b64_tr_b16 v[196:197], v224 offset:8192
    v_mfma_f32_16x16x32_bf16 v[156:159], a[92:95], v[204:207], v[156:159]
    s_waitcnt lgkmcnt(5)
    ds_read_b64_tr_b16 v[198:199], v224 offset:9216
    v_mfma_f32_16x16x32_bf16 v[160:163], a[64:67], v[208:211], v[160:163]
    v_mfma_f32_16x16x32_bf16 v[160:163], a[80:83], v[212:215], v[160:163]
    v_mfma_f32_16x16x32_bf16 v[164:167], a[68:71], v[208:211], v[164:167]
    v_mfma_f32_16x16x32_bf16 v[164:167], a[84:87], v[212:215], v[164:167]
    v_mfma_f32_16x16x32_bf16 v[168:171], a[72:75], v[208:211], v[168:171]
    s_add_u32 s19, s64, 0
    ds_read_b64_tr_b16 v[200:201], v225 offset:0
    buffer_store_dwordx4 v[80:83], v248, s[32:35], s19 offen offset:0 sc1
    v_mfma_f32_16x16x32_bf16 v[168:171], a[88:91], v[212:215], v[168:171]
    ds_read_b64_tr_b16 v[202:203], v225 offset:1024
    v_mfma_f32_16x16x32_bf16 v[172:175], a[76:79], v[208:211], v[172:175]
    ds_read_b64_tr_b16 v[204:205], v225 offset:8192
    v_mfma_f32_16x16x32_bf16 v[172:175], a[92:95], v[212:215], v[172:175]
    ds_read_b64_tr_b16 v[206:207], v225 offset:9216
    v_mfma_f32_16x16x32_bf16 v[176:179], a[64:67], v[216:219], v[176:179]
    s_waitcnt lgkmcnt(4)
    v_mfma_f32_16x16x32_bf16 v[176:179], a[80:83], v[220:223], v[176:179]
    v_mfma_f32_16x16x32_bf16 v[180:183], a[68:71], v[216:219], v[180:183]
    v_mfma_f32_16x16x32_bf16 v[180:183], a[84:87], v[220:223], v[180:183]
    v_mfma_f32_16x16x32_bf16 v[184:187], a[72:75], v[216:219], v[184:187]
    ds_read_b64_tr_b16 v[208:209], v226 offset:0
    v_mfma_f32_16x16x32_bf16 v[184:187], a[88:91], v[220:223], v[184:187]
    ds_read_b64_tr_b16 v[210:211], v226 offset:1024
    v_mfma_f32_16x16x32_bf16 v[188:191], a[76:79], v[216:219], v[188:191]
    ds_read_b64_tr_b16 v[212:213], v226 offset:8192
    v_mfma_f32_16x16x32_bf16 v[188:191], a[92:95], v[220:223], v[188:191]
    ds_read_b64_tr_b16 v[214:215], v226 offset:9216
    v_mfma_f32_16x16x32_bf16 v[128:131], a[192:195], v[192:195], v[128:131]
    v_mfma_f32_16x16x32_bf16 v[128:131], a[208:211], v[196:199], v[128:131]
    v_mfma_f32_16x16x32_bf16 v[132:135], a[196:199], v[192:195], v[132:135]
    s_add_u32 s19, s64, 4096
    buffer_store_dwordx4 v[84:87], v248, s[32:35], s19 offen offset:0 sc1
    v_mfma_f32_16x16x32_bf16 v[132:135], a[212:215], v[196:199], v[132:135]
    v_mfma_f32_16x16x32_bf16 v[136:139], a[200:203], v[192:195], v[136:139]
    ds_read_b64_tr_b16 v[216:217], v227 offset:0
    v_mfma_f32_16x16x32_bf16 v[136:139], a[216:219], v[196:199], v[136:139]
    ds_read_b64_tr_b16 v[218:219], v227 offset:1024
    v_mfma_f32_16x16x32_bf16 v[140:143], a[204:207], v[192:195], v[140:143]
    ds_read_b64_tr_b16 v[220:221], v227 offset:8192
    v_mfma_f32_16x16x32_bf16 v[140:143], a[220:223], v[196:199], v[140:143]
    s_waitcnt lgkmcnt(5)
    ds_read_b64_tr_b16 v[222:223], v227 offset:9216
    v_mfma_f32_16x16x32_bf16 v[144:147], a[192:195], v[200:203], v[144:147]
    v_mfma_f32_16x16x32_bf16 v[144:147], a[208:211], v[204:207], v[144:147]
    v_mfma_f32_16x16x32_bf16 v[148:151], a[196:199], v[200:203], v[148:151]
    v_mfma_f32_16x16x32_bf16 v[148:151], a[212:215], v[204:207], v[148:151]
    v_mfma_f32_16x16x32_bf16 v[152:155], a[200:203], v[200:203], v[152:155]
    ds_read_b64_tr_b16 v[192:193], v224 offset:16384
    v_mfma_f32_16x16x32_bf16 v[152:155], a[216:219], v[204:207], v[152:155]
    ds_read_b64_tr_b16 v[194:195], v224 offset:17408
    v_mfma_f32_16x16x32_bf16 v[156:159], a[204:207], v[200:203], v[156:159]
    ds_read_b64_tr_b16 v[196:197], v224 offset:24576
    v_mfma_f32_16x16x32_bf16 v[156:159], a[220:223], v[204:207], v[156:159]
    ds_read_b64_tr_b16 v[198:199], v224 offset:25600
    v_mfma_f32_16x16x32_bf16 v[160:163], a[192:195], v[208:211], v[160:163]
    s_waitcnt vmcnt(11)
    s_waitcnt lgkmcnt(0)
    s_barrier
    v_mfma_f32_16x16x32_bf16 v[160:163], a[208:211], v[212:215], v[160:163]
    s_add_u32 s19, s64, 8192
    buffer_store_dwordx4 v[88:91], v248, s[32:35], s19 offen offset:0 sc1
    v_mfma_f32_16x16x32_bf16 v[164:167], a[196:199], v[208:211], v[164:167]
    v_mfma_f32_16x16x32_bf16 v[164:167], a[212:215], v[212:215], v[164:167]
    v_mfma_f32_16x16x32_bf16 v[168:171], a[200:203], v[208:211], v[168:171]
    ds_read_b64_tr_b16 v[200:201], v225 offset:16384
    v_mfma_f32_16x16x32_bf16 v[168:171], a[216:219], v[212:215], v[168:171]
    ds_read_b64_tr_b16 v[202:203], v225 offset:17408
    v_mfma_f32_16x16x32_bf16 v[172:175], a[204:207], v[208:211], v[172:175]
    ds_read_b64_tr_b16 v[204:205], v225 offset:24576
    v_mfma_f32_16x16x32_bf16 v[172:175], a[220:223], v[212:215], v[172:175]
    ds_read_b64_tr_b16 v[206:207], v225 offset:25600
    v_mfma_f32_16x16x32_bf16 v[176:179], a[192:195], v[216:219], v[176:179]
    v_mfma_f32_16x16x32_bf16 v[176:179], a[208:211], v[220:223], v[176:179]
    v_mfma_f32_16x16x32_bf16 v[180:183], a[196:199], v[216:219], v[180:183]
    v_mfma_f32_16x16x32_bf16 v[180:183], a[212:215], v[220:223], v[180:183]
    v_mfma_f32_16x16x32_bf16 v[184:187], a[200:203], v[216:219], v[184:187]
    ds_read_b64_tr_b16 v[208:209], v226 offset:16384
    v_mfma_f32_16x16x32_bf16 v[184:187], a[216:219], v[220:223], v[184:187]
    ds_read_b64_tr_b16 v[210:211], v226 offset:17408
    v_mfma_f32_16x16x32_bf16 v[188:191], a[204:207], v[216:219], v[188:191]
    ds_read_b64_tr_b16 v[212:213], v226 offset:24576
    v_mfma_f32_16x16x32_bf16 v[188:191], a[220:223], v[220:223], v[188:191]
    s_waitcnt lgkmcnt(5)
    ds_read_b64_tr_b16 v[214:215], v226 offset:25600
    v_mfma_f32_16x16x32_bf16 v[128:131], a[224:227], v[192:195], v[128:131]
    s_lshl_b32 s69, s74, 7
    s_add_u32 s69, s69, 0x3c0000
    s_add_u32 s19, s64, 12288
    buffer_store_dwordx4 v[92:95], v248, s[32:35], s19 offen offset:0 sc1
    v_and_b32 v253, 1, v249
    v_mfma_f32_16x16x32_bf16 v[128:131], a[240:243], v[196:199], v[128:131]
    v_lshl_add_u32 v253, v253, 4, s69
    v_mfma_f32_16x16x32_bf16 v[132:135], a[228:231], v[192:195], v[132:135]
    buffer_load_dwordx4 v[236:239], v253, s[32:35], 0 offen sc1
    v_mfma_f32_16x16x32_bf16 v[132:135], a[244:247], v[196:199], v[132:135]
    v_mfma_f32_16x16x32_bf16 v[136:139], a[232:235], v[192:195], v[136:139]
    ds_read_b64_tr_b16 v[216:217], v227 offset:16384
    v_mfma_f32_16x16x32_bf16 v[136:139], a[248:251], v[196:199], v[136:139]
    ds_read_b64_tr_b16 v[218:219], v227 offset:17408
    v_mfma_f32_16x16x32_bf16 v[140:143], a[236:239], v[192:195], v[140:143]
    ds_read_b64_tr_b16 v[220:221], v227 offset:24576
    v_mfma_f32_16x16x32_bf16 v[140:143], a[252:255], v[196:199], v[140:143]
    ds_read_b64_tr_b16 v[222:223], v227 offset:25600
    v_mfma_f32_16x16x32_bf16 v[144:147], a[224:227], v[200:203], v[144:147]
    s_waitcnt lgkmcnt(4)
    v_mfma_f32_16x16x32_bf16 v[144:147], a[240:243], v[204:207], v[144:147]
    v_mfma_f32_16x16x32_bf16 v[148:151], a[228:231], v[200:203], v[148:151]
    v_mfma_f32_16x16x32_bf16 v[148:151], a[244:247], v[204:207], v[148:151]
    v_mfma_f32_16x16x32_bf16 v[152:155], a[232:235], v[200:203], v[152:155]
    ds_read_b64_tr_b16 v[192:193], v228 offset:49152
    v_mfma_f32_16x16x32_bf16 v[152:155], a[248:251], v[204:207], v[152:155]
    ds_read_b64_tr_b16 v[194:195], v228 offset:50176
    v_mfma_f32_16x16x32_bf16 v[156:159], a[236:239], v[200:203], v[156:159]
    ds_read_b64_tr_b16 v[196:197], v228 offset:57344
    v_mfma_f32_16x16x32_bf16 v[156:159], a[252:255], v[204:207], v[156:159]
    ds_read_b64_tr_b16 v[198:199], v228 offset:58368
    v_mfma_f32_16x16x32_bf16 v[160:163], a[224:227], v[208:211], v[160:163]
    s_add_u32 s19, s64, 0
    buffer_store_dwordx4 v[112:115], v248, s[32:35], s19 offen offset:1024 sc1
    v_mfma_f32_16x16x32_bf16 v[160:163], a[240:243], v[212:215], v[160:163]
    v_mfma_f32_16x16x32_bf16 v[164:167], a[228:231], v[208:211], v[164:167]
    v_mfma_f32_16x16x32_bf16 v[164:167], a[244:247], v[212:215], v[164:167]
    v_mfma_f32_16x16x32_bf16 v[168:171], a[232:235], v[208:211], v[168:171]
    ds_read_b64_tr_b16 v[200:201], v229 offset:49152
    v_mfma_f32_16x16x32_bf16 v[168:171], a[248:251], v[212:215], v[168:171]
    ds_read_b64_tr_b16 v[202:203], v229 offset:50176
    v_mfma_f32_16x16x32_bf16 v[172:175], a[236:239], v[208:211], v[172:175]
    ds_read_b64_tr_b16 v[204:205], v229 offset:57344
    v_mfma_f32_16x16x32_bf16 v[172:175], a[252:255], v[212:215], v[172:175]
    s_waitcnt lgkmcnt(5)
    ds_read_b64_tr_b16 v[206:207], v229 offset:58368
    v_mfma_f32_16x16x32_bf16 v[176:179], a[224:227], v[216:219], v[176:179]
    v_mfma_f32_16x16x32_bf16 v[176:179], a[240:243], v[220:223], v[176:179]
    v_mfma_f32_16x16x32_bf16 v[180:183], a[228:231], v[216:219], v[180:183]
    v_mfma_f32_16x16x32_bf16 v[180:183], a[244:247], v[220:223], v[180:183]
    v_mfma_f32_16x16x32_bf16 v[184:187], a[232:235], v[216:219], v[184:187]
    ds_read_b64_tr_b16 v[208:209], v230 offset:49152
    v_mfma_f32_16x16x32_bf16 v[184:187], a[248:251], v[220:223], v[184:187]
    s_add_u32 s19, s64, 4096
    ds_read_b64_tr_b16 v[210:211], v230 offset:50176
    buffer_store_dwordx4 v[116:119], v248, s[32:35], s19 offen offset:1024 sc1
    v_mfma_f32_16x16x32_bf16 v[188:191], a[236:239], v[216:219], v[188:191]
    ds_read_b64_tr_b16 v[212:213], v230 offset:57344
    v_mfma_f32_16x16x32_bf16 v[188:191], a[252:255], v[220:223], v[188:191]
    ds_read_b64_tr_b16 v[214:215], v230 offset:58368
    v_mfma_f32_16x16x32_bf16 v[128:131], a[96:99], v[192:195], v[128:131]
    s_waitcnt lgkmcnt(4)
    v_mfma_f32_16x16x32_bf16 v[128:131], a[112:115], v[196:199], v[128:131]
    v_mfma_f32_16x16x32_bf16 v[132:135], a[100:103], v[192:195], v[132:135]
    v_mfma_f32_16x16x32_bf16 v[132:135], a[116:119], v[196:199], v[132:135]
    v_mfma_f32_16x16x32_bf16 v[136:139], a[104:107], v[192:195], v[136:139]
    ds_read_b64_tr_b16 v[216:217], v231 offset:49152
    v_mfma_f32_16x16x32_bf16 v[136:139], a[120:123], v[196:199], v[136:139]
    ds_read_b64_tr_b16 v[218:219], v231 offset:50176
    v_mfma_f32_16x16x32_bf16 v[140:143], a[108:111], v[192:195], v[140:143]
    ds_read_b64_tr_b16 v[220:221], v231 offset:57344
    v_mfma_f32_16x16x32_bf16 v[140:143], a[124:127], v[196:199], v[140:143]
    ds_read_b64_tr_b16 v[222:223], v231 offset:58368
    v_mfma_f32_16x16x32_bf16 v[144:147], a[96:99], v[200:203], v[144:147]
    v_mfma_f32_16x16x32_bf16 v[144:147], a[112:115], v[204:207], v[144:147]
    v_mfma_f32_16x16x32_bf16 v[148:151], a[100:103], v[200:203], v[148:151]
    v_xor_b32 v224, 128, v224
    v_xor_b32 v225, 128, v225
    v_xor_b32 v226, 128, v226
    v_xor_b32 v227, 128, v227
    v_xor_b32 v228, 128, v228
    v_xor_b32 v229, 128, v229
    v_xor_b32 v230, 128, v230
    v_xor_b32 v231, 128, v231
    v_xor_b32 v232, 128, v232
    v_xor_b32 v233, 128, v233
    v_xor_b32 v234, 128, v234
    v_xor_b32 v235, 128, v235
    v_mfma_f32_16x16x32_bf16 v[148:151], a[116:119], v[204:207], v[148:151]
    v_mfma_f32_16x16x32_bf16 v[152:155], a[104:107], v[200:203], v[152:155]
    s_add_u32 s19, s64, 8192
    ds_read_b64_tr_b16 v[192:193], v228 offset:0
    buffer_store_dwordx4 v[120:123], v248, s[32:35], s19 offen offset:1024 sc1
    v_mfma_f32_16x16x32_bf16 v[152:155], a[120:123], v[204:207], v[152:155]
    ds_read_b64_tr_b16 v[194:195], v228 offset:1024
    v_mfma_f32_16x16x32_bf16 v[156:159], a[108:111], v[200:203], v[156:159]
    ds_read_b64_tr_b16 v[196:197], v228 offset:8192
    v_mfma_f32_16x16x32_bf16 v[156:159], a[124:127], v[204:207], v[156:159]
    s_waitcnt lgkmcnt(5)
    ds_read_b64_tr_b16 v[198:199], v228 offset:9216
    v_mfma_f32_16x16x32_bf16 v[160:163], a[96:99], v[208:211], v[160:163]
    v_mfma_f32_16x16x32_bf16 v[160:163], a[112:115], v[212:215], v[160:163]
    v_mfma_f32_16x16x32_bf16 v[164:167], a[100:103], v[208:211], v[164:167]
    v_mfma_f32_16x16x32_bf16 v[164:167], a[116:119], v[212:215], v[164:167]
    v_mfma_f32_16x16x32_bf16 v[168:171], a[104:107], v[208:211], v[168:171]
    ds_read_b64_tr_b16 v[200:201], v229 offset:0
    v_mfma_f32_16x16x32_bf16 v[168:171], a[120:123], v[212:215], v[168:171]
    ds_read_b64_tr_b16 v[202:203], v229 offset:1024
    v_mfma_f32_16x16x32_bf16 v[172:175], a[108:111], v[208:211], v[172:175]
    ds_read_b64_tr_b16 v[204:205], v229 offset:8192
    v_mfma_f32_16x16x32_bf16 v[172:175], a[124:127], v[212:215], v[172:175]
    ds_read_b64_tr_b16 v[206:207], v229 offset:9216
    v_mfma_f32_16x16x32_bf16 v[176:179], a[96:99], v[216:219], v[176:179]
    s_waitcnt lgkmcnt(4)
    v_mfma_f32_16x16x32_bf16 v[176:179], a[112:115], v[220:223], v[176:179]
    v_mfma_f32_16x16x32_bf16 v[180:183], a[100:103], v[216:219], v[180:183]
    v_mfma_f32_16x16x32_bf16 v[180:183], a[116:119], v[220:223], v[180:183]
    s_add_u32 s19, s64, 12288
    buffer_store_dwordx4 v[124:127], v248, s[32:35], s19 offen offset:1024 sc1
    v_mfma_f32_16x16x32_bf16 v[184:187], a[104:107], v[216:219], v[184:187]
    ds_read_b64_tr_b16 v[208:209], v230 offset:0
    v_mfma_f32_16x16x32_bf16 v[184:187], a[120:123], v[220:223], v[184:187]
    ds_read_b64_tr_b16 v[210:211], v230 offset:1024
    v_mfma_f32_16x16x32_bf16 v[188:191], a[108:111], v[216:219], v[188:191]
    ds_read_b64_tr_b16 v[212:213], v230 offset:8192
    v_mfma_f32_16x16x32_bf16 v[188:191], a[124:127], v[220:223], v[188:191]
    ds_read_b64_tr_b16 v[214:215], v230 offset:9216
F_mA2:
    v_mfma_f32_16x16x32_bf16 v[0:3], a[0:3], v[192:195], 0
    v_mfma_f32_16x16x32_bf16 v[0:3], a[16:19], v[196:199], v[0:3]
    v_mfma_f32_16x16x32_bf16 v[4:7], a[4:7], v[192:195], 0
    s_waitcnt vmcnt(4)
    s_mov_b32 s16, 100000
F_pl2:
    v_xor_b32 v236, s94, v236
    v_xor_b32 v237, s94, v237
    v_xor_b32 v238, s94, v238
    v_xor_b32 v239, s94, v239
    v_or3_b32 v236, v236, v237, v238
    v_or_b32 v236, v236, v239
    v_cmp_ne_u32 vcc, 0, v236
    s_nop 4
    s_cbranch_vccz F_pd2
    s_sleep 8
    buffer_load_dwordx4 v[236:239], v253, s[32:35], 0 offen sc1
    s_sub_u32 s16, s16, 1
    s_waitcnt vmcnt(0)
    s_cbranch_scc0 F_pl2
F_pd2:
    v_mfma_f32_16x16x32_bf16 v[4:7], a[20:23], v[196:199], v[4:7]
    v_mfma_f32_16x16x32_bf16 v[8:11], a[8:11], v[192:195], 0
    s_add_u32 m0, s55, 32768
    ds_read_b64_tr_b16 v[216:217], v231 offset:0
    v_mfma_f32_16x16x32_bf16 v[8:11], a[24:27], v[196:199], v[8:11]
    s_add_u32 s57, s2, 0
    ds_read_b64_tr_b16 v[218:219], v231 offset:1024
    v_mfma_f32_16x16x32_bf16 v[12:15], a[12:15], v[192:195], 0
    s_and_b32 s57, s57, 7
    ds_read_b64_tr_b16 v[220:221], v231 offset:8192
    v_mfma_f32_16x16x32_bf16 v[12:15], a[28:31], v[196:199], v[12:15]
    s_waitcnt lgkmcnt(5)
    s_lshl_b32 s57, s57, 19
    ds_read_b64_tr_b16 v[222:223], v231 offset:9216
    v_mfma_f32_16x16x32_bf16 v[16:19], a[0:3], v[200:203], 0
    s_add_u32 s57, s57, s59
    buffer_load_dwordx4 v244, s[36:39], s57 offen offset:0 lds
    v_cvt_pk_bf16_f32 v128, v128, v129
    v_cvt_pk_bf16_f32 v129, v130, v131
    v_mfma_f32_16x16x32_bf16 v[16:19], a[16:19], v[204:207], v[16:19]
    v_cvt_pk_bf16_f32 v130, v132, v133
    v_cvt_pk_bf16_f32 v131, v134, v135
    v_mfma_f32_16x16x32_bf16 v[20:23], a[4:7], v[200:203], 0
    buffer_load_dwordx4 v245, s[36:39], s57 offen offset:1024 lds
    v_cvt_pk_bf16_f32 v136, v136, v137
    v_cvt_pk_bf16_f32 v137, v138, v139
    v_mfma_f32_16x16x32_bf16 v[20:23], a[20:23], v[204:207], v[20:23]
    v_cvt_pk_bf16_f32 v138, v140, v141
    v_cvt_pk_bf16_f32 v139, v142, v143
    v_mfma_f32_16x16x32_bf16 v[24:27], a[8:11], v[200:203], 0
    ds_read_b64_tr_b16 v[192:193], v228 offset:16384
    v_cvt_pk_bf16_f32 v144, v144, v145
    v_mfma_f32_16x16x32_bf16 v[24:27], a[24:27], v[204:207], v[24:27]
    ds_read_b64_tr_b16 v[194:195], v228 offset:17408
    v_cvt_pk_bf16_f32 v145, v146, v147
    v_mfma_f32_16x16x32_bf16 v[28:31], a[12:15], v[200:203], 0
    ds_read_b64_tr_b16 v[196:197], v228 offset:24576
    v_cvt_pk_bf16_f32 v146, v148, v149
    v_mfma_f32_16x16x32_bf16 v[28:31], a[28:31], v[204:207], v[28:31]
    ds_read_b64_tr_b16 v[198:199], v228 offset:25600
    v_cvt_pk_bf16_f32 v147, v150, v151
    v_mfma_f32_16x16x32_bf16 v[32:35], a[0:3], v[208:211], 0
    s_waitcnt lgkmcnt(4)
    buffer_load_dwordx4 v246, s[36:39], s57 offen offset:2048 lds
    v_cvt_pk_bf16_f32 v152, v152, v153
    v_cvt_pk_bf16_f32 v153, v154, v155
    v_mfma_f32_16x16x32_bf16 v[32:35], a[16:19], v[212:215], v[32:35]
    v_cvt_pk_bf16_f32 v154, v156, v157
    v_cvt_pk_bf16_f32 v155, v158, v159
    v_mfma_f32_16x16x32_bf16 v[36:39], a[4:7], v[208:211], 0
    v_cvt_pk_bf16_f32 v160, v160, v161
    v_cvt_pk_bf16_f32 v161, v162, v163
    v_mfma_f32_16x16x32_bf16 v[36:39], a[20:23], v[212:215], v[36:39]
    v_cvt_pk_bf16_f32 v162, v164, v165
    v_cvt_pk_bf16_f32 v163, v166, v167
    v_mfma_f32_16x16x32_bf16 v[40:43], a[8:11], v[208:211], 0
    ds_read_b64_tr_b16 v[200:201], v229 offset:16384
    v_cvt_pk_bf16_f32 v168, v168, v169
    v_mfma_f32_16x16x32_bf16 v[40:43], a[24:27], v[212:215], v[40:43]
    ds_read_b64_tr_b16 v[202:203], v229 offset:17408
    v_cvt_pk_bf16_f32 v169, v170, v171
    v_mfma_f32_16x16x32_bf16 v[44:47], a[12:15], v[208:211], 0
    ds_read_b64_tr_b16 v[204:205], v229 offset:24576
    buffer_load_dwordx4 v247, s[36:39], s57 offen offset:3072 lds
    v_cvt_pk_bf16_f32 v170, v172, v173
    v_mfma_f32_16x16x32_bf16 v[44:47], a[28:31], v[212:215], v[44:47]
    ds_read_b64_tr_b16 v[206:207], v229 offset:25600
    v_cvt_pk_bf16_f32 v171, v174, v175
    v_mfma_f32_16x16x32_bf16 v[48:51], a[0:3], v[216:219], 0
    v_cvt_pk_bf16_f32 v176, v176, v177
    v_cvt_pk_bf16_f32 v177, v178, v179
    v_mfma_f32_16x16x32_bf16 v[48:51], a[16:19], v[220:223], v[48:51]
    v_cvt_pk_bf16_f32 v178, v180, v181
    v_cvt_pk_bf16_f32 v179, v182, v183
    v_mfma_f32_16x16x32_bf16 v[52:55], a[4:7], v[216:219], 0
    v_cvt_pk_bf16_f32 v184, v184, v185
    v_cvt_pk_bf16_f32 v185, v186, v187
    v_mfma_f32_16x16x32_bf16 v[52:55], a[20:23], v[220:223], v[52:55]
    v_cvt_pk_bf16_f32 v186, v188, v189
    v_cvt_pk_bf16_f32 v187, v190, v191
    v_mfma_f32_16x16x32_bf16 v[56:59], a[8:11], v[216:219], 0
    ds_read_b64_tr_b16 v[208:209], v230 offset:16384
    v_mfma_f32_16x16x32_bf16 v[56:59], a[24:27], v[220:223], v[56:59]
    ds_read_b64_tr_b16 v[210:211], v230 offset:17408
    v_mfma_f32_16x16x32_bf16 v[60:63], a[12:15], v[216:219], 0
    ds_read_b64_tr_b16 v[212:213], v230 offset:24576
    v_mfma_f32_16x16x32_bf16 v[60:63], a[28:31], v[220:223], v[60:63]
    s_waitcnt lgkmcnt(5)
    ds_read_b64_tr_b16 v[214:215], v230 offset:25600
    v_mfma_f32_16x16x32_bf16 v[0:3], a[32:35], v[192:195], v[0:3]
    s_add_u32 s56, s2, 0
    v_mfma_f32_16x16x32_bf16 v[0:3], a[48:51], v[196:199], v[0:3]
    s_and_b32 s56, s56, 7
    v_mfma_f32_16x16x32_bf16 v[4:7], a[36:39], v[192:195], v[4:7]
    s_lshl_b32 s56, s56, 13
    v_mfma_f32_16x16x32_bf16 v[4:7], a[52:55], v[196:199], v[4:7]
    s_add_u32 s56, s56, s73
    buffer_load_dwordx4 a[0:3], v248, s[32:35], s56 offen offset:0 sc1
    v_mfma_f32_16x16x32_bf16 v[8:11], a[40:43], v[192:195], v[8:11]
    ds_read_b64_tr_b16 v[216:217], v231 offset:16384
    v_mfma_f32_16x16x32_bf16 v[8:11], a[56:59], v[196:199], v[8:11]
    ds_read_b64_tr_b16 v[218:219], v231 offset:17408
    buffer_load_dwordx4 a[4:7], v248, s[32:35], s56 offen offset:1024 sc1
    v_mfma_f32_16x16x32_bf16 v[12:15], a[44:47], v[192:195], v[12:15]
    ds_read_b64_tr_b16 v[220:221], v231 offset:24576
    v_mfma_f32_16x16x32_bf16 v[12:15], a[60:63], v[196:199], v[12:15]
    ds_read_b64_tr_b16 v[222:223], v231 offset:25600
    v_mfma_f32_16x16x32_bf16 v[16:19], a[32:35], v[200:203], v[16:19]
    s_waitcnt lgkmcnt(4)
    s_add_u32 s19, s18, 0
    buffer_store_dwordx4 v[128:131], v248, s[32:35], s19 offen offset:0 sc1
    v_mfma_f32_16x16x32_bf16 v[16:19], a[48:51], v[204:207], v[16:19]
    v_mfma_f32_16x16x32_bf16 v[20:23], a[36:39], v[200:203], v[20:23]
    buffer_load_dwordx4 a[8:11], v248, s[32:35], s56 offen offset:2048 sc1
    v_mfma_f32_16x16x32_bf16 v[20:23], a[52:55], v[204:207], v[20:23]
    v_mfma_f32_16x16x32_bf16 v[24:27], a[40:43], v[200:203], v[24:27]
    ds_read_b64_tr_b16 v[192:193], v228 offset:32768
    v_mfma_f32_16x16x32_bf16 v[24:27], a[56:59], v[204:207], v[24:27]
    ds_read_b64_tr_b16 v[194:195], v228 offset:33792
    v_mfma_f32_16x16x32_bf16 v[28:31], a[44:47], v[200:203], v[28:31]
    ds_read_b64_tr_b16 v[196:197], v228 offset:40960
    v_mfma_f32_16x16x32_bf16 v[28:31], a[60:63], v[204:207], v[28:31]
    ds_read_b64_tr_b16 v[198:199], v228 offset:41984
    v_mfma_f32_16x16x32_bf16 v[32:35], a[32:35], v[208:211], v[32:35]
    buffer_load_dwordx4 a[12:15], v248, s[32:35], s56 offen offset:3072 sc1
    v_mfma_f32_16x16x32_bf16 v[32:35], a[48:51], v[212:215], v[32:35]
    v_mfma_f32_16x16x32_bf16 v[36:39], a[36:39], v[208:211], v[36:39]
    v_mfma_f32_16x16x32_bf16 v[36:39], a[52:55], v[212:215], v[36:39]
    v_mfma_f32_16x16x32_bf16 v[40:43], a[40:43], v[208:211], v[40:43]
    ds_read_b64_tr_b16 v[200:201], v229 offset:32768
    v_mfma_f32_16x16x32_bf16 v[40:43], a[56:59], v[212:215], v[40:43]
    s_add_u32 s56, s2, 0
    ds_read_b64_tr_b16 v[202:203], v229 offset:33792
    v_mfma_f32_16x16x32_bf16 v[44:47], a[44:47], v[208:211], v[44:47]
    s_and_b32 s56, s56, 7
    ds_read_b64_tr_b16 v[204:205], v229 offset:40960
    v_mfma_f32_16x16x32_bf16 v[44:47], a[60:63], v[212:215], v[44:47]
    s_waitcnt lgkmcnt(5)
    s_lshl_b32 s56, s56, 13
    ds_read_b64_tr_b16 v[206:207], v229 offset:41984
    v_mfma_f32_16x16x32_bf16 v[48:51], a[32:35], v[216:219], v[48:51]
    s_add_u32 s56, s56, s73
    v_mfma_f32_16x16x32_bf16 v[48:51], a[48:51], v[220:223], v[48:51]
    s_add_u32 s56, s56, 4096
    buffer_load_dwordx4 a[16:19], v248, s[32:35], s56 offen offset:0 sc1
    v_mfma_f32_16x16x32_bf16 v[52:55], a[36:39], v[216:219], v[52:55]
    v_mfma_f32_16x16x32_bf16 v[52:55], a[52:55], v[220:223], v[52:55]
    buffer_load_dwordx4 a[20:23], v248, s[32:35], s56 offen offset:1024 sc1
    v_mfma_f32_16x16x32_bf16 v[56:59], a[40:43], v[216:219], v[56:59]
    s_barrier
    ds_read_b64_tr_b16 v[208:209], v230 offset:32768
    v_mfma_f32_16x16x32_bf16 v[56:59], a[56:59], v[220:223], v[56:59]
    ds_read_b64_tr_b16 v[210:211], v230 offset:33792
    v_mfma_f32_16x16x32_bf16 v[60:63], a[44:47], v[216:219], v[60:63]
    ds_read_b64_tr_b16 v[212:213], v230 offset:40960
    v_mfma_f32_16x16x32_bf16 v[60:63], a[60:63], v[220:223], v[60:63]
    ds_read_b64_tr_b16 v[214:215], v230 offset:41984
    v_mfma_f32_16x16x32_bf16 v[0:3], a[64:67], v[192:195], v[0:3]
    s_waitcnt lgkmcnt(4)
    v_mfma_f32_16x16x32_bf16 v[0:3], a[80:83], v[196:199], v[0:3]
    buffer_load_dwordx4 a[24:27], v248, s[32:35], s56 offen offset:2048 sc1
    v_mfma_f32_16x16x32_bf16 v[4:7], a[68:71], v[192:195], v[4:7]
    v_mfma_f32_16x16x32_bf16 v[4:7], a[84:87], v[196:199], v[4:7]
    s_add_u32 s19, s18, 8192
    buffer_store_dwordx4 v[136:139], v248, s[32:35], s19 offen offset:0 sc1
    v_mfma_f32_16x16x32_bf16 v[8:11], a[72:75], v[192:195], v[8:11]
    ds_read_b64_tr_b16 v[216:217], v231 offset:32768
    v_mfma_f32_16x16x32_bf16 v[8:11], a[88:91], v[196:199], v[8:11]
    ds_read_b64_tr_b16 v[218:219], v231 offset:33792
    v_mfma_f32_16x16x32_bf16 v[12:15], a[76:79], v[192:195], v[12:15]
    ds_read_b64_tr_b16 v[220:221], v231 offset:40960
    v_mfma_f32_16x16x32_bf16 v[12:15], a[92:95], v[196:199], v[12:15]
    ds_read_b64_tr_b16 v[222:223], v231 offset:41984
    v_mfma_f32_16x16x32_bf16 v[16:19], a[64:67], v[200:203], v[16:19]
    buffer_load_dwordx4 a[28:31], v248, s[32:35], s56 offen offset:3072 sc1
    v_mfma_f32_16x16x32_bf16 v[16:19], a[80:83], v[204:207], v[16:19]
    v_mfma_f32_16x16x32_bf16 v[20:23], a[68:71], v[200:203], v[20:23]
    v_mfma_f32_16x16x32_bf16 v[20:23], a[84:87], v[204:207], v[20:23]
    v_mfma_f32_16x16x32_bf16 v[24:27], a[72:75], v[200:203], v[24:27]
    ds_read_b64_tr_b16 v[192:193], v228 offset:49152
    v_mfma_f32_16x16x32_bf16 v[24:27], a[88:91], v[204:207], v[24:27]
    ds_read_b64_tr_b16 v[194:195], v228 offset:50176
    v_mfma_f32_16x16x32_bf16 v[28:31], a[76:79], v[200:203], v[28:31]
    s_add_u32 m0, s55, 49152
    ds_read_b64_tr_b16 v[196:197], v228 offset:57344
    v_mfma_f32_16x16x32_bf16 v[28:31], a[92:95], v[204:207], v[28:31]
    s_waitcnt lgkmcnt(5)
    s_add_u32 s57, s2, 1
    ds_read_b64_tr_b16 v[198:199], v228 offset:58368
    v_mfma_f32_16x16x32_bf16 v[32:35], a[64:67], v[208:211], v[32:35]
    s_and_b32 s57, s57, 7
    v_mfma_f32_16x16x32_bf16 v[32:35], a[80:83], v[212:215], v[32:35]
    s_lshl_b32 s57, s57, 19
    v_mfma_f32_16x16x32_bf16 v[36:39], a[68:71], v[208:211], v[36:39]
    s_add_u32 s57, s57, s59
    buffer_load_dwordx4 v244, s[36:39], s57 offen offset:0 lds
    v_mfma_f32_16x16x32_bf16 v[36:39], a[84:87], v[212:215], v[36:39]
    v_mfma_f32_16x16x32_bf16 v[40:43], a[72:75], v[208:211], v[40:43]
    ds_read_b64_tr_b16 v[200:201], v229 offset:49152
    buffer_load_dwordx4 v245, s[36:39], s57 offen offset:1024 lds
    v_mfma_f32_16x16x32_bf16 v[40:43], a[88:91], v[212:215], v[40:43]
    ds_read_b64_tr_b16 v[202:203], v229 offset:50176
    v_mfma_f32_16x16x32_bf16 v[44:47], a[76:79], v[208:211], v[44:47]
    ds_read_b64_tr_b16 v[204:205], v229 offset:57344
    v_mfma_f32_16x16x32_bf16 v[44:47], a[92:95], v[212:215], v[44:47]
    ds_read_b64_tr_b16 v[206:207], v229 offset:58368
    v_mfma_f32_16x16x32_bf16 v[48:51], a[64:67], v[216:219], v[48:51]
    s_waitcnt lgkmcnt(4)
    v_mfma_f32_16x16x32_bf16 v[48:51], a[80:83], v[220:223], v[48:51]
    v_mfma_f32_16x16x32_bf16 v[52:55], a[68:71], v[216:219], v[52:55]
    buffer_load_dwordx4 v246, s[36:39], s57 offen offset:2048 lds
    v_mfma_f32_16x16x32_bf16 v[52:55], a[84:87], v[220:223], v[52:55]
    v_mfma_f32_16x16x32_bf16 v[56:59], a[72:75], v[216:219], v[56:59]
    ds_read_b64_tr_b16 v[208:209], v230 offset:49152
    v_mfma_f32_16x16x32_bf16 v[56:59], a[88:91], v[220:223], v[56:59]
    ds_read_b64_tr_b16 v[210:211], v230 offset:50176
    v_mfma_f32_16x16x32_bf16 v[60:63], a[76:79], v[216:219], v[60:63]
    ds_read_b64_tr_b16 v[212:213], v230 offset:57344
    v_mfma_f32_16x16x32_bf16 v[60:63], a[92:95], v[220:223], v[60:63]
    s_add_u32 s19, s18, 0
    ds_read_b64_tr_b16 v[214:215], v230 offset:58368
    buffer_store_dwordx4 v[144:147], v248, s[32:35], s19 offen offset:1024 sc1
    v_mfma_f32_16x16x32_bf16 v[0:3], a[96:99], v[192:195], v[0:3]
    buffer_load_dwordx4 v247, s[36:39], s57 offen offset:3072 lds
    v_mfma_f32_16x16x32_bf16 v[0:3], a[112:115], v[196:199], v[0:3]
    v_mfma_f32_16x16x32_bf16 v[4:7], a[100:103], v[192:195], v[4:7]
    v_mfma_f32_16x16x32_bf16 v[4:7], a[116:119], v[196:199], v[4:7]
    v_mfma_f32_16x16x32_bf16 v[8:11], a[104:107], v[192:195], v[8:11]
    ds_read_b64_tr_b16 v[216:217], v231 offset:49152
    v_mfma_f32_16x16x32_bf16 v[8:11], a[120:123], v[196:199], v[8:11]
    ds_read_b64_tr_b16 v[218:219], v231 offset:50176
    v_mfma_f32_16x16x32_bf16 v[12:15], a[108:111], v[192:195], v[12:15]
    s_add_u32 s56, s2, 1
    ds_read_b64_tr_b16 v[220:221], v231 offset:57344
    v_mfma_f32_16x16x32_bf16 v[12:15], a[124:127], v[196:199], v[12:15]
    s_waitcnt lgkmcnt(5)
    s_and_b32 s56, s56, 7
    ds_read_b64_tr_b16 v[222:223], v231 offset:58368
    v_mfma_f32_16x16x32_bf16 v[16:19], a[96:99], v[200:203], v[16:19]
    s_lshl_b32 s56, s56, 13
    v_mfma_f32_16x16x32_bf16 v[16:19], a[112:115], v[204:207], v[16:19]
    s_add_u32 s56, s56, s73
    buffer_load_dwordx4 a[32:35], v248, s[32:35], s56 offen offset:0 sc1
    v_mfma_f32_16x16x32_bf16 v[20:23], a[100:103], v[200:203], v[20:23]
    v_mfma_f32_16x16x32_bf16 v[20:23], a[116:119], v[204:207], v[20:23]
    v_mfma_f32_16x16x32_bf16 v[24:27], a[104:107], v[200:203], v[24:27]
    ds_read_b64_tr_b16 v[192:193], v232 offset:0
    buffer_load_dwordx4 a[36:39], v248, s[32:35], s56 offen offset:1024 sc1
    v_mfma_f32_16x16x32_bf16 v[24:27], a[120:123], v[204:207], v[24:27]
    ds_read_b64_tr_b16 v[194:195], v232 offset:1024
    v_mfma_f32_16x16x32_bf16 v[28:31], a[108:111], v[200:203], v[28:31]
    ds_read_b64_tr_b16 v[196:197], v232 offset:8192
    v_mfma_f32_16x16x32_bf16 v[28:31], a[124:127], v[204:207], v[28:31]
    ds_read_b64_tr_b16 v[198:199], v232 offset:9216
    v_mfma_f32_16x16x32_bf16 v[32:35], a[96:99], v[208:211], v[32:35]
    s_waitcnt lgkmcnt(4)
    v_mfma_f32_16x16x32_bf16 v[32:35], a[112:115], v[212:215], v[32:35]
    v_mfma_f32_16x16x32_bf16 v[36:39], a[100:103], v[208:211], v[36:39]
    buffer_load_dwordx4 a[40:43], v248, s[32:35], s56 offen offset:2048 sc1
    v_mfma_f32_16x16x32_bf16 v[36:39], a[116:119], v[212:215], v[36:39]
    v_mfma_f32_16x16x32_bf16 v[40:43], a[104:107], v[208:211], v[40:43]
    ds_read_b64_tr_b16 v[200:201], v233 offset:0
    v_mfma_f32_16x16x32_bf16 v[40:43], a[120:123], v[212:215], v[40:43]
    ds_read_b64_tr_b16 v[202:203], v233 offset:1024
    v_mfma_f32_16x16x32_bf16 v[44:47], a[108:111], v[208:211], v[44:47]
    ds_read_b64_tr_b16 v[204:205], v233 offset:8192
    v_mfma_f32_16x16x32_bf16 v[44:47], a[124:127], v[212:215], v[44:47]
    ds_read_b64_tr_b16 v[206:207], v233 offset:9216
    v_mfma_f32_16x16x32_bf16 v[48:51], a[96:99], v[216:219], v[48:51]
    buffer_load_dwordx4 a[44:47], v248, s[32:35], s56 offen offset:3072 sc1
    v_mfma_f32_16x16x32_bf16 v[48:51], a[112:115], v[220:223], v[48:51]
    v_mfma_f32_16x16x32_bf16 v[52:55], a[100:103], v[216:219], v[52:55]
    s_add_u32 s19, s18, 8192
    buffer_store_dwordx4 v[152:155], v248, s[32:35], s19 offen offset:1024 sc1
    v_mfma_f32_16x16x32_bf16 v[52:55], a[116:119], v[220:223], v[52:55]
    v_mfma_f32_16x16x32_bf16 v[56:59], a[104:107], v[216:219], v[56:59]
    s_barrier
    ds_read_b64_tr_b16 v[208:209], v234 offset:0
    v_mfma_f32_16x16x32_bf16 v[56:59], a[120:123], v[220:223], v[56:59]
    ds_read_b64_tr_b16 v[210:211], v234 offset:1024
    v_mfma_f32_16x16x32_bf16 v[60:63], a[108:111], v[216:219], v[60:63]
    ds_read_b64_tr_b16 v[212:213], v234 offset:8192
    v_mfma_f32_16x16x32_bf16 v[60:63], a[124:127], v[220:223], v[60:63]
    s_waitcnt lgkmcnt(5)
    s_add_u32 s56, s2, 1
    ds_read_b64_tr_b16 v[214:215], v234 offset:9216
    v_mfma_f32_16x16x32_bf16 v[0:3], a[128:131], v[192:195], v[0:3]
    s_and_b32 s56, s56, 7
    v_mfma_f32_16x16x32_bf16 v[0:3], a[144:147], v[196:199], v[0:3]
    s_lshl_b32 s56, s56, 13
    v_mfma_f32_16x16x32_bf16 v[4:7], a[132:135], v[192:195], v[4:7]
    s_add_u32 s56, s56, s73
    v_mfma_f32_16x16x32_bf16 v[4:7], a[148:151], v[196:199], v[4:7]
    s_add_u32 s56, s56, 4096
    buffer_load_dwordx4 a[48:51], v248, s[32:35], s56 offen offset:0 sc1
    v_mfma_f32_16x16x32_bf16 v[8:11], a[136:139], v[192:195], v[8:11]
    ds_read_b64_tr_b16 v[216:217], v235 offset:0
    v_mfma_f32_16x16x32_bf16 v[8:11], a[152:155], v[196:199], v[8:11]
    ds_read_b64_tr_b16 v[218:219], v235 offset:1024
    buffer_load_dwordx4 a[52:55], v248, s[32:35], s56 offen offset:1024 sc1
    v_mfma_f32_16x16x32_bf16 v[12:15], a[140:143], v[192:195], v[12:15]
    ds_read_b64_tr_b16 v[220:221], v235 offset:8192
    v_mfma_f32_16x16x32_bf16 v[12:15], a[156:159], v[196:199], v[12:15]
    ds_read_b64_tr_b16 v[222:223], v235 offset:9216
    v_mfma_f32_16x16x32_bf16 v[16:19], a[128:131], v[200:203], v[16:19]
    s_waitcnt lgkmcnt(4)
    v_mfma_f32_16x16x32_bf16 v[16:19], a[144:147], v[204:207], v[16:19]
    v_mfma_f32_16x16x32_bf16 v[20:23], a[132:135], v[200:203], v[20:23]
    v_mfma_f32_16x16x32_bf16 v[20:23], a[148:151], v[204:207], v[20:23]
    buffer_load_dwordx4 a[56:59], v248, s[32:35], s56 offen offset:2048 sc1
    v_mfma_f32_16x16x32_bf16 v[24:27], a[136:139], v[200:203], v[24:27]
    ds_read_b64_tr_b16 v[192:193], v232 offset:16384
    v_mfma_f32_16x16x32_bf16 v[24:27], a[152:155], v[204:207], v[24:27]
    ds_read_b64_tr_b16 v[194:195], v232 offset:17408
    v_mfma_f32_16x16x32_bf16 v[28:31], a[140:143], v[200:203], v[28:31]
    ds_read_b64_tr_b16 v[196:197], v232 offset:24576
    v_mfma_f32_16x16x32_bf16 v[28:31], a[156:159], v[204:207], v[28:31]
    ds_read_b64_tr_b16 v[198:199], v232 offset:25600
    v_mfma_f32_16x16x32_bf16 v[32:35], a[128:131], v[208:211], v[32:35]
    v_mfma_f32_16x16x32_bf16 v[32:35], a[144:147], v[212:215], v[32:35]
    buffer_load_dwordx4 a[60:63], v248, s[32:35], s56 offen offset:3072 sc1
    v_mfma_f32_16x16x32_bf16 v[36:39], a[132:135], v[208:211], v[36:39]
    v_mfma_f32_16x16x32_bf16 v[36:39], a[148:151], v[212:215], v[36:39]
    v_mfma_f32_16x16x32_bf16 v[40:43], a[136:139], v[208:211], v[40:43]
    ds_read_b64_tr_b16 v[200:201], v233 offset:16384
    v_mfma_f32_16x16x32_bf16 v[40:43], a[152:155], v[212:215], v[40:43]
    ds_read_b64_tr_b16 v[202:203], v233 offset:17408
    v_mfma_f32_16x16x32_bf16 v[44:47], a[140:143], v[208:211], v[44:47]
    s_add_u32 s19, s18, 0
    ds_read_b64_tr_b16 v[204:205], v233 offset:24576
    buffer_store_dwordx4 v[160:163], v248, s[32:35], s19 offen offset:2048 sc1
    v_mfma_f32_16x16x32_bf16 v[44:47], a[156:159], v[212:215], v[44:47]
    s_waitcnt lgkmcnt(5)
    ds_read_b64_tr_b16 v[206:207], v233 offset:25600
    v_mfma_f32_16x16x32_bf16 v[48:51], a[128:131], v[216:219], v[48:51]
    s_add_u32 m0, s55, 65536
    v_mfma_f32_16x16x32_bf16 v[48:51], a[144:147], v[220:223], v[48:51]
    s_add_u32 s57, s2, 2
    v_mfma_f32_16x16x32_bf16 v[52:55], a[132:135], v[216:219], v[52:55]
    s_and_b32 s57, s57, 7
    v_mfma_f32_16x16x32_bf16 v[52:55], a[148:151], v[220:223], v[52:55]
    s_lshl_b32 s57, s57, 19
    v_mfma_f32_16x16x32_bf16 v[56:59], a[136:139], v[216:219], v[56:59]
    s_add_u32 s57, s57, s59
    ds_read_b64_tr_b16 v[208:209], v234 offset:16384
    buffer_load_dwordx4 v244, s[36:39], s57 offen offset:0 lds
    v_mfma_f32_16x16x32_bf16 v[56:59], a[152:155], v[220:223], v[56:59]
    ds_read_b64_tr_b16 v[210:211], v234 offset:17408
    v_mfma_f32_16x16x32_bf16 v[60:63], a[140:143], v[216:219], v[60:63]
    ds_read_b64_tr_b16 v[212:213], v234 offset:24576
    buffer_load_dwordx4 v245, s[36:39], s57 offen offset:1024 lds
    v_mfma_f32_16x16x32_bf16 v[60:63], a[156:159], v[220:223], v[60:63]
    ds_read_b64_tr_b16 v[214:215], v234 offset:25600
    v_mfma_f32_16x16x32_bf16 v[0:3], a[160:163], v[192:195], v[0:3]
    s_waitcnt lgkmcnt(4)
    v_mfma_f32_16x16x32_bf16 v[0:3], a[176:179], v[196:199], v[0:3]
    v_mfma_f32_16x16x32_bf16 v[4:7], a[164:167], v[192:195], v[4:7]
    v_mfma_f32_16x16x32_bf16 v[4:7], a[180:183], v[196:199], v[4:7]
    v_mfma_f32_16x16x32_bf16 v[8:11], a[168:171], v[192:195], v[8:11]
    ds_read_b64_tr_b16 v[216:217], v235 offset:16384
    buffer_load_dwordx4 v246, s[36:39], s57 offen offset:2048 lds
    v_mfma_f32_16x16x32_bf16 v[8:11], a[184:187], v[196:199], v[8:11]
    ds_read_b64_tr_b16 v[218:219], v235 offset:17408
    v_mfma_f32_16x16x32_bf16 v[12:15], a[172:175], v[192:195], v[12:15]
    ds_read_b64_tr_b16 v[220:221], v235 offset:24576
    v_mfma_f32_16x16x32_bf16 v[12:15], a[188:191], v[196:199], v[12:15]
    ds_read_b64_tr_b16 v[222:223], v235 offset:25600
    v_mfma_f32_16x16x32_bf16 v[16:19], a[160:163], v[200:203], v[16:19]
    v_mfma_f32_16x16x32_bf16 v[16:19], a[176:179], v[204:207], v[16:19]
    v_mfma_f32_16x16x32_bf16 v[20:23], a[164:167], v[200:203], v[20:23]
    buffer_load_dwordx4 v247, s[36:39], s57 offen offset:3072 lds
    v_mfma_f32_16x16x32_bf16 v[20:23], a[180:183], v[204:207], v[20:23]
    v_mfma_f32_16x16x32_bf16 v[24:27], a[168:171], v[200:203], v[24:27]
    ds_read_b64_tr_b16 v[192:193], v224 offset:0
    v_mfma_f32_16x16x32_bf16 v[24:27], a[184:187], v[204:207], v[24:27]
    ds_read_b64_tr_b16 v[194:195], v224 offset:1024
    v_mfma_f32_16x16x32_bf16 v[28:31], a[172:175], v[200:203], v[28:31]
    ds_read_b64_tr_b16 v[196:197], v224 offset:8192
    v_mfma_f32_16x16x32_bf16 v[28:31], a[188:191], v[204:207], v[28:31]
    s_waitcnt lgkmcnt(5)
    ds_read_b64_tr_b16 v[198:199], v224 offset:9216
    v_mfma_f32_16x16x32_bf16 v[32:35], a[160:163], v[208:211], v[32:35]
    s_add_u32 s56, s2, 2
    v_mfma_f32_16x16x32_bf16 v[32:35], a[176:179], v[212:215], v[32:35]
    s_and_b32 s56, s56, 7
    s_add_u32 s19, s18, 8192
    buffer_store_dwordx4 v[168:171], v248, s[32:35], s19 offen offset:2048 sc1
    v_mfma_f32_16x16x32_bf16 v[36:39], a[164:167], v[208:211], v[36:39]
    s_lshl_b32 s56, s56, 13
    v_mfma_f32_16x16x32_bf16 v[36:39], a[180:183], v[212:215], v[36:39]
    s_add_u32 s56, s56, s73
    buffer_load_dwordx4 a[64:67], v248, s[32:35], s56 offen offset:0 sc1
    v_mfma_f32_16x16x32_bf16 v[40:43], a[168:171], v[208:211], v[40:43]
    ds_read_b64_tr_b16 v[200:201], v225 offset:0
    v_lshrrev_b32 v253, 1, v249
    v_mfma_f32_16x16x32_bf16 v[40:43], a[184:187], v[212:215], v[40:43]
    ds_read_b64_tr_b16 v[202:203], v225 offset:1024
    v_lshlrev_b32 v253, 7, v253
    v_mfma_f32_16x16x32_bf16 v[44:47], a[172:175], v[208:211], v[44:47]
    ds_read_b64_tr_b16 v[204:205], v225 offset:8192
    buffer_load_dwordx4 a[68:71], v248, s[32:35], s56 offen offset:1024 sc1
    v_mfma_f32_16x16x32_bf16 v[44:47], a[188:191], v[212:215], v[44:47]
    ds_read_b64_tr_b16 v[206:207], v225 offset:9216
    v_and_b32 v254, 1, v249
    v_mfma_f32_16x16x32_bf16 v[48:51], a[160:163], v[216:219], v[48:51]
    s_waitcnt lgkmcnt(4)
    v_lshl_add_u32 v253, v254, 4, v253
    v_add_u32 v253, 0x3c0000, v253
    v_mfma_f32_16x16x32_bf16 v[48:51], a[176:179], v[220:223], v[48:51]
    buffer_load_dwordx4 v[236:239], v253, s[32:35], 0 offen sc1
    v_mfma_f32_16x16x32_bf16 v[52:55], a[164:167], v[216:219], v[52:55]
    v_mfma_f32_16x16x32_bf16 v[52:55], a[180:183], v[220:223], v[52:55]
    v_mfma_f32_16x16x32_bf16 v[56:59], a[168:171], v[216:219], v[56:59]
    s_barrier
    ds_read_b64_tr_b16 v[208:209], v226 offset:0
    buffer_load_dwordx4 a[72:75], v248, s[32:35], s56 offen offset:2048 sc1
    v_mfma_f32_16x16x32_bf16 v[56:59], a[184:187], v[220:223], v[56:59]
    ds_read_b64_tr_b16 v[210:211], v226 offset:1024
    v_mfma_f32_16x16x32_bf16 v[60:63], a[172:175], v[216:219], v[60:63]
    ds_read_b64_tr_b16 v[212:213], v226 offset:8192
    v_mfma_f32_16x16x32_bf16 v[60:63], a[188:191], v[220:223], v[60:63]
    ds_read_b64_tr_b16 v[214:215], v226 offset:9216
    v_mfma_f32_16x16x32_bf16 v[0:3], a[192:195], v[192:195], v[0:3]
    v_mfma_f32_16x16x32_bf16 v[0:3], a[208:211], v[196:199], v[0:3]
    v_mfma_f32_16x16x32_bf16 v[4:7], a[196:199], v[192:195], v[4:7]
    buffer_load_dwordx4 a[76:79], v248, s[32:35], s56 offen offset:3072 sc1
    v_mfma_f32_16x16x32_bf16 v[4:7], a[212:215], v[196:199], v[4:7]
    v_mfma_f32_16x16x32_bf16 v[8:11], a[200:203], v[192:195], v[8:11]
    ds_read_b64_tr_b16 v[216:217], v227 offset:0
    v_mfma_f32_16x16x32_bf16 v[8:11], a[216:219], v[196:199], v[8:11]
    ds_read_b64_tr_b16 v[218:219], v227 offset:1024
    v_mfma_f32_16x16x32_bf16 v[12:15], a[204:207], v[192:195], v[12:15]
    ds_read_b64_tr_b16 v[220:221], v227 offset:8192
    v_mfma_f32_16x16x32_bf16 v[12:15], a[220:223], v[196:199], v[12:15]
    s_waitcnt lgkmcnt(5)
    ds_read_b64_tr_b16 v[222:223], v227 offset:9216
    v_mfma_f32_16x16x32_bf16 v[16:19], a[192:195], v[200:203], v[16:19]
    v_mfma_f32_16x16x32_bf16 v[16:19], a[208:211], v[204:207], v[16:19]
    s_add_u32 s56, s2, 2
    v_mfma_f32_16x16x32_bf16 v[20:23], a[196:199], v[200:203], v[20:23]
    s_and_b32 s56, s56, 7
    v_mfma_f32_16x16x32_bf16 v[20:23], a[212:215], v[204:207], v[20:23]
    s_lshl_b32 s56, s56, 13
    v_mfma_f32_16x16x32_bf16 v[24:27], a[200:203], v[200:203], v[24:27]
    s_add_u32 s56, s56, s73
    ds_read_b64_tr_b16 v[192:193], v224 offset:16384
    v_mfma_f32_16x16x32_bf16 v[24:27], a[216:219], v[204:207], v[24:27]
    s_add_u32 s56, s56, 4096
    s_add_u32 s19, s18, 0
    ds_read_b64_tr_b16 v[194:195], v224 offset:17408
    buffer_load_dwordx4 a[80:83], v248, s[32:35], s56 offen offset:0 sc1
    buffer_store_dwordx4 v[176:179], v248, s[32:35], s19 offen offset:3072 sc1
    v_mfma_f32_16x16x32_bf16 v[28:31], a[204:207], v[200:203], v[28:31]
    ds_read_b64_tr_b16 v[196:197], v224 offset:24576
    v_mfma_f32_16x16x32_bf16 v[28:31], a[220:223], v[204:207], v[28:31]
    ds_read_b64_tr_b16 v[198:199], v224 offset:25600
    v_mfma_f32_16x16x32_bf16 v[32:35], a[192:195], v[208:211], v[32:35]
    s_waitcnt lgkmcnt(4)
    buffer_load_dwordx4 a[84:87], v248, s[32:35], s56 offen offset:1024 sc1
    v_mfma_f32_16x16x32_bf16 v[32:35], a[208:211], v[212:215], v[32:35]
    v_mfma_f32_16x16x32_bf16 v[36:39], a[196:199], v[208:211], v[36:39]
    v_mfma_f32_16x16x32_bf16 v[36:39], a[212:215], v[212:215], v[36:39]
    v_mfma_f32_16x16x32_bf16 v[40:43], a[200:203], v[208:211], v[40:43]
    ds_read_b64_tr_b16 v[200:201], v225 offset:16384
    v_mfma_f32_16x16x32_bf16 v[40:43], a[216:219], v[212:215], v[40:43]
    ds_read_b64_tr_b16 v[202:203], v225 offset:17408
    buffer_load_dwordx4 a[88:91], v248, s[32:35], s56 offen offset:2048 sc1
    v_mfma_f32_16x16x32_bf16 v[44:47], a[204:207], v[208:211], v[44:47]
    ds_read_b64_tr_b16 v[204:205], v225 offset:24576
    v_mfma_f32_16x16x32_bf16 v[44:47], a[220:223], v[212:215], v[44:47]
    ds_read_b64_tr_b16 v[206:207], v225 offset:25600
    v_mfma_f32_16x16x32_bf16 v[48:51], a[192:195], v[216:219], v[48:51]
    v_mfma_f32_16x16x32_bf16 v[48:51], a[208:211], v[220:223], v[48:51]
    v_mfma_f32_16x16x32_bf16 v[52:55], a[196:199], v[216:219], v[52:55]
    v_mfma_f32_16x16x32_bf16 v[52:55], a[212:215], v[220:223], v[52:55]
    buffer_load_dwordx4 a[92:95], v248, s[32:35], s56 offen offset:3072 sc1
    v_mfma_f32_16x16x32_bf16 v[56:59], a[200:203], v[216:219], v[56:59]
    ds_read_b64_tr_b16 v[208:209], v226 offset:16384
    v_mfma_f32_16x16x32_bf16 v[56:59], a[216:219], v[220:223], v[56:59]
    ds_read_b64_tr_b16 v[210:211], v226 offset:17408
    v_mfma_f32_16x16x32_bf16 v[60:63], a[204:207], v[216:219], v[60:63]
    ds_read_b64_tr_b16 v[212:213], v226 offset:24576
    v_mfma_f32_16x16x32_bf16 v[60:63], a[220:223], v[220:223], v[60:63]
    s_waitcnt lgkmcnt(5)
    ds_read_b64_tr_b16 v[214:215], v226 offset:25600
    v_mfma_f32_16x16x32_bf16 v[0:3], a[224:227], v[192:195], v[0:3]
    v_mfma_f32_16x16x32_bf16 v[0:3], a[240:243], v[196:199], v[0:3]
    v_mfma_f32_16x16x32_bf16 v[4:7], a[228:231], v[192:195], v[4:7]
    s_add_u32 m0, s55, 81920
    s_getpc_b64 s[100:101]
F_cp2:
    s_lshr_b32 s16, s2, 3
    s_lshl_b32 s16, s16, 9
    s_add_u32 s16, s16, F_mB-F_cp2
    v_and_b32 v250, 1, v249
    v_lshl_add_u32 v250, v250, 14, s16
    s_lshl_b32 s16, s52, 7
    v_add_u32 v250, s16, v250
    v_min_u32 v250, F_end-F_cp2, v250
    v_mov_b32 v251, s101
    v_add_co_u32 v250, vcc, s100, v250
    s_nop 1
    v_addc_co_u32 v251, vcc, 0, v251, vcc
    global_load_dword v255, v[250:251], off
    v_mfma_f32_16x16x32_bf16 v[4:7], a[244:247], v[196:199], v[4:7]
    s_add_u32 s57, s2, 3
    v_mfma_f32_16x16x32_bf16 v[8:11], a[232:235], v[192:195], v[8:11]
    s_and_b32 s57, s57, 7
    ds_read_b64_tr_b16 v[216:217], v227 offset:16384
    v_mfma_f32_16x16x32_bf16 v[8:11], a[248:251], v[196:199], v[8:11]
    s_lshl_b32 s57, s57, 19
    ds_read_b64_tr_b16 v[218:219], v227 offset:17408
    v_mfma_f32_16x16x32_bf16 v[12:15], a[236:239], v[192:195], v[12:15]
    s_add_u32 s57, s57, s59
    ds_read_b64_tr_b16 v[220:221], v227 offset:24576
    buffer_load_dwordx4 v244, s[36:39], s57 offen offset:0 lds
    v_mfma_f32_16x16x32_bf16 v[12:15], a[252:255], v[196:199], v[12:15]
    ds_read_b64_tr_b16 v[222:223], v227 offset:25600
    v_mfma_f32_16x16x32_bf16 v[16:19], a[224:227], v[200:203], v[16:19]
    s_waitcnt vmcnt(42)
    s_barrier
    s_waitcnt lgkmcnt(4)
    buffer_load_dwordx4 v245, s[36:39], s57 offen offset:1024 lds
    v_mfma_f32_16x16x32_bf16 v[16:19], a[240:243], v[204:207], v[16:19]
    s_add_u32 s19, s18, 8192
    buffer_store_dwordx4 v[184:187], v248, s[32:35], s19 offen offset:3072 sc1
    v_mfma_f32_16x16x32_bf16 v[20:23], a[228:231], v[200:203], v[20:23]
    v_add_u32 v228, 32768, v224
    v_add_u32 v229, 32768, v225
    v_add_u32 v230, 32768, v226
    v_add_u32 v231, 32768, v227
    v_xor_b32 v224, 128, v228
    v_xor_b32 v225, 128, v229
    v_xor_b32 v226, 128, v230
    v_xor_b32 v227, 128, v231
    v_mfma_f32_16x16x32_bf16 v[20:23], a[244:247], v[204:207], v[20:23]
    v_mfma_f32_16x16x32_bf16 v[24:27], a[232:235], v[200:203], v[24:27]
    ds_read_b64_tr_b16 v[192:193], v228 offset:0
    v_mfma_f32_16x16x32_bf16 v[24:27], a[248:251], v[204:207], v[24:27]
    ds_read_b64_tr_b16 v[194:195], v228 offset:1024
    v_mfma_f32_16x16x32_bf16 v[28:31], a[236:239], v[200:203], v[28:31]
    ds_read_b64_tr_b16 v[196:197], v228 offset:8192
    buffer_load_dwordx4 v246, s[36:39], s57 offen offset:2048 lds
    v_mfma_f32_16x16x32_bf16 v[28:31], a[252:255], v[204:207], v[28:31]
    ds_read_b64_tr_b16 v[198:199], v228 offset:9216
    v_cvt_pk_bf16_f32 v132, v0, v1
    v_mfma_f32_16x16x32_bf16 v[32:35], a[224:227], v[208:211], v[32:35]
    v_cvt_pk_bf16_f32 v133, v2, v3
    v_cvt_pk_bf16_f32 v134, v4, v5
    v_mfma_f32_16x16x32_bf16 v[32:35], a[240:243], v[212:215], v[32:35]
    v_cvt_pk_bf16_f32 v135, v6, v7
    v_mfma_f32_16x16x32_bf16 v[36:39], a[228:231], v[208:211], v[36:39]
    v_cvt_pk_bf16_f32 v140, v8, v9
    v_cvt_pk_bf16_f32 v141, v10, v11
    v_mfma_f32_16x16x32_bf16 v[36:39], a[244:247], v[212:215], v[36:39]
    v_cvt_pk_bf16_f32 v142, v12, v13
    v_cvt_pk_bf16_f32 v143, v14, v15
    v_mfma_f32_16x16x32_bf16 v[40:43], a[232:235], v[208:211], v[40:43]
    ds_read_b64_tr_b16 v[200:201], v229 offset:0
    buffer_load_dwordx4 v247, s[36:39], s57 offen offset:3072 lds
    v_mfma_f32_16x16x32_bf16 v[40:43], a[248:251], v[212:215], v[40:43]
    ds_read_b64_tr_b16 v[202:203], v229 offset:1024
    v_mfma_f32_16x16x32_bf16 v[44:47], a[236:239], v[208:211], v[44:47]
    ds_read_b64_tr_b16 v[204:205], v229 offset:8192
    v_cvt_pk_bf16_f32 v148, v16, v17
    v_mfma_f32_16x16x32_bf16 v[44:47], a[252:255], v[212:215], v[44:47]
    s_waitcnt lgkmcnt(5)
    ds_read_b64_tr_b16 v[206:207], v229 offset:9216
    v_cvt_pk_bf16_f32 v149, v18, v19
    v_mfma_f32_16x16x32_bf16 v[48:51], a[224:227], v[216:219], v[48:51]
    v_cvt_pk_bf16_f32 v150, v20, v21
    v_cvt_pk_bf16_f32 v151, v22, v23
    v_mfma_f32_16x16x32_bf16 v[48:51], a[240:243], v[220:223], v[48:51]
    v_cvt_pk_bf16_f32 v156, v24, v25
    v_cvt_pk_bf16_f32 v157, v26, v27
    v_mfma_f32_16x16x32_bf16 v[52:55], a[228:231], v[216:219], v[52:55]
    s_add_u32 s56, s2, 3
    v_cvt_pk_bf16_f32 v158, v28, v29
    v_cvt_pk_bf16_f32 v159, v30, v31
    v_mfma_f32_16x16x32_bf16 v[52:55], a[244:247], v[220:223], v[52:55]
    s_and_b32 s56, s56, 7
    s_waitcnt vmcnt(13)
    s_mov_b32 s16, 100000
F_pl3:
    v_xor_b32 v236, s94, v236
    v_xor_b32 v237, s94, v237
    v_xor_b32 v238, s94, v238
    v_xor_b32 v239, s94, v239
    v_or3_b32 v236, v236, v237, v238
    v_or_b32 v236, v236, v239
    v_cmp_ne_u32 vcc, 0, v236
    s_nop 4
    s_cbranch_vccz F_pd3
    s_sleep 8
    buffer_load_dwordx4 v[236:239], v253, s[32:35], 0 offen sc1
    s_sub_u32 s16, s16, 1
    s_waitcnt vmcnt(0)
    s_cbranch_scc0 F_pl3
F_pd3:
    v_mfma_f32_16x16x32_bf16 v[56:59], a[232:235], v[216:219], v[56:59]
    s_lshl_b32 s56, s56, 13
    s_lshl_b32 s69, s52, 11
    s_add_u32 s69, s69, 0x200000
    ds_read_b64_tr_b16 v[208:209], v230 offset:0
    v_mfma_f32_16x16x32_bf16 v[56:59], a[248:251], v[220:223], v[56:59]
    s_add_u32 s56, s56, s73
    ds_read_b64_tr_b16 v[210:211], v230 offset:1024
    buffer_load_dwordx4 a[96:99], v248, s[32:35], s56 offen offset:0 sc1
    buffer_load_dwordx4 v[236:239], v248, s[32:35], s69 offen sc1
    v_mfma_f32_16x16x32_bf16 v[60:63], a[236:239], v[216:219], v[60:63]
    ds_read_b64_tr_b16 v[212:213], v230 offset:8192
    buffer_load_dwordx4 v[240:243], v248, s[32:35], s69 offen offset:1024 sc1
    v_cvt_pk_bf16_f32 v164, v32, v33
    v_mfma_f32_16x16x32_bf16 v[60:63], a[252:255], v[220:223], v[60:63]
    ds_read_b64_tr_b16 v[214:215], v230 offset:9216
    v_cvt_pk_bf16_f32 v165, v34, v35
    v_mfma_f32_16x16x32_bf16 v[64:67], v[192:195], a[0:3], 0
    s_waitcnt lgkmcnt(4)
    buffer_load_dwordx4 a[100:103], v248, s[32:35], s56 offen offset:1024 sc1
    v_cvt_pk_bf16_f32 v166, v36, v37
    v_mfma_f32_16x16x32_bf16 v[64:67], v[196:199], a[16:19], v[64:67]
    s_and_b32 s69, s2, 0xc7
    s_lshl_b32 s69, s69, 9
    v_cvt_pk_bf16_f32 v167, v38, v39
    v_mfma_f32_16x16x32_bf16 v[68:71], v[192:195], a[4:7], 0
    s_lshl_b32 s70, s54, 2
    v_cvt_pk_bf16_f32 v172, v40, v41
    v_cvt_pk_bf16_f32 v173, v42, v43
    v_mfma_f32_16x16x32_bf16 v[68:71], v[196:199], a[20:23], v[68:71]
    s_add_u32 s69, s69, s70
    v_cvt_pk_bf16_f32 v174, v44, v45
    v_cvt_pk_bf16_f32 v175, v46, v47
    v_mfma_f32_16x16x32_bf16 v[72:75], v[192:195], a[8:11], 0
    ds_read_b64_tr_b16 v[216:217], v231 offset:0
    v_lshl_add_u32 v254, v249, 12, s69
    v_mfma_f32_16x16x32_bf16 v[72:75], v[196:199], a[24:27], v[72:75]
    ds_read_b64_tr_b16 v[218:219], v231 offset:1024
    v_cmp_gt_u32 vcc, 8, v249
    v_mfma_f32_16x16x32_bf16 v[76:79], v[192:195], a[12:15], 0
    ds_read_b64_tr_b16 v[220:221], v231 offset:8192
    buffer_load_dwordx4 a[104:107], v248, s[32:35], s56 offen offset:2048 sc1
    v_mfma_f32_16x16x32_bf16 v[76:79], v[196:199], a[28:31], v[76:79]
    ds_read_b64_tr_b16 v[222:223], v231 offset:9216
    v_cvt_pk_bf16_f32 v180, v48, v49
    v_mfma_f32_16x16x32_bf16 v[80:83], v[200:203], a[0:3], 0
    v_cvt_pk_bf16_f32 v181, v50, v51
    v_cvt_pk_bf16_f32 v182, v52, v53
    v_mfma_f32_16x16x32_bf16 v[80:83], v[204:207], a[16:19], v[80:83]
    v_cvt_pk_bf16_f32 v183, v54, v55
    v_mov_b32 v253, 0x40000000
    v_mfma_f32_16x16x32_bf16 v[84:87], v[200:203], a[4:7], 0
    v_cvt_pk_bf16_f32 v188, v56, v57
    v_cvt_pk_bf16_f32 v189, v58, v59
    v_mfma_f32_16x16x32_bf16 v[84:87], v[204:207], a[20:23], v[84:87]
    v_cvt_pk_bf16_f32 v190, v60, v61
    v_cvt_pk_bf16_f32 v191, v62, v63
    v_mfma_f32_16x16x32_bf16 v[88:91], v[200:203], a[8:11], 0
    ds_read_b64_tr_b16 v[192:193], v224 offset:0
    buffer_load_dwordx4 a[108:111], v248, s[32:35], s56 offen offset:3072 sc1
    v_mfma_f32_16x16x32_bf16 v[88:91], v[204:207], a[24:27], v[88:91]
    ds_read_b64_tr_b16 v[194:195], v224 offset:1024
    v_cndmask_b32 v254, v253, v254, vcc
    v_mfma_f32_16x16x32_bf16 v[92:95], v[200:203], a[12:15], 0
    s_add_u32 s19, s18, 4096
    ds_read_b64_tr_b16 v[196:197], v224 offset:8192
    buffer_store_dwordx4 v[132:135], v248, s[32:35], s19 offen offset:0 sc1
    v_mfma_f32_16x16x32_bf16 v[92:95], v[204:207], a[28:31], v[92:95]
    s_waitcnt lgkmcnt(5)
    ds_read_b64_tr_b16 v[198:199], v224 offset:9216
    v_mfma_f32_16x16x32_bf16 v[96:99], v[208:211], a[0:3], 0
    v_mfma_f32_16x16x32_bf16 v[96:99], v[212:215], a[16:19], v[96:99]
    v_mfma_f32_16x16x32_bf16 v[100:103], v[208:211], a[4:7], 0
    v_mfma_f32_16x16x32_bf16 v[100:103], v[212:215], a[20:23], v[100:103]
    v_mfma_f32_16x16x32_bf16 v[104:107], v[208:211], a[8:11], 0
    s_add_u32 s56, s2, 3
    ds_read_b64_tr_b16 v[200:201], v225 offset:0
    v_mfma_f32_16x16x32_bf16 v[104:107], v[212:215], a[24:27], v[104:107]
    s_and_b32 s56, s56, 7
    ds_read_b64_tr_b16 v[202:203], v225 offset:1024
    v_mfma_f32_16x16x32_bf16 v[108:111], v[208:211], a[12:15], 0
    s_lshl_b32 s56, s56, 13
    ds_read_b64_tr_b16 v[204:205], v225 offset:8192
    v_mfma_f32_16x16x32_bf16 v[108:111], v[212:215], a[28:31], v[108:111]
    s_add_u32 s56, s56, s73
    ds_read_b64_tr_b16 v[206:207], v225 offset:9216
    v_mfma_f32_16x16x32_bf16 v[112:115], v[216:219], a[0:3], 0
    s_waitcnt lgkmcnt(4)
    s_add_u32 s56, s56, 4096
    buffer_load_dwordx4 a[112:115], v248, s[32:35], s56 offen offset:0 sc1
    v_mfma_f32_16x16x32_bf16 v[112:115], v[220:223], a[16:19], v[112:115]
    buffer_load_dwordx4 a[116:119], v248, s[32:35], s56 offen offset:1024 sc1
    v_mfma_f32_16x16x32_bf16 v[116:119], v[216:219], a[4:7], 0
    v_mfma_f32_16x16x32_bf16 v[116:119], v[220:223], a[20:23], v[116:119]
    v_mfma_f32_16x16x32_bf16 v[120:123], v[216:219], a[8:11], 0
    s_add_u32 s19, s18, 12288
    ds_read_b64_tr_b16 v[208:209], v226 offset:0
    buffer_store_dwordx4 v[140:143], v248, s[32:35], s19 offen offset:0 sc1
    v_mfma_f32_16x16x32_bf16 v[120:123], v[220:223], a[24:27], v[120:123]
    ds_read_b64_tr_b16 v[210:211], v226 offset:1024
    v_mfma_f32_16x16x32_bf16 v[124:127], v[216:219], a[12:15], 0
    ds_read_b64_tr_b16 v[212:213], v226 offset:8192
    v_mfma_f32_16x16x32_bf16 v[124:127], v[220:223], a[28:31], v[124:127]
    ds_read_b64_tr_b16 v[214:215], v226 offset:9216
    v_mfma_f32_16x16x32_bf16 v[0:3], v[192:195], a[0:3], 0
    buffer_load_dwordx4 a[120:123], v248, s[32:35], s56 offen offset:2048 sc1
    v_mfma_f32_16x16x32_bf16 v[0:3], v[196:199], a[16:19], v[0:3]
    v_mfma_f32_16x16x32_bf16 v[4:7], v[192:195], a[4:7], 0
    v_mfma_f32_16x16x32_bf16 v[4:7], v[196:199], a[20:23], v[4:7]
    v_mfma_f32_16x16x32_bf16 v[8:11], v[192:195], a[8:11], 0
    ds_read_b64_tr_b16 v[216:217], v227 offset:0
    v_mfma_f32_16x16x32_bf16 v[8:11], v[196:199], a[24:27], v[8:11]
    ds_read_b64_tr_b16 v[218:219], v227 offset:1024
    buffer_load_dwordx4 a[124:127], v248, s[32:35], s56 offen offset:3072 sc1
    v_mfma_f32_16x16x32_bf16 v[12:15], v[192:195], a[12:15], 0
    ds_read_b64_tr_b16 v[220:221], v227 offset:8192
    v_mfma_f32_16x16x32_bf16 v[12:15], v[196:199], a[28:31], v[12:15]
    s_waitcnt lgkmcnt(5)
    ds_read_b64_tr_b16 v[222:223], v227 offset:9216
    v_mfma_f32_16x16x32_bf16 v[16:19], v[200:203], a[0:3], 0
    v_mfma_f32_16x16x32_bf16 v[16:19], v[204:207], a[16:19], v[16:19]
    v_mfma_f32_16x16x32_bf16 v[20:23], v[200:203], a[4:7], 0
    s_add_u32 s19, s18, 4096
    buffer_store_dwordx4 v[148:151], v248, s[32:35], s19 offen offset:1024 sc1
    v_mfma_f32_16x16x32_bf16 v[20:23], v[204:207], a[20:23], v[20:23]
    v_mfma_f32_16x16x32_bf16 v[24:27], v[200:203], a[8:11], 0
    s_add_u32 m0, s55, 98304
    s_waitcnt vmcnt(10)
    v_mov_b32 v235, 0
    v_mfma_f32_16x16x32_bf16 v[24:27], v[204:207], a[24:27], v[24:27]
    s_add_u32 s57, s2, 4
    v_and_b32 v250, 7, v249
    v_max3_u32 v232, v236, v237, v238
    v_mfma_f32_16x16x32_bf16 v[28:31], v[200:203], a[12:15], 0
    s_waitcnt lgkmcnt(0)
    s_barrier
    s_and_b32 s57, s57, 7
    ds_read_b64_tr_b16 v[192:193], v224 offset:16384
    v_max3_u32 v233, v239, v240, v241
    v_mfma_f32_16x16x32_bf16 v[28:31], v[204:207], a[28:31], v[28:31]
    s_lshl_b32 s57, s57, 19
    ds_read_b64_tr_b16 v[194:195], v224 offset:17408
    v_max3_u32 v232, v232, v242, v243
    v_mfma_f32_16x16x32_bf16 v[32:35], v[208:211], a[0:3], 0
    s_add_u32 s57, s57, s59
    ds_read_b64_tr_b16 v[196:197], v224 offset:24576
    buffer_load_dwordx4 v244, s[36:39], s57 offen offset:0 lds
    v_mfma_f32_16x16x32_bf16 v[32:35], v[212:215], a[16:19], v[32:35]
    ds_read_b64_tr_b16 v[198:199], v224 offset:25600
    v_max_u32 v232, v232, v233
    v_mfma_f32_16x16x32_bf16 v[36:39], v[208:211], a[4:7], 0
    buffer_load_dwordx4 v245, s[36:39], s57 offen offset:1024 lds
    v_cmp_eq_u32 s[0:1], 0, v250
    v_mfma_f32_16x16x32_bf16 v[36:39], v[212:215], a[20:23], v[36:39]
    v_mfma_f32_16x16x32_bf16 v[40:43], v[208:211], a[8:11], 0
    ds_read_b64_tr_b16 v[200:201], v225 offset:16384
    v_max_u32_dpp v232, v232, v232 quad_perm:[1,0,3,2] row_mask:0xf bank_mask:0xf
    v_mfma_f32_16x16x32_bf16 v[40:43], v[212:215], a[24:27], v[40:43]
    ds_read_b64_tr_b16 v[202:203], v225 offset:17408
    v_mfma_f32_16x16x32_bf16 v[44:47], v[208:211], a[12:15], 0
    ds_read_b64_tr_b16 v[204:205], v225 offset:24576
    v_max_u32_dpp v232, v232, v232 quad_perm:[2,3,0,1] row_mask:0xf bank_mask:0xf
    v_mfma_f32_16x16x32_bf16 v[44:47], v[212:215], a[28:31], v[44:47]
    ds_read_b64_tr_b16 v[206:207], v225 offset:25600
    v_mfma_f32_16x16x32_bf16 v[48:51], v[216:219], a[0:3], 0
    buffer_load_dwordx4 v246, s[36:39], s57 offen offset:2048 lds
    v_max_u32_dpp v232, v232, v232 row_half_mirror row_mask:0xf bank_mask:0xf
    v_mfma_f32_16x16x32_bf16 v[48:51], v[220:223], a[16:19], v[48:51]
    s_add_u32 s19, s18, 12288
    buffer_store_dwordx4 v[156:159], v248, s[32:35], s19 offen offset:1024 sc1
    v_mfma_f32_16x16x32_bf16 v[52:55], v[216:219], a[4:7], 0
    v_max_u32_dpp v232, v232, v232 row_mirror row_mask:0xf bank_mask:0xf
    v_mov_b32 v233, v232
    v_mfma_f32_16x16x32_bf16 v[52:55], v[220:223], a[20:23], v[52:55]
    v_mfma_f32_16x16x32_bf16 v[56:59], v[216:219], a[8:11], 0
    ds_read_b64_tr_b16 v[208:209], v226 offset:16384
    v_permlane16_swap_b32 v232, v233
    v_mfma_f32_16x16x32_bf16 v[56:59], v[220:223], a[24:27], v[56:59]
    ds_read_b64_tr_b16 v[210:211], v226 offset:17408
    v_max_u32 v232, v232, v233
    v_mfma_f32_16x16x32_bf16 v[60:63], v[216:219], a[12:15], 0
    ds_read_b64_tr_b16 v[212:213], v226 offset:24576
    buffer_load_dwordx4 v247, s[36:39], s57 offen offset:3072 lds
    v_mfma_f32_16x16x32_bf16 v[60:63], v[220:223], a[28:31], v[60:63]
    s_waitcnt lgkmcnt(5)
    ds_read_b64_tr_b16 v[214:215], v226 offset:25600
    v_mfma_f32_16x16x32_bf16 v[0:3], v[192:195], a[32:35], v[0:3]
    v_mov_b32 v233, v232
    v_mfma_f32_16x16x32_bf16 v[0:3], v[196:199], a[48:51], v[0:3]
    v_mfma_f32_16x16x32_bf16 v[4:7], v[192:195], a[36:39], v[4:7]
    v_permlane32_swap_b32 v232, v233
    v_max_u32 v232, v232, v233
    v_mfma_f32_16x16x32_bf16 v[4:7], v[196:199], a[52:55], v[4:7]
    v_add_u32 v235, v235, v232
    v_cndmask_b32 v234, v234, v235, s[0:1]
    v_mfma_f32_16x16x32_bf16 v[8:11], v[192:195], a[40:43], v[8:11]
    ds_read_b64_tr_b16 v[216:217], v227 offset:16384
    v_sub_u32 v236, v236, v232
    v_mfma_f32_16x16x32_bf16 v[8:11], v[196:199], a[56:59], v[8:11]
    s_add_u32 s56, s2, 4
    ds_read_b64_tr_b16 v[218:219], v227 offset:17408
    v_sub_u32 v237, v237, v232
    v_mfma_f32_16x16x32_bf16 v[12:15], v[192:195], a[44:47], v[12:15]
    s_and_b32 s56, s56, 7
    s_add_u32 s19, s18, 4096
    ds_read_b64_tr_b16 v[220:221], v227 offset:24576
    buffer_store_dwordx4 v[164:167], v248, s[32:35], s19 offen offset:2048 sc1
    v_mfma_f32_16x16x32_bf16 v[12:15], v[196:199], a[60:63], v[12:15]
    s_lshl_b32 s56, s56, 13
    ds_read_b64_tr_b16 v[222:223], v227 offset:25600
    v_sub_u32 v238, v238, v232
    v_mfma_f32_16x16x32_bf16 v[16:19], v[200:203], a[32:35], v[16:19]
    s_waitcnt lgkmcnt(4)
    s_add_u32 s56, s56, s73
    buffer_load_dwordx4 a[128:131], v248, s[32:35], s56 offen offset:0 sc1
    v_mfma_f32_16x16x32_bf16 v[16:19], v[204:207], a[48:51], v[16:19]
    v_sub_u32 v239, v239, v232
    v_sub_u32 v240, v240, v232
    v_mfma_f32_16x16x32_bf16 v[20:23], v[200:203], a[36:39], v[20:23]
    buffer_load_dwordx4 a[132:135], v248, s[32:35], s56 offen offset:1024 sc1
    v_sub_u32 v241, v241, v232
    v_mfma_f32_16x16x32_bf16 v[20:23], v[204:207], a[52:55], v[20:23]
    v_sub_u32 v242, v242, v232
    v_sub_u32 v243, v243, v232
    v_mfma_f32_16x16x32_bf16 v[24:27], v[200:203], a[40:43], v[24:27]
    ds_read_b64_tr_b16 v[192:193], v228 offset:16384
    v_max3_u32 v232, v236, v237, v238
    v_mfma_f32_16x16x32_bf16 v[24:27], v[204:207], a[56:59], v[24:27]
    ds_read_b64_tr_b16 v[194:195], v228 offset:17408
    v_max3_u32 v233, v239, v240, v241
    v_mfma_f32_16x16x32_bf16 v[28:31], v[200:203], a[44:47], v[28:31]
    ds_read_b64_tr_b16 v[196:197], v228 offset:24576
    v_max3_u32 v232, v232, v242, v243
    v_mfma_f32_16x16x32_bf16 v[28:31], v[204:207], a[60:63], v[28:31]
    ds_read_b64_tr_b16 v[198:199], v228 offset:25600
    v_max_u32 v232, v232, v233
    v_mfma_f32_16x16x32_bf16 v[32:35], v[208:211], a[32:35], v[32:35]
    buffer_load_dwordx4 a[136:139], v248, s[32:35], s56 offen offset:2048 sc1
    v_cmp_eq_u32 s[0:1], 1, v250
    v_mfma_f32_16x16x32_bf16 v[32:35], v[212:215], a[48:51], v[32:35]
    v_mfma_f32_16x16x32_bf16 v[36:39], v[208:211], a[36:39], v[36:39]
    v_max_u32_dpp v232, v232, v232 quad_perm:[1,0,3,2] row_mask:0xf bank_mask:0xf
    v_mfma_f32_16x16x32_bf16 v[36:39], v[212:215], a[52:55], v[36:39]
    v_mfma_f32_16x16x32_bf16 v[40:43], v[208:211], a[40:43], v[40:43]
    s_add_u32 s19, s18, 12288
    ds_read_b64_tr_b16 v[200:201], v229 offset:16384
    buffer_store_dwordx4 v[172:175], v248, s[32:35], s19 offen offset:2048 sc1
    v_mfma_f32_16x16x32_bf16 v[40:43], v[212:215], a[56:59], v[40:43]
    ds_read_b64_tr_b16 v[202:203], v229 offset:17408
    v_max_u32_dpp v232, v232, v232 quad_perm:[2,3,0,1] row_mask:0xf bank_mask:0xf
    v_mfma_f32_16x16x32_bf16 v[44:47], v[208:211], a[44:47], v[44:47]
    ds_read_b64_tr_b16 v[204:205], v229 offset:24576
    buffer_load_dwordx4 a[140:143], v248, s[32:35], s56 offen offset:3072 sc1
    v_mfma_f32_16x16x32_bf16 v[44:47], v[212:215], a[60:63], v[44:47]
    s_waitcnt lgkmcnt(5)
    ds_read_b64_tr_b16 v[206:207], v229 offset:25600
    v_max_u32_dpp v232, v232, v232 row_half_mirror row_mask:0xf bank_mask:0xf
    v_mfma_f32_16x16x32_bf16 v[48:51], v[216:219], a[32:35], v[48:51]
    v_mfma_f32_16x16x32_bf16 v[48:51], v[220:223], a[48:51], v[48:51]
    v_max_u32_dpp v232, v232, v232 row_mirror row_mask:0xf bank_mask:0xf
    v_mov_b32 v233, v232
    v_mfma_f32_16x16x32_bf16 v[52:55], v[216:219], a[36:39], v[52:55]
    v_mfma_f32_16x16x32_bf16 v[52:55], v[220:223], a[52:55], v[52:55]
    v_permlane16_swap_b32 v232, v233
    v_max_u32 v232, v232, v233
    v_mfma_f32_16x16x32_bf16 v[56:59], v[216:219], a[40:43], v[56:59]
    ds_read_b64_tr_b16 v[208:209], v230 offset:16384
    v_mov_b32 v233, v232
    v_mfma_f32_16x16x32_bf16 v[56:59], v[220:223], a[56:59], v[56:59]
    s_add_u32 s56, s2, 4
    ds_read_b64_tr_b16 v[210:211], v230 offset:17408
    v_mfma_f32_16x16x32_bf16 v[60:63], v[216:219], a[44:47], v[60:63]
    s_and_b32 s56, s56, 7
    ds_read_b64_tr_b16 v[212:213], v230 offset:24576
    v_permlane32_swap_b32 v232, v233
    v_mfma_f32_16x16x32_bf16 v[60:63], v[220:223], a[60:63], v[60:63]
    s_lshl_b32 s56, s56, 13
    ds_read_b64_tr_b16 v[214:215], v230 offset:25600
    v_max_u32 v232, v232, v233
    v_mfma_f32_16x16x32_bf16 v[64:67], v[192:195], a[32:35], v[64:67]
    s_waitcnt lgkmcnt(4)
    s_add_u32 s56, s56, s73
    v_add_u32 v235, v235, v232
    v_mfma_f32_16x16x32_bf16 v[64:67], v[196:199], a[48:51], v[64:67]
    s_add_u32 s56, s56, 4096
    buffer_load_dwordx4 a[144:147], v248, s[32:35], s56 offen offset:0 sc1
    v_cndmask_b32 v234, v234, v235, s[0:1]
    v_mfma_f32_16x16x32_bf16 v[68:71], v[192:195], a[36:39], v[68:71]
    s_add_u32 s19, s18, 4096
    buffer_store_dwordx4 v[180:183], v248, s[32:35], s19 offen offset:3072 sc1
    v_sub_u32 v236, v236, v232
    v_mfma_f32_16x16x32_bf16 v[68:71], v[196:199], a[52:55], v[68:71]
    buffer_load_dwordx4 a[148:151], v248, s[32:35], s56 offen offset:1024 sc1
    v_sub_u32 v237, v237, v232
    v_mfma_f32_16x16x32_bf16 v[72:75], v[192:195], a[40:43], v[72:75]
    ds_read_b64_tr_b16 v[216:217], v231 offset:16384
    v_sub_u32 v238, v238, v232
    v_mfma_f32_16x16x32_bf16 v[72:75], v[196:199], a[56:59], v[72:75]
    ds_read_b64_tr_b16 v[218:219], v231 offset:17408
    v_sub_u32 v239, v239, v232
    v_mfma_f32_16x16x32_bf16 v[76:79], v[192:195], a[44:47], v[76:79]
    ds_read_b64_tr_b16 v[220:221], v231 offset:24576
    v_sub_u32 v240, v240, v232
    v_mfma_f32_16x16x32_bf16 v[76:79], v[196:199], a[60:63], v[76:79]
    ds_read_b64_tr_b16 v[222:223], v231 offset:25600
    v_sub_u32 v241, v241, v232
    v_mfma_f32_16x16x32_bf16 v[80:83], v[200:203], a[32:35], v[80:83]
    v_sub_u32 v242, v242, v232
    v_sub_u32 v243, v243, v232
    v_mfma_f32_16x16x32_bf16 v[80:83], v[204:207], a[48:51], v[80:83]
    buffer_load_dwordx4 a[152:155], v248, s[32:35], s56 offen offset:2048 sc1
    v_max3_u32 v232, v236, v237, v238
    v_mfma_f32_16x16x32_bf16 v[84:87], v[200:203], a[36:39], v[84:87]
    v_max3_u32 v233, v239, v240, v241
    v_max3_u32 v232, v232, v242, v243
    v_mfma_f32_16x16x32_bf16 v[84:87], v[204:207], a[52:55], v[84:87]
    v_max_u32 v232, v232, v233
    v_cmp_eq_u32 s[0:1], 2, v250
    v_mfma_f32_16x16x32_bf16 v[88:91], v[200:203], a[40:43], v[88:91]
    v_mfma_f32_16x16x32_bf16 v[88:91], v[204:207], a[56:59], v[88:91]
    v_max_u32_dpp v232, v232, v232 quad_perm:[1,0,3,2] row_mask:0xf bank_mask:0xf
    v_mfma_f32_16x16x32_bf16 v[92:95], v[200:203], a[44:47], v[92:95]
    s_waitcnt lgkmcnt(0)
    s_barrier
    ds_read_b64_tr_b16 v[192:193], v224 offset:32768
    v_mfma_f32_16x16x32_bf16 v[92:95], v[204:207], a[60:63], v[92:95]
    ds_read_b64_tr_b16 v[194:195], v224 offset:33792
    buffer_load_dwordx4 a[156:159], v248, s[32:35], s56 offen offset:3072 sc1
    v_mfma_f32_16x16x32_bf16 v[96:99], v[208:211], a[32:35], v[96:99]
    s_add_u32 s19, s18, 12288
    ds_read_b64_tr_b16 v[196:197], v224 offset:40960
    buffer_store_dwordx4 v[188:191], v248, s[32:35], s19 offen offset:3072 sc1
    v_mfma_f32_16x16x32_bf16 v[96:99], v[212:215], a[48:51], v[96:99]
    ds_read_b64_tr_b16 v[198:199], v224 offset:41984
    v_max_u32_dpp v232, v232, v232 quad_perm:[2,3,0,1] row_mask:0xf bank_mask:0xf
    v_mfma_f32_16x16x32_bf16 v[100:103], v[208:211], a[36:39], v[100:103]
    v_mfma_f32_16x16x32_bf16 v[100:103], v[212:215], a[52:55], v[100:103]
    v_max_u32_dpp v232, v232, v232 row_half_mirror row_mask:0xf bank_mask:0xf
    v_mfma_f32_16x16x32_bf16 v[104:107], v[208:211], a[40:43], v[104:107]
    ds_read_b64_tr_b16 v[200:201], v225 offset:32768
    v_mfma_f32_16x16x32_bf16 v[104:107], v[212:215], a[56:59], v[104:107]
    ds_read_b64_tr_b16 v[202:203], v225 offset:33792
    v_max_u32_dpp v232, v232, v232 row_mirror row_mask:0xf bank_mask:0xf
    v_mfma_f32_16x16x32_bf16 v[108:111], v[208:211], a[44:47], v[108:111]
    s_add_u32 m0, s55, 114688
    ds_read_b64_tr_b16 v[204:205], v225 offset:40960
    v_mov_b32 v233, v232
    v_mfma_f32_16x16x32_bf16 v[108:111], v[212:215], a[60:63], v[108:111]
    s_add_u32 s57, s2, 5
    ds_read_b64_tr_b16 v[206:207], v225 offset:41984
    v_mfma_f32_16x16x32_bf16 v[112:115], v[216:219], a[32:35], v[112:115]
    s_waitcnt lgkmcnt(6)
    s_and_b32 s57, s57, 7
    v_permlane16_swap_b32 v232, v233
    v_mfma_f32_16x16x32_bf16 v[112:115], v[220:223], a[48:51], v[112:115]
    s_lshl_b32 s57, s57, 19
    v_max_u32 v232, v232, v233
    v_mov_b32 v233, v232
    v_mfma_f32_16x16x32_bf16 v[116:119], v[216:219], a[36:39], v[116:119]
    s_add_u32 s57, s57, s59
    buffer_load_dwordx4 v244, s[36:39], s57 offen offset:0 lds
    v_mfma_f32_16x16x32_bf16 v[116:119], v[220:223], a[52:55], v[116:119]
    v_permlane32_swap_b32 v232, v233
    v_max_u32 v232, v232, v233
    v_mfma_f32_16x16x32_bf16 v[120:123], v[216:219], a[40:43], v[120:123]
    ds_read_b64_tr_b16 v[208:209], v226 offset:32768
    buffer_load_dwordx4 v245, s[36:39], s57 offen offset:1024 lds
    v_mfma_f32_16x16x32_bf16 v[120:123], v[220:223], a[56:59], v[120:123]
    ds_read_b64_tr_b16 v[210:211], v226 offset:33792
    v_add_u32 v235, v235, v232
    v_mfma_f32_16x16x32_bf16 v[124:127], v[216:219], a[44:47], v[124:127]
    ds_read_b64_tr_b16 v[212:213], v226 offset:40960
    v_cndmask_b32 v234, v234, v235, s[0:1]
    v_mfma_f32_16x16x32_bf16 v[124:127], v[220:223], a[60:63], v[124:127]
    ds_read_b64_tr_b16 v[214:215], v226 offset:41984
    v_sub_u32 v236, v236, v232
    v_mfma_f32_16x16x32_bf16 v[0:3], v[192:195], a[64:67], v[0:3]
    s_waitcnt lgkmcnt(4)
    v_sub_u32 v237, v237, v232
    v_sub_u32 v238, v238, v232
    v_mfma_f32_16x16x32_bf16 v[0:3], v[196:199], a[80:83], v[0:3]
    v_sub_u32 v239, v239, v232
    v_sub_u32 v240, v240, v232
    v_mfma_f32_16x16x32_bf16 v[4:7], v[192:195], a[68:71], v[4:7]
    buffer_load_dwordx4 v246, s[36:39], s57 offen offset:2048 lds
    v_sub_u32 v241, v241, v232
    v_mfma_f32_16x16x32_bf16 v[4:7], v[196:199], a[84:87], v[4:7]
    v_sub_u32 v242, v242, v232
    v_sub_u32 v243, v243, v232
    v_mfma_f32_16x16x32_bf16 v[8:11], v[192:195], a[72:75], v[8:11]
    ds_read_b64_tr_b16 v[216:217], v227 offset:32768
    v_max3_u32 v232, v236, v237, v238
    v_mfma_f32_16x16x32_bf16 v[8:11], v[196:199], a[88:91], v[8:11]
    ds_read_b64_tr_b16 v[218:219], v227 offset:33792
    v_max3_u32 v233, v239, v240, v241
    v_mfma_f32_16x16x32_bf16 v[12:15], v[192:195], a[76:79], v[12:15]
    ds_read_b64_tr_b16 v[220:221], v227 offset:40960
    v_max3_u32 v232, v232, v242, v243
    v_mfma_f32_16x16x32_bf16 v[12:15], v[196:199], a[92:95], v[12:15]
    ds_read_b64_tr_b16 v[222:223], v227 offset:41984
    v_max_u32 v232, v232, v233
    v_mfma_f32_16x16x32_bf16 v[16:19], v[200:203], a[64:67], v[16:19]
    buffer_load_dwordx4 v247, s[36:39], s57 offen offset:3072 lds
    v_cmp_eq_u32 s[0:1], 3, v250
    v_mfma_f32_16x16x32_bf16 v[16:19], v[204:207], a[80:83], v[16:19]
    v_mfma_f32_16x16x32_bf16 v[20:23], v[200:203], a[68:71], v[20:23]
    v_max_u32_dpp v232, v232, v232 quad_perm:[1,0,3,2] row_mask:0xf bank_mask:0xf
    v_mfma_f32_16x16x32_bf16 v[20:23], v[204:207], a[84:87], v[20:23]
    v_mfma_f32_16x16x32_bf16 v[24:27], v[200:203], a[72:75], v[24:27]
    ds_read_b64_tr_b16 v[192:193], v228 offset:32768
    v_max_u32_dpp v232, v232, v232 quad_perm:[2,3,0,1] row_mask:0xf bank_mask:0xf
    v_mfma_f32_16x16x32_bf16 v[24:27], v[204:207], a[88:91], v[24:27]
    ds_read_b64_tr_b16 v[194:195], v228 offset:33792
    v_mfma_f32_16x16x32_bf16 v[28:31], v[200:203], a[76:79], v[28:31]
    s_add_u32 s56, s2, 5
    ds_read_b64_tr_b16 v[196:197], v228 offset:40960
    v_max_u32_dpp v232, v232, v232 row_half_mirror row_mask:0xf bank_mask:0xf
    v_mfma_f32_16x16x32_bf16 v[28:31], v[204:207], a[92:95], v[28:31]
    s_waitcnt lgkmcnt(5)
    s_and_b32 s56, s56, 7
    ds_read_b64_tr_b16 v[198:199], v228 offset:41984
    v_mfma_f32_16x16x32_bf16 v[32:35], v[208:211], a[64:67], v[32:35]
    s_lshl_b32 s56, s56, 13
    v_max_u32_dpp v232, v232, v232 row_mirror row_mask:0xf bank_mask:0xf
    v_mov_b32 v233, v232
    v_mfma_f32_16x16x32_bf16 v[32:35], v[212:215], a[80:83], v[32:35]
    s_add_u32 s56, s56, s73
    buffer_load_dwordx4 a[160:163], v248, s[32:35], s56 offen offset:0 sc1
    v_mfma_f32_16x16x32_bf16 v[36:39], v[208:211], a[68:71], v[36:39]
    v_permlane16_swap_b32 v232, v233
    v_max_u32 v232, v232, v233
    v_mfma_f32_16x16x32_bf16 v[36:39], v[212:215], a[84:87], v[36:39]
    v_mov_b32 v233, v232
    v_mfma_f32_16x16x32_bf16 v[40:43], v[208:211], a[72:75], v[40:43]
    ds_read_b64_tr_b16 v[200:201], v229 offset:32768
    buffer_load_dwordx4 a[164:167], v248, s[32:35], s56 offen offset:1024 sc1
    v_mfma_f32_16x16x32_bf16 v[40:43], v[212:215], a[88:91], v[40:43]
    ds_read_b64_tr_b16 v[202:203], v229 offset:33792
    v_permlane32_swap_b32 v232, v233
    v_mfma_f32_16x16x32_bf16 v[44:47], v[208:211], a[76:79], v[44:47]
    ds_read_b64_tr_b16 v[204:205], v229 offset:40960
    v_max_u32 v232, v232, v233
    v_mfma_f32_16x16x32_bf16 v[44:47], v[212:215], a[92:95], v[44:47]
    ds_read_b64_tr_b16 v[206:207], v229 offset:41984
    v_add_u32 v235, v235, v232
    v_mfma_f32_16x16x32_bf16 v[48:51], v[216:219], a[64:67], v[48:51]
    s_waitcnt lgkmcnt(4)
    v_cndmask_b32 v234, v234, v235, s[0:1]
    v_sub_u32 v236, v236, v232
    v_mfma_f32_16x16x32_bf16 v[48:51], v[220:223], a[80:83], v[48:51]
    v_sub_u32 v237, v237, v232
    v_sub_u32 v238, v238, v232
    v_mfma_f32_16x16x32_bf16 v[52:55], v[216:219], a[68:71], v[52:55]
    buffer_load_dwordx4 a[168:171], v248, s[32:35], s56 offen offset:2048 sc1
    v_sub_u32 v239, v239, v232
    v_mfma_f32_16x16x32_bf16 v[52:55], v[220:223], a[84:87], v[52:55]
    v_sub_u32 v240, v240, v232
    v_sub_u32 v241, v241, v232
    v_mfma_f32_16x16x32_bf16 v[56:59], v[216:219], a[72:75], v[56:59]
    ds_read_b64_tr_b16 v[208:209], v230 offset:32768
    v_sub_u32 v242, v242, v232
    v_mfma_f32_16x16x32_bf16 v[56:59], v[220:223], a[88:91], v[56:59]
    ds_read_b64_tr_b16 v[210:211], v230 offset:33792
    v_sub_u32 v243, v243, v232
    v_mfma_f32_16x16x32_bf16 v[60:63], v[216:219], a[76:79], v[60:63]
    ds_read_b64_tr_b16 v[212:213], v230 offset:40960
    v_max3_u32 v232, v236, v237, v238
    v_mfma_f32_16x16x32_bf16 v[60:63], v[220:223], a[92:95], v[60:63]
    ds_read_b64_tr_b16 v[214:215], v230 offset:41984
    v_max3_u32 v233, v239, v240, v241
    v_mfma_f32_16x16x32_bf16 v[64:67], v[192:195], a[64:67], v[64:67]
    buffer_load_dwordx4 a[172:175], v248, s[32:35], s56 offen offset:3072 sc1
    v_max3_u32 v232, v232, v242, v243
    v_mfma_f32_16x16x32_bf16 v[64:67], v[196:199], a[80:83], v[64:67]
    v_max_u32 v232, v232, v233
    v_cmp_eq_u32 s[0:1], 4, v250
    v_mfma_f32_16x16x32_bf16 v[68:71], v[192:195], a[68:71], v[68:71]
    v_mfma_f32_16x16x32_bf16 v[68:71], v[196:199], a[84:87], v[68:71]
    v_max_u32_dpp v232, v232, v232 quad_perm:[1,0,3,2] row_mask:0xf bank_mask:0xf
    v_mfma_f32_16x16x32_bf16 v[72:75], v[192:195], a[72:75], v[72:75]
    ds_read_b64_tr_b16 v[216:217], v231 offset:32768
    v_mfma_f32_16x16x32_bf16 v[72:75], v[196:199], a[88:91], v[72:75]
    ds_read_b64_tr_b16 v[218:219], v231 offset:33792
    v_max_u32_dpp v232, v232, v232 quad_perm:[2,3,0,1] row_mask:0xf bank_mask:0xf
    v_mfma_f32_16x16x32_bf16 v[76:79], v[192:195], a[76:79], v[76:79]
    ds_read_b64_tr_b16 v[220:221], v231 offset:40960
    v_mfma_f32_16x16x32_bf16 v[76:79], v[196:199], a[92:95], v[76:79]
    s_waitcnt lgkmcnt(5)
    s_add_u32 s56, s2, 5
    ds_read_b64_tr_b16 v[222:223], v231 offset:41984
    v_mfma_f32_16x16x32_bf16 v[80:83], v[200:203], a[64:67], v[80:83]
    s_and_b32 s56, s56, 7
    v_max_u32_dpp v232, v232, v232 row_half_mirror row_mask:0xf bank_mask:0xf
    v_mfma_f32_16x16x32_bf16 v[80:83], v[204:207], a[80:83], v[80:83]
    s_lshl_b32 s56, s56, 13
    v_mfma_f32_16x16x32_bf16 v[84:87], v[200:203], a[68:71], v[84:87]
    s_add_u32 s56, s56, s73
    v_max_u32_dpp v232, v232, v232 row_mirror row_mask:0xf bank_mask:0xf
    v_mov_b32 v233, v232
    v_mfma_f32_16x16x32_bf16 v[84:87], v[204:207], a[84:87], v[84:87]
    s_add_u32 s56, s56, 4096
    buffer_load_dwordx4 a[176:179], v248, s[32:35], s56 offen offset:0 sc1
    v_mfma_f32_16x16x32_bf16 v[88:91], v[200:203], a[72:75], v[88:91]
    v_permlane16_swap_b32 v232, v233
    v_max_u32 v232, v232, v233
    v_mfma_f32_16x16x32_bf16 v[88:91], v[204:207], a[88:91], v[88:91]
    buffer_load_dwordx4 a[180:183], v248, s[32:35], s56 offen offset:1024 sc1
    v_mov_b32 v233, v232
    v_mfma_f32_16x16x32_bf16 v[92:95], v[200:203], a[76:79], v[92:95]
    s_waitcnt vmcnt(10)
    s_waitcnt lgkmcnt(0)
    s_barrier
    ds_read_b64_tr_b16 v[192:193], v224 offset:49152
    v_mfma_f32_16x16x32_bf16 v[92:95], v[204:207], a[92:95], v[92:95]
    ds_read_b64_tr_b16 v[194:195], v224 offset:50176
    v_mov_b32 v255, s94
    s_cmp_eq_u32 s52, 0
    s_mov_b32 s58, 0x7fff0000
    s_cselect_b32 s58, 0x3a0000, s58
    buffer_store_dword v255, v254, s[32:35], s58 offen sc1
    v_mfma_f32_16x16x32_bf16 v[96:99], v[208:211], a[64:67], v[96:99]
    ds_read_b64_tr_b16 v[196:197], v224 offset:57344
    v_permlane32_swap_b32 v232, v233
    v_mfma_f32_16x16x32_bf16 v[96:99], v[212:215], a[80:83], v[96:99]
    ds_read_b64_tr_b16 v[198:199], v224 offset:58368
    v_max_u32 v232, v232, v233
    v_mfma_f32_16x16x32_bf16 v[100:103], v[208:211], a[68:71], v[100:103]
    v_add_u32 v235, v235, v232
    v_cndmask_b32 v234, v234, v235, s[0:1]
    v_mfma_f32_16x16x32_bf16 v[100:103], v[212:215], a[84:87], v[100:103]
    buffer_load_dwordx4 a[184:187], v248, s[32:35], s56 offen offset:2048 sc1
    v_sub_u32 v236, v236, v232
    v_mfma_f32_16x16x32_bf16 v[104:107], v[208:211], a[72:75], v[104:107]
    s_mov_b32 s62, s74
    ds_read_b64_tr_b16 v[200:201], v225 offset:49152
    v_sub_u32 v237, v237, v232
    v_mfma_f32_16x16x32_bf16 v[104:107], v[212:215], a[88:91], v[104:107]
    s_lshl_b32 s96, s54, 1
    ds_read_b64_tr_b16 v[202:203], v225 offset:50176
    v_sub_u32 v238, v238, v232
    v_mfma_f32_16x16x32_bf16 v[108:111], v[208:211], a[76:79], v[108:111]
    s_sub_u32 s99, 30, s96
    ds_read_b64_tr_b16 v[204:205], v225 offset:57344
    v_sub_u32 v239, v239, v232
    v_mfma_f32_16x16x32_bf16 v[108:111], v[212:215], a[92:95], v[108:111]
    s_sub_u32 s96, 3, s52
    ds_read_b64_tr_b16 v[206:207], v225 offset:58368
    v_sub_u32 v240, v240, v232
    v_mfma_f32_16x16x32_bf16 v[112:115], v[216:219], a[64:67], v[112:115]
    s_min_u32 s96, s96, s52
    v_sub_u32 v241, v241, v232
    v_sub_u32 v242, v242, v232
    v_mfma_f32_16x16x32_bf16 v[112:115], v[220:223], a[80:83], v[112:115]
    s_add_u32 s63, s96, s99
    buffer_load_dwordx4 a[188:191], v248, s[32:35], s56 offen offset:3072 sc1
    v_sub_u32 v243, v243, v232
    v_mfma_f32_16x16x32_bf16 v[116:119], v[216:219], a[68:71], v[116:119]
    s_mul_i32 s97, s53, 537600
    v_max3_u32 v232, v236, v237, v238
    v_max3_u32 v233, v239, v240, v241
    v_mfma_f32_16x16x32_bf16 v[116:119], v[220:223], a[84:87], v[116:119]
    s_cmp_lt_u32 s52, 2
    s_mov_b32 s96, 0x1009000
    s_cselect_b32 s96, 0x5800000, s96
    s_cselect_b32 s64, 0, 0xffffe000
    s_cselect_b32 s65, 0, 8192
    v_max3_u32 v232, v232, v242, v243
    v_max_u32 v232, v232, v233
    v_mfma_f32_16x16x32_bf16 v[120:123], v[216:219], a[72:75], v[120:123]
    s_add_u32 s96, s96, s97
    ds_read_b64_tr_b16 v[208:209], v226 offset:49152
    v_cmp_eq_u32 s[0:1], 5, v250
    v_mfma_f32_16x16x32_bf16 v[120:123], v[220:223], a[88:91], v[120:123]
    s_add_u32 s40, s30, s96
    s_addc_u32 s41, s31, 0
    ds_read_b64_tr_b16 v[210:211], v226 offset:50176
    v_mfma_f32_16x16x32_bf16 v[124:127], v[216:219], a[76:79], v[124:127]
    s_and_b32 s41, s41, 0xffff
    ds_read_b64_tr_b16 v[212:213], v226 offset:57344
    v_max_u32_dpp v232, v232, v232 quad_perm:[1,0,3,2] row_mask:0xf bank_mask:0xf
    v_mfma_f32_16x16x32_bf16 v[124:127], v[220:223], a[92:95], v[124:127]
    s_waitcnt lgkmcnt(5)
    ds_read_b64_tr_b16 v[214:215], v226 offset:58368
    v_mfma_f32_16x16x32_bf16 v[0:3], v[192:195], a[96:99], v[0:3]
    s_add_u32 m0, s55, 131072
    s_mov_b32 s42, 524288
    v_max_u32_dpp v232, v232, v232 quad_perm:[2,3,0,1] row_mask:0xf bank_mask:0xf
    v_mfma_f32_16x16x32_bf16 v[0:3], v[196:199], a[112:115], v[0:3]
    s_add_u32 s57, s2, 6
    s_mov_b32 s43, 0x20000
    v_mfma_f32_16x16x32_bf16 v[4:7], v[192:195], a[100:103], v[4:7]
    s_and_b32 s57, s57, 7
    s_and_b32 s96, s52, 1
    v_max_u32_dpp v232, v232, v232 row_half_mirror row_mask:0xf bank_mask:0xf
    v_mfma_f32_16x16x32_bf16 v[4:7], v[196:199], a[116:119], v[4:7]
    s_lshl_b32 s57, s57, 19
    s_lshl_b32 s96, s96, 12
    v_mfma_f32_16x16x32_bf16 v[8:11], v[192:195], a[104:107], v[8:11]
    s_add_u32 s57, s57, s59
    ds_read_b64_tr_b16 v[216:217], v227 offset:49152
    buffer_load_dwordx4 v244, s[36:39], s57 offen offset:0 lds
    v_mfma_f32_16x16x32_bf16 v[8:11], v[196:199], a[120:123], v[8:11]
    s_add_u32 s64, s64, s96
    ds_read_b64_tr_b16 v[218:219], v227 offset:50176
    v_max_u32_dpp v232, v232, v232 row_mirror row_mask:0xf bank_mask:0xf
    v_mfma_f32_16x16x32_bf16 v[12:15], v[192:195], a[108:111], v[12:15]
    s_add_u32 s65, s65, s96
    ds_read_b64_tr_b16 v[220:221], v227 offset:57344
    buffer_load_dwordx4 v245, s[36:39], s57 offen offset:1024 lds
    v_mfma_f32_16x16x32_bf16 v[12:15], v[196:199], a[124:127], v[12:15]
    s_lshl_b32 s96, s54, 2
    ds_read_b64_tr_b16 v[222:223], v227 offset:58368
    v_mov_b32 v233, v232
F_mB:
    v_mfma_f32_16x16x32_bf16 v[16:19], v[200:203], a[96:99], v[16:19]
    s_waitcnt lgkmcnt(4)
    s_max_u32 s70, s96, 2
    v_mfma_f32_16x16x32_bf16 v[16:19], v[204:207], a[112:115], v[16:19]
    s_sub_u32 s70, s70, 1
    v_permlane16_swap_b32 v232, v233
    v_max_u32 v232, v232, v233
    v_mfma_f32_16x16x32_bf16 v[20:23], v[200:203], a[100:103], v[20:23]
    s_sub_u32 s99, 64, s70
    v_mov_b32 v233, v232
    v_mfma_f32_16x16x32_bf16 v[20:23], v[204:207], a[116:119], v[20:23]
    s_mul_i32 s99, s99, 8192
    v_mfma_f32_16x16x32_bf16 v[24:27], v[200:203], a[104:107], v[24:27]
    s_add_u32 s65, s65, s99
    ds_read_b64_tr_b16 v[192:193], v228 offset:49152
    buffer_load_dwordx4 v246, s[36:39], s57 offen offset:2048 lds
    v_mfma_f32_16x16x32_bf16 v[24:27], v[204:207], a[120:123], v[24:27]
    s_lshl_b32 s99, s52, 1
    ds_read_b64_tr_b16 v[194:195], v228 offset:50176
    v_permlane32_swap_b32 v232, v233
    v_mfma_f32_16x16x32_bf16 v[28:31], v[200:203], a[108:111], v[28:31]
    s_add_u32 s99, s99, s96
    ds_read_b64_tr_b16 v[196:197], v228 offset:57344
    v_max_u32 v232, v232, v233
    v_mfma_f32_16x16x32_bf16 v[28:31], v[204:207], a[124:127], v[28:31]
    s_sub_u32 s74, s99, 5
    ds_read_b64_tr_b16 v[198:199], v228 offset:58368
    v_add_u32 v235, v235, v232
    v_mfma_f32_16x16x32_bf16 v[32:35], v[208:211], a[96:99], v[32:35]
    s_sub_u32 s75, s99, 2
    v_cndmask_b32 v234, v234, v235, s[0:1]
    v_sub_u32 v236, v236, v232
    v_mfma_f32_16x16x32_bf16 v[32:35], v[212:215], a[112:115], v[32:35]
    s_cmp_lt_u32 s52, 2
    s_cselect_b32 s74, 100, s74
    s_cselect_b32 s75, 34, s75
    v_sub_u32 v237, v237, v232
    v_sub_u32 v238, v238, v232
    v_mfma_f32_16x16x32_bf16 v[36:39], v[208:211], a[100:103], v[36:39]
    s_cmp_eq_u32 s99, 28
    s_cselect_b32 s71, 32, 100
    s_cmp_eq_u32 s52, 0
    s_cselect_b32 s71, s71, 100
    buffer_load_dwordx4 v247, s[36:39], s57 offen offset:3072 lds
    v_sub_u32 v239, v239, v232
    v_mfma_f32_16x16x32_bf16 v[36:39], v[212:215], a[116:119], v[36:39]
    s_mov_b32 s3, 0
    v_sub_u32 v240, v240, v232
    v_sub_u32 v241, v241, v232
    v_mfma_f32_16x16x32_bf16 v[40:43], v[208:211], a[104:107], v[40:43]
    s_mov_b32 s66, s55
    ds_read_b64_tr_b16 v[200:201], v229 offset:49152
    v_sub_u32 v242, v242, v232
    v_mfma_f32_16x16x32_bf16 v[40:43], v[212:215], a[120:123], v[40:43]
    s_mov_b32 s67, 0
    ds_read_b64_tr_b16 v[202:203], v229 offset:50176
    v_sub_u32 v243, v243, v232
    v_mfma_f32_16x16x32_bf16 v[44:47], v[208:211], a[108:111], v[44:47]
    s_bfe_u32 s9, s2, 0x20001
    ds_read_b64_tr_b16 v[204:205], v229 offset:57344
    v_max3_u32 v232, v236, v237, v238
    v_mfma_f32_16x16x32_bf16 v[44:47], v[212:215], a[124:127], v[44:47]
    s_waitcnt lgkmcnt(5)
    s_and_b32 s7, s2, 1
    ds_read_b64_tr_b16 v[206:207], v229 offset:58368
    v_mfma_f32_16x16x32_bf16 v[48:51], v[216:219], a[96:99], v[48:51]
    s_add_u32 s56, s2, 6
    s_lshl_b32 s96, s54, 1
    v_max3_u32 v233, v239, v240, v241
    v_mfma_f32_16x16x32_bf16 v[48:51], v[220:223], a[112:115], v[48:51]
    s_and_b32 s56, s56, 7
    s_add_u32 s7, s7, s96
    v_max3_u32 v232, v232, v242, v243
    v_mfma_f32_16x16x32_bf16 v[52:55], v[216:219], a[100:103], v[52:55]
    s_lshl_b32 s56, s56, 13
    s_and_b32 s8, s53, 3
    v_max_u32 v232, v232, v233
    v_mfma_f32_16x16x32_bf16 v[52:55], v[220:223], a[116:119], v[52:55]
    s_add_u32 s56, s56, s73
    s_lshl_b32 s10, s9, 4
    buffer_load_dwordx4 a[192:195], v248, s[32:35], s56 offen offset:0 sc1
    v_mfma_f32_16x16x32_bf16 v[56:59], v[216:219], a[104:107], v[56:59]
    s_lshl_b32 s96, s8, 2
    ds_read_b64_tr_b16 v[208:209], v230 offset:49152
    v_cmp_eq_u32 s[0:1], 6, v250
    v_mfma_f32_16x16x32_bf16 v[56:59], v[220:223], a[120:123], v[56:59]
    s_add_u32 s10, s10, s96
    ds_read_b64_tr_b16 v[210:211], v230 offset:50176
    v_mfma_f32_16x16x32_bf16 v[60:63], v[216:219], a[108:111], v[60:63]
    s_add_u32 s10, s10, s52
    ds_read_b64_tr_b16 v[212:213], v230 offset:57344
    buffer_load_dwordx4 a[196:199], v248, s[32:35], s56 offen offset:1024 sc1
    v_mfma_f32_16x16x32_bf16 v[60:63], v[220:223], a[124:127], v[60:63]
    s_mul_i32 s10, s10, 70656
    ds_read_b64_tr_b16 v[214:215], v230 offset:58368
    v_max_u32_dpp v232, v232, v232 quad_perm:[1,0,3,2] row_mask:0xf bank_mask:0xf
    v_mfma_f32_16x16x32_bf16 v[64:67], v[192:195], a[96:99], v[64:67]
    s_waitcnt lgkmcnt(4)
    s_add_u32 s10, s10, 0x5100000
    v_mfma_f32_16x16x32_bf16 v[64:67], v[196:199], a[112:115], v[64:67]
    s_lshl_b32 s13, s52, 13
    v_max_u32_dpp v232, v232, v232 quad_perm:[2,3,0,1] row_mask:0xf bank_mask:0xf
    v_mfma_f32_16x16x32_bf16 v[68:71], v[192:195], a[100:103], v[68:71]
    s_lshl_b32 s96, s9, 17
    v_mfma_f32_16x16x32_bf16 v[68:71], v[196:199], a[116:119], v[68:71]
    s_lshl_b32 s99, s52, 13
    v_max_u32_dpp v232, v232, v232 row_half_mirror row_mask:0xf bank_mask:0xf
    v_mfma_f32_16x16x32_bf16 v[72:75], v[192:195], a[104:107], v[72:75]
    s_add_u32 s96, s96, s99
    ds_read_b64_tr_b16 v[216:217], v231 offset:49152
    buffer_load_dwordx4 a[200:203], v248, s[32:35], s56 offen offset:2048 sc1
    v_mfma_f32_16x16x32_bf16 v[72:75], v[196:199], a[120:123], v[72:75]
    s_add_u32 s96, s96, 0x31ff000
    ds_read_b64_tr_b16 v[218:219], v231 offset:50176
    v_max_u32_dpp v232, v232, v232 row_mirror row_mask:0xf bank_mask:0xf
    v_mfma_f32_16x16x32_bf16 v[76:79], v[192:195], a[108:111], v[76:79]
    s_mul_i32 s11, s7, 529408
    ds_read_b64_tr_b16 v[220:221], v231 offset:57344
    v_mov_b32 v233, v232
    v_mfma_f32_16x16x32_bf16 v[76:79], v[196:199], a[124:127], v[76:79]
    s_sub_u32 s12, 0xfa6c00, s11
    ds_read_b64_tr_b16 v[222:223], v231 offset:58368
    v_mfma_f32_16x16x32_bf16 v[80:83], v[200:203], a[96:99], v[80:83]
    s_add_u32 s11, s11, s96
    v_permlane16_swap_b32 v232, v233
    v_max_u32 v232, v232, v233
    v_mfma_f32_16x16x32_bf16 v[80:83], v[204:207], a[112:115], v[80:83]
    s_add_u32 s12, s12, s96
    v_mov_b32 v233, v232
    v_mfma_f32_16x16x32_bf16 v[84:87], v[200:203], a[100:103], v[84:87]
    s_mul_i32 s96, s52, 24576
    buffer_load_dwordx4 a[204:207], v248, s[32:35], s56 offen offset:3072 sc1
    v_mfma_f32_16x16x32_bf16 v[84:87], v[204:207], a[116:119], v[84:87]
    s_add_u32 s12, s12, s96
    v_permlane32_swap_b32 v232, v233
    v_max_u32 v232, v232, v233
    v_mfma_f32_16x16x32_bf16 v[88:91], v[200:203], a[104:107], v[88:91]
    s_add_u32 s12, s12, 4096
    v_add_u32 v235, v235, v232
    v_cndmask_b32 v234, v234, v235, s[0:1]
    v_mfma_f32_16x16x32_bf16 v[88:91], v[204:207], a[120:123], v[88:91]
    s_lshr_b32 s99, s2, 6
    v_sub_u32 v236, v236, v232
    v_sub_u32 v237, v237, v232
    v_mfma_f32_16x16x32_bf16 v[92:95], v[200:203], a[108:111], v[92:95]
    s_waitcnt lgkmcnt(0)
    s_barrier
    v_add_u32 v224, 0x10000, v224
    v_add_u32 v225, 0x10000, v225
    v_add_u32 v226, 0x10000, v226
    v_add_u32 v227, 0x10000, v227
    v_add_u32 v228, 0x10000, v228
    v_add_u32 v229, 0x10000, v229
    v_add_u32 v230, 0x10000, v230
    v_add_u32 v231, 0x10000, v231
    s_max_u32 s96, s99, 1
    ds_read_b64_tr_b16 v[192:193], v224 offset:0
    v_sub_u32 v238, v238, v232
    v_mfma_f32_16x16x32_bf16 v[92:95], v[204:207], a[124:127], v[92:95]
    s_sub_u32 s96, s96, 1
    ds_read_b64_tr_b16 v[194:195], v224 offset:1024
    v_mfma_f32_16x16x32_bf16 v[96:99], v[208:211], a[96:99], v[96:99]
    s_lshl_b32 s96, s96, 5
    ds_read_b64_tr_b16 v[196:197], v224 offset:8192
    v_sub_u32 v239, v239, v232
    v_mfma_f32_16x16x32_bf16 v[96:99], v[212:215], a[112:115], v[96:99]
    s_add_u32 s56, s2, 6
    s_cmp_eq_u32 s99, 1
    s_cselect_b32 s99, 1000, s96
    ds_read_b64_tr_b16 v[198:199], v224 offset:9216
    v_mfma_f32_16x16x32_bf16 v[100:103], v[208:211], a[100:103], v[100:103]
    s_and_b32 s56, s56, 7
    s_and_b32 s96, s2, 63
    v_sub_u32 v240, v240, v232
    v_mfma_f32_16x16x32_bf16 v[100:103], v[212:215], a[116:119], v[100:103]
    s_lshl_b32 s56, s56, 13
    s_sub_u32 s96, s96, 16
    v_sub_u32 v241, v241, v232
    v_mfma_f32_16x16x32_bf16 v[104:107], v[208:211], a[104:107], v[104:107]
    s_add_u32 s56, s56, s73
    s_add_u32 s99, s99, s96
    ds_read_b64_tr_b16 v[200:201], v225 offset:0
    v_mfma_f32_16x16x32_bf16 v[104:107], v[212:215], a[120:123], v[104:107]
    s_add_u32 s56, s56, 4096
    ds_read_b64_tr_b16 v[202:203], v225 offset:1024
    buffer_load_dwordx4 a[208:211], v248, s[32:35], s56 offen offset:0 sc1
    v_mfma_f32_16x16x32_bf16 v[108:111], v[208:211], a[108:111], v[108:111]
    s_cmp_lt_u32 s96, 32
    s_cselect_b32 s99, s99, 1000
    s_cmp_lt_u32 s99, 86
    s_cselect_b32 s17, 0, 0x40000000
    ds_read_b64_tr_b16 v[204:205], v225 offset:8192
    v_sub_u32 v242, v242, v232
    v_mfma_f32_16x16x32_bf16 v[108:111], v[212:215], a[124:127], v[108:111]
    s_mov_b64 s[60:61], 0
    ds_read_b64_tr_b16 v[206:207], v225 offset:9216
    v_sub_u32 v243, v243, v232
    v_mfma_f32_16x16x32_bf16 v[112:115], v[216:219], a[96:99], v[112:115]
    s_waitcnt lgkmcnt(6)
    s_cmp_eq_u32 s52, 1
    s_cselect_b32 s60, 12288, 0
    buffer_load_dwordx4 a[212:215], v248, s[32:35], s56 offen offset:1024 sc1
    v_mfma_f32_16x16x32_bf16 v[112:115], v[220:223], a[112:115], v[112:115]
    s_bitset1_b64 s[60:61], 32
    v_max3_u32 v232, v236, v237, v238
    v_max3_u32 v233, v239, v240, v241
    v_mfma_f32_16x16x32_bf16 v[116:119], v[216:219], a[100:103], v[116:119]
    s_bitset1_b64 s[60:61], s70
    v_max3_u32 v232, v232, v242, v243
    v_max_u32 v232, v232, v233
    v_mfma_f32_16x16x32_bf16 v[116:119], v[220:223], a[116:119], v[116:119]
    s_bitset1_b64 s[60:61], s74
    v_cmp_eq_u32 s[0:1], 7, v250
    v_mfma_f32_16x16x32_bf16 v[120:123], v[216:219], a[104:107], v[120:123]
    ds_read_b64_tr_b16 v[208:209], v226 offset:0
    v_mfma_f32_16x16x32_bf16 v[120:123], v[220:223], a[120:123], v[120:123]
    ds_read_b64_tr_b16 v[210:211], v226 offset:1024
    buffer_load_dwordx4 a[216:219], v248, s[32:35], s56 offen offset:2048 sc1
    v_mfma_f32_16x16x32_bf16 v[124:127], v[216:219], a[108:111], v[124:127]
    ds_read_b64_tr_b16 v[212:213], v226 offset:8192
    v_max_u32_dpp v232, v232, v232 quad_perm:[1,0,3,2] row_mask:0xf bank_mask:0xf
    v_mfma_f32_16x16x32_bf16 v[124:127], v[220:223], a[124:127], v[124:127]
    ds_read_b64_tr_b16 v[214:215], v226 offset:9216
    v_mfma_f32_16x16x32_bf16 v[0:3], v[192:195], a[128:131], v[0:3]
    s_waitcnt lgkmcnt(4)
    v_max_u32_dpp v232, v232, v232 quad_perm:[2,3,0,1] row_mask:0xf bank_mask:0xf
    v_mfma_f32_16x16x32_bf16 v[0:3], v[196:199], a[144:147], v[0:3]
    v_mfma_f32_16x16x32_bf16 v[4:7], v[192:195], a[132:135], v[4:7]
    v_max_u32_dpp v232, v232, v232 row_half_mirror row_mask:0xf bank_mask:0xf
    v_mfma_f32_16x16x32_bf16 v[4:7], v[196:199], a[148:151], v[4:7]
    buffer_load_dwordx4 a[220:223], v248, s[32:35], s56 offen offset:3072 sc1
    v_mfma_f32_16x16x32_bf16 v[8:11], v[192:195], a[136:139], v[8:11]
    ds_read_b64_tr_b16 v[216:217], v227 offset:0
    v_max_u32_dpp v232, v232, v232 row_mirror row_mask:0xf bank_mask:0xf
    v_mfma_f32_16x16x32_bf16 v[8:11], v[196:199], a[152:155], v[8:11]
    ds_read_b64_tr_b16 v[218:219], v227 offset:1024
    v_mov_b32 v233, v232
    v_mfma_f32_16x16x32_bf16 v[12:15], v[192:195], a[140:143], v[12:15]
    ds_read_b64_tr_b16 v[220:221], v227 offset:8192
    v_mfma_f32_16x16x32_bf16 v[12:15], v[196:199], a[156:159], v[12:15]
    ds_read_b64_tr_b16 v[222:223], v227 offset:9216
    v_permlane16_swap_b32 v232, v233
    v_mfma_f32_16x16x32_bf16 v[16:19], v[200:203], a[128:131], v[16:19]
    v_max_u32 v232, v232, v233
    v_mov_b32 v233, v232
    v_mfma_f32_16x16x32_bf16 v[16:19], v[204:207], a[144:147], v[16:19]
    v_mfma_f32_16x16x32_bf16 v[20:23], v[200:203], a[132:135], v[20:23]
    s_add_u32 m0, s55, 147456
    v_permlane32_swap_b32 v232, v233
    v_max_u32 v232, v232, v233
    v_mfma_f32_16x16x32_bf16 v[20:23], v[204:207], a[148:151], v[20:23]
    s_add_u32 s57, s2, 7
    v_add_u32 v235, v235, v232
    v_cndmask_b32 v234, v234, v235, s[0:1]
    v_mfma_f32_16x16x32_bf16 v[24:27], v[200:203], a[136:139], v[24:27]
    s_and_b32 s57, s57, 7
    s_lshl_b32 s98, s52, 5
    ds_read_b64_tr_b16 v[192:193], v228 offset:0
    v_mfma_f32_16x16x32_bf16 v[24:27], v[204:207], a[152:155], v[24:27]
    s_lshl_b32 s57, s57, 19
    s_add_u32 s98, s98, 65536
    ds_read_b64_tr_b16 v[194:195], v228 offset:1024
    v_mfma_f32_16x16x32_bf16 v[28:31], v[200:203], a[140:143], v[28:31]
    s_add_u32 s57, s57, s59
    ds_read_b64_tr_b16 v[196:197], v228 offset:8192
    buffer_load_dwordx4 v244, s[36:39], s57 offen offset:0 lds
    v_mfma_f32_16x16x32_bf16 v[28:31], v[204:207], a[156:159], v[28:31]
    s_waitcnt lgkmcnt(5)
    ds_read_b64_tr_b16 v[198:199], v228 offset:9216
    v_lshl_add_u32 v251, v250, 2, s98
    v_mfma_f32_16x16x32_bf16 v[32:35], v[208:211], a[128:131], v[32:35]
    buffer_load_dwordx4 v245, s[36:39], s57 offen offset:1024 lds
    ds_write_b32 v251, v234
    v_mfma_f32_16x16x32_bf16 v[32:35], v[212:215], a[144:147], v[32:35]
    v_mfma_f32_16x16x32_bf16 v[36:39], v[208:211], a[132:135], v[36:39]
    v_mfma_f32_16x16x32_bf16 v[36:39], v[212:215], a[148:151], v[36:39]
    v_mfma_f32_16x16x32_bf16 v[40:43], v[208:211], a[136:139], v[40:43]
    ds_read_b64_tr_b16 v[200:201], v229 offset:0
    v_mfma_f32_16x16x32_bf16 v[40:43], v[212:215], a[152:155], v[40:43]
    ds_read_b64_tr_b16 v[202:203], v229 offset:1024
    v_mfma_f32_16x16x32_bf16 v[44:47], v[208:211], a[140:143], v[44:47]
    ds_read_b64_tr_b16 v[204:205], v229 offset:8192
    buffer_load_dwordx4 v246, s[36:39], s57 offen offset:2048 lds
    v_mfma_f32_16x16x32_bf16 v[44:47], v[212:215], a[156:159], v[44:47]
    ds_read_b64_tr_b16 v[206:207], v229 offset:9216
    v_mfma_f32_16x16x32_bf16 v[48:51], v[216:219], a[128:131], v[48:51]
    s_waitcnt lgkmcnt(5)
    v_mfma_f32_16x16x32_bf16 v[48:51], v[220:223], a[144:147], v[48:51]
    v_mfma_f32_16x16x32_bf16 v[52:55], v[216:219], a[132:135], v[52:55]
    v_mfma_f32_16x16x32_bf16 v[52:55], v[220:223], a[148:151], v[52:55]
    v_mfma_f32_16x16x32_bf16 v[56:59], v[216:219], a[136:139], v[56:59]
    ds_read_b64_tr_b16 v[208:209], v230 offset:0
    buffer_load_dwordx4 v247, s[36:39], s57 offen offset:3072 lds
    v_mfma_f32_16x16x32_bf16 v[56:59], v[220:223], a[152:155], v[56:59]
    ds_read_b64_tr_b16 v[210:211], v230 offset:1024
    v_mfma_f32_16x16x32_bf16 v[60:63], v[216:219], a[140:143], v[60:63]
    ds_read_b64_tr_b16 v[212:213], v230 offset:8192
    v_mfma_f32_16x16x32_bf16 v[60:63], v[220:223], a[156:159], v[60:63]
    ds_read_b64_tr_b16 v[214:215], v230 offset:9216
    v_mfma_f32_16x16x32_bf16 v[64:67], v[192:195], a[128:131], v[64:67]
    v_mfma_f32_16x16x32_bf16 v[64:67], v[196:199], a[144:147], v[64:67]
    v_mfma_f32_16x16x32_bf16 v[68:71], v[192:195], a[132:135], v[68:71]
    s_add_u32 s56, s2, 7
    v_mfma_f32_16x16x32_bf16 v[68:71], v[196:199], a[148:151], v[68:71]
    s_and_b32 s56, s56, 7
    v_mfma_f32_16x16x32_bf16 v[72:75], v[192:195], a[136:139], v[72:75]
    s_lshl_b32 s56, s56, 13
    ds_read_b64_tr_b16 v[216:217], v231 offset:0
    v_mfma_f32_16x16x32_bf16 v[72:75], v[196:199], a[152:155], v[72:75]
    s_add_u32 s56, s56, s73
    ds_read_b64_tr_b16 v[218:219], v231 offset:1024
    buffer_load_dwordx4 a[224:227], v248, s[32:35], s56 offen offset:0 sc1
    v_mfma_f32_16x16x32_bf16 v[76:79], v[192:195], a[140:143], v[76:79]
    ds_read_b64_tr_b16 v[220:221], v231 offset:8192
    v_mfma_f32_16x16x32_bf16 v[76:79], v[196:199], a[156:159], v[76:79]
    s_waitcnt lgkmcnt(5)
    ds_read_b64_tr_b16 v[222:223], v231 offset:9216
    v_mfma_f32_16x16x32_bf16 v[80:83], v[200:203], a[128:131], v[80:83]
    buffer_load_dwordx4 a[228:231], v248, s[32:35], s56 offen offset:1024 sc1
    v_mfma_f32_16x16x32_bf16 v[80:83], v[204:207], a[144:147], v[80:83]
    v_min_u32 v253, 7, v249
    v_lshlrev_b32 v253, 2, v253
    buffer_load_dword v252, v253, s[32:35], s95 offen offset:0 sc1
    v_mfma_f32_16x16x32_bf16 v[84:87], v[200:203], a[132:135], v[84:87]
    v_mfma_f32_16x16x32_bf16 v[84:87], v[204:207], a[148:151], v[84:87]
    v_mfma_f32_16x16x32_bf16 v[88:91], v[200:203], a[136:139], v[88:91]
    v_mfma_f32_16x16x32_bf16 v[88:91], v[204:207], a[152:155], v[88:91]
    v_mfma_f32_16x16x32_bf16 v[92:95], v[200:203], a[140:143], v[92:95]
    s_waitcnt vmcnt(28)
    s_waitcnt lgkmcnt(0)
    s_barrier
    ds_read_b64_tr_b16 v[192:193], v224 offset:16384
    buffer_load_dwordx4 a[232:235], v248, s[32:35], s56 offen offset:2048 sc1
    v_mfma_f32_16x16x32_bf16 v[92:95], v[204:207], a[156:159], v[92:95]
    ds_read_b64_tr_b16 v[194:195], v224 offset:17408
    v_and_b32 v251, 31, v249
    v_mfma_f32_16x16x32_bf16 v[96:99], v[208:211], a[128:131], v[96:99]
    ds_read_b64_tr_b16 v[196:197], v224 offset:24576
    v_lshlrev_b32 v251, 2, v251
    v_mfma_f32_16x16x32_bf16 v[96:99], v[212:215], a[144:147], v[96:99]
    ds_read_b64_tr_b16 v[198:199], v224 offset:25600
    v_add_u32 v251, 65536, v251
    v_mfma_f32_16x16x32_bf16 v[100:103], v[208:211], a[132:135], v[100:103]
    ds_read_b32 v236, v251
    v_mov_b32 v235, 0
    v_mfma_f32_16x16x32_bf16 v[100:103], v[212:215], a[148:151], v[100:103]
    v_mfma_f32_16x16x32_bf16 v[104:107], v[208:211], a[136:139], v[104:107]
    ds_read_b64_tr_b16 v[200:201], v225 offset:16384
    buffer_load_dwordx4 a[236:239], v248, s[32:35], s56 offen offset:3072 sc1
    v_mfma_f32_16x16x32_bf16 v[104:107], v[212:215], a[152:155], v[104:107]
    ds_read_b64_tr_b16 v[202:203], v225 offset:17408
    v_mfma_f32_16x16x32_bf16 v[108:111], v[208:211], a[140:143], v[108:111]
    ds_read_b64_tr_b16 v[204:205], v225 offset:24576
    v_mfma_f32_16x16x32_bf16 v[108:111], v[212:215], a[156:159], v[108:111]
    ds_read_b64_tr_b16 v[206:207], v225 offset:25600
    v_mfma_f32_16x16x32_bf16 v[112:115], v[216:219], a[128:131], v[112:115]
    s_waitcnt lgkmcnt(4)
    v_sub_u32 v232, v236, v235
    v_cmp_eq_u32 s[0:1], 0, v250
    v_mfma_f32_16x16x32_bf16 v[112:115], v[220:223], a[144:147], v[112:115]
    v_mfma_f32_16x16x32_bf16 v[116:119], v[216:219], a[132:135], v[116:119]
    v_max_u32_dpp v232, v232, v232 quad_perm:[1,0,3,2] row_mask:0xf bank_mask:0xf
    v_mfma_f32_16x16x32_bf16 v[116:119], v[220:223], a[148:151], v[116:119]
    v_mfma_f32_16x16x32_bf16 v[120:123], v[216:219], a[136:139], v[120:123]
    s_add_u32 s56, s2, 7
    ds_read_b64_tr_b16 v[208:209], v226 offset:16384
    v_max_u32_dpp v232, v232, v232 quad_perm:[2,3,0,1] row_mask:0xf bank_mask:0xf
    v_mfma_f32_16x16x32_bf16 v[120:123], v[220:223], a[152:155], v[120:123]
    s_and_b32 s56, s56, 7
    ds_read_b64_tr_b16 v[210:211], v226 offset:17408
    v_mfma_f32_16x16x32_bf16 v[124:127], v[216:219], a[140:143], v[124:127]
    s_lshl_b32 s56, s56, 13
    ds_read_b64_tr_b16 v[212:213], v226 offset:24576
    v_max_u32_dpp v232, v232, v232 row_half_mirror row_mask:0xf bank_mask:0xf
    v_mfma_f32_16x16x32_bf16 v[124:127], v[220:223], a[156:159], v[124:127]
    s_waitcnt lgkmcnt(5)
    s_add_u32 s56, s56, s73
    s_waitcnt vmcnt(21)
    ds_read_b64_tr_b16 v[214:215], v226 offset:25600
    v_mfma_f32_16x16x32_bf16 v[0:3], v[192:195], a[160:163], v[0:3]
    s_add_u32 s56, s56, 4096
    buffer_load_dwordx4 a[240:243], v248, s[32:35], s56 offen offset:0 sc1
    v_max_u32_dpp v232, v232, v232 row_mirror row_mask:0xf bank_mask:0xf
    v_mfma_f32_16x16x32_bf16 v[0:3], v[196:199], a[176:179], v[0:3]
    buffer_load_dwordx4 a[244:247], v248, s[32:35], s56 offen offset:1024 sc1
    v_mov_b32 v233, v232
    v_mfma_f32_16x16x32_bf16 v[4:7], v[192:195], a[164:167], v[4:7]
    v_mfma_f32_16x16x32_bf16 v[4:7], v[196:199], a[180:183], v[4:7]
    v_permlane16_swap_b32 v232, v233
    v_max_u32 v232, v232, v233
    v_mfma_f32_16x16x32_bf16 v[8:11], v[192:195], a[168:171], v[8:11]
    ds_read_b64_tr_b16 v[216:217], v227 offset:16384
    v_add_u32 v235, v235, v232
    v_mfma_f32_16x16x32_bf16 v[8:11], v[196:199], a[184:187], v[8:11]
    ds_read_b64_tr_b16 v[218:219], v227 offset:17408
    v_cndmask_b32 v234, v234, v235, s[0:1]
    v_mfma_f32_16x16x32_bf16 v[12:15], v[192:195], a[172:175], v[12:15]
    ds_read_b64_tr_b16 v[220:221], v227 offset:24576
    v_sub_u32 v232, v236, v235
    v_mfma_f32_16x16x32_bf16 v[12:15], v[196:199], a[188:191], v[12:15]
    ds_read_b64_tr_b16 v[222:223], v227 offset:25600
    v_cmp_eq_u32 s[0:1], 1, v250
    v_mfma_f32_16x16x32_bf16 v[16:19], v[200:203], a[160:163], v[16:19]
    s_waitcnt lgkmcnt(4)
    buffer_load_dwordx4 a[248:251], v248, s[32:35], s56 offen offset:2048 sc1
    v_mfma_f32_16x16x32_bf16 v[16:19], v[204:207], a[176:179], v[16:19]
    v_max_u32_dpp v232, v232, v232 quad_perm:[1,0,3,2] row_mask:0xf bank_mask:0xf
    v_mfma_f32_16x16x32_bf16 v[20:23], v[200:203], a[164:167], v[20:23]
    v_mfma_f32_16x16x32_bf16 v[20:23], v[204:207], a[180:183], v[20:23]
    v_max_u32_dpp v232, v232, v232 quad_perm:[2,3,0,1] row_mask:0xf bank_mask:0xf
    v_mfma_f32_16x16x32_bf16 v[24:27], v[200:203], a[168:171], v[24:27]
    ds_read_b64_tr_b16 v[192:193], v228 offset:16384
    v_mfma_f32_16x16x32_bf16 v[24:27], v[204:207], a[184:187], v[24:27]
    ds_read_b64_tr_b16 v[194:195], v228 offset:17408
    buffer_load_dwordx4 a[252:255], v248, s[32:35], s56 offen offset:3072 sc1
    v_mfma_f32_16x16x32_bf16 v[28:31], v[200:203], a[172:175], v[28:31]
    ds_read_b64_tr_b16 v[196:197], v228 offset:24576
    v_max_u32_dpp v232, v232, v232 row_half_mirror row_mask:0xf bank_mask:0xf
    v_mfma_f32_16x16x32_bf16 v[28:31], v[204:207], a[188:191], v[28:31]
    ds_read_b64_tr_b16 v[198:199], v228 offset:25600
    v_mfma_f32_16x16x32_bf16 v[32:35], v[208:211], a[160:163], v[32:35]
    v_max_u32_dpp v232, v232, v232 row_mirror row_mask:0xf bank_mask:0xf
    v_mov_b32 v233, v232
    v_mfma_f32_16x16x32_bf16 v[32:35], v[212:215], a[176:179], v[32:35]
    v_mfma_f32_16x16x32_bf16 v[36:39], v[208:211], a[164:167], v[36:39]
    v_permlane16_swap_b32 v232, v233
    v_max_u32 v232, v232, v233
    v_mfma_f32_16x16x32_bf16 v[36:39], v[212:215], a[180:183], v[36:39]
    v_add_u32 v235, v235, v232
    v_cndmask_b32 v234, v234, v235, s[0:1]
    v_mfma_f32_16x16x32_bf16 v[40:43], v[208:211], a[168:171], v[40:43]
    ds_read_b64_tr_b16 v[200:201], v229 offset:16384
    v_sub_u32 v232, v236, v235
    v_mfma_f32_16x16x32_bf16 v[40:43], v[212:215], a[184:187], v[40:43]
    ds_read_b64_tr_b16 v[202:203], v229 offset:17408
    v_cmp_eq_u32 s[0:1], 2, v250
    v_mfma_f32_16x16x32_bf16 v[44:47], v[208:211], a[172:175], v[44:47]
    ds_read_b64_tr_b16 v[204:205], v229 offset:24576
    s_waitcnt vmcnt(6)
    s_mov_b32 s16, 100000
F_pl4:
    v_cmp_ne_u32 vcc, s94, v252
    s_nop 4
    s_cbranch_vccz F_pd4
    s_sleep 4
    buffer_load_dword v252, v253, s[32:35], s95 offen offset:0 sc1
    s_sub_u32 s16, s16, 1
    s_waitcnt vmcnt(0)
    s_cbranch_scc0 F_pl4
F_pd4:
    v_mfma_f32_16x16x32_bf16 v[44:47], v[212:215], a[188:191], v[44:47]
    s_waitcnt lgkmcnt(5)
    ds_read_b64_tr_b16 v[206:207], v229 offset:25600
    v_max_u32_dpp v232, v232, v232 quad_perm:[1,0,3,2] row_mask:0xf bank_mask:0xf
    v_mfma_f32_16x16x32_bf16 v[48:51], v[216:219], a[160:163], v[48:51]
    v_mfma_f32_16x16x32_bf16 v[48:51], v[220:223], a[176:179], v[48:51]
    v_max_u32_dpp v232, v232, v232 quad_perm:[2,3,0,1] row_mask:0xf bank_mask:0xf
    v_mfma_f32_16x16x32_bf16 v[52:55], v[216:219], a[164:167], v[52:55]
    v_mfma_f32_16x16x32_bf16 v[52:55], v[220:223], a[180:183], v[52:55]
    v_max_u32_dpp v232, v232, v232 row_half_mirror row_mask:0xf bank_mask:0xf
    v_mfma_f32_16x16x32_bf16 v[56:59], v[216:219], a[168:171], v[56:59]
    s_add_u32 m0, s55, 0
    ds_read_b64_tr_b16 v[208:209], v230 offset:16384
    v_mfma_f32_16x16x32_bf16 v[56:59], v[220:223], a[184:187], v[56:59]
    s_nop 0
    ds_read_b64_tr_b16 v[210:211], v230 offset:17408
    buffer_load_dwordx4 v248, s[40:43], s64 offen offset:0 sc1 lds
    v_mfma_f32_16x16x32_bf16 v[60:63], v[216:219], a[172:175], v[60:63]
    ds_read_b64_tr_b16 v[212:213], v230 offset:24576
    buffer_load_dwordx4 v248, s[40:43], s64 offen offset:1024 sc1 lds
    v_mfma_f32_16x16x32_bf16 v[60:63], v[220:223], a[188:191], v[60:63]
    ds_read_b64_tr_b16 v[214:215], v230 offset:25600
    v_max_u32_dpp v232, v232, v232 row_mirror row_mask:0xf bank_mask:0xf
    v_mfma_f32_16x16x32_bf16 v[64:67], v[192:195], a[160:163], v[64:67]
    s_waitcnt lgkmcnt(4)
    v_mov_b32 v233, v232
    v_mfma_f32_16x16x32_bf16 v[64:67], v[196:199], a[176:179], v[64:67]
    buffer_load_dwordx4 v248, s[40:43], s64 offen offset:2048 sc1 lds
    v_mfma_f32_16x16x32_bf16 v[68:71], v[192:195], a[164:167], v[68:71]
    v_lshrrev_b32 v240, 3, v249
    v_mul_u32_u24 v241, 2752, v240
    v_mfma_f32_16x16x32_bf16 v[68:71], v[196:199], a[180:183], v[68:71]
    v_lshlrev_b32 v240, 10, v240
    v_and_b32 v242, 7, v249
    v_mfma_f32_16x16x32_bf16 v[72:75], v[192:195], a[168:171], v[72:75]
    ds_read_b64_tr_b16 v[216:217], v231 offset:16384
    buffer_load_dwordx4 v248, s[40:43], s64 offen offset:3072 sc1 lds
    v_mfma_f32_16x16x32_bf16 v[72:75], v[196:199], a[184:187], v[72:75]
    ds_read_b64_tr_b16 v[218:219], v231 offset:17408
    v_lshl_add_u32 v240, v242, 4, v240
    v_mfma_f32_16x16x32_bf16 v[76:79], v[192:195], a[172:175], v[76:79]
    s_add_u32 s64, s64, 8192
    ds_read_b64_tr_b16 v[220:221], v231 offset:24576
    v_lshl_add_u32 v241, v242, 4, v241
    v_mfma_f32_16x16x32_bf16 v[76:79], v[196:199], a[188:191], v[76:79]
    s_add_u32 m0, s55, 16384
    ds_read_b64_tr_b16 v[222:223], v231 offset:25600
    v_permlane16_swap_b32 v232, v233
    v_mfma_f32_16x16x32_bf16 v[80:83], v[200:203], a[160:163], v[80:83]
    s_nop 0
    buffer_load_dwordx4 v248, s[40:43], s64 offen offset:0 sc1 lds
    v_max_u32 v232, v232, v233
    v_mfma_f32_16x16x32_bf16 v[80:83], v[204:207], a[176:179], v[80:83]
    v_add_u32 v235, v235, v232
    v_cndmask_b32 v234, v234, v235, s[0:1]
    v_mfma_f32_16x16x32_bf16 v[84:87], v[200:203], a[164:167], v[84:87]
    buffer_load_dwordx4 v248, s[40:43], s64 offen offset:1024 sc1 lds
    v_sub_u32 v232, v236, v235
    v_mfma_f32_16x16x32_bf16 v[84:87], v[204:207], a[180:183], v[84:87]
    v_cmp_eq_u32 s[0:1], 3, v250
    v_mfma_f32_16x16x32_bf16 v[88:91], v[200:203], a[168:171], v[88:91]
    v_mfma_f32_16x16x32_bf16 v[88:91], v[204:207], a[184:187], v[88:91]
    buffer_load_dwordx4 v248, s[40:43], s64 offen offset:2048 sc1 lds
    v_max_u32_dpp v232, v232, v232 quad_perm:[1,0,3,2] row_mask:0xf bank_mask:0xf
    v_mfma_f32_16x16x32_bf16 v[92:95], v[200:203], a[172:175], v[92:95]
    s_waitcnt lgkmcnt(0)
    s_barrier
    ds_read_b64_tr_b16 v[192:193], v224 offset:32768
    v_mfma_f32_16x16x32_bf16 v[92:95], v[204:207], a[188:191], v[92:95]
    ds_read_b64_tr_b16 v[194:195], v224 offset:33792
    v_max_u32_dpp v232, v232, v232 quad_perm:[2,3,0,1] row_mask:0xf bank_mask:0xf
    v_mfma_f32_16x16x32_bf16 v[96:99], v[208:211], a[160:163], v[96:99]
    ds_read_b64_tr_b16 v[196:197], v224 offset:40960
    buffer_load_dwordx4 v248, s[40:43], s64 offen offset:3072 sc1 lds
    v_mfma_f32_16x16x32_bf16 v[96:99], v[212:215], a[176:179], v[96:99]
    s_add_u32 s64, s64, 8192
    ds_read_b64_tr_b16 v[198:199], v224 offset:41984
    v_min_u32 v243, 10, v249
    v_mfma_f32_16x16x32_bf16 v[100:103], v[208:211], a[164:167], v[100:103]
    s_add_u32 m0, s55, 32768
    v_lshlrev_b32 v243, 7, v243
    v_max_u32_dpp v232, v232, v232 row_half_mirror row_mask:0xf bank_mask:0xf
    v_mfma_f32_16x16x32_bf16 v[100:103], v[212:215], a[180:183], v[100:103]
    s_nop 0
    buffer_load_dwordx4 v248, s[40:43], s64 offen offset:0 sc1 lds
    v_mfma_f32_16x16x32_bf16 v[104:107], v[208:211], a[168:171], v[104:107]
    ds_read_b64_tr_b16 v[200:201], v225 offset:32768
    v_max_u32_dpp v232, v232, v232 row_mirror row_mask:0xf bank_mask:0xf
    v_mfma_f32_16x16x32_bf16 v[104:107], v[212:215], a[184:187], v[104:107]
    ds_read_b64_tr_b16 v[202:203], v225 offset:33792
    buffer_load_dwordx4 v248, s[40:43], s64 offen offset:1024 sc1 lds
    v_mfma_f32_16x16x32_bf16 v[108:111], v[208:211], a[172:175], v[108:111]
    s_lshr_b32 s59, s2, 6
    ds_read_b64_tr_b16 v[204:205], v225 offset:40960
    v_mov_b32 v233, v232
    v_mfma_f32_16x16x32_bf16 v[108:111], v[212:215], a[188:191], v[108:111]
    s_lshl_b32 s59, s59, 4
    ds_read_b64_tr_b16 v[206:207], v225 offset:41984
    v_mfma_f32_16x16x32_bf16 v[112:115], v[216:219], a[160:163], v[112:115]
    s_waitcnt lgkmcnt(6)
    s_and_b32 s73, s2, 1
    buffer_load_dwordx4 v248, s[40:43], s64 offen offset:2048 sc1 lds
    v_mfma_f32_16x16x32_bf16 v[112:115], v[220:223], a[176:179], v[112:115]
    s_lshl_b32 s73, s73, 3
    v_permlane16_swap_b32 v232, v233
    v_max_u32 v232, v232, v233
    v_mfma_f32_16x16x32_bf16 v[116:119], v[216:219], a[164:167], v[116:119]
    s_add_u32 s59, s59, s73
    v_add_u32 v235, v235, v232
    v_cndmask_b32 v234, v234, v235, s[0:1]
    v_mfma_f32_16x16x32_bf16 v[116:119], v[220:223], a[180:183], v[116:119]
    s_lshl_b32 s73, s52, 1
    buffer_load_dwordx4 v248, s[40:43], s64 offen offset:3072 sc1 lds
    v_sub_u32 v232, v236, v235
    v_mfma_f32_16x16x32_bf16 v[120:123], v[216:219], a[168:171], v[120:123]
    s_add_u32 s64, s64, 8192
    s_add_u32 s59, s59, s73
    ds_read_b64_tr_b16 v[208:209], v226 offset:32768
    v_mfma_f32_16x16x32_bf16 v[120:123], v[220:223], a[184:187], v[120:123]
    s_add_u32 m0, s55, 49152
    s_mul_i32 s59, s59, 70656
    ds_read_b64_tr_b16 v[210:211], v226 offset:33792
    v_mfma_f32_16x16x32_bf16 v[124:127], v[216:219], a[172:175], v[124:127]
    s_nop 0
    ds_read_b64_tr_b16 v[212:213], v226 offset:40960
    buffer_load_dwordx4 v248, s[40:43], s64 offen offset:0 sc1 lds
    v_mfma_f32_16x16x32_bf16 v[124:127], v[220:223], a[188:191], v[124:127]
    s_bfe_u32 s73, s2, 0x50001
    ds_read_b64_tr_b16 v[214:215], v226 offset:41984
    v_mfma_f32_16x16x32_bf16 v[0:3], v[192:195], a[192:195], v[0:3]
    s_waitcnt lgkmcnt(4)
    s_lshl_b32 s73, s73, 11
    v_cmp_eq_u32 s[0:1], 4, v250
    v_mfma_f32_16x16x32_bf16 v[0:3], v[196:199], a[208:211], v[0:3]
    s_add_u32 s59, s59, s73
    buffer_load_dwordx4 v248, s[40:43], s64 offen offset:1024 sc1 lds
    v_mfma_f32_16x16x32_bf16 v[4:7], v[192:195], a[196:199], v[4:7]
    s_add_u32 s59, s59, 0x5100000
    s_xor_b32 s18, s18, 0x40000000
    v_max_u32_dpp v232, v232, v232 quad_perm:[1,0,3,2] row_mask:0xf bank_mask:0xf
    v_mfma_f32_16x16x32_bf16 v[4:7], v[196:199], a[212:215], v[4:7]
    s_mul_i32 s72, s53, 98304
    v_accvgpr_write_b32 a128, v128
    v_accvgpr_write_b32 a129, v129
    v_mfma_f32_16x16x32_bf16 v[8:11], v[192:195], a[200:203], v[8:11]
    s_lshl_b32 s73, s54, 12
    ds_read_b64_tr_b16 v[216:217], v227 offset:32768
    buffer_load_dwordx4 v248, s[40:43], s64 offen offset:2048 sc1 lds
    v_mfma_f32_16x16x32_bf16 v[8:11], v[196:199], a[216:219], v[8:11]
    s_add_u32 s72, s72, s73
    ds_read_b64_tr_b16 v[218:219], v227 offset:33792
    v_max_u32_dpp v232, v232, v232 quad_perm:[2,3,0,1] row_mask:0xf bank_mask:0xf
    v_mfma_f32_16x16x32_bf16 v[12:15], v[192:195], a[204:207], v[12:15]
    s_lshl_b32 s73, s52, 10
    ds_read_b64_tr_b16 v[220:221], v227 offset:40960
    v_accvgpr_write_b32 a130, v130
    v_mfma_f32_16x16x32_bf16 v[12:15], v[196:199], a[220:223], v[12:15]
    s_add_u32 s72, s72, s73
    ds_read_b64_tr_b16 v[222:223], v227 offset:41984
    v_max_u32_dpp v232, v232, v232 row_half_mirror row_mask:0xf bank_mask:0xf
    v_mfma_f32_16x16x32_bf16 v[16:19], v[200:203], a[192:195], v[16:19]
    s_add_u32 s72, s72, 0x800000
    buffer_load_dwordx4 v248, s[40:43], s64 offen offset:3072 sc1 lds
    v_accvgpr_write_b32 a131, v131
    v_mfma_f32_16x16x32_bf16 v[16:19], v[204:207], a[208:211], v[16:19]
    s_add_u32 s64, s64, 8192
    s_add_u32 s73, s59, 70656
    v_max_u32_dpp v232, v232, v232 row_mirror row_mask:0xf bank_mask:0xf
    v_mfma_f32_16x16x32_bf16 v[20:23], v[200:203], a[196:199], v[20:23]
    s_cmp_lt_u32 s54, 4
    s_cselect_b32 s48, s20, s22
    s_cselect_b32 s49, s21, s23
    v_mov_b32 v233, v232
    v_accvgpr_write_b32 a132, v132
    v_mfma_f32_16x16x32_bf16 v[20:23], v[204:207], a[212:215], v[20:23]
    s_and_b32 s49, s49, 0xffff
    v_accvgpr_write_b32 a133, v133
    v_accvgpr_write_b32 a134, v134
    v_mfma_f32_16x16x32_bf16 v[24:27], v[200:203], a[200:203], v[24:27]
    s_cmp_lt_u32 s53, 29
    s_cselect_b32 s50, 1409024, 0
    ds_read_b64_tr_b16 v[192:193], v228 offset:32768
    v_permlane16_swap_b32 v232, v233
    v_mfma_f32_16x16x32_bf16 v[24:27], v[204:207], a[216:219], v[24:27]
    s_lshl_b32 s56, s54, 2
    ds_read_b64_tr_b16 v[194:195], v228 offset:33792
    v_max_u32 v232, v232, v233
    v_mfma_f32_16x16x32_bf16 v[28:31], v[200:203], a[204:207], v[28:31]
    s_add_u32 s56, s56, s52
    ds_read_b64_tr_b16 v[196:197], v228 offset:40960
    v_add_u32 v235, v235, v232
    v_mfma_f32_16x16x32_bf16 v[28:31], v[204:207], a[220:223], v[28:31]
    s_waitcnt lgkmcnt(5)
    s_and_b32 s56, s56, 15
    ds_read_b64_tr_b16 v[198:199], v228 offset:41984
    v_mfma_f32_16x16x32_bf16 v[32:35], v[208:211], a[192:195], v[32:35]
    s_mul_i32 s56, s56, 88064
    v_cndmask_b32 v234, v234, v235, s[0:1]
    v_sub_u32 v232, v236, v235
    v_mfma_f32_16x16x32_bf16 v[32:35], v[212:215], a[208:211], v[32:35]
    s_mul_i32 s57, s53, 96
    v_cmp_eq_u32 s[0:1], 5, v250
    v_accvgpr_write_b32 a135, v135
    v_mfma_f32_16x16x32_bf16 v[36:39], v[208:211], a[196:199], v[36:39]
    s_add_u32 s56, s56, s57
    v_accvgpr_write_b32 a136, v136
    v_accvgpr_write_b32 a137, v137
    v_mfma_f32_16x16x32_bf16 v[36:39], v[212:215], a[212:215], v[36:39]
    s_add_u32 m0, s55, 98304
    v_max_u32_dpp v232, v232, v232 quad_perm:[1,0,3,2] row_mask:0xf bank_mask:0xf
    v_accvgpr_write_b32 a138, v138
    v_mfma_f32_16x16x32_bf16 v[40:43], v[208:211], a[200:203], v[40:43]
    s_add_u32 s57, s56, 0
    ds_read_b64_tr_b16 v[200:201], v229 offset:32768
    buffer_load_dwordx4 v241, s[48:51], s57 offen lds
    v_mfma_f32_16x16x32_bf16 v[40:43], v[212:215], a[216:219], v[40:43]
    s_add_u32 m0, s55, 99328
    ds_read_b64_tr_b16 v[202:203], v229 offset:33792
    v_max_u32_dpp v232, v232, v232 quad_perm:[2,3,0,1] row_mask:0xf bank_mask:0xf
    v_mfma_f32_16x16x32_bf16 v[44:47], v[208:211], a[204:207], v[44:47]
    s_add_u32 s57, s56, 22016
    ds_read_b64_tr_b16 v[204:205], v229 offset:40960
    buffer_load_dwordx4 v241, s[48:51], s57 offen lds
    v_mfma_f32_16x16x32_bf16 v[44:47], v[212:215], a[220:223], v[44:47]
    s_add_u32 m0, s55, 100352
    ds_read_b64_tr_b16 v[206:207], v229 offset:41984
    v_max_u32_dpp v232, v232, v232 row_half_mirror row_mask:0xf bank_mask:0xf
    v_mfma_f32_16x16x32_bf16 v[48:51], v[216:219], a[192:195], v[48:51]
    s_waitcnt lgkmcnt(4)
    s_add_u32 s57, s56, 44032
    buffer_load_dwordx4 v241, s[48:51], s57 offen lds
    v_mfma_f32_16x16x32_bf16 v[48:51], v[220:223], a[208:211], v[48:51]
    v_max_u32_dpp v232, v232, v232 row_mirror row_mask:0xf bank_mask:0xf
    v_mov_b32 v233, v232
    v_mfma_f32_16x16x32_bf16 v[52:55], v[216:219], a[196:199], v[52:55]
    v_accvgpr_write_b32 a139, v139
    v_accvgpr_write_b32 a140, v140
    v_mfma_f32_16x16x32_bf16 v[52:55], v[220:223], a[212:215], v[52:55]
    v_permlane16_swap_b32 v232, v233
    v_max_u32 v232, v232, v233
    v_mfma_f32_16x16x32_bf16 v[56:59], v[216:219], a[200:203], v[56:59]
    ds_read_b64_tr_b16 v[208:209], v230 offset:32768
    v_add_u32 v235, v235, v232
    v_mfma_f32_16x16x32_bf16 v[56:59], v[220:223], a[216:219], v[56:59]
    ds_read_b64_tr_b16 v[210:211], v230 offset:33792
    v_cndmask_b32 v234, v234, v235, s[0:1]
    v_mfma_f32_16x16x32_bf16 v[60:63], v[216:219], a[204:207], v[60:63]
    ds_read_b64_tr_b16 v[212:213], v230 offset:40960
    v_sub_u32 v232, v236, v235
    v_mfma_f32_16x16x32_bf16 v[60:63], v[220:223], a[220:223], v[60:63]
    s_add_u32 m0, s55, 101376
    ds_read_b64_tr_b16 v[214:215], v230 offset:41984
    v_cmp_eq_u32 s[0:1], 6, v250
    v_mfma_f32_16x16x32_bf16 v[64:67], v[192:195], a[192:195], v[64:67]
    s_add_u32 s57, s56, 66048
    buffer_load_dwordx4 v241, s[48:51], s57 offen lds
    v_accvgpr_write_b32 a141, v141
    v_mfma_f32_16x16x32_bf16 v[64:67], v[196:199], a[208:211], v[64:67]
    s_mov_b32 s48, s14
    v_max_u32_dpp v232, v232, v232 quad_perm:[1,0,3,2] row_mask:0xf bank_mask:0xf
    v_accvgpr_write_b32 a142, v142
    v_mfma_f32_16x16x32_bf16 v[68:71], v[192:195], a[196:199], v[68:71]
    s_and_b32 s49, s15, 0xffff
    v_accvgpr_write_b32 a143, v143
    v_accvgpr_write_b32 a144, v144
    v_mfma_f32_16x16x32_bf16 v[68:71], v[196:199], a[212:215], v[68:71]
    s_mov_b32 s50, 0x400000
    v_max_u32_dpp v232, v232, v232 quad_perm:[2,3,0,1] row_mask:0xf bank_mask:0xf
    v_accvgpr_write_b32 a145, v145
    v_mfma_f32_16x16x32_bf16 v[72:75], v[192:195], a[200:203], v[72:75]
    s_mov_b32 s51, 0x20000
    ds_read_b64_tr_b16 v[216:217], v231 offset:32768
    v_accvgpr_write_b32 a146, v146
    v_mfma_f32_16x16x32_bf16 v[72:75], v[196:199], a[216:219], v[72:75]
    s_lshr_b32 s56, s2, 1
    ds_read_b64_tr_b16 v[218:219], v231 offset:33792
    v_max_u32_dpp v232, v232, v232 row_half_mirror row_mask:0xf bank_mask:0xf
    v_mfma_f32_16x16x32_bf16 v[76:79], v[192:195], a[204:207], v[76:79]
    s_lshl_b32 s56, s56, 15
    ds_read_b64_tr_b16 v[220:221], v231 offset:40960
    v_accvgpr_write_b32 a147, v147
    v_mfma_f32_16x16x32_bf16 v[76:79], v[196:199], a[220:223], v[76:79]
    s_waitcnt lgkmcnt(5)
    s_and_b32 s57, s2, 1
    ds_read_b64_tr_b16 v[222:223], v231 offset:41984
    v_mfma_f32_16x16x32_bf16 v[80:83], v[200:203], a[192:195], v[80:83]
    s_lshl_b32 s57, s57, 9
    v_max_u32_dpp v232, v232, v232 row_mirror row_mask:0xf bank_mask:0xf
    v_mov_b32 v233, v232
    v_mfma_f32_16x16x32_bf16 v[80:83], v[204:207], a[208:211], v[80:83]
    s_add_u32 s56, s56, s57
    v_accvgpr_write_b32 a148, v148
    v_accvgpr_write_b32 a149, v149
    v_mfma_f32_16x16x32_bf16 v[84:87], v[200:203], a[196:199], v[84:87]
    s_lshl_b32 s57, s52, 7
    v_permlane16_swap_b32 v232, v233
    v_max_u32 v232, v232, v233
    v_mfma_f32_16x16x32_bf16 v[84:87], v[204:207], a[212:215], v[84:87]
    s_add_u32 s56, s56, s57
    v_add_u32 v235, v235, v232
    v_cndmask_b32 v234, v234, v235, s[0:1]
    v_mfma_f32_16x16x32_bf16 v[88:91], v[200:203], a[200:203], v[88:91]
    s_add_u32 m0, s55, 114688
    v_sub_u32 v232, v236, v235
    v_cmp_eq_u32 s[0:1], 7, v250
    v_mfma_f32_16x16x32_bf16 v[88:91], v[204:207], a[216:219], v[88:91]
    s_add_u32 s57, s56, 0
    buffer_load_dwordx4 v240, s[48:51], s57 offen lds
    v_accvgpr_write_b32 a150, v150
    v_mfma_f32_16x16x32_bf16 v[92:95], v[200:203], a[204:207], v[92:95]
    s_waitcnt lgkmcnt(0)
    s_barrier
    s_add_u32 m0, s55, 115712
    ds_read_b64_tr_b16 v[192:193], v224 offset:49152
    v_max_u32_dpp v232, v232, v232 quad_perm:[1,0,3,2] row_mask:0xf bank_mask:0xf
    v_mfma_f32_16x16x32_bf16 v[92:95], v[204:207], a[220:223], v[92:95]
    s_add_u32 s57, s56, 8192
    ds_read_b64_tr_b16 v[194:195], v224 offset:50176
    buffer_load_dwordx4 v240, s[48:51], s57 offen lds
    v_mfma_f32_16x16x32_bf16 v[96:99], v[208:211], a[192:195], v[96:99]
    ds_read_b64_tr_b16 v[196:197], v224 offset:57344
    v_max_u32_dpp v232, v232, v232 quad_perm:[2,3,0,1] row_mask:0xf bank_mask:0xf
    v_mfma_f32_16x16x32_bf16 v[96:99], v[212:215], a[208:211], v[96:99]
    ds_read_b64_tr_b16 v[198:199], v224 offset:58368
    v_accvgpr_write_b32 a151, v151
    v_mfma_f32_16x16x32_bf16 v[100:103], v[208:211], a[196:199], v[100:103]
    v_max_u32_dpp v232, v232, v232 row_half_mirror row_mask:0xf bank_mask:0xf
    v_accvgpr_write_b32 a152, v152
    v_mfma_f32_16x16x32_bf16 v[100:103], v[212:215], a[212:215], v[100:103]
    s_add_u32 m0, s55, 116736
    v_accvgpr_write_b32 a153, v153
    v_accvgpr_write_b32 a154, v154
    v_mfma_f32_16x16x32_bf16 v[104:107], v[208:211], a[200:203], v[104:107]
    s_add_u32 s57, s56, 16384
    ds_read_b64_tr_b16 v[200:201], v225 offset:49152
    buffer_load_dwordx4 v240, s[48:51], s57 offen lds
    v_mfma_f32_16x16x32_bf16 v[104:107], v[212:215], a[216:219], v[104:107]
    ds_read_b64_tr_b16 v[202:203], v225 offset:50176
    v_max_u32_dpp v232, v232, v232 row_mirror row_mask:0xf bank_mask:0xf
    v_mfma_f32_16x16x32_bf16 v[108:111], v[208:211], a[204:207], v[108:111]
    ds_read_b64_tr_b16 v[204:205], v225 offset:57344
    v_mov_b32 v233, v232
    v_mfma_f32_16x16x32_bf16 v[108:111], v[212:215], a[220:223], v[108:111]
    ds_read_b64_tr_b16 v[206:207], v225 offset:58368
    v_accvgpr_write_b32 a155, v155
    v_mfma_f32_16x16x32_bf16 v[112:115], v[216:219], a[192:195], v[112:115]
    v_permlane16_swap_b32 v232, v233
    v_max_u32 v232, v232, v233
    v_mfma_f32_16x16x32_bf16 v[112:115], v[220:223], a[208:211], v[112:115]
    v_add_u32 v235, v235, v232
    v_cndmask_b32 v234, v234, v235, s[0:1]
    v_mfma_f32_16x16x32_bf16 v[116:119], v[216:219], a[196:199], v[116:119]
    s_add_u32 m0, s55, 117760
    v_and_b32 v232, 0x7ff, v234
    v_sub_u32 v232, 2047, v232
    v_mfma_f32_16x16x32_bf16 v[116:119], v[220:223], a[212:215], v[116:119]
    s_add_u32 s57, s56, 24576
    buffer_load_dwordx4 v240, s[48:51], s57 offen lds
    v_lshrrev_b32 v235, 6, v232
    v_mfma_f32_16x16x32_bf16 v[120:123], v[216:219], a[200:203], v[120:123]
    ds_read_b64_tr_b16 v[208:209], v226 offset:49152
    v_mul_u32_u24 v235, 70656, v235
    v_mfma_f32_16x16x32_bf16 v[120:123], v[220:223], a[216:219], v[120:123]
    ds_read_b64_tr_b16 v[210:211], v226 offset:50176
    v_bfe_u32 v233, v232, 4, 2
    v_mfma_f32_16x16x32_bf16 v[124:127], v[216:219], a[204:207], v[124:127]
    ds_read_b64_tr_b16 v[212:213], v226 offset:57344
    v_lshl_add_u32 v235, v233, 10, v235
    v_mfma_f32_16x16x32_bf16 v[124:127], v[220:223], a[220:223], v[124:127]
    s_waitcnt lgkmcnt(5)
    s_waitcnt vmcnt(24)
    ds_read_b64_tr_b16 v[214:215], v226 offset:58368
    v_mfma_f32_16x16x32_bf16 v[0:3], v[192:195], a[224:227], v[0:3]
    v_and_b32 v233, 15, v232
    v_lshl_add_u32 v235, v233, 4, v235
    v_mfma_f32_16x16x32_bf16 v[0:3], v[196:199], a[240:243], v[0:3]
    v_lshrrev_b32 v233, 4, v249
    v_lshl_add_u32 v235, v233, 8, v235
    v_mfma_f32_16x16x32_bf16 v[4:7], v[192:195], a[228:231], v[4:7]
    v_mov_b32 v233, 0xc000
    v_mov_b32 v232, v248
    v_mfma_f32_16x16x32_bf16 v[4:7], v[196:199], a[244:247], v[4:7]
    v_accvgpr_write_b32 a156, v156
    v_accvgpr_write_b32 a157, v157
    v_mfma_f32_16x16x32_bf16 v[8:11], v[192:195], a[232:235], v[8:11]
    ds_read_b64_tr_b16 v[216:217], v227 offset:49152
    v_accvgpr_write_b32 a158, v158
    v_mfma_f32_16x16x32_bf16 v[8:11], v[196:199], a[248:251], v[8:11]
    ds_read_b64_tr_b16 v[218:219], v227 offset:50176
    v_accvgpr_write_b32 a159, v159
    v_mfma_f32_16x16x32_bf16 v[12:15], v[192:195], a[236:239], v[12:15]
    ds_read_b64_tr_b16 v[220:221], v227 offset:57344
    v_accvgpr_write_b32 a160, v160
    v_mfma_f32_16x16x32_bf16 v[12:15], v[196:199], a[252:255], v[12:15]
    ds_read_b64_tr_b16 v[222:223], v227 offset:58368
    v_accvgpr_write_b32 a161, v161
    v_mfma_f32_16x16x32_bf16 v[16:19], v[200:203], a[224:227], v[16:19]
    s_waitcnt lgkmcnt(4)
    v_accvgpr_write_b32 a162, v162
    v_accvgpr_write_b32 a163, v163
    v_mfma_f32_16x16x32_bf16 v[16:19], v[204:207], a[240:243], v[16:19]
    v_accvgpr_write_b32 a164, v164
    v_accvgpr_write_b32 a165, v165
    v_mfma_f32_16x16x32_bf16 v[20:23], v[200:203], a[228:231], v[20:23]
    v_accvgpr_write_b32 a166, v166
    v_accvgpr_write_b32 a167, v167
    v_mfma_f32_16x16x32_bf16 v[20:23], v[204:207], a[244:247], v[20:23]
    v_accvgpr_write_b32 a168, v168
    v_accvgpr_write_b32 a169, v169
    v_mfma_f32_16x16x32_bf16 v[24:27], v[200:203], a[232:235], v[24:27]
    ds_read_b64_tr_b16 v[192:193], v228 offset:49152
    v_accvgpr_write_b32 a170, v170
    v_mfma_f32_16x16x32_bf16 v[24:27], v[204:207], a[248:251], v[24:27]
    ds_read_b64_tr_b16 v[194:195], v228 offset:50176
    v_accvgpr_write_b32 a171, v171
    v_mfma_f32_16x16x32_bf16 v[28:31], v[200:203], a[236:239], v[28:31]
    ds_read_b64_tr_b16 v[196:197], v228 offset:57344
    v_accvgpr_write_b32 a172, v172
    v_mfma_f32_16x16x32_bf16 v[28:31], v[204:207], a[252:255], v[28:31]
    ds_read_b64_tr_b16 v[198:199], v228 offset:58368
    v_accvgpr_write_b32 a173, v173
    v_mfma_f32_16x16x32_bf16 v[32:35], v[208:211], a[224:227], v[32:35]
    v_accvgpr_write_b32 a174, v174
    v_accvgpr_write_b32 a175, v175
    v_mfma_f32_16x16x32_bf16 v[32:35], v[212:215], a[240:243], v[32:35]
    v_accvgpr_write_b32 a176, v176
    v_accvgpr_write_b32 a177, v177
    v_mfma_f32_16x16x32_bf16 v[36:39], v[208:211], a[228:231], v[36:39]
    v_accvgpr_write_b32 a178, v178
    v_accvgpr_write_b32 a179, v179
    v_mfma_f32_16x16x32_bf16 v[36:39], v[212:215], a[244:247], v[36:39]
    v_accvgpr_write_b32 a180, v180
    v_accvgpr_write_b32 a181, v181
    v_mfma_f32_16x16x32_bf16 v[40:43], v[208:211], a[232:235], v[40:43]
    ds_read_b64_tr_b16 v[200:201], v229 offset:49152
    v_accvgpr_write_b32 a182, v182
    v_mfma_f32_16x16x32_bf16 v[40:43], v[212:215], a[248:251], v[40:43]
    ds_read_b64_tr_b16 v[202:203], v229 offset:50176
    v_accvgpr_write_b32 a183, v183
    v_mfma_f32_16x16x32_bf16 v[44:47], v[208:211], a[236:239], v[44:47]
    ds_read_b64_tr_b16 v[204:205], v229 offset:57344
    v_accvgpr_write_b32 a184, v184
    v_mfma_f32_16x16x32_bf16 v[44:47], v[212:215], a[252:255], v[44:47]
    s_waitcnt lgkmcnt(5)
    ds_read_b64_tr_b16 v[206:207], v229 offset:58368
    v_accvgpr_write_b32 a185, v185
    v_mfma_f32_16x16x32_bf16 v[48:51], v[216:219], a[224:227], v[48:51]
    v_accvgpr_write_b32 a186, v186
    v_accvgpr_write_b32 a187, v187
    v_mfma_f32_16x16x32_bf16 v[48:51], v[220:223], a[240:243], v[48:51]
    v_accvgpr_write_b32 a188, v188
    v_accvgpr_write_b32 a189, v189
    v_mfma_f32_16x16x32_bf16 v[52:55], v[216:219], a[228:231], v[52:55]
    v_accvgpr_write_b32 a190, v190
    v_accvgpr_write_b32 a191, v191
    v_mfma_f32_16x16x32_bf16 v[52:55], v[220:223], a[244:247], v[52:55]
    v_mfma_f32_16x16x32_bf16 v[56:59], v[216:219], a[232:235], v[56:59]
    ds_read_b64_tr_b16 v[208:209], v230 offset:49152
    v_mfma_f32_16x16x32_bf16 v[56:59], v[220:223], a[248:251], v[56:59]
    ds_read_b64_tr_b16 v[210:211], v230 offset:50176
    v_mfma_f32_16x16x32_bf16 v[60:63], v[216:219], a[236:239], v[60:63]
    ds_read_b64_tr_b16 v[212:213], v230 offset:57344
    v_mfma_f32_16x16x32_bf16 v[60:63], v[220:223], a[252:255], v[60:63]
    ds_read_b64_tr_b16 v[214:215], v230 offset:58368
    v_mfma_f32_16x16x32_bf16 v[64:67], v[192:195], a[224:227], v[64:67]
    s_waitcnt lgkmcnt(4)
    v_mfma_f32_16x16x32_bf16 v[64:67], v[196:199], a[240:243], v[64:67]
    v_mfma_f32_16x16x32_bf16 v[68:71], v[192:195], a[228:231], v[68:71]
    v_mfma_f32_16x16x32_bf16 v[68:71], v[196:199], a[244:247], v[68:71]
    v_mfma_f32_16x16x32_bf16 v[72:75], v[192:195], a[232:235], v[72:75]
    ds_read_b64_tr_b16 v[216:217], v231 offset:49152
    v_cvt_pk_bf16_f32 v128, v0, v1
    v_mfma_f32_16x16x32_bf16 v[72:75], v[196:199], a[248:251], v[72:75]
    ds_read_b64_tr_b16 v[218:219], v231 offset:50176
    v_cvt_pk_bf16_f32 v129, v2, v3
    v_mfma_f32_16x16x32_bf16 v[76:79], v[192:195], a[236:239], v[76:79]
    ds_read_b64_tr_b16 v[220:221], v231 offset:57344
    v_cvt_pk_bf16_f32 v130, v16, v17
    v_mfma_f32_16x16x32_bf16 v[76:79], v[196:199], a[252:255], v[76:79]
    ds_read_b64_tr_b16 v[222:223], v231 offset:58368
    v_cvt_pk_bf16_f32 v131, v18, v19
    v_mfma_f32_16x16x32_bf16 v[80:83], v[200:203], a[224:227], v[80:83]
    v_cvt_pk_bf16_f32 v144, v4, v5
    v_cvt_pk_bf16_f32 v145, v6, v7
    v_mfma_f32_16x16x32_bf16 v[80:83], v[204:207], a[240:243], v[80:83]
    v_cvt_pk_bf16_f32 v146, v20, v21
    v_cvt_pk_bf16_f32 v147, v22, v23
    v_mfma_f32_16x16x32_bf16 v[84:87], v[200:203], a[228:231], v[84:87]
    v_cvt_pk_bf16_f32 v160, v8, v9
    v_cvt_pk_bf16_f32 v161, v10, v11
    v_mfma_f32_16x16x32_bf16 v[84:87], v[204:207], a[244:247], v[84:87]
    v_cvt_pk_bf16_f32 v162, v24, v25
    v_cvt_pk_bf16_f32 v163, v26, v27
    v_mfma_f32_16x16x32_bf16 v[88:91], v[200:203], a[232:235], v[88:91]
    v_cvt_pk_bf16_f32 v176, v12, v13
    v_cvt_pk_bf16_f32 v177, v14, v15
    v_mfma_f32_16x16x32_bf16 v[88:91], v[204:207], a[248:251], v[88:91]
    v_cvt_pk_bf16_f32 v178, v28, v29
    v_cvt_pk_bf16_f32 v179, v30, v31
    v_mfma_f32_16x16x32_bf16 v[92:95], v[200:203], a[236:239], v[92:95]
    s_waitcnt vmcnt(20)
    s_waitcnt lgkmcnt(0)
    s_barrier
    ds_read_b128 a[192:195], v232 offset:0
    v_cvt_pk_bf16_f32 v132, v32, v33
    v_mfma_f32_16x16x32_bf16 v[92:95], v[204:207], a[252:255], v[92:95]
    ds_read_b128 a[196:199], v232 offset:1024
    v_cvt_pk_bf16_f32 v133, v34, v35
    v_mfma_f32_16x16x32_bf16 v[96:99], v[208:211], a[224:227], v[96:99]
    ds_read_b128 a[200:203], v232 offset:2048
    v_cvt_pk_bf16_f32 v134, v48, v49
    v_mfma_f32_16x16x32_bf16 v[96:99], v[212:215], a[240:243], v[96:99]
    v_cvt_pk_bf16_f32 v135, v50, v51
    v_cvt_pk_bf16_f32 v148, v36, v37
    v_mfma_f32_16x16x32_bf16 v[100:103], v[208:211], a[228:231], v[100:103]
    v_cvt_pk_bf16_f32 v149, v38, v39
    v_cvt_pk_bf16_f32 v150, v52, v53
    v_mfma_f32_16x16x32_bf16 v[100:103], v[212:215], a[244:247], v[100:103]
    v_cvt_pk_bf16_f32 v151, v54, v55
    v_cvt_pk_bf16_f32 v164, v40, v41
    v_mfma_f32_16x16x32_bf16 v[104:107], v[208:211], a[232:235], v[104:107]
    ds_read_b128 a[204:207], v232 offset:3072
    v_cvt_pk_bf16_f32 v165, v42, v43
    v_mfma_f32_16x16x32_bf16 v[104:107], v[212:215], a[248:251], v[104:107]
    v_cvt_pk_bf16_f32 v166, v56, v57
    v_cvt_pk_bf16_f32 v167, v58, v59
    v_mfma_f32_16x16x32_bf16 v[108:111], v[208:211], a[236:239], v[108:111]
    v_cvt_pk_bf16_f32 v180, v44, v45
    v_cvt_pk_bf16_f32 v181, v46, v47
    v_mfma_f32_16x16x32_bf16 v[108:111], v[212:215], a[252:255], v[108:111]
    v_cvt_pk_bf16_f32 v182, v60, v61
    v_cvt_pk_bf16_f32 v183, v62, v63
    v_mfma_f32_16x16x32_bf16 v[112:115], v[216:219], a[224:227], v[112:115]
    s_waitcnt lgkmcnt(2)
    ds_read_b128 a[208:211], v232 offset:4096
    v_cvt_pk_bf16_f32 v136, v64, v65
    v_mfma_f32_16x16x32_bf16 v[112:115], v[220:223], a[240:243], v[112:115]
    v_cvt_pk_bf16_f32 v137, v66, v67
    v_cvt_pk_bf16_f32 v138, v80, v81
    v_mfma_f32_16x16x32_bf16 v[116:119], v[216:219], a[228:231], v[116:119]
    v_cvt_pk_bf16_f32 v139, v82, v83
    v_cvt_pk_bf16_f32 v152, v68, v69
    v_mfma_f32_16x16x32_bf16 v[116:119], v[220:223], a[244:247], v[116:119]
    v_cvt_pk_bf16_f32 v153, v70, v71
    v_cvt_pk_bf16_f32 v154, v84, v85
    v_mfma_f32_16x16x32_bf16 v[120:123], v[216:219], a[232:235], v[120:123]
    ds_read_b128 a[212:215], v232 offset:5120
    v_cvt_pk_bf16_f32 v155, v86, v87
    v_mfma_f32_16x16x32_bf16 v[120:123], v[220:223], a[248:251], v[120:123]
    v_cvt_pk_bf16_f32 v168, v72, v73
    v_cvt_pk_bf16_f32 v169, v74, v75
    v_mfma_f32_16x16x32_bf16 v[124:127], v[216:219], a[236:239], v[124:127]
    v_cvt_pk_bf16_f32 v170, v88, v89
    v_cvt_pk_bf16_f32 v171, v90, v91
    v_mfma_f32_16x16x32_bf16 v[124:127], v[220:223], a[252:255], v[124:127]
    v_cvt_pk_bf16_f32 v184, v76, v77
    v_cvt_pk_bf16_f32 v185, v78, v79
    v_mfma_f32_16x16x32_bf16 v[0:3], a[192:195], v[128:131], 0
    ds_read_b128 a[216:219], v232 offset:6144
    v_cvt_pk_bf16_f32 v186, v92, v93
    v_mfma_f32_16x16x32_bf16 v[8:11], a[192:195], v[144:147], 0
    v_cvt_pk_bf16_f32 v187, v94, v95
    v_cvt_pk_bf16_f32 v140, v96, v97
    v_mfma_f32_16x16x32_bf16 v[16:19], a[192:195], v[160:163], 0
    v_cvt_pk_bf16_f32 v141, v98, v99
    v_cvt_pk_bf16_f32 v142, v112, v113
    v_mfma_f32_16x16x32_bf16 v[24:27], a[192:195], v[176:179], 0
    v_cvt_pk_bf16_f32 v143, v114, v115
    v_cvt_pk_bf16_f32 v156, v100, v101
    v_mfma_f32_16x16x32_bf16 v[0:3], a[196:199], v[132:135], v[0:3]
    ds_read_b128 a[220:223], v232 offset:7168
    v_cvt_pk_bf16_f32 v157, v102, v103
    v_mfma_f32_16x16x32_bf16 v[8:11], a[196:199], v[148:151], v[8:11]
    v_cvt_pk_bf16_f32 v158, v116, v117
    v_cvt_pk_bf16_f32 v159, v118, v119
    v_mfma_f32_16x16x32_bf16 v[16:19], a[196:199], v[164:167], v[16:19]
    v_cvt_pk_bf16_f32 v172, v104, v105
    v_cvt_pk_bf16_f32 v173, v106, v107
    v_mfma_f32_16x16x32_bf16 v[24:27], a[196:199], v[180:183], v[24:27]
    s_waitcnt lgkmcnt(2)
    v_cvt_pk_bf16_f32 v174, v120, v121
    v_cvt_pk_bf16_f32 v175, v122, v123
    v_mfma_f32_16x16x32_bf16 v[0:3], a[200:203], v[136:139], v[0:3]
    v_cvt_pk_bf16_f32 v188, v108, v109
    v_cvt_pk_bf16_f32 v189, v110, v111
    v_mfma_f32_16x16x32_bf16 v[8:11], a[200:203], v[152:155], v[8:11]
    v_cvt_pk_bf16_f32 v190, v124, v125
    v_cvt_pk_bf16_f32 v191, v126, v127
    v_mfma_f32_16x16x32_bf16 v[16:19], a[200:203], v[168:171], v[16:19]
    v_mfma_f32_16x16x32_bf16 v[24:27], a[200:203], v[184:187], v[24:27]
    v_mfma_f32_16x16x32_bf16 v[0:3], a[204:207], v[140:143], v[0:3]
    v_mov_b32 v208, 0x3f803f80
    v_mov_b32 v209, 0x3f803f80
    v_mfma_f32_16x16x32_bf16 v[8:11], a[204:207], v[156:159], v[8:11]
    v_mov_b32 v210, 0x3f803f80
    v_mov_b32 v211, 0x3f803f80
    v_mfma_f32_16x16x32_bf16 v[16:19], a[204:207], v[172:175], v[16:19]
    v_mov_b32 v192, 0
    v_mov_b32 v193, 0
    v_mfma_f32_16x16x32_bf16 v[24:27], a[204:207], v[188:191], v[24:27]
    v_mov_b32 v194, 0
    v_mov_b32 v195, 0
    v_mfma_f32_16x16x32_bf16 v[4:7], a[208:211], v[128:131], 0
    v_mov_b32 v196, 0
    v_mov_b32 v197, 0
    v_mfma_f32_16x16x32_bf16 v[12:15], a[208:211], v[144:147], 0
    v_mov_b32 v198, 0
    v_mov_b32 v199, 0
    v_mfma_f32_16x16x32_bf16 v[20:23], a[208:211], v[160:163], 0
    v_mov_b32 v200, 0
    v_mov_b32 v201, 0
    v_mfma_f32_16x16x32_bf16 v[28:31], a[208:211], v[176:179], 0
    v_mov_b32 v202, 0
    v_mov_b32 v203, 0
    v_mfma_f32_16x16x32_bf16 v[4:7], a[212:215], v[132:135], v[4:7]
    v_mov_b32 v204, 0
    v_mov_b32 v205, 0
    v_mfma_f32_16x16x32_bf16 v[12:15], a[212:215], v[148:151], v[12:15]
    v_mov_b32 v206, 0
    v_mov_b32 v207, 0
    v_mfma_f32_16x16x32_bf16 v[20:23], a[212:215], v[164:167], v[20:23]
    v_mov_b32 v244, 0
    v_mov_b32 v245, 0
    v_mfma_f32_16x16x32_bf16 v[28:31], a[212:215], v[180:183], v[28:31]
    s_waitcnt lgkmcnt(0)
    v_mov_b32 v246, 0
    v_mov_b32 v247, 0
    v_mfma_f32_16x16x32_bf16 v[4:7], a[216:219], v[136:139], v[4:7]
    v_and_b32 v236, 15, v249
    v_lshrrev_b32 v237, 4, v249
    v_mfma_f32_16x16x32_bf16 v[12:15], a[216:219], v[152:155], v[12:15]
    v_lshlrev_b32 v237, 2, v237
    v_sub_u32 v236, v236, v237
    v_mfma_f32_16x16x32_bf16 v[20:23], a[216:219], v[168:171], v[20:23]
    v_mov_b32 v238, 0xf149f2ca
    v_mfma_f32_16x16x32_bf16 v[28:31], a[216:219], v[184:187], v[28:31]
    v_mfma_f32_16x16x32_bf16 v[4:7], a[220:223], v[140:143], v[4:7]
    v_mfma_f32_16x16x32_bf16 v[12:15], a[220:223], v[156:159], v[12:15]
    v_mfma_f32_16x16x32_bf16 v[20:23], a[220:223], v[172:175], v[20:23]
    v_mfma_f32_16x16x32_bf16 v[28:31], a[220:223], v[188:191], v[28:31]
    v_cmp_gt_i32 vcc, 0, v236
    s_nop 1
    v_cndmask_b32 v216, 0, v238, vcc
    v_cmp_gt_i32 vcc, 1, v236
    s_nop 1
    v_cndmask_b32 v217, 0, v238, vcc
    v_cmp_gt_i32 vcc, 2, v236
    s_nop 1
    v_cndmask_b32 v218, 0, v238, vcc
    v_cmp_gt_i32 vcc, 3, v236
    s_nop 1
    v_cndmask_b32 v219, 0, v238, vcc
    s_add_u32 s67, s67, 0x4000
    v_bfi_b32 v232, v233, s67, v232
    s_waitcnt vmcnt(16)
    s_waitcnt lgkmcnt(0)
    s_barrier
    ds_read_b128 a[192:195], v232 offset:0
    ds_read_b128 a[196:199], v232 offset:1024
    ds_read_b128 a[200:203], v232 offset:2048
    ds_read_b128 a[204:207], v232 offset:3072
    ds_read_b128 a[208:211], v232 offset:4096
    ds_read_b128 a[212:215], v232 offset:5120
    ds_read_b128 a[216:219], v232 offset:6144
    ds_read_b128 a[220:223], v232 offset:7168
    ds_read_b128 a[224:227], v232 offset:8192
    ds_read_b128 a[228:231], v232 offset:9216
    s_mov_b32 m0, s66
    s_nop 0
    buffer_load_dwordx4 v248, s[40:43], s64 offen offset:0 sc1 lds
    buffer_load_dwordx4 v248, s[40:43], s64 offen offset:1024 sc1 lds
    buffer_load_dwordx4 v248, s[40:43], s64 offen offset:2048 sc1 lds
    buffer_load_dwordx4 v248, s[40:43], s64 offen offset:3072 sc1 lds
    s_add_u32 s64, s64, 8192
    s_add_u32 s66, s66, 0x4000
    s_and_b32 s66, s66, 0xffff
    s_cmp_lg_u32 s75, 2
    s_cbranch_scc1 F_fill_nomask
    v_add_f32 v0, v0, v216
    v_mov_b32 v4, 0xf149f2ca
    v_add_f32 v12, v12, v216
    v_add_f32 v1, v1, v217
    v_mov_b32 v5, 0xf149f2ca
    v_add_f32 v13, v13, v217
    v_add_f32 v2, v2, v218
    v_mov_b32 v6, 0xf149f2ca
    v_add_f32 v14, v14, v218
    v_add_f32 v3, v3, v219
    v_mov_b32 v7, 0xf149f2ca
    v_add_f32 v15, v15, v219
F_fill_nomask:
    v_mfma_f32_32x32x16_bf16 a[0:15], v[244:247], v[244:247], 0
    v_max3_f32 v236, v0, v1, v2
    v_max3_f32 v236, v236, v3, v4
    v_max3_f32 v236, v236, v5, v6
    v_max_f32 v236, v236, v7
    v_max3_f32 v237, v8, v9, v10
    v_max3_f32 v237, v237, v11, v12
    v_mfma_f32_32x32x16_bf16 a[16:31], v[244:247], v[244:247], 0
    v_max3_f32 v237, v237, v13, v14
    v_max_f32 v237, v237, v15
    v_max3_f32 v238, v16, v17, v18
    v_max3_f32 v238, v238, v19, v20
    v_max3_f32 v238, v238, v21, v22
    v_max_f32 v238, v238, v23
    v_mfma_f32_32x32x16_bf16 a[32:47], v[244:247], v[244:247], 0
    v_max3_f32 v239, v24, v25, v26
    v_max3_f32 v239, v239, v27, v28
    v_max3_f32 v239, v239, v29, v30
    v_max_f32 v239, v239, v31
    v_mov_b32 v240, v236
    v_mov_b32 v241, v237
    v_mfma_f32_32x32x16_bf16 a[48:63], v[244:247], v[244:247], 0
    v_mov_b32 v242, v238
    v_mov_b32 v243, v239
    s_nop 1
    v_permlane16_swap_b32 v236, v240
    v_permlane16_swap_b32 v237, v241
    v_permlane16_swap_b32 v238, v242
    v_mfma_f32_32x32x16_bf16 a[64:79], v[244:247], v[244:247], 0
    v_permlane16_swap_b32 v239, v243
    v_max_f32 v236, v236, v240
    v_max_f32 v237, v237, v241
    v_max_f32 v238, v238, v242
    v_max_f32 v239, v239, v243
    v_mov_b32 v240, v236
    v_mfma_f32_32x32x16_bf16 a[80:95], v[244:247], v[244:247], 0
    v_mov_b32 v241, v237
    v_mov_b32 v242, v238
    v_mov_b32 v243, v239
    s_nop 1
    v_permlane32_swap_b32 v236, v240
    v_permlane32_swap_b32 v237, v241
    v_mfma_f32_32x32x16_bf16 a[96:111], v[244:247], v[244:247], 0
    v_permlane32_swap_b32 v238, v242
    v_permlane32_swap_b32 v239, v243
    v_max_f32 v236, v236, v240
    v_max_f32 v237, v237, v241
    v_max_f32 v238, v238, v242
    v_max_f32 v239, v239, v243
    v_mfma_f32_32x32x16_bf16 a[112:127], v[244:247], v[244:247], 0
    v_sub_f32 v212, 0, v236
    v_sub_f32 v213, 0, v237
    v_sub_f32 v214, 0, v238
    v_sub_f32 v215, 0, v239
    v_add_f32 v0, v0, v212
    v_add_f32 v1, v1, v212
    v_add_f32 v2, v2, v212
    v_add_f32 v3, v3, v212
    v_add_f32 v4, v4, v212
    v_add_f32 v5, v5, v212
    v_add_f32 v6, v6, v212
    v_add_f32 v7, v7, v212
    v_add_f32 v8, v8, v213
    v_add_f32 v9, v9, v213
    v_add_f32 v10, v10, v213
    v_add_f32 v11, v11, v213
    v_add_f32 v12, v12, v213
    v_add_f32 v13, v13, v213
    v_add_f32 v14, v14, v213
    v_add_f32 v15, v15, v213
    v_add_f32 v16, v16, v214
    v_add_f32 v17, v17, v214
    v_add_f32 v18, v18, v214
    v_add_f32 v19, v19, v214
    v_add_f32 v20, v20, v214
    v_add_f32 v21, v21, v214
    v_add_f32 v22, v22, v214
    v_add_f32 v23, v23, v214
    v_add_f32 v24, v24, v215
    v_add_f32 v25, v25, v215
    v_add_f32 v26, v26, v215
    v_add_f32 v27, v27, v215
    v_add_f32 v28, v28, v215
    v_add_f32 v29, v29, v215
    v_add_f32 v30, v30, v215
    v_add_f32 v31, v31, v215
    s_cmp_ge_u32 s52, 2
    s_cbranch_scc1 F_noq
    s_lshl_b32 s56, s2, 11
    s_lshl_b32 s57, s52, 10
    s_add_u32 s56, s56, s57
    s_add_u32 s56, s56, 0x400000
    buffer_store_dwordx4 v[212:215], v248, s[32:35], s56 offen sc1
    s_lshl_b32 s56, s52, 14
    s_add_u32 s56, s56, 131072
    v_add_u32 v250, s56, v248
    ds_write_b128 v250, v[128:131] offset:0
    ds_write_b128 v250, v[132:135] offset:1024
    ds_write_b128 v250, v[136:139] offset:2048
    ds_write_b128 v250, v[140:143] offset:3072
    ds_write_b128 v250, v[144:147] offset:4096
    ds_write_b128 v250, v[148:151] offset:5120
    ds_write_b128 v250, v[152:155] offset:6144
    ds_write_b128 v250, v[156:159] offset:7168
    ds_write_b128 v250, v[160:163] offset:8192
    ds_write_b128 v250, v[164:167] offset:9216
    ds_write_b128 v250, v[168:171] offset:10240
    ds_write_b128 v250, v[172:175] offset:11264
    ds_write_b128 v250, v[176:179] offset:12288
    ds_write_b128 v250, v[180:183] offset:13312
    ds_write_b128 v250, v[184:187] offset:14336
    ds_write_b128 v250, v[188:191] offset:15360
F_noq:
    v_exp_f32 v0, v0
    v_exp_f32 v1, v1
    v_exp_f32 v2, v2
    v_exp_f32 v3, v3
    v_exp_f32 v8, v8
    v_exp_f32 v9, v9
    v_exp_f32 v10, v10
    v_exp_f32 v11, v11
    v_exp_f32 v16, v16
    v_exp_f32 v17, v17
    v_exp_f32 v18, v18
    v_exp_f32 v19, v19
    v_exp_f32 v24, v24
    v_exp_f32 v25, v25
    v_exp_f32 v26, v26
    v_exp_f32 v27, v27
    v_exp_f32 v4, v4
    v_exp_f32 v5, v5
    v_exp_f32 v6, v6
    v_exp_f32 v7, v7
    v_exp_f32 v12, v12
    v_exp_f32 v13, v13
    v_exp_f32 v14, v14
    s_nop 0
    v_cvt_pk_bf16_f32 v64, v0, v1
    v_cvt_pk_bf16_f32 v65, v2, v3
    v_cvt_pk_bf16_f32 v68, v8, v9
    v_cvt_pk_bf16_f32 v69, v10, v11
    v_cvt_pk_bf16_f32 v72, v16, v17
    v_cvt_pk_bf16_f32 v73, v18, v19
    v_cvt_pk_bf16_f32 v76, v24, v25
    v_cvt_pk_bf16_f32 v77, v26, v27
    v_cvt_pk_bf16_f32 v66, v4, v5
    v_cvt_pk_bf16_f32 v67, v6, v7
    v_cvt_pk_bf16_f32 v70, v12, v13
    v_mov_b32 v96, v212
    v_mov_b32 v97, v212
    v_mov_b32 v98, v212
    v_mov_b32 v99, v212
    v_mov_b32 v100, v213
    v_mov_b32 v101, v213
    v_mov_b32 v102, v213
    v_mov_b32 v103, v213
    v_mov_b32 v104, v214
    v_mov_b32 v105, v214
    v_mov_b32 v106, v214
    v_mov_b32 v107, v214
    v_mov_b32 v108, v215
    v_mov_b32 v109, v215
    v_mov_b32 v110, v215
    v_mov_b32 v111, v215
    v_mov_b32 v112, v212
    v_mov_b32 v113, v212
    v_mov_b32 v114, v212
    v_mov_b32 v115, v212
    v_mov_b32 v116, v213
    v_mov_b32 v117, v213
    v_mov_b32 v118, v213
    v_mov_b32 v119, v213
    v_mov_b32 v120, v214
    v_mov_b32 v121, v214
    v_mov_b32 v122, v214
    v_mov_b32 v123, v214
    v_mov_b32 v124, v215
    v_mov_b32 v125, v215
    v_mov_b32 v126, v215
    v_mov_b32 v127, v215
    v_lshrrev_b32 v228, 1, v249
    v_lshlrev_b32 v228, 7, v228
    v_and_b32 v229, 1, v249
    v_lshl_add_u32 v228, v229, 4, v228
    v_add_u32 v228, 0x3c1000, v228
    v_lshrrev_b32 v224, 2, v249
    v_and_b32 v227, 3, v249
    s_add_u32 s56, s55, 81920
    v_lshlrev_b32 v226, 8, v224
    v_lshlrev_b32 v224, 7, v224
    v_lshl_add_u32 v224, v227, 4, v224
    v_add_u32 v224, s56, v224
    v_lshl_add_u32 v226, v227, 3, v226
    v_add_u32 v226, s56, v226
    v_lshlrev_b32 v227, 3, v227
    v_lshrrev_b32 v225, 4, v249
    v_lshl_add_u32 v227, v225, 10, v227
    v_bfe_u32 v225, v249, 2, 2
    v_lshl_add_u32 v225, v225, 7, v227
    v_add_u32 v225, s56, v225
    v_lshrrev_b32 v230, 4, v249
    v_lshlrev_b32 v230, 10, v230
    v_and_b32 v231, 15, v249
    v_lshl_add_u32 v230, v231, 4, v230
    s_lshl_b32 s98, s2, 11
    s_sub_u32 s57, 3, s52
    s_lshl_b32 s57, s57, 10
    s_add_u32 s98, s98, s57
    s_add_u32 s98, s98, 0x400000
    s_waitcnt lgkmcnt(0)
    s_mov_b32 s69, 1
    s_lshr_b64 s[56:57], s[60:61], 7
    s_ff1_i32_b64 s68, s[56:57]
    s_add_u32 s56, s68, 7
    s_cmp_ge_u32 s54, 2
    s_cselect_b32 s69, s56, 1
    s_cbranch_scc1 F_S1
    s_waitcnt vmcnt(0)
    ds_read_b64_tr_b16 a[128:129], v224 offset:32768
    ds_read_b64_tr_b16 a[130:131], v224 offset:34816
    ds_read_b64_tr_b16 a[132:133], v224 offset:32776
    ds_read_b64_tr_b16 a[134:135], v224 offset:34824
    ds_read_b64_tr_b16 a[136:137], v224 offset:32832
    ds_read_b64_tr_b16 a[138:139], v224 offset:34880
    ds_read_b64_tr_b16 a[140:141], v224 offset:32840
    ds_read_b64_tr_b16 a[142:143], v224 offset:34888
    ds_read_b64_tr_b16 a[144:145], v225 offset:16384
    ds_read_b64_tr_b16 a[146:147], v225 offset:16896
    ds_read_b64_tr_b16 a[148:149], v225 offset:16416
    ds_read_b64_tr_b16 a[150:151], v225 offset:16928
    ds_read_b64_tr_b16 a[152:153], v225 offset:16448
    ds_read_b64_tr_b16 a[154:155], v225 offset:16960
    s_waitcnt lgkmcnt(0)
    buffer_store_dwordx4 a[128:131], v248, s[32:35], s59 offen offset:0 sc1
    buffer_store_dwordx4 a[132:135], v248, s[32:35], s59 offen offset:1024 sc1
    buffer_store_dwordx4 a[136:139], v248, s[32:35], s73 offen offset:0 sc1
    buffer_store_dwordx4 a[140:143], v248, s[32:35], s73 offen offset:1024 sc1
    buffer_store_dwordx4 a[144:147], v248, s[32:35], s72 offen sc1
    s_add_u32 s72, s72, 32768
    buffer_store_dwordx4 a[148:151], v248, s[32:35], s72 offen sc1
    s_add_u32 s72, s72, 32768
    buffer_store_dwordx4 a[152:155], v248, s[32:35], s72 offen sc1
    s_cmp_lg_u32 s54, 0
    s_cbranch_scc1 F_next
    s_mov_b32 s3, 2
    s_cmp_eq_u32 s52, 3
    s_cbranch_scc1 F_X0
    s_cmp_lg_u32 s52, 2
    s_cbranch_scc1 F_next
    v_mov_b32 v96, 0xf149f2ca
    v_mov_b32 v97, 0xf149f2ca
    v_mov_b32 v98, 0xf149f2ca
    v_mov_b32 v99, 0xf149f2ca
    v_mov_b32 v100, 0xf149f2ca
    v_mov_b32 v101, 0xf149f2ca
    v_mov_b32 v102, 0xf149f2ca
    v_mov_b32 v103, 0xf149f2ca
    v_add_f32 v104, v214, v216
    v_add_f32 v105, v214, v217
    v_add_f32 v106, v214, v218
    v_add_f32 v107, v214, v219
    v_mov_b32 v112, 0xf149f2ca
    v_mov_b32 v113, 0xf149f2ca
    v_mov_b32 v114, 0xf149f2ca
    v_mov_b32 v115, 0xf149f2ca
    v_mov_b32 v116, 0xf149f2ca
    v_mov_b32 v117, 0xf149f2ca
    v_mov_b32 v118, 0xf149f2ca
    v_mov_b32 v119, 0xf149f2ca
    v_mov_b32 v120, 0xf149f2ca
    v_mov_b32 v121, 0xf149f2ca
    v_mov_b32 v122, 0xf149f2ca
    v_mov_b32 v123, 0xf149f2ca
    v_add_f32 v124, v215, v216
    v_add_f32 v125, v215, v217
    v_add_f32 v126, v215, v218
    v_add_f32 v127, v215, v219
    s_branch F_X2
F_event:
    s_cmp_eq_u32 s69, s71
    s_cbranch_scc1 F_xp1
F_rxp1:
    s_cmp_eq_u32 s69, 32
    s_cbranch_scc1 F_T32
F_rT32:
    s_cmp_eq_u32 s69, 12
    s_cbranch_scc1 F_xsg
F_rxsg:
    s_cmp_eq_u32 s69, s70
    s_cbranch_scc1 F_xsw
F_rxsw:
    s_cmp_eq_u32 s69, s74
    s_cbranch_scc1 F_X0
F_rX0:
    s_cmp_eq_u32 s69, 13
    s_cbranch_scc1 F_xvc
F_rxvc:
F_next:
    s_add_u32 s69, s69, 1
    s_lshr_b64 s[56:57], s[60:61], s69
    s_ff1_i32_b64 s68, s[56:57]
    s_bitcmp1_b32 s69, 0
    s_cselect_b32 s56, 0, 1
    s_add_u32 s69, s69, s68
    s_or_b32 s56, s56, s3
    s_cmp_eq_u32 s56, 3
    s_cbranch_scc1 F_O2
    s_cmp_eq_u32 s56, 2
    s_cbranch_scc1 F_E2
    s_cmp_eq_u32 s56, 1
    s_cbranch_scc1 F_O1
    s_branch F_E1
F_xsg:
    v_mov_b32 v251, s94
    s_lshr_b32 s58, s2, 3
    s_mul_i32 s58, s58, 96
    s_lshl_b32 s16, s2, 2
    s_add_u32 s58, s58, s16
    s_add_u32 s58, s58, 0x3c1000
    s_cmp_eq_u32 s52, 1
    s_cselect_b32 s58, s58, 0x7fff0000
    v_min_u32 v250, 1, v249
    v_lshlrev_b32 v250, 30, v250
    buffer_store_dword v251, v250, s[32:35], s58 offen sc1
    v_min_u32 v237, 3, v249
    v_lshlrev_b32 v237, 2, v237
    v_add_u32 v237, 40, v237
    buffer_load_dword v236, v237, s[32:35], s95 offen offset:0 sc1
    s_branch F_next
F_xvc:
    s_waitcnt vmcnt(4)
    s_mov_b32 s16, 100000
F_pl5:
    v_cmp_ne_u32 vcc, s94, v236
    s_nop 4
    s_cbranch_vccz F_pd5
    s_sleep 4
    buffer_load_dword v236, v237, s[32:35], s95 offen offset:0 sc1
    s_sub_u32 s16, s16, 1
    s_waitcnt vmcnt(0)
    s_cbranch_scc0 F_pl5
F_pd5:
    s_branch F_next
F_xsw:
    s_waitcnt vmcnt(8)
    s_mov_b32 s3, 2
    s_getpc_b64 s[100:101]
F_cpx:
    s_lshl_b32 s56, s52, 13
    s_add_u32 s56, s56, F_T32-F_cpx
    v_lshl_add_u32 v250, v249, 7, s56
    v_min_u32 v250, F_end-F_cpx, v250
    v_mov_b32 v251, s101
    v_add_co_u32 v250, vcc, s100, v250
    s_nop 1
    v_addc_co_u32 v251, vcc, 0, v251, vcc
    global_load_dword v255, v[250:251], off
    s_branch F_rxsw
F_xp1:
    v_add_f32 v96, v212, v216
    v_add_f32 v97, v212, v217
    v_add_f32 v98, v212, v218
    v_add_f32 v99, v212, v219
    v_mov_b32 v112, 0xf149f2ca
    v_mov_b32 v113, 0xf149f2ca
    v_mov_b32 v114, 0xf149f2ca
    v_mov_b32 v115, 0xf149f2ca
    v_add_f32 v116, v213, v216
    v_add_f32 v117, v213, v217
    v_add_f32 v118, v213, v218
    v_add_f32 v119, v213, v219
    s_branch F_T32
F_xp2:
    v_mov_b32 v96, 0xf149f2ca
    v_mov_b32 v97, 0xf149f2ca
    v_mov_b32 v98, 0xf149f2ca
    v_mov_b32 v99, 0xf149f2ca
    v_mov_b32 v100, 0xf149f2ca
    v_mov_b32 v101, 0xf149f2ca
    v_mov_b32 v102, 0xf149f2ca
    v_mov_b32 v103, 0xf149f2ca
    v_add_f32 v104, v214, v216
    v_add_f32 v105, v214, v217
    v_add_f32 v106, v214, v218
    v_add_f32 v107, v214, v219
    v_mov_b32 v112, 0xf149f2ca
    v_mov_b32 v113, 0xf149f2ca
    v_mov_b32 v114, 0xf149f2ca
    v_mov_b32 v115, 0xf149f2ca
    v_mov_b32 v116, 0xf149f2ca
    v_mov_b32 v117, 0xf149f2ca
    v_mov_b32 v118, 0xf149f2ca
    v_mov_b32 v119, 0xf149f2ca
    v_mov_b32 v120, 0xf149f2ca
    v_mov_b32 v121, 0xf149f2ca
    v_mov_b32 v122, 0xf149f2ca
    v_mov_b32 v123, 0xf149f2ca
    v_add_f32 v124, v215, v216
    v_add_f32 v125, v215, v217
    v_add_f32 v126, v215, v218
    v_add_f32 v127, v215, v219
    s_branch F_T33
.p2align 6
F_O1:
    s_waitcnt lgkmcnt(2)
    v_mfma_f32_16x16x32_bf16 v[32:35], a[192:195], v[128:131], v[96:99]
    v_exp_f32 v15, v15
    v_mfma_f32_16x16x32_bf16 v[32:35], a[196:199], v[132:135], v[32:35]
    ds_read_b128 a[232:235], v232 offset:10240
    v_cvt_pk_bf16_f32 v71, v14, v15
    v_mfma_f32_16x16x32_bf16 v[32:35], a[200:203], v[136:139], v[32:35]
    v_exp_f32 v20, v20
    v_mfma_f32_16x16x32_bf16 v[32:35], a[204:207], v[140:143], v[32:35]
    ds_read_b128 a[236:239], v232 offset:11264
    v_mfma_f32_16x16x32_bf16 v[40:43], a[192:195], v[144:147], v[100:103]
    v_exp_f32 v21, v21
    v_mfma_f32_16x16x32_bf16 v[40:43], a[196:199], v[148:151], v[40:43]
    ds_read_b128 a[240:243], v232 offset:12288
    v_cvt_pk_bf16_f32 v74, v20, v21
    v_mfma_f32_16x16x32_bf16 v[40:43], a[200:203], v[152:155], v[40:43]
    v_exp_f32 v22, v22
    v_mfma_f32_16x16x32_bf16 v[40:43], a[204:207], v[156:159], v[40:43]
    v_mfma_f32_16x16x32_bf16 v[48:51], a[192:195], v[160:163], v[104:107]
    v_exp_f32 v23, v23
    v_mfma_f32_16x16x32_bf16 v[48:51], a[196:199], v[164:167], v[48:51]
    ds_read_b128 a[244:247], v232 offset:13312
    v_cvt_pk_bf16_f32 v75, v22, v23
    v_mfma_f32_16x16x32_bf16 v[48:51], a[200:203], v[168:171], v[48:51]
    v_exp_f32 v28, v28
    v_mfma_f32_16x16x32_bf16 v[48:51], a[204:207], v[172:175], v[48:51]
    v_mfma_f32_16x16x32_bf16 v[56:59], a[192:195], v[176:179], v[108:111]
    v_exp_f32 v29, v29
    v_mfma_f32_16x16x32_bf16 v[56:59], a[196:199], v[180:183], v[56:59]
    ds_read_b128 a[248:251], v232 offset:14336
    v_cvt_pk_bf16_f32 v78, v28, v29
    v_mfma_f32_16x16x32_bf16 v[56:59], a[200:203], v[184:187], v[56:59]
    v_exp_f32 v30, v30
    v_mfma_f32_16x16x32_bf16 v[56:59], a[204:207], v[188:191], v[56:59]
    v_mfma_f32_16x16x32_bf16 v[36:39], a[208:211], v[128:131], v[112:115]
    v_exp_f32 v31, v31
    v_mfma_f32_16x16x32_bf16 v[36:39], a[212:215], v[132:135], v[36:39]
    ds_read_b128 a[252:255], v232 offset:15360
    v_cvt_pk_bf16_f32 v79, v30, v31
    v_mfma_f32_16x16x32_bf16 v[36:39], a[216:219], v[136:139], v[36:39]
    s_add_u32 s67, s67, 0x4000
    v_mfma_f32_16x16x32_bf16 v[36:39], a[220:223], v[140:143], v[36:39]
    v_mfma_f32_16x16x32_bf16 v[44:47], a[208:211], v[144:147], v[116:119]
    v_mfma_f32_16x16x32_bf16 v[44:47], a[212:215], v[148:151], v[44:47]
    v_bfi_b32 v232, v233, s67, v232
    v_mfma_f32_16x16x32_bf16 v[44:47], a[216:219], v[152:155], v[44:47]
    v_exp_f32 v32, v32
    v_mfma_f32_16x16x32_bf16 v[44:47], a[220:223], v[156:159], v[44:47]
    s_mov_b32 m0, s66
    v_mfma_f32_16x16x32_bf16 v[52:55], a[208:211], v[160:163], v[120:123]
    v_exp_f32 v33, v33
    v_mfma_f32_16x16x32_bf16 v[52:55], a[212:215], v[164:167], v[52:55]
    v_cvt_pk_bf16_f32 v80, v32, v33
    v_mfma_f32_16x16x32_bf16 v[52:55], a[216:219], v[168:171], v[52:55]
    v_exp_f32 v34, v34
    v_mfma_f32_16x16x32_bf16 v[52:55], a[220:223], v[172:175], v[52:55]
    v_mfma_f32_16x16x32_bf16 v[60:63], a[208:211], v[176:179], v[124:127]
    v_exp_f32 v35, v35
    v_mfma_f32_16x16x32_bf16 v[60:63], a[212:215], v[180:183], v[60:63]
    v_cvt_pk_bf16_f32 v81, v34, v35
    v_mfma_f32_16x16x32_bf16 v[60:63], a[216:219], v[184:187], v[60:63]
    v_exp_f32 v40, v40
    v_mfma_f32_16x16x32_bf16 v[60:63], a[220:223], v[188:191], v[60:63]
    s_waitcnt vmcnt(8) lgkmcnt(0)
    s_barrier
    v_mfma_f32_16x16x32_bf16 a[0:3], a[224:227], v[64:67], a[0:3]
    v_exp_f32 v41, v41
    v_mfma_f32_16x16x32_bf16 a[4:7], a[224:227], v[68:71], a[4:7]
    ds_read_b128 a[192:195], v232 offset:0
    v_cvt_pk_bf16_f32 v84, v40, v41
    v_mfma_f32_16x16x32_bf16 a[8:11], a[224:227], v[72:75], a[8:11]
    v_exp_f32 v42, v42
    v_mfma_f32_16x16x32_bf16 a[12:15], a[224:227], v[76:79], a[12:15]
    ds_read_b128 a[196:199], v232 offset:1024
    v_mfma_f32_16x16x32_bf16 a[16:19], a[228:231], v[64:67], a[16:19]
    v_exp_f32 v43, v43
    v_mfma_f32_16x16x32_bf16 a[20:23], a[228:231], v[68:71], a[20:23]
    ds_read_b128 a[200:203], v232 offset:2048
    v_cvt_pk_bf16_f32 v85, v42, v43
    v_mfma_f32_16x16x32_bf16 a[24:27], a[228:231], v[72:75], a[24:27]
    v_exp_f32 v48, v48
    v_mfma_f32_16x16x32_bf16 a[28:31], a[228:231], v[76:79], a[28:31]
    ds_read_b128 a[204:207], v232 offset:3072
    v_mfma_f32_16x16x32_bf16 a[32:35], a[232:235], v[64:67], a[32:35]
    v_exp_f32 v49, v49
    v_mfma_f32_16x16x32_bf16 a[36:39], a[232:235], v[68:71], a[36:39]
    ds_read_b128 a[208:211], v232 offset:4096
    v_cvt_pk_bf16_f32 v88, v48, v49
    v_mfma_f32_16x16x32_bf16 a[40:43], a[232:235], v[72:75], a[40:43]
    v_exp_f32 v50, v50
    v_mfma_f32_16x16x32_bf16 a[44:47], a[232:235], v[76:79], a[44:47]
    buffer_load_dwordx4 v248, s[40:43], s64 offen offset:0 sc1 lds
    v_mfma_f32_16x16x32_bf16 a[48:51], a[236:239], v[64:67], a[48:51]
    v_exp_f32 v51, v51
    v_mfma_f32_16x16x32_bf16 a[52:55], a[236:239], v[68:71], a[52:55]
    ds_read_b128 a[212:215], v232 offset:5120
    v_cvt_pk_bf16_f32 v89, v50, v51
    v_mfma_f32_16x16x32_bf16 a[56:59], a[236:239], v[72:75], a[56:59]
    v_exp_f32 v56, v56
    v_mfma_f32_16x16x32_bf16 a[60:63], a[236:239], v[76:79], a[60:63]
    buffer_load_dwordx4 v248, s[40:43], s64 offen offset:1024 sc1 lds
    v_mfma_f32_16x16x32_bf16 v[192:195], v[208:211], v[64:67], v[192:195]
    v_exp_f32 v57, v57
    v_mfma_f32_16x16x32_bf16 v[196:199], v[208:211], v[68:71], v[196:199]
    ds_read_b128 a[216:219], v232 offset:6144
    v_cvt_pk_bf16_f32 v92, v56, v57
    v_mfma_f32_16x16x32_bf16 v[200:203], v[208:211], v[72:75], v[200:203]
    v_exp_f32 v58, v58
    v_mfma_f32_16x16x32_bf16 v[204:207], v[208:211], v[76:79], v[204:207]
    buffer_load_dwordx4 v248, s[40:43], s64 offen offset:2048 sc1 lds
    v_mfma_f32_16x16x32_bf16 a[64:67], a[240:243], v[64:67], a[64:67]
    v_exp_f32 v59, v59
    v_mfma_f32_16x16x32_bf16 a[68:71], a[240:243], v[68:71], a[68:71]
    ds_read_b128 a[220:223], v232 offset:7168
    v_cvt_pk_bf16_f32 v93, v58, v59
    v_mfma_f32_16x16x32_bf16 a[72:75], a[240:243], v[72:75], a[72:75]
    v_exp_f32 v36, v36
    v_mfma_f32_16x16x32_bf16 a[76:79], a[240:243], v[76:79], a[76:79]
    buffer_load_dwordx4 v248, s[40:43], s64 offen offset:3072 sc1 lds
    v_mfma_f32_16x16x32_bf16 a[80:83], a[244:247], v[64:67], a[80:83]
    v_exp_f32 v37, v37
    v_mfma_f32_16x16x32_bf16 a[84:87], a[244:247], v[68:71], a[84:87]
    ds_read_b128 a[224:227], v232 offset:8192
    v_cvt_pk_bf16_f32 v82, v36, v37
    v_mfma_f32_16x16x32_bf16 a[88:91], a[244:247], v[72:75], a[88:91]
    s_add_u32 s64, s64, 8192
    v_exp_f32 v38, v38
    v_mfma_f32_16x16x32_bf16 a[92:95], a[244:247], v[76:79], a[92:95]
    s_add_u32 s66, s66, 0x4000
    v_mfma_f32_16x16x32_bf16 a[96:99], a[248:251], v[64:67], a[96:99]
    s_and_b32 s66, s66, 0xffff
    v_exp_f32 v39, v39
    v_mfma_f32_16x16x32_bf16 a[100:103], a[248:251], v[68:71], a[100:103]
    ds_read_b128 a[228:231], v232 offset:9216
    v_cvt_pk_bf16_f32 v83, v38, v39
    v_mfma_f32_16x16x32_bf16 a[104:107], a[248:251], v[72:75], a[104:107]
    v_exp_f32 v44, v44
    v_mfma_f32_16x16x32_bf16 a[108:111], a[248:251], v[76:79], a[108:111]
    s_sub_u32 s68, s68, 1
    v_mfma_f32_16x16x32_bf16 a[112:115], a[252:255], v[64:67], a[112:115]
    v_exp_f32 v45, v45
    v_mfma_f32_16x16x32_bf16 a[116:119], a[252:255], v[68:71], a[116:119]
    v_cvt_pk_bf16_f32 v86, v44, v45
    v_mfma_f32_16x16x32_bf16 a[120:123], a[252:255], v[72:75], a[120:123]
    v_exp_f32 v46, v46
    v_mfma_f32_16x16x32_bf16 a[124:127], a[252:255], v[76:79], a[124:127]
    s_cbranch_scc1 F_event
F_E1:
    s_waitcnt lgkmcnt(2)
    v_mfma_f32_16x16x32_bf16 v[0:3], a[192:195], v[128:131], v[96:99]
    v_exp_f32 v47, v47
    v_mfma_f32_16x16x32_bf16 v[0:3], a[196:199], v[132:135], v[0:3]
    ds_read_b128 a[232:235], v232 offset:10240
    v_cvt_pk_bf16_f32 v87, v46, v47
    v_mfma_f32_16x16x32_bf16 v[0:3], a[200:203], v[136:139], v[0:3]
    v_exp_f32 v52, v52
    v_mfma_f32_16x16x32_bf16 v[0:3], a[204:207], v[140:143], v[0:3]
    ds_read_b128 a[236:239], v232 offset:11264
    v_mfma_f32_16x16x32_bf16 v[8:11], a[192:195], v[144:147], v[100:103]
    v_exp_f32 v53, v53
    v_mfma_f32_16x16x32_bf16 v[8:11], a[196:199], v[148:151], v[8:11]
    ds_read_b128 a[240:243], v232 offset:12288
    v_cvt_pk_bf16_f32 v90, v52, v53
    v_mfma_f32_16x16x32_bf16 v[8:11], a[200:203], v[152:155], v[8:11]
    v_exp_f32 v54, v54
    v_mfma_f32_16x16x32_bf16 v[8:11], a[204:207], v[156:159], v[8:11]
    v_mfma_f32_16x16x32_bf16 v[16:19], a[192:195], v[160:163], v[104:107]
    v_exp_f32 v55, v55
    v_mfma_f32_16x16x32_bf16 v[16:19], a[196:199], v[164:167], v[16:19]
    ds_read_b128 a[244:247], v232 offset:13312
    v_cvt_pk_bf16_f32 v91, v54, v55
    v_mfma_f32_16x16x32_bf16 v[16:19], a[200:203], v[168:171], v[16:19]
    v_exp_f32 v60, v60
    v_mfma_f32_16x16x32_bf16 v[16:19], a[204:207], v[172:175], v[16:19]
    v_mfma_f32_16x16x32_bf16 v[24:27], a[192:195], v[176:179], v[108:111]
    v_exp_f32 v61, v61
    v_mfma_f32_16x16x32_bf16 v[24:27], a[196:199], v[180:183], v[24:27]
    ds_read_b128 a[248:251], v232 offset:14336
    v_cvt_pk_bf16_f32 v94, v60, v61
    v_mfma_f32_16x16x32_bf16 v[24:27], a[200:203], v[184:187], v[24:27]
    v_exp_f32 v62, v62
    v_mfma_f32_16x16x32_bf16 v[24:27], a[204:207], v[188:191], v[24:27]
    v_mfma_f32_16x16x32_bf16 v[4:7], a[208:211], v[128:131], v[112:115]
    v_exp_f32 v63, v63
    v_mfma_f32_16x16x32_bf16 v[4:7], a[212:215], v[132:135], v[4:7]
    ds_read_b128 a[252:255], v232 offset:15360
    v_cvt_pk_bf16_f32 v95, v62, v63
    v_mfma_f32_16x16x32_bf16 v[4:7], a[216:219], v[136:139], v[4:7]
    s_add_u32 s67, s67, 0x4000
    v_mfma_f32_16x16x32_bf16 v[4:7], a[220:223], v[140:143], v[4:7]
    v_mfma_f32_16x16x32_bf16 v[12:15], a[208:211], v[144:147], v[116:119]
    v_mfma_f32_16x16x32_bf16 v[12:15], a[212:215], v[148:151], v[12:15]
    v_bfi_b32 v232, v233, s67, v232
    v_mfma_f32_16x16x32_bf16 v[12:15], a[216:219], v[152:155], v[12:15]
    v_exp_f32 v0, v0
    v_mfma_f32_16x16x32_bf16 v[12:15], a[220:223], v[156:159], v[12:15]
    s_mov_b32 m0, s66
    v_mfma_f32_16x16x32_bf16 v[20:23], a[208:211], v[160:163], v[120:123]
    v_exp_f32 v1, v1
    v_mfma_f32_16x16x32_bf16 v[20:23], a[212:215], v[164:167], v[20:23]
    v_cvt_pk_bf16_f32 v64, v0, v1
    v_mfma_f32_16x16x32_bf16 v[20:23], a[216:219], v[168:171], v[20:23]
    v_exp_f32 v2, v2
    v_mfma_f32_16x16x32_bf16 v[20:23], a[220:223], v[172:175], v[20:23]
    v_mfma_f32_16x16x32_bf16 v[28:31], a[208:211], v[176:179], v[124:127]
    v_exp_f32 v3, v3
    v_mfma_f32_16x16x32_bf16 v[28:31], a[212:215], v[180:183], v[28:31]
    v_cvt_pk_bf16_f32 v65, v2, v3
    v_mfma_f32_16x16x32_bf16 v[28:31], a[216:219], v[184:187], v[28:31]
    v_exp_f32 v8, v8
    v_mfma_f32_16x16x32_bf16 v[28:31], a[220:223], v[188:191], v[28:31]
    s_waitcnt vmcnt(8) lgkmcnt(0)
    s_barrier
    v_mfma_f32_16x16x32_bf16 a[0:3], a[224:227], v[80:83], a[0:3]
    v_exp_f32 v9, v9
    v_mfma_f32_16x16x32_bf16 a[4:7], a[224:227], v[84:87], a[4:7]
    ds_read_b128 a[192:195], v232 offset:0
    v_cvt_pk_bf16_f32 v68, v8, v9
    v_mfma_f32_16x16x32_bf16 a[8:11], a[224:227], v[88:91], a[8:11]
    v_exp_f32 v10, v10
    v_mfma_f32_16x16x32_bf16 a[12:15], a[224:227], v[92:95], a[12:15]
    ds_read_b128 a[196:199], v232 offset:1024
    v_mfma_f32_16x16x32_bf16 a[16:19], a[228:231], v[80:83], a[16:19]
    v_exp_f32 v11, v11
    v_mfma_f32_16x16x32_bf16 a[20:23], a[228:231], v[84:87], a[20:23]
    ds_read_b128 a[200:203], v232 offset:2048
    v_cvt_pk_bf16_f32 v69, v10, v11
    v_mfma_f32_16x16x32_bf16 a[24:27], a[228:231], v[88:91], a[24:27]
    v_exp_f32 v16, v16
    v_mfma_f32_16x16x32_bf16 a[28:31], a[228:231], v[92:95], a[28:31]
    ds_read_b128 a[204:207], v232 offset:3072
    v_mfma_f32_16x16x32_bf16 a[32:35], a[232:235], v[80:83], a[32:35]
    v_exp_f32 v17, v17
    v_mfma_f32_16x16x32_bf16 a[36:39], a[232:235], v[84:87], a[36:39]
    ds_read_b128 a[208:211], v232 offset:4096
    v_cvt_pk_bf16_f32 v72, v16, v17
    v_mfma_f32_16x16x32_bf16 a[40:43], a[232:235], v[88:91], a[40:43]
    v_exp_f32 v18, v18
    v_mfma_f32_16x16x32_bf16 a[44:47], a[232:235], v[92:95], a[44:47]
    buffer_load_dwordx4 v248, s[40:43], s64 offen offset:0 sc1 lds
    v_mfma_f32_16x16x32_bf16 a[48:51], a[236:239], v[80:83], a[48:51]
    v_exp_f32 v19, v19
    v_mfma_f32_16x16x32_bf16 a[52:55], a[236:239], v[84:87], a[52:55]
    ds_read_b128 a[212:215], v232 offset:5120
    v_cvt_pk_bf16_f32 v73, v18, v19
    v_mfma_f32_16x16x32_bf16 a[56:59], a[236:239], v[88:91], a[56:59]
    v_exp_f32 v24, v24
    v_mfma_f32_16x16x32_bf16 a[60:63], a[236:239], v[92:95], a[60:63]
    buffer_load_dwordx4 v248, s[40:43], s64 offen offset:1024 sc1 lds
    v_mfma_f32_16x16x32_bf16 v[192:195], v[208:211], v[80:83], v[192:195]
    v_exp_f32 v25, v25
    v_mfma_f32_16x16x32_bf16 v[196:199], v[208:211], v[84:87], v[196:199]
    ds_read_b128 a[216:219], v232 offset:6144
    v_cvt_pk_bf16_f32 v76, v24, v25
    v_mfma_f32_16x16x32_bf16 v[200:203], v[208:211], v[88:91], v[200:203]
    v_exp_f32 v26, v26
    v_mfma_f32_16x16x32_bf16 v[204:207], v[208:211], v[92:95], v[204:207]
    buffer_load_dwordx4 v248, s[40:43], s64 offen offset:2048 sc1 lds
    v_mfma_f32_16x16x32_bf16 a[64:67], a[240:243], v[80:83], a[64:67]
    v_exp_f32 v27, v27
    v_mfma_f32_16x16x32_bf16 a[68:71], a[240:243], v[84:87], a[68:71]
    ds_read_b128 a[220:223], v232 offset:7168
    v_cvt_pk_bf16_f32 v77, v26, v27
    v_mfma_f32_16x16x32_bf16 a[72:75], a[240:243], v[88:91], a[72:75]
    v_exp_f32 v4, v4
    v_mfma_f32_16x16x32_bf16 a[76:79], a[240:243], v[92:95], a[76:79]
    buffer_load_dwordx4 v248, s[40:43], s64 offen offset:3072 sc1 lds
    v_mfma_f32_16x16x32_bf16 a[80:83], a[244:247], v[80:83], a[80:83]
    v_exp_f32 v5, v5
    v_mfma_f32_16x16x32_bf16 a[84:87], a[244:247], v[84:87], a[84:87]
    ds_read_b128 a[224:227], v232 offset:8192
    v_cvt_pk_bf16_f32 v66, v4, v5
    v_mfma_f32_16x16x32_bf16 a[88:91], a[244:247], v[88:91], a[88:91]
    s_add_u32 s64, s64, 8192
    v_exp_f32 v6, v6
    v_mfma_f32_16x16x32_bf16 a[92:95], a[244:247], v[92:95], a[92:95]
    s_add_u32 s66, s66, 0x4000
    v_mfma_f32_16x16x32_bf16 a[96:99], a[248:251], v[80:83], a[96:99]
    s_and_b32 s66, s66, 0xffff
    v_exp_f32 v7, v7
    v_mfma_f32_16x16x32_bf16 a[100:103], a[248:251], v[84:87], a[100:103]
    ds_read_b128 a[228:231], v232 offset:9216
    v_cvt_pk_bf16_f32 v67, v6, v7
    v_mfma_f32_16x16x32_bf16 a[104:107], a[248:251], v[88:91], a[104:107]
    v_exp_f32 v12, v12
    v_mfma_f32_16x16x32_bf16 a[108:111], a[248:251], v[92:95], a[108:111]
    s_sub_u32 s68, s68, 1
    v_mfma_f32_16x16x32_bf16 a[112:115], a[252:255], v[80:83], a[112:115]
    v_exp_f32 v13, v13
    v_mfma_f32_16x16x32_bf16 a[116:119], a[252:255], v[84:87], a[116:119]
    v_cvt_pk_bf16_f32 v70, v12, v13
    v_mfma_f32_16x16x32_bf16 a[120:123], a[252:255], v[88:91], a[120:123]
    v_exp_f32 v14, v14
    v_mfma_f32_16x16x32_bf16 a[124:127], a[252:255], v[92:95], a[124:127]
    s_cbranch_scc1 F_event
    s_branch F_O1
.p2align 6
F_O2:
    s_waitcnt lgkmcnt(2)
    v_mfma_f32_16x16x32_bf16 v[32:35], a[192:195], v[128:131], v[96:99]
    v_exp_f32 v15, v15
    v_mfma_f32_16x16x32_bf16 v[32:35], a[196:199], v[132:135], v[32:35]
    ds_read_b128 a[232:235], v232 offset:10240
    v_cvt_pk_bf16_f32 v71, v14, v15
    v_mfma_f32_16x16x32_bf16 v[32:35], a[200:203], v[136:139], v[32:35]
    v_exp_f32 v20, v20
    v_mfma_f32_16x16x32_bf16 v[32:35], a[204:207], v[140:143], v[32:35]
    s_add_u32 m0, s66, 0x10000
    ds_read_b128 a[236:239], v232 offset:11264
    v_mfma_f32_16x16x32_bf16 v[40:43], a[192:195], v[144:147], v[100:103]
    v_exp_f32 v21, v21
    v_mfma_f32_16x16x32_bf16 v[40:43], a[196:199], v[148:151], v[40:43]
    ds_read_b128 a[240:243], v232 offset:12288
    v_cvt_pk_bf16_f32 v74, v20, v21
    v_mfma_f32_16x16x32_bf16 v[40:43], a[200:203], v[152:155], v[40:43]
    v_exp_f32 v22, v22
    v_mfma_f32_16x16x32_bf16 v[40:43], a[204:207], v[156:159], v[40:43]
    buffer_load_dwordx4 v248, s[40:43], s65 offen offset:0 sc1 lds
    v_mfma_f32_16x16x32_bf16 v[48:51], a[192:195], v[160:163], v[104:107]
    v_exp_f32 v23, v23
    v_mfma_f32_16x16x32_bf16 v[48:51], a[196:199], v[164:167], v[48:51]
    ds_read_b128 a[244:247], v232 offset:13312
    v_cvt_pk_bf16_f32 v75, v22, v23
    v_mfma_f32_16x16x32_bf16 v[48:51], a[200:203], v[168:171], v[48:51]
    v_exp_f32 v28, v28
    v_mfma_f32_16x16x32_bf16 v[48:51], a[204:207], v[172:175], v[48:51]
    buffer_load_dwordx4 v248, s[40:43], s65 offen offset:1024 sc1 lds
    v_mfma_f32_16x16x32_bf16 v[56:59], a[192:195], v[176:179], v[108:111]
    v_exp_f32 v29, v29
    v_mfma_f32_16x16x32_bf16 v[56:59], a[196:199], v[180:183], v[56:59]
    ds_read_b128 a[248:251], v232 offset:14336
    v_cvt_pk_bf16_f32 v78, v28, v29
    v_mfma_f32_16x16x32_bf16 v[56:59], a[200:203], v[184:187], v[56:59]
    v_exp_f32 v30, v30
    v_mfma_f32_16x16x32_bf16 v[56:59], a[204:207], v[188:191], v[56:59]
    buffer_load_dwordx4 v248, s[40:43], s65 offen offset:2048 sc1 lds
    v_mfma_f32_16x16x32_bf16 v[36:39], a[208:211], v[128:131], v[112:115]
    v_exp_f32 v31, v31
    v_mfma_f32_16x16x32_bf16 v[36:39], a[212:215], v[132:135], v[36:39]
    ds_read_b128 a[252:255], v232 offset:15360
    v_cvt_pk_bf16_f32 v79, v30, v31
    v_mfma_f32_16x16x32_bf16 v[36:39], a[216:219], v[136:139], v[36:39]
    s_add_u32 s67, s67, 0x4000
    v_mfma_f32_16x16x32_bf16 v[36:39], a[220:223], v[140:143], v[36:39]
    buffer_load_dwordx4 v248, s[40:43], s65 offen offset:3072 sc1 lds
    v_mfma_f32_16x16x32_bf16 v[44:47], a[208:211], v[144:147], v[116:119]
    s_sub_u32 s65, s65, 8192
    v_mfma_f32_16x16x32_bf16 v[44:47], a[212:215], v[148:151], v[44:47]
    v_bfi_b32 v232, v233, s67, v232
    v_mfma_f32_16x16x32_bf16 v[44:47], a[216:219], v[152:155], v[44:47]
    v_exp_f32 v32, v32
    v_mfma_f32_16x16x32_bf16 v[44:47], a[220:223], v[156:159], v[44:47]
    s_mov_b32 m0, s66
    v_mfma_f32_16x16x32_bf16 v[52:55], a[208:211], v[160:163], v[120:123]
    v_exp_f32 v33, v33
    v_mfma_f32_16x16x32_bf16 v[52:55], a[212:215], v[164:167], v[52:55]
    v_cvt_pk_bf16_f32 v80, v32, v33
    v_mfma_f32_16x16x32_bf16 v[52:55], a[216:219], v[168:171], v[52:55]
    v_exp_f32 v34, v34
    v_mfma_f32_16x16x32_bf16 v[52:55], a[220:223], v[172:175], v[52:55]
    v_mfma_f32_16x16x32_bf16 v[60:63], a[208:211], v[176:179], v[124:127]
    v_exp_f32 v35, v35
    v_mfma_f32_16x16x32_bf16 v[60:63], a[212:215], v[180:183], v[60:63]
    v_cvt_pk_bf16_f32 v81, v34, v35
    v_mfma_f32_16x16x32_bf16 v[60:63], a[216:219], v[184:187], v[60:63]
    v_exp_f32 v40, v40
    v_mfma_f32_16x16x32_bf16 v[60:63], a[220:223], v[188:191], v[60:63]
    s_waitcnt vmcnt(16) lgkmcnt(0)
    s_barrier
    v_mfma_f32_16x16x32_bf16 a[0:3], a[224:227], v[64:67], a[0:3]
    v_exp_f32 v41, v41
    v_mfma_f32_16x16x32_bf16 a[4:7], a[224:227], v[68:71], a[4:7]
    ds_read_b128 a[192:195], v232 offset:0
    v_cvt_pk_bf16_f32 v84, v40, v41
    v_mfma_f32_16x16x32_bf16 a[8:11], a[224:227], v[72:75], a[8:11]
    v_exp_f32 v42, v42
    v_mfma_f32_16x16x32_bf16 a[12:15], a[224:227], v[76:79], a[12:15]
    ds_read_b128 a[196:199], v232 offset:1024
    v_mfma_f32_16x16x32_bf16 a[16:19], a[228:231], v[64:67], a[16:19]
    v_exp_f32 v43, v43
    v_mfma_f32_16x16x32_bf16 a[20:23], a[228:231], v[68:71], a[20:23]
    ds_read_b128 a[200:203], v232 offset:2048
    v_cvt_pk_bf16_f32 v85, v42, v43
    v_mfma_f32_16x16x32_bf16 a[24:27], a[228:231], v[72:75], a[24:27]
    v_exp_f32 v48, v48
    v_mfma_f32_16x16x32_bf16 a[28:31], a[228:231], v[76:79], a[28:31]
    ds_read_b128 a[204:207], v232 offset:3072
    v_mfma_f32_16x16x32_bf16 a[32:35], a[232:235], v[64:67], a[32:35]
    v_exp_f32 v49, v49
    v_mfma_f32_16x16x32_bf16 a[36:39], a[232:235], v[68:71], a[36:39]
    ds_read_b128 a[208:211], v232 offset:4096
    v_cvt_pk_bf16_f32 v88, v48, v49
    v_mfma_f32_16x16x32_bf16 a[40:43], a[232:235], v[72:75], a[40:43]
    v_exp_f32 v50, v50
    v_mfma_f32_16x16x32_bf16 a[44:47], a[232:235], v[76:79], a[44:47]
    buffer_load_dwordx4 v248, s[40:43], s64 offen offset:0 sc1 lds
    v_mfma_f32_16x16x32_bf16 a[48:51], a[236:239], v[64:67], a[48:51]
    v_exp_f32 v51, v51
    v_mfma_f32_16x16x32_bf16 a[52:55], a[236:239], v[68:71], a[52:55]
    ds_read_b128 a[212:215], v232 offset:5120
    v_cvt_pk_bf16_f32 v89, v50, v51
    v_mfma_f32_16x16x32_bf16 a[56:59], a[236:239], v[72:75], a[56:59]
    v_exp_f32 v56, v56
    v_mfma_f32_16x16x32_bf16 a[60:63], a[236:239], v[76:79], a[60:63]
    buffer_load_dwordx4 v248, s[40:43], s64 offen offset:1024 sc1 lds
    v_mfma_f32_16x16x32_bf16 v[192:195], v[208:211], v[64:67], v[192:195]
    v_exp_f32 v57, v57
    v_mfma_f32_16x16x32_bf16 v[196:199], v[208:211], v[68:71], v[196:199]
    ds_read_b128 a[216:219], v232 offset:6144
    v_cvt_pk_bf16_f32 v92, v56, v57
    v_mfma_f32_16x16x32_bf16 v[200:203], v[208:211], v[72:75], v[200:203]
    v_exp_f32 v58, v58
    v_mfma_f32_16x16x32_bf16 v[204:207], v[208:211], v[76:79], v[204:207]
    buffer_load_dwordx4 v248, s[40:43], s64 offen offset:2048 sc1 lds
    v_mfma_f32_16x16x32_bf16 a[64:67], a[240:243], v[64:67], a[64:67]
    v_exp_f32 v59, v59
    v_mfma_f32_16x16x32_bf16 a[68:71], a[240:243], v[68:71], a[68:71]
    ds_read_b128 a[220:223], v232 offset:7168
    v_cvt_pk_bf16_f32 v93, v58, v59
    v_mfma_f32_16x16x32_bf16 a[72:75], a[240:243], v[72:75], a[72:75]
    v_exp_f32 v36, v36
    v_mfma_f32_16x16x32_bf16 a[76:79], a[240:243], v[76:79], a[76:79]
    buffer_load_dwordx4 v248, s[40:43], s64 offen offset:3072 sc1 lds
    v_mfma_f32_16x16x32_bf16 a[80:83], a[244:247], v[64:67], a[80:83]
    v_exp_f32 v37, v37
    v_mfma_f32_16x16x32_bf16 a[84:87], a[244:247], v[68:71], a[84:87]
    ds_read_b128 a[224:227], v232 offset:8192
    v_cvt_pk_bf16_f32 v82, v36, v37
    v_mfma_f32_16x16x32_bf16 a[88:91], a[244:247], v[72:75], a[88:91]
    s_add_u32 s64, s64, 8192
    v_exp_f32 v38, v38
    v_mfma_f32_16x16x32_bf16 a[92:95], a[244:247], v[76:79], a[92:95]
    s_add_u32 s66, s66, 0x4000
    v_mfma_f32_16x16x32_bf16 a[96:99], a[248:251], v[64:67], a[96:99]
    s_and_b32 s66, s66, 0xffff
    v_exp_f32 v39, v39
    v_mfma_f32_16x16x32_bf16 a[100:103], a[248:251], v[68:71], a[100:103]
    ds_read_b128 a[228:231], v232 offset:9216
    v_cvt_pk_bf16_f32 v83, v38, v39
    v_mfma_f32_16x16x32_bf16 a[104:107], a[248:251], v[72:75], a[104:107]
    v_exp_f32 v44, v44
    v_mfma_f32_16x16x32_bf16 a[108:111], a[248:251], v[76:79], a[108:111]
    s_sub_u32 s68, s68, 1
    v_mfma_f32_16x16x32_bf16 a[112:115], a[252:255], v[64:67], a[112:115]
    v_exp_f32 v45, v45
    v_mfma_f32_16x16x32_bf16 a[116:119], a[252:255], v[68:71], a[116:119]
    v_cvt_pk_bf16_f32 v86, v44, v45
    v_mfma_f32_16x16x32_bf16 a[120:123], a[252:255], v[72:75], a[120:123]
    v_exp_f32 v46, v46
    v_mfma_f32_16x16x32_bf16 a[124:127], a[252:255], v[76:79], a[124:127]
    s_cbranch_scc1 F_event
F_E2:
    s_waitcnt lgkmcnt(2)
    v_mfma_f32_16x16x32_bf16 v[0:3], a[192:195], v[128:131], v[96:99]
    v_exp_f32 v47, v47
    v_mfma_f32_16x16x32_bf16 v[0:3], a[196:199], v[132:135], v[0:3]
    ds_read_b128 a[232:235], v232 offset:10240
    v_cvt_pk_bf16_f32 v87, v46, v47
    v_mfma_f32_16x16x32_bf16 v[0:3], a[200:203], v[136:139], v[0:3]
    v_exp_f32 v52, v52
    v_mfma_f32_16x16x32_bf16 v[0:3], a[204:207], v[140:143], v[0:3]
    s_add_u32 m0, s66, 0x10000
    ds_read_b128 a[236:239], v232 offset:11264
    v_mfma_f32_16x16x32_bf16 v[8:11], a[192:195], v[144:147], v[100:103]
    v_exp_f32 v53, v53
    v_mfma_f32_16x16x32_bf16 v[8:11], a[196:199], v[148:151], v[8:11]
    ds_read_b128 a[240:243], v232 offset:12288
    v_cvt_pk_bf16_f32 v90, v52, v53
    v_mfma_f32_16x16x32_bf16 v[8:11], a[200:203], v[152:155], v[8:11]
    v_exp_f32 v54, v54
    v_mfma_f32_16x16x32_bf16 v[8:11], a[204:207], v[156:159], v[8:11]
    buffer_load_dwordx4 v248, s[40:43], s65 offen offset:0 sc1 lds
    v_mfma_f32_16x16x32_bf16 v[16:19], a[192:195], v[160:163], v[104:107]
    v_exp_f32 v55, v55
    v_mfma_f32_16x16x32_bf16 v[16:19], a[196:199], v[164:167], v[16:19]
    ds_read_b128 a[244:247], v232 offset:13312
    v_cvt_pk_bf16_f32 v91, v54, v55
    v_mfma_f32_16x16x32_bf16 v[16:19], a[200:203], v[168:171], v[16:19]
    v_exp_f32 v60, v60
    v_mfma_f32_16x16x32_bf16 v[16:19], a[204:207], v[172:175], v[16:19]
    buffer_load_dwordx4 v248, s[40:43], s65 offen offset:1024 sc1 lds
    v_mfma_f32_16x16x32_bf16 v[24:27], a[192:195], v[176:179], v[108:111]
    v_exp_f32 v61, v61
    v_mfma_f32_16x16x32_bf16 v[24:27], a[196:199], v[180:183], v[24:27]
    ds_read_b128 a[248:251], v232 offset:14336
    v_cvt_pk_bf16_f32 v94, v60, v61
    v_mfma_f32_16x16x32_bf16 v[24:27], a[200:203], v[184:187], v[24:27]
    v_exp_f32 v62, v62
    v_mfma_f32_16x16x32_bf16 v[24:27], a[204:207], v[188:191], v[24:27]
    buffer_load_dwordx4 v248, s[40:43], s65 offen offset:2048 sc1 lds
    v_mfma_f32_16x16x32_bf16 v[4:7], a[208:211], v[128:131], v[112:115]
    v_exp_f32 v63, v63
    v_mfma_f32_16x16x32_bf16 v[4:7], a[212:215], v[132:135], v[4:7]
    ds_read_b128 a[252:255], v232 offset:15360
    v_cvt_pk_bf16_f32 v95, v62, v63
    v_mfma_f32_16x16x32_bf16 v[4:7], a[216:219], v[136:139], v[4:7]
    s_add_u32 s67, s67, 0x4000
    v_mfma_f32_16x16x32_bf16 v[4:7], a[220:223], v[140:143], v[4:7]
    buffer_load_dwordx4 v248, s[40:43], s65 offen offset:3072 sc1 lds
    v_mfma_f32_16x16x32_bf16 v[12:15], a[208:211], v[144:147], v[116:119]
    s_sub_u32 s65, s65, 8192
    v_mfma_f32_16x16x32_bf16 v[12:15], a[212:215], v[148:151], v[12:15]
    v_bfi_b32 v232, v233, s67, v232
    v_mfma_f32_16x16x32_bf16 v[12:15], a[216:219], v[152:155], v[12:15]
    v_exp_f32 v0, v0
    v_mfma_f32_16x16x32_bf16 v[12:15], a[220:223], v[156:159], v[12:15]
    s_mov_b32 m0, s66
    v_mfma_f32_16x16x32_bf16 v[20:23], a[208:211], v[160:163], v[120:123]
    v_exp_f32 v1, v1
    v_mfma_f32_16x16x32_bf16 v[20:23], a[212:215], v[164:167], v[20:23]
    v_cvt_pk_bf16_f32 v64, v0, v1
    v_mfma_f32_16x16x32_bf16 v[20:23], a[216:219], v[168:171], v[20:23]
    v_exp_f32 v2, v2
    v_mfma_f32_16x16x32_bf16 v[20:23], a[220:223], v[172:175], v[20:23]
    v_mfma_f32_16x16x32_bf16 v[28:31], a[208:211], v[176:179], v[124:127]
    v_exp_f32 v3, v3
    v_mfma_f32_16x16x32_bf16 v[28:31], a[212:215], v[180:183], v[28:31]
    v_cvt_pk_bf16_f32 v65, v2, v3
    v_mfma_f32_16x16x32_bf16 v[28:31], a[216:219], v[184:187], v[28:31]
    v_exp_f32 v8, v8
    v_mfma_f32_16x16x32_bf16 v[28:31], a[220:223], v[188:191], v[28:31]
    s_waitcnt vmcnt(16) lgkmcnt(0)
    s_barrier
    v_mfma_f32_16x16x32_bf16 a[0:3], a[224:227], v[80:83], a[0:3]
    v_exp_f32 v9, v9
    v_mfma_f32_16x16x32_bf16 a[4:7], a[224:227], v[84:87], a[4:7]
    ds_read_b128 a[192:195], v232 offset:0
    v_cvt_pk_bf16_f32 v68, v8, v9
    v_mfma_f32_16x16x32_bf16 a[8:11], a[224:227], v[88:91], a[8:11]
    v_exp_f32 v10, v10
    v_mfma_f32_16x16x32_bf16 a[12:15], a[224:227], v[92:95], a[12:15]
    ds_read_b128 a[196:199], v232 offset:1024
    v_mfma_f32_16x16x32_bf16 a[16:19], a[228:231], v[80:83], a[16:19]
    v_exp_f32 v11, v11
    v_mfma_f32_16x16x32_bf16 a[20:23], a[228:231], v[84:87], a[20:23]
    ds_read_b128 a[200:203], v232 offset:2048
    v_cvt_pk_bf16_f32 v69, v10, v11
    v_mfma_f32_16x16x32_bf16 a[24:27], a[228:231], v[88:91], a[24:27]
    v_exp_f32 v16, v16
    v_mfma_f32_16x16x32_bf16 a[28:31], a[228:231], v[92:95], a[28:31]
    ds_read_b128 a[204:207], v232 offset:3072
    v_mfma_f32_16x16x32_bf16 a[32:35], a[232:235], v[80:83], a[32:35]
    v_exp_f32 v17, v17
    v_mfma_f32_16x16x32_bf16 a[36:39], a[232:235], v[84:87], a[36:39]
    ds_read_b128 a[208:211], v232 offset:4096
    v_cvt_pk_bf16_f32 v72, v16, v17
    v_mfma_f32_16x16x32_bf16 a[40:43], a[232:235], v[88:91], a[40:43]
    v_exp_f32 v18, v18
    v_mfma_f32_16x16x32_bf16 a[44:47], a[232:235], v[92:95], a[44:47]
    buffer_load_dwordx4 v248, s[40:43], s64 offen offset:0 sc1 lds
    v_mfma_f32_16x16x32_bf16 a[48:51], a[236:239], v[80:83], a[48:51]
    v_exp_f32 v19, v19
    v_mfma_f32_16x16x32_bf16 a[52:55], a[236:239], v[84:87], a[52:55]
    ds_read_b128 a[212:215], v232 offset:5120
    v_cvt_pk_bf16_f32 v73, v18, v19
    v_mfma_f32_16x16x32_bf16 a[56:59], a[236:239], v[88:91], a[56:59]
    v_exp_f32 v24, v24
    v_mfma_f32_16x16x32_bf16 a[60:63], a[236:239], v[92:95], a[60:63]
    buffer_load_dwordx4 v248, s[40:43], s64 offen offset:1024 sc1 lds
    v_mfma_f32_16x16x32_bf16 v[192:195], v[208:211], v[80:83], v[192:195]
    v_exp_f32 v25, v25
    v_mfma_f32_16x16x32_bf16 v[196:199], v[208:211], v[84:87], v[196:199]
    ds_read_b128 a[216:219], v232 offset:6144
    v_cvt_pk_bf16_f32 v76, v24, v25
    v_mfma_f32_16x16x32_bf16 v[200:203], v[208:211], v[88:91], v[200:203]
    v_exp_f32 v26, v26
    v_mfma_f32_16x16x32_bf16 v[204:207], v[208:211], v[92:95], v[204:207]
    buffer_load_dwordx4 v248, s[40:43], s64 offen offset:2048 sc1 lds
    v_mfma_f32_16x16x32_bf16 a[64:67], a[240:243], v[80:83], a[64:67]
    v_exp_f32 v27, v27
    v_mfma_f32_16x16x32_bf16 a[68:71], a[240:243], v[84:87], a[68:71]
    ds_read_b128 a[220:223], v232 offset:7168
    v_cvt_pk_bf16_f32 v77, v26, v27
    v_mfma_f32_16x16x32_bf16 a[72:75], a[240:243], v[88:91], a[72:75]
    v_exp_f32 v4, v4
    v_mfma_f32_16x16x32_bf16 a[76:79], a[240:243], v[92:95], a[76:79]
    buffer_load_dwordx4 v248, s[40:43], s64 offen offset:3072 sc1 lds
    v_mfma_f32_16x16x32_bf16 a[80:83], a[244:247], v[80:83], a[80:83]
    v_exp_f32 v5, v5
    v_mfma_f32_16x16x32_bf16 a[84:87], a[244:247], v[84:87], a[84:87]
    ds_read_b128 a[224:227], v232 offset:8192
    v_cvt_pk_bf16_f32 v66, v4, v5
    v_mfma_f32_16x16x32_bf16 a[88:91], a[244:247], v[88:91], a[88:91]
    s_add_u32 s64, s64, 8192
    v_exp_f32 v6, v6
    v_mfma_f32_16x16x32_bf16 a[92:95], a[244:247], v[92:95], a[92:95]
    s_add_u32 s66, s66, 0x4000
    v_mfma_f32_16x16x32_bf16 a[96:99], a[248:251], v[80:83], a[96:99]
    s_and_b32 s66, s66, 0xffff
    v_exp_f32 v7, v7
    v_mfma_f32_16x16x32_bf16 a[100:103], a[248:251], v[84:87], a[100:103]
    ds_read_b128 a[228:231], v232 offset:9216
    v_cvt_pk_bf16_f32 v67, v6, v7
    v_mfma_f32_16x16x32_bf16 a[104:107], a[248:251], v[88:91], a[104:107]
    v_exp_f32 v12, v12
    v_mfma_f32_16x16x32_bf16 a[108:111], a[248:251], v[92:95], a[108:111]
    s_sub_u32 s68, s68, 1
    v_mfma_f32_16x16x32_bf16 a[112:115], a[252:255], v[80:83], a[112:115]
    v_exp_f32 v13, v13
    v_mfma_f32_16x16x32_bf16 a[116:119], a[252:255], v[84:87], a[116:119]
    v_cvt_pk_bf16_f32 v70, v12, v13
    v_mfma_f32_16x16x32_bf16 a[120:123], a[252:255], v[88:91], a[120:123]
    v_exp_f32 v14, v14
    v_mfma_f32_16x16x32_bf16 a[124:127], a[252:255], v[92:95], a[124:127]
    s_cbranch_scc1 F_event
    s_branch F_O2
F_slow:
    s_waitcnt vmcnt(0) lgkmcnt(0)
    v_mov_b32 v240, 0xf149f2ca
    v_mov_b32 v241, 0xf149f2ca
    v_mov_b32 v242, 0xf149f2ca
    v_mov_b32 v243, 0xf149f2ca
    v_mov_b32 v212, 0
    v_mov_b32 v213, 0
    v_mov_b32 v214, 0
    v_mov_b32 v215, 0
    v_mov_b32 v192, 0
    v_mov_b32 v193, 0
    v_mov_b32 v194, 0
    v_mov_b32 v195, 0
    v_mov_b32 v196, 0
    v_mov_b32 v197, 0
    v_mov_b32 v198, 0
    v_mov_b32 v199, 0
    v_mov_b32 v200, 0
    v_mov_b32 v201, 0
    v_mov_b32 v202, 0
    v_mov_b32 v203, 0
    v_mov_b32 v204, 0
    v_mov_b32 v205, 0
    v_mov_b32 v206, 0
    v_mov_b32 v207, 0
    v_mfma_f32_32x32x16_bf16 a[0:15], v[244:247], v[244:247], 0
    v_mfma_f32_32x32x16_bf16 a[16:31], v[244:247], v[244:247], 0
    v_mfma_f32_32x32x16_bf16 a[32:47], v[244:247], v[244:247], 0
    v_mfma_f32_32x32x16_bf16 a[48:63], v[244:247], v[244:247], 0
    v_mfma_f32_32x32x16_bf16 a[64:79], v[244:247], v[244:247], 0
    v_mfma_f32_32x32x16_bf16 a[80:95], v[244:247], v[244:247], 0
    v_mfma_f32_32x32x16_bf16 a[96:111], v[244:247], v[244:247], 0
    v_mfma_f32_32x32x16_bf16 a[112:127], v[244:247], v[244:247], 0
    v_mov_b32 v96, v212
    v_mov_b32 v97, v212
    v_mov_b32 v98, v212
    v_mov_b32 v99, v212
    v_mov_b32 v100, v213
    v_mov_b32 v101, v213
    v_mov_b32 v102, v213
    v_mov_b32 v103, v213
    v_mov_b32 v104, v214
    v_mov_b32 v105, v214
    v_mov_b32 v106, v214
    v_mov_b32 v107, v214
    v_mov_b32 v108, v215
    v_mov_b32 v109, v215
    v_mov_b32 v110, v215
    v_mov_b32 v111, v215
    v_mov_b32 v112, v212
    v_mov_b32 v113, v212
    v_mov_b32 v114, v212
    v_mov_b32 v115, v212
    v_mov_b32 v116, v213
    v_mov_b32 v117, v213
    v_mov_b32 v118, v213
    v_mov_b32 v119, v213
    v_mov_b32 v120, v214
    v_mov_b32 v121, v214
    v_mov_b32 v122, v214
    v_mov_b32 v123, v214
    v_mov_b32 v124, v215
    v_mov_b32 v125, v215
    v_mov_b32 v126, v215
    v_mov_b32 v127, v215
    s_mov_b32 s98, 0
F_sl_loop:
    s_mul_i32 s56, s98, 8192
    s_add_u32 s56, s56, s97
    s_add_u32 s57, s56, 0x5800000
    buffer_load_dwordx4 a[192:195], v248, s[32:35], s57 offen offset:0 sc1
    buffer_load_dwordx4 a[196:199], v248, s[32:35], s57 offen offset:1024 sc1
    buffer_load_dwordx4 a[200:203], v248, s[32:35], s57 offen offset:2048 sc1
    buffer_load_dwordx4 a[204:207], v248, s[32:35], s57 offen offset:3072 sc1
    s_add_u32 s57, s56, 0x5801000
    buffer_load_dwordx4 a[208:211], v248, s[32:35], s57 offen offset:0 sc1
    buffer_load_dwordx4 a[212:215], v248, s[32:35], s57 offen offset:1024 sc1
    buffer_load_dwordx4 a[216:219], v248, s[32:35], s57 offen offset:2048 sc1
    buffer_load_dwordx4 a[220:223], v248, s[32:35], s57 offen offset:3072 sc1
    s_add_u32 s57, s56, 0x1009000
    buffer_load_dwordx4 a[224:227], v248, s[32:35], s57 offen offset:0 sc1
    buffer_load_dwordx4 a[228:231], v248, s[32:35], s57 offen offset:1024 sc1
    buffer_load_dwordx4 a[232:235], v248, s[32:35], s57 offen offset:2048 sc1
    buffer_load_dwordx4 a[236:239], v248, s[32:35], s57 offen offset:3072 sc1
    s_add_u32 s57, s56, 0x100a000
    buffer_load_dwordx4 a[240:243], v248, s[32:35], s57 offen offset:0 sc1
    buffer_load_dwordx4 a[244:247], v248, s[32:35], s57 offen offset:1024 sc1
    buffer_load_dwordx4 a[248:251], v248, s[32:35], s57 offen offset:2048 sc1
    buffer_load_dwordx4 a[252:255], v248, s[32:35], s57 offen offset:3072 sc1
    s_add_u32 s56, s98, 2
    s_cmp_lg_u32 s56, s96
    s_cbranch_scc1 F_sl1
    v_add_f32 v96, v212, v216
    v_add_f32 v97, v212, v217
    v_add_f32 v98, v212, v218
    v_add_f32 v99, v212, v219
    v_mov_b32 v100, v213
    v_mov_b32 v101, v213
    v_mov_b32 v102, v213
    v_mov_b32 v103, v213
    v_mov_b32 v104, v214
    v_mov_b32 v105, v214
    v_mov_b32 v106, v214
    v_mov_b32 v107, v214
    v_mov_b32 v108, v215
    v_mov_b32 v109, v215
    v_mov_b32 v110, v215
    v_mov_b32 v111, v215
    v_mov_b32 v112, 0xf149f2ca
    v_mov_b32 v113, 0xf149f2ca
    v_mov_b32 v114, 0xf149f2ca
    v_mov_b32 v115, 0xf149f2ca
    v_add_f32 v116, v213, v216
    v_add_f32 v117, v213, v217
    v_add_f32 v118, v213, v218
    v_add_f32 v119, v213, v219
    v_mov_b32 v120, v214
    v_mov_b32 v121, v214
    v_mov_b32 v122, v214
    v_mov_b32 v123, v214
    v_mov_b32 v124, v215
    v_mov_b32 v125, v215
    v_mov_b32 v126, v215
    v_mov_b32 v127, v215
F_sl1:
    s_add_u32 s56, s98, 1
    s_cmp_lg_u32 s56, s96
    s_cbranch_scc1 F_sl2
    v_mov_b32 v96, 0xf149f2ca
    v_mov_b32 v97, 0xf149f2ca
    v_mov_b32 v98, 0xf149f2ca
    v_mov_b32 v99, 0xf149f2ca
    v_mov_b32 v100, 0xf149f2ca
    v_mov_b32 v101, 0xf149f2ca
    v_mov_b32 v102, 0xf149f2ca
    v_mov_b32 v103, 0xf149f2ca
    v_add_f32 v104, v214, v216
    v_add_f32 v105, v214, v217
    v_add_f32 v106, v214, v218
    v_add_f32 v107, v214, v219
    v_mov_b32 v108, v215
    v_mov_b32 v109, v215
    v_mov_b32 v110, v215
    v_mov_b32 v111, v215
    v_mov_b32 v112, 0xf149f2ca
    v_mov_b32 v113, 0xf149f2ca
    v_mov_b32 v114, 0xf149f2ca
    v_mov_b32 v115, 0xf149f2ca
    v_mov_b32 v116, 0xf149f2ca
    v_mov_b32 v117, 0xf149f2ca
    v_mov_b32 v118, 0xf149f2ca
    v_mov_b32 v119, 0xf149f2ca
    v_mov_b32 v120, 0xf149f2ca
    v_mov_b32 v121, 0xf149f2ca
    v_mov_b32 v122, 0xf149f2ca
    v_mov_b32 v123, 0xf149f2ca
    v_add_f32 v124, v215, v216
    v_add_f32 v125, v215, v217
    v_add_f32 v126, v215, v218
    v_add_f32 v127, v215, v219
F_sl2:
    s_waitcnt vmcnt(0)
    v_mfma_f32_16x16x32_bf16 v[0:3], a[192:195], v[128:131], v[96:99]
    v_mfma_f32_16x16x32_bf16 v[0:3], a[196:199], v[132:135], v[0:3]
    v_mfma_f32_16x16x32_bf16 v[0:3], a[200:203], v[136:139], v[0:3]
    v_mfma_f32_16x16x32_bf16 v[0:3], a[204:207], v[140:143], v[0:3]
    v_mfma_f32_16x16x32_bf16 v[8:11], a[192:195], v[144:147], v[100:103]
    v_mfma_f32_16x16x32_bf16 v[8:11], a[196:199], v[148:151], v[8:11]
    v_mfma_f32_16x16x32_bf16 v[8:11], a[200:203], v[152:155], v[8:11]
    v_mfma_f32_16x16x32_bf16 v[8:11], a[204:207], v[156:159], v[8:11]
    v_mfma_f32_16x16x32_bf16 v[16:19], a[192:195], v[160:163], v[104:107]
    v_mfma_f32_16x16x32_bf16 v[16:19], a[196:199], v[164:167], v[16:19]
    v_mfma_f32_16x16x32_bf16 v[16:19], a[200:203], v[168:171], v[16:19]
    v_mfma_f32_16x16x32_bf16 v[16:19], a[204:207], v[172:175], v[16:19]
    v_mfma_f32_16x16x32_bf16 v[24:27], a[192:195], v[176:179], v[108:111]
    v_mfma_f32_16x16x32_bf16 v[24:27], a[196:199], v[180:183], v[24:27]
    v_mfma_f32_16x16x32_bf16 v[24:27], a[200:203], v[184:187], v[24:27]
    v_mfma_f32_16x16x32_bf16 v[24:27], a[204:207], v[188:191], v[24:27]
    v_mfma_f32_16x16x32_bf16 v[4:7], a[208:211], v[128:131], v[112:115]
    v_mfma_f32_16x16x32_bf16 v[4:7], a[212:215], v[132:135], v[4:7]
    v_mfma_f32_16x16x32_bf16 v[4:7], a[216:219], v[136:139], v[4:7]
    v_mfma_f32_16x16x32_bf16 v[4:7], a[220:223], v[140:143], v[4:7]
    v_mfma_f32_16x16x32_bf16 v[12:15], a[208:211], v[144:147], v[116:119]
    v_mfma_f32_16x16x32_bf16 v[12:15], a[212:215], v[148:151], v[12:15]
    v_mfma_f32_16x16x32_bf16 v[12:15], a[216:219], v[152:155], v[12:15]
    v_mfma_f32_16x16x32_bf16 v[12:15], a[220:223], v[156:159], v[12:15]
    v_mfma_f32_16x16x32_bf16 v[20:23], a[208:211], v[160:163], v[120:123]
    v_mfma_f32_16x16x32_bf16 v[20:23], a[212:215], v[164:167], v[20:23]
    v_mfma_f32_16x16x32_bf16 v[20:23], a[216:219], v[168:171], v[20:23]
    v_mfma_f32_16x16x32_bf16 v[20:23], a[220:223], v[172:175], v[20:23]
    v_mfma_f32_16x16x32_bf16 v[28:31], a[208:211], v[176:179], v[124:127]
    v_mfma_f32_16x16x32_bf16 v[28:31], a[212:215], v[180:183], v[28:31]
    v_mfma_f32_16x16x32_bf16 v[28:31], a[216:219], v[184:187], v[28:31]
    v_mfma_f32_16x16x32_bf16 v[28:31], a[220:223], v[188:191], v[28:31]
    s_nop 7
    v_max3_f32 v32, v0, v1, v2
    v_max3_f32 v32, v32, v3, v4
    v_max3_f32 v32, v32, v5, v6
    v_max_f32 v32, v32, v7
    v_max3_f32 v33, v8, v9, v10
    v_max3_f32 v33, v33, v11, v12
    v_max3_f32 v33, v33, v13, v14
    v_max_f32 v33, v33, v15
    v_max3_f32 v34, v16, v17, v18
    v_max3_f32 v34, v34, v19, v20
    v_max3_f32 v34, v34, v21, v22
    v_max_f32 v34, v34, v23
    v_max3_f32 v35, v24, v25, v26
    v_max3_f32 v35, v35, v27, v28
    v_max3_f32 v35, v35, v29, v30
    v_max_f32 v35, v35, v31
    v_mov_b32 v36, v32
    v_mov_b32 v37, v33
    v_mov_b32 v38, v34
    v_mov_b32 v39, v35
    s_nop 1
    v_permlane16_swap_b32 v32, v36
    v_permlane16_swap_b32 v33, v37
    v_permlane16_swap_b32 v34, v38
    v_permlane16_swap_b32 v35, v39
    v_max_f32 v32, v32, v36
    v_max_f32 v33, v33, v37
    v_max_f32 v34, v34, v38
    v_max_f32 v35, v35, v39
    v_mov_b32 v36, v32
    v_mov_b32 v37, v33
    v_mov_b32 v38, v34
    v_mov_b32 v39, v35
    s_nop 1
    v_permlane32_swap_b32 v32, v36
    v_permlane32_swap_b32 v33, v37
    v_permlane32_swap_b32 v34, v38
    v_permlane32_swap_b32 v35, v39
    v_max_f32 v32, v32, v36
    v_max_f32 v33, v33, v37
    v_max_f32 v34, v34, v38
    v_max_f32 v35, v35, v39
    v_max_f32 v32, v32, v240
    v_max_f32 v33, v33, v241
    v_max_f32 v34, v34, v242
    v_max_f32 v35, v35, v243
    v_sub_f32 v40, v240, v32
    v_sub_f32 v41, v241, v33
    v_sub_f32 v42, v242, v34
    v_sub_f32 v43, v243, v35
    v_exp_f32 v40, v40
    v_exp_f32 v41, v41
    v_exp_f32 v42, v42
    v_exp_f32 v43, v43
    v_mov_b32 v240, v32
    v_mov_b32 v241, v33
    v_mov_b32 v242, v34
    v_mov_b32 v243, v35
    v_sub_f32 v0, v0, v240
    v_sub_f32 v1, v1, v240
    v_sub_f32 v2, v2, v240
    v_sub_f32 v3, v3, v240
    v_sub_f32 v4, v4, v240
    v_sub_f32 v5, v5, v240
    v_sub_f32 v6, v6, v240
    v_sub_f32 v7, v7, v240
    v_sub_f32 v8, v8, v241
    v_sub_f32 v9, v9, v241
    v_sub_f32 v10, v10, v241
    v_sub_f32 v11, v11, v241
    v_sub_f32 v12, v12, v241
    v_sub_f32 v13, v13, v241
    v_sub_f32 v14, v14, v241
    v_sub_f32 v15, v15, v241
    v_sub_f32 v16, v16, v242
    v_sub_f32 v17, v17, v242
    v_sub_f32 v18, v18, v242
    v_sub_f32 v19, v19, v242
    v_sub_f32 v20, v20, v242
    v_sub_f32 v21, v21, v242
    v_sub_f32 v22, v22, v242
    v_sub_f32 v23, v23, v242
    v_sub_f32 v24, v24, v243
    v_sub_f32 v25, v25, v243
    v_sub_f32 v26, v26, v243
    v_sub_f32 v27, v27, v243
    v_sub_f32 v28, v28, v243
    v_sub_f32 v29, v29, v243
    v_sub_f32 v30, v30, v243
    v_sub_f32 v31, v31, v243
    v_exp_f32 v0, v0
    v_exp_f32 v1, v1
    v_exp_f32 v2, v2
    v_exp_f32 v3, v3
    v_exp_f32 v8, v8
    v_exp_f32 v9, v9
    v_exp_f32 v10, v10
    v_exp_f32 v11, v11
    v_exp_f32 v16, v16
    v_exp_f32 v17, v17
    v_exp_f32 v18, v18
    v_exp_f32 v19, v19
    v_exp_f32 v24, v24
    v_exp_f32 v25, v25
    v_exp_f32 v26, v26
    v_exp_f32 v27, v27
    v_exp_f32 v4, v4
    v_exp_f32 v5, v5
    v_exp_f32 v6, v6
    v_exp_f32 v7, v7
    v_exp_f32 v12, v12
    v_exp_f32 v13, v13
    v_exp_f32 v14, v14
    v_exp_f32 v15, v15
    v_exp_f32 v20, v20
    v_exp_f32 v21, v21
    v_exp_f32 v22, v22
    v_exp_f32 v23, v23
    v_exp_f32 v28, v28
    v_exp_f32 v29, v29
    v_exp_f32 v30, v30
    v_exp_f32 v31, v31
    s_nop 0
    v_cvt_pk_bf16_f32 v64, v0, v1
    v_cvt_pk_bf16_f32 v65, v2, v3
    v_cvt_pk_bf16_f32 v68, v8, v9
    v_cvt_pk_bf16_f32 v69, v10, v11
    v_cvt_pk_bf16_f32 v72, v16, v17
    v_cvt_pk_bf16_f32 v73, v18, v19
    v_cvt_pk_bf16_f32 v76, v24, v25
    v_cvt_pk_bf16_f32 v77, v26, v27
    v_cvt_pk_bf16_f32 v66, v4, v5
    v_cvt_pk_bf16_f32 v67, v6, v7
    v_cvt_pk_bf16_f32 v70, v12, v13
    v_cvt_pk_bf16_f32 v71, v14, v15
    v_cvt_pk_bf16_f32 v74, v20, v21
    v_cvt_pk_bf16_f32 v75, v22, v23
    v_cvt_pk_bf16_f32 v78, v28, v29
    v_cvt_pk_bf16_f32 v79, v30, v31
    v_mul_f32 v192, v192, v40
    v_mul_f32 v193, v193, v40
    v_mul_f32 v194, v194, v40
    v_mul_f32 v195, v195, v40
    v_mul_f32 v196, v196, v41
    v_mul_f32 v197, v197, v41
    v_mul_f32 v198, v198, v41
    v_mul_f32 v199, v199, v41
    v_mul_f32 v200, v200, v42
    v_mul_f32 v201, v201, v42
    v_mul_f32 v202, v202, v42
    v_mul_f32 v203, v203, v42
    v_mul_f32 v204, v204, v43
    v_mul_f32 v205, v205, v43
    v_mul_f32 v206, v206, v43
    v_mul_f32 v207, v207, v43
    v_accvgpr_read_b32 v44, a0
    v_accvgpr_read_b32 v45, a1
    v_accvgpr_read_b32 v46, a2
    v_accvgpr_read_b32 v47, a3
    v_mul_f32 v44, v44, v40
    v_mul_f32 v45, v45, v40
    v_mul_f32 v46, v46, v40
    v_mul_f32 v47, v47, v40
    v_accvgpr_write_b32 a0, v44
    v_accvgpr_write_b32 a1, v45
    v_accvgpr_write_b32 a2, v46
    v_accvgpr_write_b32 a3, v47
    v_accvgpr_read_b32 v44, a4
    v_accvgpr_read_b32 v45, a5
    v_accvgpr_read_b32 v46, a6
    v_accvgpr_read_b32 v47, a7
    v_mul_f32 v44, v44, v41
    v_mul_f32 v45, v45, v41
    v_mul_f32 v46, v46, v41
    v_mul_f32 v47, v47, v41
    v_accvgpr_write_b32 a4, v44
    v_accvgpr_write_b32 a5, v45
    v_accvgpr_write_b32 a6, v46
    v_accvgpr_write_b32 a7, v47
    v_accvgpr_read_b32 v44, a8
    v_accvgpr_read_b32 v45, a9
    v_accvgpr_read_b32 v46, a10
    v_accvgpr_read_b32 v47, a11
    v_mul_f32 v44, v44, v42
    v_mul_f32 v45, v45, v42
    v_mul_f32 v46, v46, v42
    v_mul_f32 v47, v47, v42
    v_accvgpr_write_b32 a8, v44
    v_accvgpr_write_b32 a9, v45
    v_accvgpr_write_b32 a10, v46
    v_accvgpr_write_b32 a11, v47
    v_accvgpr_read_b32 v44, a12
    v_accvgpr_read_b32 v45, a13
    v_accvgpr_read_b32 v46, a14
    v_accvgpr_read_b32 v47, a15
    v_mul_f32 v44, v44, v43
    v_mul_f32 v45, v45, v43
    v_mul_f32 v46, v46, v43
    v_mul_f32 v47, v47, v43
    v_accvgpr_write_b32 a12, v44
    v_accvgpr_write_b32 a13, v45
    v_accvgpr_write_b32 a14, v46
    v_accvgpr_write_b32 a15, v47
    v_accvgpr_read_b32 v44, a16
    v_accvgpr_read_b32 v45, a17
    v_accvgpr_read_b32 v46, a18
    v_accvgpr_read_b32 v47, a19
    v_mul_f32 v44, v44, v40
    v_mul_f32 v45, v45, v40
    v_mul_f32 v46, v46, v40
    v_mul_f32 v47, v47, v40
    v_accvgpr_write_b32 a16, v44
    v_accvgpr_write_b32 a17, v45
    v_accvgpr_write_b32 a18, v46
    v_accvgpr_write_b32 a19, v47
    v_accvgpr_read_b32 v44, a20
    v_accvgpr_read_b32 v45, a21
    v_accvgpr_read_b32 v46, a22
    v_accvgpr_read_b32 v47, a23
    v_mul_f32 v44, v44, v41
    v_mul_f32 v45, v45, v41
    v_mul_f32 v46, v46, v41
    v_mul_f32 v47, v47, v41
    v_accvgpr_write_b32 a20, v44
    v_accvgpr_write_b32 a21, v45
    v_accvgpr_write_b32 a22, v46
    v_accvgpr_write_b32 a23, v47
    v_accvgpr_read_b32 v44, a24
    v_accvgpr_read_b32 v45, a25
    v_accvgpr_read_b32 v46, a26
    v_accvgpr_read_b32 v47, a27
    v_mul_f32 v44, v44, v42
    v_mul_f32 v45, v45, v42
    v_mul_f32 v46, v46, v42
    v_mul_f32 v47, v47, v42
    v_accvgpr_write_b32 a24, v44
    v_accvgpr_write_b32 a25, v45
    v_accvgpr_write_b32 a26, v46
    v_accvgpr_write_b32 a27, v47
    v_accvgpr_read_b32 v44, a28
    v_accvgpr_read_b32 v45, a29
    v_accvgpr_read_b32 v46, a30
    v_accvgpr_read_b32 v47, a31
    v_mul_f32 v44, v44, v43
    v_mul_f32 v45, v45, v43
    v_mul_f32 v46, v46, v43
    v_mul_f32 v47, v47, v43
    v_accvgpr_write_b32 a28, v44
    v_accvgpr_write_b32 a29, v45
    v_accvgpr_write_b32 a30, v46
    v_accvgpr_write_b32 a31, v47
    v_accvgpr_read_b32 v44, a32
    v_accvgpr_read_b32 v45, a33
    v_accvgpr_read_b32 v46, a34
    v_accvgpr_read_b32 v47, a35
    v_mul_f32 v44, v44, v40
    v_mul_f32 v45, v45, v40
    v_mul_f32 v46, v46, v40
    v_mul_f32 v47, v47, v40
    v_accvgpr_write_b32 a32, v44
    v_accvgpr_write_b32 a33, v45
    v_accvgpr_write_b32 a34, v46
    v_accvgpr_write_b32 a35, v47
    v_accvgpr_read_b32 v44, a36
    v_accvgpr_read_b32 v45, a37
    v_accvgpr_read_b32 v46, a38
    v_accvgpr_read_b32 v47, a39
    v_mul_f32 v44, v44, v41
    v_mul_f32 v45, v45, v41
    v_mul_f32 v46, v46, v41
    v_mul_f32 v47, v47, v41
    v_accvgpr_write_b32 a36, v44
    v_accvgpr_write_b32 a37, v45
    v_accvgpr_write_b32 a38, v46
    v_accvgpr_write_b32 a39, v47
    v_accvgpr_read_b32 v44, a40
    v_accvgpr_read_b32 v45, a41
    v_accvgpr_read_b32 v46, a42
    v_accvgpr_read_b32 v47, a43
    v_mul_f32 v44, v44, v42
    v_mul_f32 v45, v45, v42
    v_mul_f32 v46, v46, v42
    v_mul_f32 v47, v47, v42
    v_accvgpr_write_b32 a40, v44
    v_accvgpr_write_b32 a41, v45
    v_accvgpr_write_b32 a42, v46
    v_accvgpr_write_b32 a43, v47
    v_accvgpr_read_b32 v44, a44
    v_accvgpr_read_b32 v45, a45
    v_accvgpr_read_b32 v46, a46
    v_accvgpr_read_b32 v47, a47
    v_mul_f32 v44, v44, v43
    v_mul_f32 v45, v45, v43
    v_mul_f32 v46, v46, v43
    v_mul_f32 v47, v47, v43
    v_accvgpr_write_b32 a44, v44
    v_accvgpr_write_b32 a45, v45
    v_accvgpr_write_b32 a46, v46
    v_accvgpr_write_b32 a47, v47
    v_accvgpr_read_b32 v44, a48
    v_accvgpr_read_b32 v45, a49
    v_accvgpr_read_b32 v46, a50
    v_accvgpr_read_b32 v47, a51
    v_mul_f32 v44, v44, v40
    v_mul_f32 v45, v45, v40
    v_mul_f32 v46, v46, v40
    v_mul_f32 v47, v47, v40
    v_accvgpr_write_b32 a48, v44
    v_accvgpr_write_b32 a49, v45
    v_accvgpr_write_b32 a50, v46
    v_accvgpr_write_b32 a51, v47
    v_accvgpr_read_b32 v44, a52
    v_accvgpr_read_b32 v45, a53
    v_accvgpr_read_b32 v46, a54
    v_accvgpr_read_b32 v47, a55
    v_mul_f32 v44, v44, v41
    v_mul_f32 v45, v45, v41
    v_mul_f32 v46, v46, v41
    v_mul_f32 v47, v47, v41
    v_accvgpr_write_b32 a52, v44
    v_accvgpr_write_b32 a53, v45
    v_accvgpr_write_b32 a54, v46
    v_accvgpr_write_b32 a55, v47
    v_accvgpr_read_b32 v44, a56
    v_accvgpr_read_b32 v45, a57
    v_accvgpr_read_b32 v46, a58
    v_accvgpr_read_b32 v47, a59
    v_mul_f32 v44, v44, v42
    v_mul_f32 v45, v45, v42
    v_mul_f32 v46, v46, v42
    v_mul_f32 v47, v47, v42
    v_accvgpr_write_b32 a56, v44
    v_accvgpr_write_b32 a57, v45
    v_accvgpr_write_b32 a58, v46
    v_accvgpr_write_b32 a59, v47
    v_accvgpr_read_b32 v44, a60
    v_accvgpr_read_b32 v45, a61
    v_accvgpr_read_b32 v46, a62
    v_accvgpr_read_b32 v47, a63
    v_mul_f32 v44, v44, v43
    v_mul_f32 v45, v45, v43
    v_mul_f32 v46, v46, v43
    v_mul_f32 v47, v47, v43
    v_accvgpr_write_b32 a60, v44
    v_accvgpr_write_b32 a61, v45
    v_accvgpr_write_b32 a62, v46
    v_accvgpr_write_b32 a63, v47
    v_accvgpr_read_b32 v44, a64
    v_accvgpr_read_b32 v45, a65
    v_accvgpr_read_b32 v46, a66
    v_accvgpr_read_b32 v47, a67
    v_mul_f32 v44, v44, v40
    v_mul_f32 v45, v45, v40
    v_mul_f32 v46, v46, v40
    v_mul_f32 v47, v47, v40
    v_accvgpr_write_b32 a64, v44
    v_accvgpr_write_b32 a65, v45
    v_accvgpr_write_b32 a66, v46
    v_accvgpr_write_b32 a67, v47
    v_accvgpr_read_b32 v44, a68
    v_accvgpr_read_b32 v45, a69
    v_accvgpr_read_b32 v46, a70
    v_accvgpr_read_b32 v47, a71
    v_mul_f32 v44, v44, v41
    v_mul_f32 v45, v45, v41
    v_mul_f32 v46, v46, v41
    v_mul_f32 v47, v47, v41
    v_accvgpr_write_b32 a68, v44
    v_accvgpr_write_b32 a69, v45
    v_accvgpr_write_b32 a70, v46
    v_accvgpr_write_b32 a71, v47
    v_accvgpr_read_b32 v44, a72
    v_accvgpr_read_b32 v45, a73
    v_accvgpr_read_b32 v46, a74
    v_accvgpr_read_b32 v47, a75
    v_mul_f32 v44, v44, v42
    v_mul_f32 v45, v45, v42
    v_mul_f32 v46, v46, v42
    v_mul_f32 v47, v47, v42
    v_accvgpr_write_b32 a72, v44
    v_accvgpr_write_b32 a73, v45
    v_accvgpr_write_b32 a74, v46
    v_accvgpr_write_b32 a75, v47
    v_accvgpr_read_b32 v44, a76
    v_accvgpr_read_b32 v45, a77
    v_accvgpr_read_b32 v46, a78
    v_accvgpr_read_b32 v47, a79
    v_mul_f32 v44, v44, v43
    v_mul_f32 v45, v45, v43
    v_mul_f32 v46, v46, v43
    v_mul_f32 v47, v47, v43
    v_accvgpr_write_b32 a76, v44
    v_accvgpr_write_b32 a77, v45
    v_accvgpr_write_b32 a78, v46
    v_accvgpr_write_b32 a79, v47
    v_accvgpr_read_b32 v44, a80
    v_accvgpr_read_b32 v45, a81
    v_accvgpr_read_b32 v46, a82
    v_accvgpr_read_b32 v47, a83
    v_mul_f32 v44, v44, v40
    v_mul_f32 v45, v45, v40
    v_mul_f32 v46, v46, v40
    v_mul_f32 v47, v47, v40
    v_accvgpr_write_b32 a80, v44
    v_accvgpr_write_b32 a81, v45
    v_accvgpr_write_b32 a82, v46
    v_accvgpr_write_b32 a83, v47
    v_accvgpr_read_b32 v44, a84
    v_accvgpr_read_b32 v45, a85
    v_accvgpr_read_b32 v46, a86
    v_accvgpr_read_b32 v47, a87
    v_mul_f32 v44, v44, v41
    v_mul_f32 v45, v45, v41
    v_mul_f32 v46, v46, v41
    v_mul_f32 v47, v47, v41
    v_accvgpr_write_b32 a84, v44
    v_accvgpr_write_b32 a85, v45
    v_accvgpr_write_b32 a86, v46
    v_accvgpr_write_b32 a87, v47
    v_accvgpr_read_b32 v44, a88
    v_accvgpr_read_b32 v45, a89
    v_accvgpr_read_b32 v46, a90
    v_accvgpr_read_b32 v47, a91
    v_mul_f32 v44, v44, v42
    v_mul_f32 v45, v45, v42
    v_mul_f32 v46, v46, v42
    v_mul_f32 v47, v47, v42
    v_accvgpr_write_b32 a88, v44
    v_accvgpr_write_b32 a89, v45
    v_accvgpr_write_b32 a90, v46
    v_accvgpr_write_b32 a91, v47
    v_accvgpr_read_b32 v44, a92
    v_accvgpr_read_b32 v45, a93
    v_accvgpr_read_b32 v46, a94
    v_accvgpr_read_b32 v47, a95
    v_mul_f32 v44, v44, v43
    v_mul_f32 v45, v45, v43
    v_mul_f32 v46, v46, v43
    v_mul_f32 v47, v47, v43
    v_accvgpr_write_b32 a92, v44
    v_accvgpr_write_b32 a93, v45
    v_accvgpr_write_b32 a94, v46
    v_accvgpr_write_b32 a95, v47
    v_accvgpr_read_b32 v44, a96
    v_accvgpr_read_b32 v45, a97
    v_accvgpr_read_b32 v46, a98
    v_accvgpr_read_b32 v47, a99
    v_mul_f32 v44, v44, v40
    v_mul_f32 v45, v45, v40
    v_mul_f32 v46, v46, v40
    v_mul_f32 v47, v47, v40
    v_accvgpr_write_b32 a96, v44
    v_accvgpr_write_b32 a97, v45
    v_accvgpr_write_b32 a98, v46
    v_accvgpr_write_b32 a99, v47
    v_accvgpr_read_b32 v44, a100
    v_accvgpr_read_b32 v45, a101
    v_accvgpr_read_b32 v46, a102
    v_accvgpr_read_b32 v47, a103
    v_mul_f32 v44, v44, v41
    v_mul_f32 v45, v45, v41
    v_mul_f32 v46, v46, v41
    v_mul_f32 v47, v47, v41
    v_accvgpr_write_b32 a100, v44
    v_accvgpr_write_b32 a101, v45
    v_accvgpr_write_b32 a102, v46
    v_accvgpr_write_b32 a103, v47
    v_accvgpr_read_b32 v44, a104
    v_accvgpr_read_b32 v45, a105
    v_accvgpr_read_b32 v46, a106
    v_accvgpr_read_b32 v47, a107
    v_mul_f32 v44, v44, v42
    v_mul_f32 v45, v45, v42
    v_mul_f32 v46, v46, v42
    v_mul_f32 v47, v47, v42
    v_accvgpr_write_b32 a104, v44
    v_accvgpr_write_b32 a105, v45
    v_accvgpr_write_b32 a106, v46
    v_accvgpr_write_b32 a107, v47
    v_accvgpr_read_b32 v44, a108
    v_accvgpr_read_b32 v45, a109
    v_accvgpr_read_b32 v46, a110
    v_accvgpr_read_b32 v47, a111
    v_mul_f32 v44, v44, v43
    v_mul_f32 v45, v45, v43
    v_mul_f32 v46, v46, v43
    v_mul_f32 v47, v47, v43
    v_accvgpr_write_b32 a108, v44
    v_accvgpr_write_b32 a109, v45
    v_accvgpr_write_b32 a110, v46
    v_accvgpr_write_b32 a111, v47
    v_accvgpr_read_b32 v44, a112
    v_accvgpr_read_b32 v45, a113
    v_accvgpr_read_b32 v46, a114
    v_accvgpr_read_b32 v47, a115
    v_mul_f32 v44, v44, v40
    v_mul_f32 v45, v45, v40
    v_mul_f32 v46, v46, v40
    v_mul_f32 v47, v47, v40
    v_accvgpr_write_b32 a112, v44
    v_accvgpr_write_b32 a113, v45
    v_accvgpr_write_b32 a114, v46
    v_accvgpr_write_b32 a115, v47
    v_accvgpr_read_b32 v44, a116
    v_accvgpr_read_b32 v45, a117
    v_accvgpr_read_b32 v46, a118
    v_accvgpr_read_b32 v47, a119
    v_mul_f32 v44, v44, v41
    v_mul_f32 v45, v45, v41
    v_mul_f32 v46, v46, v41
    v_mul_f32 v47, v47, v41
    v_accvgpr_write_b32 a116, v44
    v_accvgpr_write_b32 a117, v45
    v_accvgpr_write_b32 a118, v46
    v_accvgpr_write_b32 a119, v47
    v_accvgpr_read_b32 v44, a120
    v_accvgpr_read_b32 v45, a121
    v_accvgpr_read_b32 v46, a122
    v_accvgpr_read_b32 v47, a123
    v_mul_f32 v44, v44, v42
    v_mul_f32 v45, v45, v42
    v_mul_f32 v46, v46, v42
    v_mul_f32 v47, v47, v42
    v_accvgpr_write_b32 a120, v44
    v_accvgpr_write_b32 a121, v45
    v_accvgpr_write_b32 a122, v46
    v_accvgpr_write_b32 a123, v47
    v_accvgpr_read_b32 v44, a124
    v_accvgpr_read_b32 v45, a125
    v_accvgpr_read_b32 v46, a126
    v_accvgpr_read_b32 v47, a127
    v_mul_f32 v44, v44, v43
    v_mul_f32 v45, v45, v43
    v_mul_f32 v46, v46, v43
    v_mul_f32 v47, v47, v43
    v_accvgpr_write_b32 a124, v44
    v_accvgpr_write_b32 a125, v45
    v_accvgpr_write_b32 a126, v46
    v_accvgpr_write_b32 a127, v47
    s_nop 1
    v_mfma_f32_16x16x32_bf16 a[0:3], a[224:227], v[64:67], a[0:3]
    v_mfma_f32_16x16x32_bf16 a[4:7], a[224:227], v[68:71], a[4:7]
    v_mfma_f32_16x16x32_bf16 a[8:11], a[224:227], v[72:75], a[8:11]
    v_mfma_f32_16x16x32_bf16 a[12:15], a[224:227], v[76:79], a[12:15]
    v_mfma_f32_16x16x32_bf16 a[16:19], a[228:231], v[64:67], a[16:19]
    v_mfma_f32_16x16x32_bf16 a[20:23], a[228:231], v[68:71], a[20:23]
    v_mfma_f32_16x16x32_bf16 a[24:27], a[228:231], v[72:75], a[24:27]
    v_mfma_f32_16x16x32_bf16 a[28:31], a[228:231], v[76:79], a[28:31]
    v_mfma_f32_16x16x32_bf16 a[32:35], a[232:235], v[64:67], a[32:35]
    v_mfma_f32_16x16x32_bf16 a[36:39], a[232:235], v[68:71], a[36:39]
    v_mfma_f32_16x16x32_bf16 a[40:43], a[232:235], v[72:75], a[40:43]
    v_mfma_f32_16x16x32_bf16 a[44:47], a[232:235], v[76:79], a[44:47]
    v_mfma_f32_16x16x32_bf16 a[48:51], a[236:239], v[64:67], a[48:51]
    v_mfma_f32_16x16x32_bf16 a[52:55], a[236:239], v[68:71], a[52:55]
    v_mfma_f32_16x16x32_bf16 a[56:59], a[236:239], v[72:75], a[56:59]
    v_mfma_f32_16x16x32_bf16 a[60:63], a[236:239], v[76:79], a[60:63]
    v_mfma_f32_16x16x32_bf16 v[192:195], v[208:211], v[64:67], v[192:195]
    v_mfma_f32_16x16x32_bf16 v[196:199], v[208:211], v[68:71], v[196:199]
    v_mfma_f32_16x16x32_bf16 v[200:203], v[208:211], v[72:75], v[200:203]
    v_mfma_f32_16x16x32_bf16 v[204:207], v[208:211], v[76:79], v[204:207]
    v_mfma_f32_16x16x32_bf16 a[64:67], a[240:243], v[64:67], a[64:67]
    v_mfma_f32_16x16x32_bf16 a[68:71], a[240:243], v[68:71], a[68:71]
    v_mfma_f32_16x16x32_bf16 a[72:75], a[240:243], v[72:75], a[72:75]
    v_mfma_f32_16x16x32_bf16 a[76:79], a[240:243], v[76:79], a[76:79]
    v_mfma_f32_16x16x32_bf16 a[80:83], a[244:247], v[64:67], a[80:83]
    v_mfma_f32_16x16x32_bf16 a[84:87], a[244:247], v[68:71], a[84:87]
    v_mfma_f32_16x16x32_bf16 a[88:91], a[244:247], v[72:75], a[88:91]
    v_mfma_f32_16x16x32_bf16 a[92:95], a[244:247], v[76:79], a[92:95]
    v_mfma_f32_16x16x32_bf16 a[96:99], a[248:251], v[64:67], a[96:99]
    v_mfma_f32_16x16x32_bf16 a[100:103], a[248:251], v[68:71], a[100:103]
    v_mfma_f32_16x16x32_bf16 a[104:107], a[248:251], v[72:75], a[104:107]
    v_mfma_f32_16x16x32_bf16 a[108:111], a[248:251], v[76:79], a[108:111]
    v_mfma_f32_16x16x32_bf16 a[112:115], a[252:255], v[64:67], a[112:115]
    v_mfma_f32_16x16x32_bf16 a[116:119], a[252:255], v[68:71], a[116:119]
    v_mfma_f32_16x16x32_bf16 a[120:123], a[252:255], v[72:75], a[120:123]
    v_mfma_f32_16x16x32_bf16 a[124:127], a[252:255], v[76:79], a[124:127]
    s_add_u32 s98, s98, 1
    s_cmp_lt_u32 s98, s96
    s_nop 7
    s_cbranch_scc1 F_sl_loop
    v_mov_b32 v80, 0
    v_mov_b32 v81, 0
    v_mov_b32 v82, 0
    v_mov_b32 v83, 0
    v_mov_b32 v84, 0
    v_mov_b32 v85, 0
    v_mov_b32 v86, 0
    v_mov_b32 v87, 0
    v_mov_b32 v88, 0
    v_mov_b32 v89, 0
    v_mov_b32 v90, 0
    v_mov_b32 v91, 0
    v_mov_b32 v92, 0
    v_mov_b32 v93, 0
    v_mov_b32 v94, 0
    v_mov_b32 v95, 0
    s_setpc_b64 s[100:101]
.p2align 6
F_S1:
    s_waitcnt lgkmcnt(2)
    v_mfma_f32_16x16x32_bf16 v[32:35], a[192:195], v[128:131], v[96:99]
    s_mov_b32 s48, s24
    v_exp_f32 v15, v15
    v_mfma_f32_16x16x32_bf16 v[32:35], a[196:199], v[132:135], v[32:35]
    s_and_b32 s49, s25, 0xffff
    ds_read_b128 a[232:235], v232 offset:10240
    v_cvt_pk_bf16_f32 v71, v14, v15
    v_mfma_f32_16x16x32_bf16 v[32:35], a[200:203], v[136:139], v[32:35]
    s_mov_b32 s50, 0x158000
    v_exp_f32 v20, v20
    v_mfma_f32_16x16x32_bf16 v[32:35], a[204:207], v[140:143], v[32:35]
    s_lshl_b32 s56, s99, 14
    s_lshl_b32 s57, s52, 8
    ds_read_b128 a[236:239], v232 offset:11264
    v_mfma_f32_16x16x32_bf16 v[40:43], a[192:195], v[144:147], v[100:103]
    s_add_u32 s56, s56, s57
    v_exp_f32 v21, v21
    v_mfma_f32_16x16x32_bf16 v[40:43], a[196:199], v[148:151], v[40:43]
    s_add_u32 m0, s55, 81920
    ds_read_b128 a[240:243], v232 offset:12288
    v_cvt_pk_bf16_f32 v74, v20, v21
    v_mfma_f32_16x16x32_bf16 v[40:43], a[200:203], v[152:155], v[40:43]
    s_add_u32 s19, s18, 0
    v_exp_f32 v22, v22
    v_mfma_f32_16x16x32_bf16 v[40:43], a[204:207], v[156:159], v[40:43]
    s_add_u32 s57, s56, 0
    buffer_store_dwordx4 a[128:131], v248, s[32:35], s19 offen offset:0 sc1
    buffer_load_dwordx4 v230, s[48:51], s57 offen lds
    v_mfma_f32_16x16x32_bf16 v[48:51], a[192:195], v[160:163], v[104:107]
    s_add_u32 m0, s55, 82944
    v_exp_f32 v23, v23
    v_mfma_f32_16x16x32_bf16 v[48:51], a[196:199], v[164:167], v[48:51]
    s_add_u32 s57, s56, 4096
    ds_read_b128 a[244:247], v232 offset:13312
    v_cvt_pk_bf16_f32 v75, v22, v23
    v_mfma_f32_16x16x32_bf16 v[48:51], a[200:203], v[168:171], v[48:51]
    v_exp_f32 v28, v28
    v_mfma_f32_16x16x32_bf16 v[48:51], a[204:207], v[172:175], v[48:51]
    buffer_load_dwordx4 v230, s[48:51], s57 offen lds
    v_mfma_f32_16x16x32_bf16 v[56:59], a[192:195], v[176:179], v[108:111]
    s_add_u32 m0, s55, 83968
    v_exp_f32 v29, v29
    v_mfma_f32_16x16x32_bf16 v[56:59], a[196:199], v[180:183], v[56:59]
    s_add_u32 s57, s56, 8192
    ds_read_b128 a[248:251], v232 offset:14336
    v_cvt_pk_bf16_f32 v78, v28, v29
    v_mfma_f32_16x16x32_bf16 v[56:59], a[200:203], v[184:187], v[56:59]
    v_exp_f32 v30, v30
    v_mfma_f32_16x16x32_bf16 v[56:59], a[204:207], v[188:191], v[56:59]
    buffer_load_dwordx4 v230, s[48:51], s57 offen lds
    v_mfma_f32_16x16x32_bf16 v[36:39], a[208:211], v[128:131], v[112:115]
    s_add_u32 m0, s55, 84992
    v_exp_f32 v31, v31
    v_mfma_f32_16x16x32_bf16 v[36:39], a[212:215], v[132:135], v[36:39]
    s_add_u32 s57, s56, 12288
    ds_read_b128 a[252:255], v232 offset:15360
    v_cvt_pk_bf16_f32 v79, v30, v31
    v_mfma_f32_16x16x32_bf16 v[36:39], a[216:219], v[136:139], v[36:39]
    s_add_u32 s67, s67, 0x4000
    buffer_load_dwordx4 v230, s[48:51], s57 offen lds
    v_mfma_f32_16x16x32_bf16 v[36:39], a[220:223], v[140:143], v[36:39]
    v_mfma_f32_16x16x32_bf16 v[44:47], a[208:211], v[144:147], v[116:119]
    v_mfma_f32_16x16x32_bf16 v[44:47], a[212:215], v[148:151], v[44:47]
    v_bfi_b32 v232, v233, s67, v232
    v_mfma_f32_16x16x32_bf16 v[44:47], a[216:219], v[152:155], v[44:47]
    s_add_u32 s19, s18, 4096
    v_exp_f32 v32, v32
    v_mfma_f32_16x16x32_bf16 v[44:47], a[220:223], v[156:159], v[44:47]
    s_mov_b32 m0, s66
    buffer_store_dwordx4 a[132:135], v248, s[32:35], s19 offen offset:0 sc1
    v_mfma_f32_16x16x32_bf16 v[52:55], a[208:211], v[160:163], v[120:123]
    v_exp_f32 v33, v33
    v_mfma_f32_16x16x32_bf16 v[52:55], a[212:215], v[164:167], v[52:55]
    v_cvt_pk_bf16_f32 v80, v32, v33
    v_mfma_f32_16x16x32_bf16 v[52:55], a[216:219], v[168:171], v[52:55]
    v_exp_f32 v34, v34
    v_mfma_f32_16x16x32_bf16 v[52:55], a[220:223], v[172:175], v[52:55]
    v_mfma_f32_16x16x32_bf16 v[60:63], a[208:211], v[176:179], v[124:127]
    v_exp_f32 v35, v35
    v_mfma_f32_16x16x32_bf16 v[60:63], a[212:215], v[180:183], v[60:63]
    v_cvt_pk_bf16_f32 v81, v34, v35
    v_mfma_f32_16x16x32_bf16 v[60:63], a[216:219], v[184:187], v[60:63]
    v_exp_f32 v40, v40
    v_mfma_f32_16x16x32_bf16 v[60:63], a[220:223], v[188:191], v[60:63]
    s_waitcnt vmcnt(22)
    s_waitcnt lgkmcnt(0)
    s_barrier
    v_mfma_f32_16x16x32_bf16 a[0:3], a[224:227], v[64:67], a[0:3]
    v_exp_f32 v41, v41
    v_mfma_f32_16x16x32_bf16 a[4:7], a[224:227], v[68:71], a[4:7]
    ds_read_b128 a[192:195], v232 offset:0
    v_cvt_pk_bf16_f32 v84, v40, v41
    v_mfma_f32_16x16x32_bf16 a[8:11], a[224:227], v[72:75], a[8:11]
    v_exp_f32 v42, v42
    v_mfma_f32_16x16x32_bf16 a[12:15], a[224:227], v[76:79], a[12:15]
    ds_read_b128 a[196:199], v232 offset:1024
    v_mfma_f32_16x16x32_bf16 a[16:19], a[228:231], v[64:67], a[16:19]
    v_exp_f32 v43, v43
    v_mfma_f32_16x16x32_bf16 a[20:23], a[228:231], v[68:71], a[20:23]
    ds_read_b128 a[200:203], v232 offset:2048
    v_cvt_pk_bf16_f32 v85, v42, v43
    v_mfma_f32_16x16x32_bf16 a[24:27], a[228:231], v[72:75], a[24:27]
    s_add_u32 s19, s18, 8192
    v_exp_f32 v48, v48
    v_mfma_f32_16x16x32_bf16 a[28:31], a[228:231], v[76:79], a[28:31]
    ds_read_b128 a[204:207], v232 offset:3072
    buffer_store_dwordx4 a[136:139], v248, s[32:35], s19 offen offset:0 sc1
    v_mfma_f32_16x16x32_bf16 a[32:35], a[232:235], v[64:67], a[32:35]
    v_exp_f32 v49, v49
    v_mfma_f32_16x16x32_bf16 a[36:39], a[232:235], v[68:71], a[36:39]
    ds_read_b128 a[208:211], v232 offset:4096
    v_cvt_pk_bf16_f32 v88, v48, v49
    v_mfma_f32_16x16x32_bf16 a[40:43], a[232:235], v[72:75], a[40:43]
    v_exp_f32 v50, v50
    v_mfma_f32_16x16x32_bf16 a[44:47], a[232:235], v[76:79], a[44:47]
    buffer_load_dwordx4 v248, s[40:43], s64 offen offset:0 sc1 lds
    v_mfma_f32_16x16x32_bf16 a[48:51], a[236:239], v[64:67], a[48:51]
    v_exp_f32 v51, v51
    v_mfma_f32_16x16x32_bf16 a[52:55], a[236:239], v[68:71], a[52:55]
    ds_read_b128 a[212:215], v232 offset:5120
    v_cvt_pk_bf16_f32 v89, v50, v51
    v_mfma_f32_16x16x32_bf16 a[56:59], a[236:239], v[72:75], a[56:59]
    v_exp_f32 v56, v56
    v_mfma_f32_16x16x32_bf16 a[60:63], a[236:239], v[76:79], a[60:63]
    buffer_load_dwordx4 v248, s[40:43], s64 offen offset:1024 sc1 lds
    v_mfma_f32_16x16x32_bf16 v[192:195], v[208:211], v[64:67], v[192:195]
    v_exp_f32 v57, v57
    v_mfma_f32_16x16x32_bf16 v[196:199], v[208:211], v[68:71], v[196:199]
    ds_read_b128 a[216:219], v232 offset:6144
    v_cvt_pk_bf16_f32 v92, v56, v57
    v_mfma_f32_16x16x32_bf16 v[200:203], v[208:211], v[72:75], v[200:203]
    v_exp_f32 v58, v58
    v_mfma_f32_16x16x32_bf16 v[204:207], v[208:211], v[76:79], v[204:207]
    buffer_load_dwordx4 v248, s[40:43], s64 offen offset:2048 sc1 lds
    v_mfma_f32_16x16x32_bf16 a[64:67], a[240:243], v[64:67], a[64:67]
    v_exp_f32 v59, v59
    v_mfma_f32_16x16x32_bf16 a[68:71], a[240:243], v[68:71], a[68:71]
    ds_read_b128 a[220:223], v232 offset:7168
    v_cvt_pk_bf16_f32 v93, v58, v59
    v_mfma_f32_16x16x32_bf16 a[72:75], a[240:243], v[72:75], a[72:75]
    v_exp_f32 v36, v36
    v_mfma_f32_16x16x32_bf16 a[76:79], a[240:243], v[76:79], a[76:79]
    buffer_load_dwordx4 v248, s[40:43], s64 offen offset:3072 sc1 lds
    v_mfma_f32_16x16x32_bf16 a[80:83], a[244:247], v[64:67], a[80:83]
    v_exp_f32 v37, v37
    v_mfma_f32_16x16x32_bf16 a[84:87], a[244:247], v[68:71], a[84:87]
    ds_read_b128 a[224:227], v232 offset:8192
    v_cvt_pk_bf16_f32 v82, v36, v37
    v_mfma_f32_16x16x32_bf16 a[88:91], a[244:247], v[72:75], a[88:91]
    s_add_u32 s64, s64, 8192
    s_add_u32 s19, s18, 12288
    v_exp_f32 v38, v38
    v_mfma_f32_16x16x32_bf16 a[92:95], a[244:247], v[76:79], a[92:95]
    s_add_u32 s66, s66, 0x4000
    buffer_store_dwordx4 a[140:143], v248, s[32:35], s19 offen offset:0 sc1
    v_mfma_f32_16x16x32_bf16 a[96:99], a[248:251], v[64:67], a[96:99]
    s_and_b32 s66, s66, 0xffff
    v_exp_f32 v39, v39
    v_mfma_f32_16x16x32_bf16 a[100:103], a[248:251], v[68:71], a[100:103]
    ds_read_b128 a[228:231], v232 offset:9216
    v_cvt_pk_bf16_f32 v83, v38, v39
    v_mfma_f32_16x16x32_bf16 a[104:107], a[248:251], v[72:75], a[104:107]
    v_exp_f32 v44, v44
    v_mfma_f32_16x16x32_bf16 a[108:111], a[248:251], v[76:79], a[108:111]
    v_mfma_f32_16x16x32_bf16 a[112:115], a[252:255], v[64:67], a[112:115]
    v_exp_f32 v45, v45
    v_mfma_f32_16x16x32_bf16 a[116:119], a[252:255], v[68:71], a[116:119]
    v_cvt_pk_bf16_f32 v86, v44, v45
    v_mfma_f32_16x16x32_bf16 a[120:123], a[252:255], v[72:75], a[120:123]
    v_exp_f32 v46, v46
    v_mfma_f32_16x16x32_bf16 a[124:127], a[252:255], v[76:79], a[124:127]
    s_waitcnt lgkmcnt(2)
    v_mfma_f32_16x16x32_bf16 v[0:3], a[192:195], v[128:131], v[96:99]
    v_exp_f32 v47, v47
    v_mfma_f32_16x16x32_bf16 v[0:3], a[196:199], v[132:135], v[0:3]
    ds_read_b128 a[232:235], v232 offset:10240
    v_cvt_pk_bf16_f32 v87, v46, v47
    v_mfma_f32_16x16x32_bf16 v[0:3], a[200:203], v[136:139], v[0:3]
    v_exp_f32 v52, v52
    v_mfma_f32_16x16x32_bf16 v[0:3], a[204:207], v[140:143], v[0:3]
    ds_read_b128 a[236:239], v232 offset:11264
    v_mfma_f32_16x16x32_bf16 v[8:11], a[192:195], v[144:147], v[100:103]
    v_exp_f32 v53, v53
    v_mfma_f32_16x16x32_bf16 v[8:11], a[196:199], v[148:151], v[8:11]
    ds_read_b128 a[240:243], v232 offset:12288
    v_cvt_pk_bf16_f32 v90, v52, v53
    v_mfma_f32_16x16x32_bf16 v[8:11], a[200:203], v[152:155], v[8:11]
    s_add_u32 s19, s18, 0
    v_exp_f32 v54, v54
    v_mfma_f32_16x16x32_bf16 v[8:11], a[204:207], v[156:159], v[8:11]
    buffer_store_dwordx4 a[144:147], v248, s[32:35], s19 offen offset:1024 sc1
    v_mfma_f32_16x16x32_bf16 v[16:19], a[192:195], v[160:163], v[104:107]
    v_exp_f32 v55, v55
    v_mfma_f32_16x16x32_bf16 v[16:19], a[196:199], v[164:167], v[16:19]
    ds_read_b128 a[244:247], v232 offset:13312
    v_cvt_pk_bf16_f32 v91, v54, v55
    v_mfma_f32_16x16x32_bf16 v[16:19], a[200:203], v[168:171], v[16:19]
    v_exp_f32 v60, v60
    v_mfma_f32_16x16x32_bf16 v[16:19], a[204:207], v[172:175], v[16:19]
    v_mfma_f32_16x16x32_bf16 v[24:27], a[192:195], v[176:179], v[108:111]
    v_exp_f32 v61, v61
    v_mfma_f32_16x16x32_bf16 v[24:27], a[196:199], v[180:183], v[24:27]
    ds_read_b128 a[248:251], v232 offset:14336
    v_cvt_pk_bf16_f32 v94, v60, v61
    v_mfma_f32_16x16x32_bf16 v[24:27], a[200:203], v[184:187], v[24:27]
    v_exp_f32 v62, v62
    v_mfma_f32_16x16x32_bf16 v[24:27], a[204:207], v[188:191], v[24:27]
    v_mfma_f32_16x16x32_bf16 v[4:7], a[208:211], v[128:131], v[112:115]
    v_exp_f32 v63, v63
    v_mfma_f32_16x16x32_bf16 v[4:7], a[212:215], v[132:135], v[4:7]
    ds_read_b128 a[252:255], v232 offset:15360
    v_cvt_pk_bf16_f32 v95, v62, v63
    v_mfma_f32_16x16x32_bf16 v[4:7], a[216:219], v[136:139], v[4:7]
    s_add_u32 s67, s67, 0x4000
    v_mfma_f32_16x16x32_bf16 v[4:7], a[220:223], v[140:143], v[4:7]
    v_mfma_f32_16x16x32_bf16 v[12:15], a[208:211], v[144:147], v[116:119]
    v_mfma_f32_16x16x32_bf16 v[12:15], a[212:215], v[148:151], v[12:15]
    v_bfi_b32 v232, v233, s67, v232
    v_mfma_f32_16x16x32_bf16 v[12:15], a[216:219], v[152:155], v[12:15]
    s_add_u32 s19, s18, 4096
    v_exp_f32 v0, v0
    v_mfma_f32_16x16x32_bf16 v[12:15], a[220:223], v[156:159], v[12:15]
    s_mov_b32 m0, s66
    buffer_store_dwordx4 a[148:151], v248, s[32:35], s19 offen offset:1024 sc1
    v_mfma_f32_16x16x32_bf16 v[20:23], a[208:211], v[160:163], v[120:123]
    v_exp_f32 v1, v1
    v_mfma_f32_16x16x32_bf16 v[20:23], a[212:215], v[164:167], v[20:23]
    v_cvt_pk_bf16_f32 v64, v0, v1
    v_mfma_f32_16x16x32_bf16 v[20:23], a[216:219], v[168:171], v[20:23]
    v_exp_f32 v2, v2
    v_mfma_f32_16x16x32_bf16 v[20:23], a[220:223], v[172:175], v[20:23]
    v_mfma_f32_16x16x32_bf16 v[28:31], a[208:211], v[176:179], v[124:127]
    v_exp_f32 v3, v3
    v_mfma_f32_16x16x32_bf16 v[28:31], a[212:215], v[180:183], v[28:31]
    v_cvt_pk_bf16_f32 v65, v2, v3
    v_mfma_f32_16x16x32_bf16 v[28:31], a[216:219], v[184:187], v[28:31]
    v_exp_f32 v8, v8
    v_mfma_f32_16x16x32_bf16 v[28:31], a[220:223], v[188:191], v[28:31]
    s_waitcnt vmcnt(26)
    s_waitcnt lgkmcnt(0)
    s_barrier
    v_mfma_f32_16x16x32_bf16 a[0:3], a[224:227], v[80:83], a[0:3]
    v_exp_f32 v9, v9
    v_mfma_f32_16x16x32_bf16 a[4:7], a[224:227], v[84:87], a[4:7]
    ds_read_b128 a[192:195], v232 offset:0
    v_cvt_pk_bf16_f32 v68, v8, v9
    v_mfma_f32_16x16x32_bf16 a[8:11], a[224:227], v[88:91], a[8:11]
    v_exp_f32 v10, v10
    v_mfma_f32_16x16x32_bf16 a[12:15], a[224:227], v[92:95], a[12:15]
    ds_read_b128 a[196:199], v232 offset:1024
    v_mfma_f32_16x16x32_bf16 a[16:19], a[228:231], v[80:83], a[16:19]
    v_exp_f32 v11, v11
    v_mfma_f32_16x16x32_bf16 a[20:23], a[228:231], v[84:87], a[20:23]
    ds_read_b128 a[200:203], v232 offset:2048
    v_cvt_pk_bf16_f32 v69, v10, v11
    v_mfma_f32_16x16x32_bf16 a[24:27], a[228:231], v[88:91], a[24:27]
    s_add_u32 s19, s18, 8192
    v_exp_f32 v16, v16
    v_mfma_f32_16x16x32_bf16 a[28:31], a[228:231], v[92:95], a[28:31]
    ds_read_b128 a[204:207], v232 offset:3072
    buffer_store_dwordx4 a[152:155], v248, s[32:35], s19 offen offset:1024 sc1
    v_mfma_f32_16x16x32_bf16 a[32:35], a[232:235], v[80:83], a[32:35]
    v_exp_f32 v17, v17
    v_mfma_f32_16x16x32_bf16 a[36:39], a[232:235], v[84:87], a[36:39]
    ds_read_b128 a[208:211], v232 offset:4096
    v_cvt_pk_bf16_f32 v72, v16, v17
    v_mfma_f32_16x16x32_bf16 a[40:43], a[232:235], v[88:91], a[40:43]
    v_exp_f32 v18, v18
    v_mfma_f32_16x16x32_bf16 a[44:47], a[232:235], v[92:95], a[44:47]
    buffer_load_dwordx4 v248, s[40:43], s64 offen offset:0 sc1 lds
    v_mfma_f32_16x16x32_bf16 a[48:51], a[236:239], v[80:83], a[48:51]
    v_exp_f32 v19, v19
    v_mfma_f32_16x16x32_bf16 a[52:55], a[236:239], v[84:87], a[52:55]
    ds_read_b128 a[212:215], v232 offset:5120
    v_cvt_pk_bf16_f32 v73, v18, v19
    v_mfma_f32_16x16x32_bf16 a[56:59], a[236:239], v[88:91], a[56:59]
    v_exp_f32 v24, v24
    v_mfma_f32_16x16x32_bf16 a[60:63], a[236:239], v[92:95], a[60:63]
    buffer_load_dwordx4 v248, s[40:43], s64 offen offset:1024 sc1 lds
    v_mfma_f32_16x16x32_bf16 v[192:195], v[208:211], v[80:83], v[192:195]
    v_exp_f32 v25, v25
    v_mfma_f32_16x16x32_bf16 v[196:199], v[208:211], v[84:87], v[196:199]
    ds_read_b128 a[216:219], v232 offset:6144
    v_cvt_pk_bf16_f32 v76, v24, v25
    v_mfma_f32_16x16x32_bf16 v[200:203], v[208:211], v[88:91], v[200:203]
    v_exp_f32 v26, v26
    v_mfma_f32_16x16x32_bf16 v[204:207], v[208:211], v[92:95], v[204:207]
    buffer_load_dwordx4 v248, s[40:43], s64 offen offset:2048 sc1 lds
    v_mfma_f32_16x16x32_bf16 a[64:67], a[240:243], v[80:83], a[64:67]
    v_exp_f32 v27, v27
    v_mfma_f32_16x16x32_bf16 a[68:71], a[240:243], v[84:87], a[68:71]
    ds_read_b128 a[220:223], v232 offset:7168
    v_cvt_pk_bf16_f32 v77, v26, v27
    v_mfma_f32_16x16x32_bf16 a[72:75], a[240:243], v[88:91], a[72:75]
    v_exp_f32 v4, v4
    v_mfma_f32_16x16x32_bf16 a[76:79], a[240:243], v[92:95], a[76:79]
    buffer_load_dwordx4 v248, s[40:43], s64 offen offset:3072 sc1 lds
    v_mfma_f32_16x16x32_bf16 a[80:83], a[244:247], v[80:83], a[80:83]
    v_exp_f32 v5, v5
    v_mfma_f32_16x16x32_bf16 a[84:87], a[244:247], v[84:87], a[84:87]
    ds_read_b128 a[224:227], v232 offset:8192
    v_cvt_pk_bf16_f32 v66, v4, v5
    v_mfma_f32_16x16x32_bf16 a[88:91], a[244:247], v[88:91], a[88:91]
    s_add_u32 s64, s64, 8192
    s_add_u32 s19, s18, 12288
    v_exp_f32 v6, v6
    v_mfma_f32_16x16x32_bf16 a[92:95], a[244:247], v[92:95], a[92:95]
    s_add_u32 s66, s66, 0x4000
    buffer_store_dwordx4 a[156:159], v248, s[32:35], s19 offen offset:1024 sc1
    v_mfma_f32_16x16x32_bf16 a[96:99], a[248:251], v[80:83], a[96:99]
    s_and_b32 s66, s66, 0xffff
    v_exp_f32 v7, v7
    v_mfma_f32_16x16x32_bf16 a[100:103], a[248:251], v[84:87], a[100:103]
    ds_read_b128 a[228:231], v232 offset:9216
    v_cvt_pk_bf16_f32 v67, v6, v7
    v_mfma_f32_16x16x32_bf16 a[104:107], a[248:251], v[88:91], a[104:107]
    v_exp_f32 v12, v12
    v_mfma_f32_16x16x32_bf16 a[108:111], a[248:251], v[92:95], a[108:111]
    v_mfma_f32_16x16x32_bf16 a[112:115], a[252:255], v[80:83], a[112:115]
    v_exp_f32 v13, v13
    v_mfma_f32_16x16x32_bf16 a[116:119], a[252:255], v[84:87], a[116:119]
    v_cvt_pk_bf16_f32 v70, v12, v13
    v_mfma_f32_16x16x32_bf16 a[120:123], a[252:255], v[88:91], a[120:123]
    v_exp_f32 v14, v14
    v_mfma_f32_16x16x32_bf16 a[124:127], a[252:255], v[92:95], a[124:127]
    s_waitcnt lgkmcnt(2)
    v_mfma_f32_16x16x32_bf16 v[32:35], a[192:195], v[128:131], v[96:99]
    v_exp_f32 v15, v15
    v_mfma_f32_16x16x32_bf16 v[32:35], a[196:199], v[132:135], v[32:35]
    ds_read_b128 a[232:235], v232 offset:10240
    v_cvt_pk_bf16_f32 v71, v14, v15
    v_mfma_f32_16x16x32_bf16 v[32:35], a[200:203], v[136:139], v[32:35]
    v_exp_f32 v20, v20
    v_mfma_f32_16x16x32_bf16 v[32:35], a[204:207], v[140:143], v[32:35]
    ds_read_b128 a[236:239], v232 offset:11264
    v_mfma_f32_16x16x32_bf16 v[40:43], a[192:195], v[144:147], v[100:103]
    v_exp_f32 v21, v21
    v_mfma_f32_16x16x32_bf16 v[40:43], a[196:199], v[148:151], v[40:43]
    ds_read_b128 a[240:243], v232 offset:12288
    v_cvt_pk_bf16_f32 v74, v20, v21
    v_mfma_f32_16x16x32_bf16 v[40:43], a[200:203], v[152:155], v[40:43]
    s_add_u32 s19, s18, 0
    v_exp_f32 v22, v22
    v_mfma_f32_16x16x32_bf16 v[40:43], a[204:207], v[156:159], v[40:43]
    buffer_store_dwordx4 a[160:163], v248, s[32:35], s19 offen offset:2048 sc1
    v_mfma_f32_16x16x32_bf16 v[48:51], a[192:195], v[160:163], v[104:107]
    v_exp_f32 v23, v23
    v_mfma_f32_16x16x32_bf16 v[48:51], a[196:199], v[164:167], v[48:51]
    ds_read_b128 a[244:247], v232 offset:13312
    v_cvt_pk_bf16_f32 v75, v22, v23
    v_mfma_f32_16x16x32_bf16 v[48:51], a[200:203], v[168:171], v[48:51]
    v_exp_f32 v28, v28
    v_mfma_f32_16x16x32_bf16 v[48:51], a[204:207], v[172:175], v[48:51]
    v_mfma_f32_16x16x32_bf16 v[56:59], a[192:195], v[176:179], v[108:111]
    v_exp_f32 v29, v29
    v_mfma_f32_16x16x32_bf16 v[56:59], a[196:199], v[180:183], v[56:59]
    ds_read_b128 a[248:251], v232 offset:14336
    v_cvt_pk_bf16_f32 v78, v28, v29
    v_mfma_f32_16x16x32_bf16 v[56:59], a[200:203], v[184:187], v[56:59]
    v_exp_f32 v30, v30
    v_mfma_f32_16x16x32_bf16 v[56:59], a[204:207], v[188:191], v[56:59]
    v_mfma_f32_16x16x32_bf16 v[36:39], a[208:211], v[128:131], v[112:115]
    v_exp_f32 v31, v31
    v_mfma_f32_16x16x32_bf16 v[36:39], a[212:215], v[132:135], v[36:39]
    ds_read_b128 a[252:255], v232 offset:15360
    v_cvt_pk_bf16_f32 v79, v30, v31
    v_mfma_f32_16x16x32_bf16 v[36:39], a[216:219], v[136:139], v[36:39]
    s_add_u32 s67, s67, 0x4000
    v_mfma_f32_16x16x32_bf16 v[36:39], a[220:223], v[140:143], v[36:39]
    v_mfma_f32_16x16x32_bf16 v[44:47], a[208:211], v[144:147], v[116:119]
    v_mfma_f32_16x16x32_bf16 v[44:47], a[212:215], v[148:151], v[44:47]
    v_bfi_b32 v232, v233, s67, v232
    v_mfma_f32_16x16x32_bf16 v[44:47], a[216:219], v[152:155], v[44:47]
    s_add_u32 s19, s18, 4096
    v_exp_f32 v32, v32
    v_mfma_f32_16x16x32_bf16 v[44:47], a[220:223], v[156:159], v[44:47]
    s_mov_b32 m0, s66
    buffer_store_dwordx4 a[164:167], v248, s[32:35], s19 offen offset:2048 sc1
    v_mfma_f32_16x16x32_bf16 v[52:55], a[208:211], v[160:163], v[120:123]
    v_exp_f32 v33, v33
    v_mfma_f32_16x16x32_bf16 v[52:55], a[212:215], v[164:167], v[52:55]
    v_cvt_pk_bf16_f32 v80, v32, v33
    v_mfma_f32_16x16x32_bf16 v[52:55], a[216:219], v[168:171], v[52:55]
    v_exp_f32 v34, v34
    v_mfma_f32_16x16x32_bf16 v[52:55], a[220:223], v[172:175], v[52:55]
    v_mfma_f32_16x16x32_bf16 v[60:63], a[208:211], v[176:179], v[124:127]
    v_exp_f32 v35, v35
    v_mfma_f32_16x16x32_bf16 v[60:63], a[212:215], v[180:183], v[60:63]
    v_cvt_pk_bf16_f32 v81, v34, v35
    v_mfma_f32_16x16x32_bf16 v[60:63], a[216:219], v[184:187], v[60:63]
    v_exp_f32 v40, v40
    v_mfma_f32_16x16x32_bf16 v[60:63], a[220:223], v[188:191], v[60:63]
    s_waitcnt vmcnt(22)
    s_waitcnt lgkmcnt(0)
    s_barrier
    v_mfma_f32_16x16x32_bf16 a[0:3], a[224:227], v[64:67], a[0:3]
    v_exp_f32 v41, v41
    v_mfma_f32_16x16x32_bf16 a[4:7], a[224:227], v[68:71], a[4:7]
    ds_read_b128 a[192:195], v232 offset:0
    v_cvt_pk_bf16_f32 v84, v40, v41
    v_mfma_f32_16x16x32_bf16 a[8:11], a[224:227], v[72:75], a[8:11]
    v_exp_f32 v42, v42
    v_mfma_f32_16x16x32_bf16 a[12:15], a[224:227], v[76:79], a[12:15]
    ds_read_b128 a[196:199], v232 offset:1024
    ds_read_b64_tr_b16 a[128:129], v224 offset:32768
    v_mfma_f32_16x16x32_bf16 a[16:19], a[228:231], v[64:67], a[16:19]
    v_exp_f32 v43, v43
    v_mfma_f32_16x16x32_bf16 a[20:23], a[228:231], v[68:71], a[20:23]
    ds_read_b128 a[200:203], v232 offset:2048
    v_cvt_pk_bf16_f32 v85, v42, v43
    v_mfma_f32_16x16x32_bf16 a[24:27], a[228:231], v[72:75], a[24:27]
    s_add_u32 s19, s18, 8192
    v_exp_f32 v48, v48
    v_mfma_f32_16x16x32_bf16 a[28:31], a[228:231], v[76:79], a[28:31]
    ds_read_b128 a[204:207], v232 offset:3072
    buffer_store_dwordx4 a[168:171], v248, s[32:35], s19 offen offset:2048 sc1
    v_mfma_f32_16x16x32_bf16 a[32:35], a[232:235], v[64:67], a[32:35]
    v_exp_f32 v49, v49
    v_mfma_f32_16x16x32_bf16 a[36:39], a[232:235], v[68:71], a[36:39]
    ds_read_b128 a[208:211], v232 offset:4096
    v_cvt_pk_bf16_f32 v88, v48, v49
    v_mfma_f32_16x16x32_bf16 a[40:43], a[232:235], v[72:75], a[40:43]
    v_exp_f32 v50, v50
    v_mfma_f32_16x16x32_bf16 a[44:47], a[232:235], v[76:79], a[44:47]
    buffer_load_dwordx4 v248, s[40:43], s64 offen offset:0 sc1 lds
    ds_read_b64_tr_b16 a[130:131], v224 offset:34816
    v_mfma_f32_16x16x32_bf16 a[48:51], a[236:239], v[64:67], a[48:51]
    v_exp_f32 v51, v51
    v_mfma_f32_16x16x32_bf16 a[52:55], a[236:239], v[68:71], a[52:55]
    ds_read_b128 a[212:215], v232 offset:5120
    v_cvt_pk_bf16_f32 v89, v50, v51
    v_mfma_f32_16x16x32_bf16 a[56:59], a[236:239], v[72:75], a[56:59]
    v_exp_f32 v56, v56
    v_mfma_f32_16x16x32_bf16 a[60:63], a[236:239], v[76:79], a[60:63]
    buffer_load_dwordx4 v248, s[40:43], s64 offen offset:1024 sc1 lds
    ds_read_b64_tr_b16 a[132:133], v224 offset:32776
    v_mfma_f32_16x16x32_bf16 v[192:195], v[208:211], v[64:67], v[192:195]
    v_exp_f32 v57, v57
    v_mfma_f32_16x16x32_bf16 v[196:199], v[208:211], v[68:71], v[196:199]
    ds_read_b128 a[216:219], v232 offset:6144
    v_cvt_pk_bf16_f32 v92, v56, v57
    v_mfma_f32_16x16x32_bf16 v[200:203], v[208:211], v[72:75], v[200:203]
    v_exp_f32 v58, v58
    v_mfma_f32_16x16x32_bf16 v[204:207], v[208:211], v[76:79], v[204:207]
    buffer_load_dwordx4 v248, s[40:43], s64 offen offset:2048 sc1 lds
    ds_read_b64_tr_b16 a[134:135], v224 offset:34824
    v_mfma_f32_16x16x32_bf16 a[64:67], a[240:243], v[64:67], a[64:67]
    v_exp_f32 v59, v59
    v_mfma_f32_16x16x32_bf16 a[68:71], a[240:243], v[68:71], a[68:71]
    ds_read_b128 a[220:223], v232 offset:7168
    v_cvt_pk_bf16_f32 v93, v58, v59
    v_mfma_f32_16x16x32_bf16 a[72:75], a[240:243], v[72:75], a[72:75]
    v_exp_f32 v36, v36
    v_mfma_f32_16x16x32_bf16 a[76:79], a[240:243], v[76:79], a[76:79]
    buffer_load_dwordx4 v248, s[40:43], s64 offen offset:3072 sc1 lds
    ds_read_b64_tr_b16 a[136:137], v224 offset:32832
    v_mfma_f32_16x16x32_bf16 a[80:83], a[244:247], v[64:67], a[80:83]
    v_exp_f32 v37, v37
    v_mfma_f32_16x16x32_bf16 a[84:87], a[244:247], v[68:71], a[84:87]
    ds_read_b128 a[224:227], v232 offset:8192
    v_cvt_pk_bf16_f32 v82, v36, v37
    v_mfma_f32_16x16x32_bf16 a[88:91], a[244:247], v[72:75], a[88:91]
    s_add_u32 s64, s64, 8192
    s_add_u32 s19, s18, 12288
    v_exp_f32 v38, v38
    v_mfma_f32_16x16x32_bf16 a[92:95], a[244:247], v[76:79], a[92:95]
    s_add_u32 s66, s66, 0x4000
    buffer_store_dwordx4 a[172:175], v248, s[32:35], s19 offen offset:2048 sc1
    ds_read_b64_tr_b16 a[138:139], v224 offset:34880
    v_mfma_f32_16x16x32_bf16 a[96:99], a[248:251], v[64:67], a[96:99]
    s_and_b32 s66, s66, 0xffff
    v_exp_f32 v39, v39
    v_mfma_f32_16x16x32_bf16 a[100:103], a[248:251], v[68:71], a[100:103]
    ds_read_b128 a[228:231], v232 offset:9216
    v_cvt_pk_bf16_f32 v83, v38, v39
    v_mfma_f32_16x16x32_bf16 a[104:107], a[248:251], v[72:75], a[104:107]
    v_exp_f32 v44, v44
    v_mfma_f32_16x16x32_bf16 a[108:111], a[248:251], v[76:79], a[108:111]
    ds_read_b64_tr_b16 a[140:141], v224 offset:32840
    ds_read_b64_tr_b16 a[142:143], v224 offset:34888
    v_mfma_f32_16x16x32_bf16 a[112:115], a[252:255], v[64:67], a[112:115]
    v_exp_f32 v45, v45
    v_mfma_f32_16x16x32_bf16 a[116:119], a[252:255], v[68:71], a[116:119]
    v_cvt_pk_bf16_f32 v86, v44, v45
    v_mfma_f32_16x16x32_bf16 a[120:123], a[252:255], v[72:75], a[120:123]
    v_exp_f32 v46, v46
    v_mfma_f32_16x16x32_bf16 a[124:127], a[252:255], v[76:79], a[124:127]
    s_waitcnt lgkmcnt(0)
    v_mfma_f32_16x16x32_bf16 v[0:3], a[192:195], v[128:131], v[96:99]
    v_exp_f32 v47, v47
    v_mfma_f32_16x16x32_bf16 v[0:3], a[196:199], v[132:135], v[0:3]
    ds_read_b128 a[232:235], v232 offset:10240
    v_cvt_pk_bf16_f32 v87, v46, v47
    v_mfma_f32_16x16x32_bf16 v[0:3], a[200:203], v[136:139], v[0:3]
    v_exp_f32 v52, v52
    v_mfma_f32_16x16x32_bf16 v[0:3], a[204:207], v[140:143], v[0:3]
    ds_read_b128 a[236:239], v232 offset:11264
    ds_read_b64_tr_b16 a[144:145], v225 offset:16384
    v_mfma_f32_16x16x32_bf16 v[8:11], a[192:195], v[144:147], v[100:103]
    v_exp_f32 v53, v53
    v_mfma_f32_16x16x32_bf16 v[8:11], a[196:199], v[148:151], v[8:11]
    ds_read_b128 a[240:243], v232 offset:12288
    v_cvt_pk_bf16_f32 v90, v52, v53
    v_mfma_f32_16x16x32_bf16 v[8:11], a[200:203], v[152:155], v[8:11]
    s_add_u32 s19, s18, 0
    v_exp_f32 v54, v54
    v_mfma_f32_16x16x32_bf16 v[8:11], a[204:207], v[156:159], v[8:11]
    buffer_store_dwordx4 a[176:179], v248, s[32:35], s19 offen offset:3072 sc1
    ds_read_b64_tr_b16 a[146:147], v225 offset:16896
    v_mfma_f32_16x16x32_bf16 v[16:19], a[192:195], v[160:163], v[104:107]
    v_exp_f32 v55, v55
    v_mfma_f32_16x16x32_bf16 v[16:19], a[196:199], v[164:167], v[16:19]
    ds_read_b128 a[244:247], v232 offset:13312
    v_cvt_pk_bf16_f32 v91, v54, v55
    v_mfma_f32_16x16x32_bf16 v[16:19], a[200:203], v[168:171], v[16:19]
    v_exp_f32 v60, v60
    v_mfma_f32_16x16x32_bf16 v[16:19], a[204:207], v[172:175], v[16:19]
    ds_read_b64_tr_b16 a[148:149], v225 offset:16416
    ds_read_b64_tr_b16 a[150:151], v225 offset:16928
    v_mfma_f32_16x16x32_bf16 v[24:27], a[192:195], v[176:179], v[108:111]
    v_exp_f32 v61, v61
    v_mfma_f32_16x16x32_bf16 v[24:27], a[196:199], v[180:183], v[24:27]
    ds_read_b128 a[248:251], v232 offset:14336
    v_cvt_pk_bf16_f32 v94, v60, v61
    v_mfma_f32_16x16x32_bf16 v[24:27], a[200:203], v[184:187], v[24:27]
    v_exp_f32 v62, v62
    v_mfma_f32_16x16x32_bf16 v[24:27], a[204:207], v[188:191], v[24:27]
    ds_read_b64_tr_b16 a[152:153], v225 offset:16448
    ds_read_b64_tr_b16 a[154:155], v225 offset:16960
    v_mfma_f32_16x16x32_bf16 v[4:7], a[208:211], v[128:131], v[112:115]
    v_exp_f32 v63, v63
    v_mfma_f32_16x16x32_bf16 v[4:7], a[212:215], v[132:135], v[4:7]
    ds_read_b128 a[252:255], v232 offset:15360
    v_cvt_pk_bf16_f32 v95, v62, v63
    v_mfma_f32_16x16x32_bf16 v[4:7], a[216:219], v[136:139], v[4:7]
    s_add_u32 s67, s67, 0x4000
    v_mfma_f32_16x16x32_bf16 v[4:7], a[220:223], v[140:143], v[4:7]
    v_mfma_f32_16x16x32_bf16 v[12:15], a[208:211], v[144:147], v[116:119]
    v_mfma_f32_16x16x32_bf16 v[12:15], a[212:215], v[148:151], v[12:15]
    v_bfi_b32 v232, v233, s67, v232
    v_mfma_f32_16x16x32_bf16 v[12:15], a[216:219], v[152:155], v[12:15]
    s_add_u32 s19, s18, 4096
    v_exp_f32 v0, v0
    v_mfma_f32_16x16x32_bf16 v[12:15], a[220:223], v[156:159], v[12:15]
    s_mov_b32 m0, s66
    buffer_store_dwordx4 a[180:183], v248, s[32:35], s19 offen offset:3072 sc1
    v_mfma_f32_16x16x32_bf16 v[20:23], a[208:211], v[160:163], v[120:123]
    v_exp_f32 v1, v1
    v_mfma_f32_16x16x32_bf16 v[20:23], a[212:215], v[164:167], v[20:23]
    v_cvt_pk_bf16_f32 v64, v0, v1
    v_mfma_f32_16x16x32_bf16 v[20:23], a[216:219], v[168:171], v[20:23]
    v_exp_f32 v2, v2
    v_mfma_f32_16x16x32_bf16 v[20:23], a[220:223], v[172:175], v[20:23]
    v_mfma_f32_16x16x32_bf16 v[28:31], a[208:211], v[176:179], v[124:127]
    v_exp_f32 v3, v3
    v_mfma_f32_16x16x32_bf16 v[28:31], a[212:215], v[180:183], v[28:31]
    v_cvt_pk_bf16_f32 v65, v2, v3
    v_mfma_f32_16x16x32_bf16 v[28:31], a[216:219], v[184:187], v[28:31]
    v_exp_f32 v8, v8
    v_mfma_f32_16x16x32_bf16 v[28:31], a[220:223], v[188:191], v[28:31]
    s_waitcnt vmcnt(19)
    s_waitcnt lgkmcnt(0)
    s_barrier
    v_mfma_f32_16x16x32_bf16 a[0:3], a[224:227], v[80:83], a[0:3]
    v_exp_f32 v9, v9
    v_mfma_f32_16x16x32_bf16 a[4:7], a[224:227], v[84:87], a[4:7]
    ds_read_b128 a[192:195], v232 offset:0
    v_cvt_pk_bf16_f32 v68, v8, v9
    v_mfma_f32_16x16x32_bf16 a[8:11], a[224:227], v[88:91], a[8:11]
    v_exp_f32 v10, v10
    v_mfma_f32_16x16x32_bf16 a[12:15], a[224:227], v[92:95], a[12:15]
    ds_read_b128 a[196:199], v232 offset:1024
    v_mfma_f32_16x16x32_bf16 a[16:19], a[228:231], v[80:83], a[16:19]
    v_exp_f32 v11, v11
    v_mfma_f32_16x16x32_bf16 a[20:23], a[228:231], v[84:87], a[20:23]
    ds_read_b128 a[200:203], v232 offset:2048
    v_cvt_pk_bf16_f32 v69, v10, v11
    v_mfma_f32_16x16x32_bf16 a[24:27], a[228:231], v[88:91], a[24:27]
    s_add_u32 s19, s18, 8192
    v_exp_f32 v16, v16
    v_mfma_f32_16x16x32_bf16 a[28:31], a[228:231], v[92:95], a[28:31]
    ds_read_b128 a[204:207], v232 offset:3072
    buffer_store_dwordx4 a[184:187], v248, s[32:35], s19 offen offset:3072 sc1
    v_mfma_f32_16x16x32_bf16 a[32:35], a[232:235], v[80:83], a[32:35]
    v_exp_f32 v17, v17
    v_mfma_f32_16x16x32_bf16 a[36:39], a[232:235], v[84:87], a[36:39]
    ds_read_b128 a[208:211], v232 offset:4096
    v_cvt_pk_bf16_f32 v72, v16, v17
    v_mfma_f32_16x16x32_bf16 a[40:43], a[232:235], v[88:91], a[40:43]
    v_exp_f32 v18, v18
    v_mfma_f32_16x16x32_bf16 a[44:47], a[232:235], v[92:95], a[44:47]
    buffer_load_dwordx4 v248, s[40:43], s64 offen offset:0 sc1 lds
    v_mfma_f32_16x16x32_bf16 a[48:51], a[236:239], v[80:83], a[48:51]
    v_exp_f32 v19, v19
    v_mfma_f32_16x16x32_bf16 a[52:55], a[236:239], v[84:87], a[52:55]
    ds_read_b128 a[212:215], v232 offset:5120
    v_cvt_pk_bf16_f32 v73, v18, v19
    v_mfma_f32_16x16x32_bf16 a[56:59], a[236:239], v[88:91], a[56:59]
    v_exp_f32 v24, v24
    v_mfma_f32_16x16x32_bf16 a[60:63], a[236:239], v[92:95], a[60:63]
    buffer_load_dwordx4 v248, s[40:43], s64 offen offset:1024 sc1 lds
    v_mfma_f32_16x16x32_bf16 v[192:195], v[208:211], v[80:83], v[192:195]
    v_exp_f32 v25, v25
    v_mfma_f32_16x16x32_bf16 v[196:199], v[208:211], v[84:87], v[196:199]
    ds_read_b128 a[216:219], v232 offset:6144
    v_cvt_pk_bf16_f32 v76, v24, v25
    v_mfma_f32_16x16x32_bf16 v[200:203], v[208:211], v[88:91], v[200:203]
    v_exp_f32 v26, v26
    v_mfma_f32_16x16x32_bf16 v[204:207], v[208:211], v[92:95], v[204:207]
    buffer_load_dwordx4 v248, s[40:43], s64 offen offset:2048 sc1 lds
    v_mfma_f32_16x16x32_bf16 a[64:67], a[240:243], v[80:83], a[64:67]
    v_exp_f32 v27, v27
    v_mfma_f32_16x16x32_bf16 a[68:71], a[240:243], v[84:87], a[68:71]
    ds_read_b128 a[220:223], v232 offset:7168
    v_cvt_pk_bf16_f32 v77, v26, v27
    v_mfma_f32_16x16x32_bf16 a[72:75], a[240:243], v[88:91], a[72:75]
    v_exp_f32 v4, v4
    v_mfma_f32_16x16x32_bf16 a[76:79], a[240:243], v[92:95], a[76:79]
    buffer_load_dwordx4 v248, s[40:43], s64 offen offset:3072 sc1 lds
    v_mfma_f32_16x16x32_bf16 a[80:83], a[244:247], v[80:83], a[80:83]
    v_exp_f32 v5, v5
    v_mfma_f32_16x16x32_bf16 a[84:87], a[244:247], v[84:87], a[84:87]
    ds_read_b128 a[224:227], v232 offset:8192
    v_cvt_pk_bf16_f32 v66, v4, v5
    v_mfma_f32_16x16x32_bf16 a[88:91], a[244:247], v[88:91], a[88:91]
    s_add_u32 s64, s64, 8192
    s_add_u32 s19, s18, 12288
    v_exp_f32 v6, v6
    v_mfma_f32_16x16x32_bf16 a[92:95], a[244:247], v[92:95], a[92:95]
    s_add_u32 s66, s66, 0x4000
    buffer_store_dwordx4 a[188:191], v248, s[32:35], s19 offen offset:3072 sc1
    v_mfma_f32_16x16x32_bf16 a[96:99], a[248:251], v[80:83], a[96:99]
    s_and_b32 s66, s66, 0xffff
    v_exp_f32 v7, v7
    v_mfma_f32_16x16x32_bf16 a[100:103], a[248:251], v[84:87], a[100:103]
    ds_read_b128 a[228:231], v232 offset:9216
    v_cvt_pk_bf16_f32 v67, v6, v7
    v_mfma_f32_16x16x32_bf16 a[104:107], a[248:251], v[88:91], a[104:107]
    v_exp_f32 v12, v12
    v_mfma_f32_16x16x32_bf16 a[108:111], a[248:251], v[92:95], a[108:111]
    v_mfma_f32_16x16x32_bf16 a[112:115], a[252:255], v[80:83], a[112:115]
    v_exp_f32 v13, v13
    v_mfma_f32_16x16x32_bf16 a[116:119], a[252:255], v[84:87], a[116:119]
    v_cvt_pk_bf16_f32 v70, v12, v13
    v_mfma_f32_16x16x32_bf16 a[120:123], a[252:255], v[88:91], a[120:123]
    v_exp_f32 v14, v14
    v_mfma_f32_16x16x32_bf16 a[124:127], a[252:255], v[92:95], a[124:127]
    s_waitcnt lgkmcnt(2)
    v_mfma_f32_16x16x32_bf16 v[32:35], a[192:195], v[128:131], v[96:99]
    v_exp_f32 v15, v15
    v_mfma_f32_16x16x32_bf16 v[32:35], a[196:199], v[132:135], v[32:35]
    ds_read_b128 a[232:235], v232 offset:10240
    v_cvt_pk_bf16_f32 v71, v14, v15
    v_mfma_f32_16x16x32_bf16 v[32:35], a[200:203], v[136:139], v[32:35]
    v_exp_f32 v20, v20
    v_mfma_f32_16x16x32_bf16 v[32:35], a[204:207], v[140:143], v[32:35]
    ds_read_b128 a[236:239], v232 offset:11264
    ds_read_b64_tr_b16 a[176:177], v226 offset:0
    v_mfma_f32_16x16x32_bf16 v[40:43], a[192:195], v[144:147], v[100:103]
    v_exp_f32 v21, v21
    v_mfma_f32_16x16x32_bf16 v[40:43], a[196:199], v[148:151], v[40:43]
    ds_read_b128 a[240:243], v232 offset:12288
    v_cvt_pk_bf16_f32 v74, v20, v21
    v_mfma_f32_16x16x32_bf16 v[40:43], a[200:203], v[152:155], v[40:43]
    v_exp_f32 v22, v22
    v_mfma_f32_16x16x32_bf16 v[40:43], a[204:207], v[156:159], v[40:43]
    buffer_store_dwordx4 a[128:131], v248, s[32:35], s59 offen offset:0 sc1
    ds_read_b64_tr_b16 a[178:179], v226 offset:32
    v_mfma_f32_16x16x32_bf16 v[48:51], a[192:195], v[160:163], v[104:107]
    v_exp_f32 v23, v23
    v_mfma_f32_16x16x32_bf16 v[48:51], a[196:199], v[164:167], v[48:51]
    ds_read_b128 a[244:247], v232 offset:13312
    v_cvt_pk_bf16_f32 v75, v22, v23
    v_mfma_f32_16x16x32_bf16 v[48:51], a[200:203], v[168:171], v[48:51]
    v_exp_f32 v28, v28
    v_mfma_f32_16x16x32_bf16 v[48:51], a[204:207], v[172:175], v[48:51]
    ds_read_b64_tr_b16 a[180:181], v226 offset:64
    ds_read_b64_tr_b16 a[182:183], v226 offset:96
    v_mfma_f32_16x16x32_bf16 v[56:59], a[192:195], v[176:179], v[108:111]
    v_exp_f32 v29, v29
    v_mfma_f32_16x16x32_bf16 v[56:59], a[196:199], v[180:183], v[56:59]
    ds_read_b128 a[248:251], v232 offset:14336
    v_cvt_pk_bf16_f32 v78, v28, v29
    v_mfma_f32_16x16x32_bf16 v[56:59], a[200:203], v[184:187], v[56:59]
    v_exp_f32 v30, v30
    v_mfma_f32_16x16x32_bf16 v[56:59], a[204:207], v[188:191], v[56:59]
    ds_read_b64_tr_b16 a[184:185], v226 offset:128
    ds_read_b64_tr_b16 a[186:187], v226 offset:160
    v_mfma_f32_16x16x32_bf16 v[36:39], a[208:211], v[128:131], v[112:115]
    v_exp_f32 v31, v31
    v_mfma_f32_16x16x32_bf16 v[36:39], a[212:215], v[132:135], v[36:39]
    ds_read_b128 a[252:255], v232 offset:15360
    v_cvt_pk_bf16_f32 v79, v30, v31
    v_mfma_f32_16x16x32_bf16 v[36:39], a[216:219], v[136:139], v[36:39]
    s_add_u32 s67, s67, 0x4000
    ds_read_b64_tr_b16 a[188:189], v226 offset:192
    ds_read_b64_tr_b16 a[190:191], v226 offset:224
    v_mfma_f32_16x16x32_bf16 v[36:39], a[220:223], v[140:143], v[36:39]
    v_mfma_f32_16x16x32_bf16 v[44:47], a[208:211], v[144:147], v[116:119]
    v_mfma_f32_16x16x32_bf16 v[44:47], a[212:215], v[148:151], v[44:47]
    v_bfi_b32 v232, v233, s67, v232
    v_mfma_f32_16x16x32_bf16 v[44:47], a[216:219], v[152:155], v[44:47]
    v_exp_f32 v32, v32
    v_mfma_f32_16x16x32_bf16 v[44:47], a[220:223], v[156:159], v[44:47]
    s_mov_b32 m0, s66
    buffer_store_dwordx4 a[132:135], v248, s[32:35], s59 offen offset:1024 sc1
    v_mfma_f32_16x16x32_bf16 v[52:55], a[208:211], v[160:163], v[120:123]
    v_exp_f32 v33, v33
    v_mfma_f32_16x16x32_bf16 v[52:55], a[212:215], v[164:167], v[52:55]
    v_cvt_pk_bf16_f32 v80, v32, v33
    v_mfma_f32_16x16x32_bf16 v[52:55], a[216:219], v[168:171], v[52:55]
    v_exp_f32 v34, v34
    v_mfma_f32_16x16x32_bf16 v[52:55], a[220:223], v[172:175], v[52:55]
    v_mfma_f32_16x16x32_bf16 v[60:63], a[208:211], v[176:179], v[124:127]
    v_exp_f32 v35, v35
    v_mfma_f32_16x16x32_bf16 v[60:63], a[212:215], v[180:183], v[60:63]
    v_cvt_pk_bf16_f32 v81, v34, v35
    v_mfma_f32_16x16x32_bf16 v[60:63], a[216:219], v[184:187], v[60:63]
    v_exp_f32 v40, v40
    v_mfma_f32_16x16x32_bf16 v[60:63], a[220:223], v[188:191], v[60:63]
    s_waitcnt vmcnt(19)
    s_waitcnt lgkmcnt(0)
    s_barrier
    v_mfma_f32_16x16x32_bf16 a[0:3], a[224:227], v[64:67], a[0:3]
    v_exp_f32 v41, v41
    v_mfma_f32_16x16x32_bf16 a[4:7], a[224:227], v[68:71], a[4:7]
    ds_read_b128 a[192:195], v232 offset:0
    v_cvt_pk_bf16_f32 v84, v40, v41
    v_mfma_f32_16x16x32_bf16 a[8:11], a[224:227], v[72:75], a[8:11]
    v_exp_f32 v42, v42
    v_mfma_f32_16x16x32_bf16 a[12:15], a[224:227], v[76:79], a[12:15]
    ds_read_b128 a[196:199], v232 offset:1024
    v_mfma_f32_16x16x32_bf16 a[16:19], a[228:231], v[64:67], a[16:19]
    v_exp_f32 v43, v43
    v_mfma_f32_16x16x32_bf16 a[20:23], a[228:231], v[68:71], a[20:23]
    ds_read_b128 a[200:203], v232 offset:2048
    v_cvt_pk_bf16_f32 v85, v42, v43
    v_mfma_f32_16x16x32_bf16 a[24:27], a[228:231], v[72:75], a[24:27]
    v_exp_f32 v48, v48
    v_mfma_f32_16x16x32_bf16 a[28:31], a[228:231], v[76:79], a[28:31]
    ds_read_b128 a[204:207], v232 offset:3072
    buffer_store_dwordx4 a[136:139], v248, s[32:35], s73 offen offset:0 sc1
    v_mfma_f32_16x16x32_bf16 a[32:35], a[232:235], v[64:67], a[32:35]
    v_exp_f32 v49, v49
    v_mfma_f32_16x16x32_bf16 a[36:39], a[232:235], v[68:71], a[36:39]
    ds_read_b128 a[208:211], v232 offset:4096
    v_cvt_pk_bf16_f32 v88, v48, v49
    v_mfma_f32_16x16x32_bf16 a[40:43], a[232:235], v[72:75], a[40:43]
    v_exp_f32 v50, v50
    v_mfma_f32_16x16x32_bf16 a[44:47], a[232:235], v[76:79], a[44:47]
    buffer_load_dwordx4 v248, s[40:43], s64 offen offset:0 sc1 lds
    v_mfma_f32_16x16x32_bf16 a[48:51], a[236:239], v[64:67], a[48:51]
    v_exp_f32 v51, v51
    v_mfma_f32_16x16x32_bf16 a[52:55], a[236:239], v[68:71], a[52:55]
    ds_read_b128 a[212:215], v232 offset:5120
    v_cvt_pk_bf16_f32 v89, v50, v51
    v_mfma_f32_16x16x32_bf16 a[56:59], a[236:239], v[72:75], a[56:59]
    v_exp_f32 v56, v56
    v_mfma_f32_16x16x32_bf16 a[60:63], a[236:239], v[76:79], a[60:63]
    buffer_load_dwordx4 v248, s[40:43], s64 offen offset:1024 sc1 lds
    v_mfma_f32_16x16x32_bf16 v[192:195], v[208:211], v[64:67], v[192:195]
    v_exp_f32 v57, v57
    v_mfma_f32_16x16x32_bf16 v[196:199], v[208:211], v[68:71], v[196:199]
    ds_read_b128 a[216:219], v232 offset:6144
    v_cvt_pk_bf16_f32 v92, v56, v57
    v_mfma_f32_16x16x32_bf16 v[200:203], v[208:211], v[72:75], v[200:203]
    v_exp_f32 v58, v58
    v_mfma_f32_16x16x32_bf16 v[204:207], v[208:211], v[76:79], v[204:207]
    buffer_load_dwordx4 v248, s[40:43], s64 offen offset:2048 sc1 lds
    v_mfma_f32_16x16x32_bf16 a[64:67], a[240:243], v[64:67], a[64:67]
    v_exp_f32 v59, v59
    v_mfma_f32_16x16x32_bf16 a[68:71], a[240:243], v[68:71], a[68:71]
    ds_read_b128 a[220:223], v232 offset:7168
    v_cvt_pk_bf16_f32 v93, v58, v59
    v_mfma_f32_16x16x32_bf16 a[72:75], a[240:243], v[72:75], a[72:75]
    v_exp_f32 v36, v36
    v_mfma_f32_16x16x32_bf16 a[76:79], a[240:243], v[76:79], a[76:79]
    buffer_load_dwordx4 v248, s[40:43], s64 offen offset:3072 sc1 lds
    v_mfma_f32_16x16x32_bf16 a[80:83], a[244:247], v[64:67], a[80:83]
    v_exp_f32 v37, v37
    v_mfma_f32_16x16x32_bf16 a[84:87], a[244:247], v[68:71], a[84:87]
    ds_read_b128 a[224:227], v232 offset:8192
    v_cvt_pk_bf16_f32 v82, v36, v37
    v_mfma_f32_16x16x32_bf16 a[88:91], a[244:247], v[72:75], a[88:91]
    s_add_u32 s64, s64, 8192
    v_exp_f32 v38, v38
    v_mfma_f32_16x16x32_bf16 a[92:95], a[244:247], v[76:79], a[92:95]
    s_add_u32 s66, s66, 0x4000
    buffer_store_dwordx4 a[140:143], v248, s[32:35], s73 offen offset:1024 sc1
    v_mfma_f32_16x16x32_bf16 a[96:99], a[248:251], v[64:67], a[96:99]
    s_and_b32 s66, s66, 0xffff
    v_exp_f32 v39, v39
    v_mfma_f32_16x16x32_bf16 a[100:103], a[248:251], v[68:71], a[100:103]
    ds_read_b128 a[228:231], v232 offset:9216
    v_cvt_pk_bf16_f32 v83, v38, v39
    v_mfma_f32_16x16x32_bf16 a[104:107], a[248:251], v[72:75], a[104:107]
    v_exp_f32 v44, v44
    v_mfma_f32_16x16x32_bf16 a[108:111], a[248:251], v[76:79], a[108:111]
    v_mfma_f32_16x16x32_bf16 a[112:115], a[252:255], v[64:67], a[112:115]
    v_exp_f32 v45, v45
    v_mfma_f32_16x16x32_bf16 a[116:119], a[252:255], v[68:71], a[116:119]
    v_cvt_pk_bf16_f32 v86, v44, v45
    v_mfma_f32_16x16x32_bf16 a[120:123], a[252:255], v[72:75], a[120:123]
    v_exp_f32 v46, v46
    v_mfma_f32_16x16x32_bf16 a[124:127], a[252:255], v[76:79], a[124:127]
    s_waitcnt lgkmcnt(2)
    v_mfma_f32_16x16x32_bf16 v[0:3], a[192:195], v[128:131], v[96:99]
    v_exp_f32 v47, v47
    v_mfma_f32_16x16x32_bf16 v[0:3], a[196:199], v[132:135], v[0:3]
    ds_read_b128 a[232:235], v232 offset:10240
    v_cvt_pk_bf16_f32 v87, v46, v47
    v_mfma_f32_16x16x32_bf16 v[0:3], a[200:203], v[136:139], v[0:3]
    v_exp_f32 v52, v52
    v_mfma_f32_16x16x32_bf16 v[0:3], a[204:207], v[140:143], v[0:3]
    ds_read_b128 a[236:239], v232 offset:11264
    v_mfma_f32_16x16x32_bf16 v[8:11], a[192:195], v[144:147], v[100:103]
    v_exp_f32 v53, v53
    v_mfma_f32_16x16x32_bf16 v[8:11], a[196:199], v[148:151], v[8:11]
    ds_read_b128 a[240:243], v232 offset:12288
    v_cvt_pk_bf16_f32 v90, v52, v53
    v_mfma_f32_16x16x32_bf16 v[8:11], a[200:203], v[152:155], v[8:11]
    v_exp_f32 v54, v54
    v_mfma_f32_16x16x32_bf16 v[8:11], a[204:207], v[156:159], v[8:11]
    buffer_store_dwordx4 a[144:147], v248, s[32:35], s72 offen sc1
    v_mfma_f32_16x16x32_bf16 v[16:19], a[192:195], v[160:163], v[104:107]
    v_exp_f32 v55, v55
    v_mfma_f32_16x16x32_bf16 v[16:19], a[196:199], v[164:167], v[16:19]
    ds_read_b128 a[244:247], v232 offset:13312
    v_cvt_pk_bf16_f32 v91, v54, v55
    v_mfma_f32_16x16x32_bf16 v[16:19], a[200:203], v[168:171], v[16:19]
    v_exp_f32 v60, v60
    v_mfma_f32_16x16x32_bf16 v[16:19], a[204:207], v[172:175], v[16:19]
    v_mfma_f32_16x16x32_bf16 v[24:27], a[192:195], v[176:179], v[108:111]
    v_exp_f32 v61, v61
    v_mfma_f32_16x16x32_bf16 v[24:27], a[196:199], v[180:183], v[24:27]
    ds_read_b128 a[248:251], v232 offset:14336
    v_cvt_pk_bf16_f32 v94, v60, v61
    v_mfma_f32_16x16x32_bf16 v[24:27], a[200:203], v[184:187], v[24:27]
    v_exp_f32 v62, v62
    v_mfma_f32_16x16x32_bf16 v[24:27], a[204:207], v[188:191], v[24:27]
    v_mfma_f32_16x16x32_bf16 v[4:7], a[208:211], v[128:131], v[112:115]
    v_exp_f32 v63, v63
    v_mfma_f32_16x16x32_bf16 v[4:7], a[212:215], v[132:135], v[4:7]
    ds_read_b128 a[252:255], v232 offset:15360
    v_cvt_pk_bf16_f32 v95, v62, v63
    v_mfma_f32_16x16x32_bf16 v[4:7], a[216:219], v[136:139], v[4:7]
    s_add_u32 s67, s67, 0x4000
    v_mfma_f32_16x16x32_bf16 v[4:7], a[220:223], v[140:143], v[4:7]
    v_mfma_f32_16x16x32_bf16 v[12:15], a[208:211], v[144:147], v[116:119]
    v_mfma_f32_16x16x32_bf16 v[12:15], a[212:215], v[148:151], v[12:15]
    v_bfi_b32 v232, v233, s67, v232
    v_mfma_f32_16x16x32_bf16 v[12:15], a[216:219], v[152:155], v[12:15]
    s_add_u32 s72, s72, 32768
    v_exp_f32 v0, v0
    v_mfma_f32_16x16x32_bf16 v[12:15], a[220:223], v[156:159], v[12:15]
    s_mov_b32 m0, s66
    buffer_store_dwordx4 a[148:151], v248, s[32:35], s72 offen sc1
    v_mfma_f32_16x16x32_bf16 v[20:23], a[208:211], v[160:163], v[120:123]
    v_exp_f32 v1, v1
    v_mfma_f32_16x16x32_bf16 v[20:23], a[212:215], v[164:167], v[20:23]
    v_cvt_pk_bf16_f32 v64, v0, v1
    v_mfma_f32_16x16x32_bf16 v[20:23], a[216:219], v[168:171], v[20:23]
    v_exp_f32 v2, v2
    v_mfma_f32_16x16x32_bf16 v[20:23], a[220:223], v[172:175], v[20:23]
    v_add_u32 v254, 32, v254
    v_mfma_f32_16x16x32_bf16 v[28:31], a[208:211], v[176:179], v[124:127]
    v_exp_f32 v3, v3
    v_mfma_f32_16x16x32_bf16 v[28:31], a[212:215], v[180:183], v[28:31]
    v_cvt_pk_bf16_f32 v65, v2, v3
    v_mfma_f32_16x16x32_bf16 v[28:31], a[216:219], v[184:187], v[28:31]
    v_exp_f32 v8, v8
    v_mfma_f32_16x16x32_bf16 v[28:31], a[220:223], v[188:191], v[28:31]
    s_waitcnt vmcnt(10)
    s_waitcnt lgkmcnt(0)
    s_barrier
    v_mfma_f32_16x16x32_bf16 a[0:3], a[224:227], v[80:83], a[0:3]
    v_exp_f32 v9, v9
    v_mfma_f32_16x16x32_bf16 a[4:7], a[224:227], v[84:87], a[4:7]
    ds_read_b128 a[192:195], v232 offset:0
    v_cvt_pk_bf16_f32 v68, v8, v9
    v_mfma_f32_16x16x32_bf16 a[8:11], a[224:227], v[88:91], a[8:11]
    v_exp_f32 v10, v10
    v_mfma_f32_16x16x32_bf16 a[12:15], a[224:227], v[92:95], a[12:15]
    ds_read_b128 a[196:199], v232 offset:1024
    v_mov_b32 v253, s94
    s_cmp_eq_u32 s52, 0
    s_mov_b32 s58, 0x7fff0000
    s_cselect_b32 s58, 0x3a0000, s58
    buffer_store_dword v253, v254, s[32:35], s58 offen sc1
    v_mfma_f32_16x16x32_bf16 a[16:19], a[228:231], v[80:83], a[16:19]
    v_exp_f32 v11, v11
    v_mfma_f32_16x16x32_bf16 a[20:23], a[228:231], v[84:87], a[20:23]
    ds_read_b128 a[200:203], v232 offset:2048
    v_cvt_pk_bf16_f32 v69, v10, v11
    v_mfma_f32_16x16x32_bf16 a[24:27], a[228:231], v[88:91], a[24:27]
    s_add_u32 s72, s72, 32768
    v_exp_f32 v16, v16
    v_mfma_f32_16x16x32_bf16 a[28:31], a[228:231], v[92:95], a[28:31]
    ds_read_b128 a[204:207], v232 offset:3072
    buffer_store_dwordx4 a[152:155], v248, s[32:35], s72 offen sc1
    v_mfma_f32_16x16x32_bf16 a[32:35], a[232:235], v[80:83], a[32:35]
    v_exp_f32 v17, v17
    v_mfma_f32_16x16x32_bf16 a[36:39], a[232:235], v[84:87], a[36:39]
    ds_read_b128 a[208:211], v232 offset:4096
    v_cvt_pk_bf16_f32 v72, v16, v17
    v_mfma_f32_16x16x32_bf16 a[40:43], a[232:235], v[88:91], a[40:43]
    v_exp_f32 v18, v18
    v_mfma_f32_16x16x32_bf16 a[44:47], a[232:235], v[92:95], a[44:47]
    buffer_load_dwordx4 v248, s[40:43], s64 offen offset:0 sc1 lds
    v_mfma_f32_16x16x32_bf16 a[48:51], a[236:239], v[80:83], a[48:51]
    v_exp_f32 v19, v19
    v_mfma_f32_16x16x32_bf16 a[52:55], a[236:239], v[84:87], a[52:55]
    ds_read_b128 a[212:215], v232 offset:5120
    v_cvt_pk_bf16_f32 v73, v18, v19
    v_mfma_f32_16x16x32_bf16 a[56:59], a[236:239], v[88:91], a[56:59]
    v_exp_f32 v24, v24
    v_mfma_f32_16x16x32_bf16 a[60:63], a[236:239], v[92:95], a[60:63]
    buffer_load_dwordx4 v248, s[40:43], s64 offen offset:1024 sc1 lds
    v_mfma_f32_16x16x32_bf16 v[192:195], v[208:211], v[80:83], v[192:195]
    v_exp_f32 v25, v25
    v_mfma_f32_16x16x32_bf16 v[196:199], v[208:211], v[84:87], v[196:199]
    ds_read_b128 a[216:219], v232 offset:6144
    v_cvt_pk_bf16_f32 v76, v24, v25
    v_mfma_f32_16x16x32_bf16 v[200:203], v[208:211], v[88:91], v[200:203]
    v_exp_f32 v26, v26
    v_mfma_f32_16x16x32_bf16 v[204:207], v[208:211], v[92:95], v[204:207]
    buffer_load_dwordx4 v248, s[40:43], s64 offen offset:2048 sc1 lds
    v_mfma_f32_16x16x32_bf16 a[64:67], a[240:243], v[80:83], a[64:67]
    v_exp_f32 v27, v27
    v_mfma_f32_16x16x32_bf16 a[68:71], a[240:243], v[84:87], a[68:71]
    ds_read_b128 a[220:223], v232 offset:7168
    v_cvt_pk_bf16_f32 v77, v26, v27
    v_mfma_f32_16x16x32_bf16 a[72:75], a[240:243], v[88:91], a[72:75]
    v_exp_f32 v4, v4
    v_mfma_f32_16x16x32_bf16 a[76:79], a[240:243], v[92:95], a[76:79]
    buffer_load_dwordx4 v248, s[40:43], s64 offen offset:3072 sc1 lds
    v_mfma_f32_16x16x32_bf16 a[80:83], a[244:247], v[80:83], a[80:83]
    v_exp_f32 v5, v5
    v_mfma_f32_16x16x32_bf16 a[84:87], a[244:247], v[84:87], a[84:87]
    ds_read_b128 a[224:227], v232 offset:8192
    v_cvt_pk_bf16_f32 v66, v4, v5
    v_mfma_f32_16x16x32_bf16 a[88:91], a[244:247], v[88:91], a[88:91]
    s_add_u32 s64, s64, 8192
    v_exp_f32 v6, v6
    v_mfma_f32_16x16x32_bf16 a[92:95], a[244:247], v[92:95], a[92:95]
    s_add_u32 s66, s66, 0x4000
    v_mfma_f32_16x16x32_bf16 a[96:99], a[248:251], v[80:83], a[96:99]
    s_and_b32 s66, s66, 0xffff
    v_exp_f32 v7, v7
    v_mfma_f32_16x16x32_bf16 a[100:103], a[248:251], v[84:87], a[100:103]
    ds_read_b128 a[228:231], v232 offset:9216
    v_cvt_pk_bf16_f32 v67, v6, v7
    v_mfma_f32_16x16x32_bf16 a[104:107], a[248:251], v[88:91], a[104:107]
    v_exp_f32 v12, v12
    v_mfma_f32_16x16x32_bf16 a[108:111], a[248:251], v[92:95], a[108:111]
    s_sub_u32 s68, s68, 1
    v_mfma_f32_16x16x32_bf16 a[112:115], a[252:255], v[80:83], a[112:115]
    v_exp_f32 v13, v13
    v_mfma_f32_16x16x32_bf16 a[116:119], a[252:255], v[84:87], a[116:119]
    v_cvt_pk_bf16_f32 v70, v12, v13
    v_mfma_f32_16x16x32_bf16 a[120:123], a[252:255], v[88:91], a[120:123]
    v_exp_f32 v14, v14
    v_mfma_f32_16x16x32_bf16 a[124:127], a[252:255], v[92:95], a[124:127]
    s_cbranch_scc1 F_event
    s_branch F_O1
.p2align 6
F_T32:
    s_waitcnt lgkmcnt(2)
    v_mfma_f32_16x16x32_bf16 v[0:3], a[192:195], v[128:131], v[96:99]
    buffer_load_dwordx4 v[236:239], v228, s[32:35], 0 offen sc1
    v_exp_f32 v47, v47
    v_mfma_f32_16x16x32_bf16 v[0:3], a[196:199], v[132:135], v[0:3]
    s_add_u32 s56, s9, 1
    ds_read_b128 a[232:235], v232 offset:10240
    v_cvt_pk_bf16_f32 v87, v46, v47
    v_mfma_f32_16x16x32_bf16 v[0:3], a[200:203], v[136:139], v[0:3]
    s_and_b32 s56, s56, 3
    v_exp_f32 v52, v52
    v_mfma_f32_16x16x32_bf16 v[0:3], a[204:207], v[140:143], v[0:3]
    s_lshl_b32 s56, s56, 10
    s_add_u32 s56, s56, 4096
    ds_read_b128 a[236:239], v232 offset:11264
    v_mfma_f32_16x16x32_bf16 v[8:11], a[192:195], v[144:147], v[100:103]
    v_exp_f32 v53, v53
    v_mfma_f32_16x16x32_bf16 v[8:11], a[196:199], v[148:151], v[8:11]
    ds_read_b128 a[240:243], v232 offset:12288
    v_cvt_pk_bf16_f32 v90, v52, v53
    v_mfma_f32_16x16x32_bf16 v[8:11], a[200:203], v[152:155], v[8:11]
    v_exp_f32 v54, v54
    v_mfma_f32_16x16x32_bf16 v[8:11], a[204:207], v[156:159], v[8:11]
    v_add_u32 v224, s56, v248
    v_mfma_f32_16x16x32_bf16 v[16:19], a[192:195], v[160:163], v[104:107]
    s_add_u32 s56, s9, 2
    v_exp_f32 v55, v55
    v_mfma_f32_16x16x32_bf16 v[16:19], a[196:199], v[164:167], v[16:19]
    s_and_b32 s56, s56, 3
    ds_read_b128 a[244:247], v232 offset:13312
    v_cvt_pk_bf16_f32 v91, v54, v55
    v_mfma_f32_16x16x32_bf16 v[16:19], a[200:203], v[168:171], v[16:19]
    s_lshl_b32 s56, s56, 10
    v_exp_f32 v60, v60
    v_mfma_f32_16x16x32_bf16 v[16:19], a[204:207], v[172:175], v[16:19]
    s_add_u32 s56, s56, 3072
    v_add_u32 v225, s56, v248
    v_mfma_f32_16x16x32_bf16 v[24:27], a[192:195], v[176:179], v[108:111]
    s_add_u32 s56, s9, 3
    v_exp_f32 v61, v61
    v_mfma_f32_16x16x32_bf16 v[24:27], a[196:199], v[180:183], v[24:27]
    s_and_b32 s56, s56, 3
    ds_read_b128 a[248:251], v232 offset:14336
    v_cvt_pk_bf16_f32 v94, v60, v61
    v_mfma_f32_16x16x32_bf16 v[24:27], a[200:203], v[184:187], v[24:27]
    s_lshl_b32 s56, s56, 10
    v_exp_f32 v62, v62
    v_mfma_f32_16x16x32_bf16 v[24:27], a[204:207], v[188:191], v[24:27]
    s_add_u32 s56, s56, 2048
    v_add_u32 v226, s56, v248
    v_and_b32 v229, 1, v249
    v_mfma_f32_16x16x32_bf16 v[4:7], a[208:211], v[128:131], v[112:115]
    v_exp_f32 v63, v63
    v_mfma_f32_16x16x32_bf16 v[4:7], a[212:215], v[132:135], v[4:7]
    ds_read_b128 a[252:255], v232 offset:15360
    v_cvt_pk_bf16_f32 v95, v62, v63
    v_mfma_f32_16x16x32_bf16 v[4:7], a[216:219], v[136:139], v[4:7]
    s_add_u32 s67, s67, 0x4000
    v_lshrrev_b32 v230, 1, v249
    v_lshl_add_u32 v229, v230, 6, v229
    v_mfma_f32_16x16x32_bf16 v[4:7], a[220:223], v[140:143], v[4:7]
    s_and_b32 s56, s2, 0x3e
    s_lshl_b32 s56, s56, 9
    s_and_b32 s57, s53, 7
    v_mfma_f32_16x16x32_bf16 v[12:15], a[208:211], v[144:147], v[116:119]
    s_lshl_b32 s57, s57, 2
    s_add_u32 s56, s56, s57
    s_add_u32 s56, s56, 128
    v_mfma_f32_16x16x32_bf16 v[12:15], a[212:215], v[148:151], v[12:15]
    v_bfi_b32 v232, v233, s67, v232
    v_lshl_add_u32 v229, v229, 9, s56
    v_mfma_f32_16x16x32_bf16 v[12:15], a[216:219], v[152:155], v[12:15]
    v_exp_f32 v0, v0
    v_mfma_f32_16x16x32_bf16 v[12:15], a[220:223], v[156:159], v[12:15]
    v_cmp_gt_u32 vcc, 8, v249
    v_mov_b32 v230, 0x40000000
    v_mfma_f32_16x16x32_bf16 v[20:23], a[208:211], v[160:163], v[120:123]
    v_exp_f32 v1, v1
    v_mfma_f32_16x16x32_bf16 v[20:23], a[212:215], v[164:167], v[20:23]
    v_cvt_pk_bf16_f32 v64, v0, v1
    v_cndmask_b32 v229, v230, v229, vcc
    v_mfma_f32_16x16x32_bf16 v[20:23], a[216:219], v[168:171], v[20:23]
    v_exp_f32 v2, v2
    v_mfma_f32_16x16x32_bf16 v[20:23], a[220:223], v[172:175], v[20:23]
    v_mfma_f32_16x16x32_bf16 v[28:31], a[208:211], v[176:179], v[124:127]
    v_exp_f32 v3, v3
    v_mfma_f32_16x16x32_bf16 v[28:31], a[212:215], v[180:183], v[28:31]
    v_cvt_pk_bf16_f32 v65, v2, v3
    v_mfma_f32_16x16x32_bf16 v[28:31], a[216:219], v[184:187], v[28:31]
    v_exp_f32 v8, v8
    v_mfma_f32_16x16x32_bf16 v[28:31], a[220:223], v[188:191], v[28:31]
    s_waitcnt vmcnt(9) lgkmcnt(0)
    s_barrier
    v_mfma_f32_16x16x32_bf16 a[0:3], a[224:227], v[80:83], a[0:3]
    v_exp_f32 v9, v9
    v_mfma_f32_16x16x32_bf16 a[4:7], a[224:227], v[84:87], a[4:7]
    s_waitcnt vmcnt(0)
    ds_read_b128 a[192:195], v232 offset:0
    v_cvt_pk_bf16_f32 v68, v8, v9
    v_mfma_f32_16x16x32_bf16 a[8:11], a[224:227], v[88:91], a[8:11]
    v_exp_f32 v10, v10
    v_mfma_f32_16x16x32_bf16 a[12:15], a[224:227], v[92:95], a[12:15]
    ds_read_b128 a[196:199], v232 offset:1024
    s_mov_b32 s16, 100000
F_pl6:
    v_xor_b32 v236, s94, v236
    v_xor_b32 v237, s94, v237
    v_xor_b32 v238, s94, v238
    v_xor_b32 v239, s94, v239
    v_or3_b32 v236, v236, v237, v238
    v_or_b32 v236, v236, v239
    v_cmp_ne_u32 vcc, 0, v236
    s_nop 4
    s_cbranch_vccz F_pd6
    s_sleep 8
    buffer_load_dwordx4 v[236:239], v228, s[32:35], 0 offen sc1
    s_sub_u32 s16, s16, 1
    s_waitcnt vmcnt(0)
    s_cbranch_scc0 F_pl6
F_pd6:
    v_mfma_f32_16x16x32_bf16 a[16:19], a[228:231], v[80:83], a[16:19]
    v_exp_f32 v11, v11
    v_mfma_f32_16x16x32_bf16 a[20:23], a[228:231], v[84:87], a[20:23]
    ds_read_b128 a[200:203], v232 offset:2048
    v_cvt_pk_bf16_f32 v69, v10, v11
    v_mfma_f32_16x16x32_bf16 a[24:27], a[228:231], v[88:91], a[24:27]
    v_exp_f32 v16, v16
    v_mfma_f32_16x16x32_bf16 a[28:31], a[228:231], v[92:95], a[28:31]
    ds_read_b128 a[204:207], v232 offset:3072
    v_mov_b32 v230, s94
    s_cmp_eq_u32 s52, 0
    s_mov_b32 s58, 0x7fff0000
    s_cselect_b32 s58, 0x3a0000, s58
    s_cmp_lt_u32 s54, 7
    s_cselect_b32 s58, s58, 0x7fff0000
    buffer_store_dword v230, v229, s[32:35], s58 offen sc1
    v_mfma_f32_16x16x32_bf16 a[32:35], a[232:235], v[80:83], a[32:35]
    v_exp_f32 v17, v17
    v_mfma_f32_16x16x32_bf16 a[36:39], a[232:235], v[84:87], a[36:39]
    s_add_u32 m0, s55, 49152
    ds_read_b128 a[208:211], v232 offset:4096
    v_cvt_pk_bf16_f32 v72, v16, v17
    v_mfma_f32_16x16x32_bf16 a[40:43], a[232:235], v[88:91], a[40:43]
    v_exp_f32 v18, v18
    v_mfma_f32_16x16x32_bf16 a[44:47], a[232:235], v[92:95], a[44:47]
    s_add_u32 s56, s10, 8192
    v_mfma_f32_16x16x32_bf16 a[48:51], a[236:239], v[80:83], a[48:51]
    v_exp_f32 v19, v19
    v_mfma_f32_16x16x32_bf16 a[52:55], a[236:239], v[84:87], a[52:55]
    ds_read_b128 a[212:215], v232 offset:5120
    buffer_load_dwordx4 v248, s[32:35], s56 offen offset:0 sc1 lds
    v_cvt_pk_bf16_f32 v73, v18, v19
    v_mfma_f32_16x16x32_bf16 a[56:59], a[236:239], v[88:91], a[56:59]
    v_exp_f32 v24, v24
    v_mfma_f32_16x16x32_bf16 a[60:63], a[236:239], v[92:95], a[60:63]
    buffer_load_dwordx4 v248, s[32:35], s56 offen offset:1024 sc1 lds
    v_mfma_f32_16x16x32_bf16 v[192:195], v[208:211], v[80:83], v[192:195]
    v_exp_f32 v25, v25
    v_mfma_f32_16x16x32_bf16 v[196:199], v[208:211], v[84:87], v[196:199]
    ds_read_b128 a[216:219], v232 offset:6144
    buffer_load_dwordx4 v248, s[32:35], s56 offen offset:2048 sc1 lds
    v_cvt_pk_bf16_f32 v76, v24, v25
    v_mfma_f32_16x16x32_bf16 v[200:203], v[208:211], v[88:91], v[200:203]
    v_exp_f32 v26, v26
    v_mfma_f32_16x16x32_bf16 v[204:207], v[208:211], v[92:95], v[204:207]
    buffer_load_dwordx4 v248, s[32:35], s56 offen offset:3072 sc1 lds
    v_mfma_f32_16x16x32_bf16 a[64:67], a[240:243], v[80:83], a[64:67]
    v_exp_f32 v27, v27
    v_mfma_f32_16x16x32_bf16 a[68:71], a[240:243], v[84:87], a[68:71]
    s_add_u32 m0, s55, 65536
    ds_read_b128 a[220:223], v232 offset:7168
    v_cvt_pk_bf16_f32 v77, v26, v27
    v_mfma_f32_16x16x32_bf16 a[72:75], a[240:243], v[88:91], a[72:75]
    v_exp_f32 v4, v4
    v_mfma_f32_16x16x32_bf16 a[76:79], a[240:243], v[92:95], a[76:79]
    s_add_u32 s56, s10, 12288
    v_mfma_f32_16x16x32_bf16 a[80:83], a[244:247], v[80:83], a[80:83]
    v_exp_f32 v5, v5
    v_mfma_f32_16x16x32_bf16 a[84:87], a[244:247], v[84:87], a[84:87]
    ds_read_b128 a[224:227], v232 offset:8192
    buffer_load_dwordx4 v248, s[32:35], s56 offen offset:0 sc1 lds
    v_cvt_pk_bf16_f32 v66, v4, v5
    v_mfma_f32_16x16x32_bf16 a[88:91], a[244:247], v[88:91], a[88:91]
    v_exp_f32 v6, v6
    v_mfma_f32_16x16x32_bf16 a[92:95], a[244:247], v[92:95], a[92:95]
    buffer_load_dwordx4 v248, s[32:35], s56 offen offset:1024 sc1 lds
    v_mfma_f32_16x16x32_bf16 a[96:99], a[248:251], v[80:83], a[96:99]
    v_exp_f32 v7, v7
    v_mfma_f32_16x16x32_bf16 a[100:103], a[248:251], v[84:87], a[100:103]
    ds_read_b128 a[228:231], v232 offset:9216
    buffer_load_dwordx4 v248, s[32:35], s56 offen offset:2048 sc1 lds
    v_cvt_pk_bf16_f32 v67, v6, v7
    v_mfma_f32_16x16x32_bf16 a[104:107], a[248:251], v[88:91], a[104:107]
    v_exp_f32 v12, v12
    v_mfma_f32_16x16x32_bf16 a[108:111], a[248:251], v[92:95], a[108:111]
    buffer_load_dwordx4 v248, s[32:35], s56 offen offset:3072 sc1 lds
    v_mfma_f32_16x16x32_bf16 a[112:115], a[252:255], v[80:83], a[112:115]
    v_exp_f32 v13, v13
    v_mfma_f32_16x16x32_bf16 a[116:119], a[252:255], v[84:87], a[116:119]
    v_cvt_pk_bf16_f32 v70, v12, v13
    v_mfma_f32_16x16x32_bf16 a[120:123], a[252:255], v[88:91], a[120:123]
    v_exp_f32 v14, v14
    v_mfma_f32_16x16x32_bf16 a[124:127], a[252:255], v[92:95], a[124:127]
    s_cmp_eq_u32 s71, 32
    s_cbranch_scc1 F_xp2
F_T33:
    s_waitcnt lgkmcnt(2)
    v_mfma_f32_16x16x32_bf16 v[32:35], a[192:195], v[128:131], v[96:99]
    s_add_u32 m0, s55, 131072
    v_exp_f32 v15, v15
    v_mfma_f32_16x16x32_bf16 v[32:35], a[196:199], v[132:135], v[32:35]
    s_add_u32 s56, s10, 16384
    ds_read_b128 a[232:235], v232 offset:10240
    v_cvt_pk_bf16_f32 v71, v14, v15
    v_mfma_f32_16x16x32_bf16 v[32:35], a[200:203], v[136:139], v[32:35]
    buffer_load_dwordx4 v248, s[32:35], s56 offen offset:0 sc1 lds
    v_exp_f32 v20, v20
    v_mfma_f32_16x16x32_bf16 v[32:35], a[204:207], v[140:143], v[32:35]
    ds_read_b128 a[236:239], v232 offset:11264
    buffer_load_dwordx4 v248, s[32:35], s56 offen offset:1024 sc1 lds
    v_mfma_f32_16x16x32_bf16 v[40:43], a[192:195], v[144:147], v[100:103]
    buffer_load_dwordx4 v248, s[32:35], s56 offen offset:2048 sc1 lds
    v_exp_f32 v21, v21
    v_mfma_f32_16x16x32_bf16 v[40:43], a[196:199], v[148:151], v[40:43]
    ds_read_b128 a[240:243], v232 offset:12288
    buffer_load_dwordx4 v248, s[32:35], s56 offen offset:3072 sc1 lds
    v_cvt_pk_bf16_f32 v74, v20, v21
    v_mfma_f32_16x16x32_bf16 v[40:43], a[200:203], v[152:155], v[40:43]
    s_add_u32 m0, s55, 147456
    v_exp_f32 v22, v22
    v_mfma_f32_16x16x32_bf16 v[40:43], a[204:207], v[156:159], v[40:43]
    s_add_u32 s56, s10, 20480
    v_mfma_f32_16x16x32_bf16 v[48:51], a[192:195], v[160:163], v[104:107]
    buffer_load_dwordx4 v248, s[32:35], s56 offen offset:0 sc1 lds
    v_exp_f32 v23, v23
    v_mfma_f32_16x16x32_bf16 v[48:51], a[196:199], v[164:167], v[48:51]
    ds_read_b128 a[244:247], v232 offset:13312
    buffer_load_dwordx4 v248, s[32:35], s56 offen offset:1024 sc1 lds
    v_cvt_pk_bf16_f32 v75, v22, v23
    v_mfma_f32_16x16x32_bf16 v[48:51], a[200:203], v[168:171], v[48:51]
    buffer_load_dwordx4 v248, s[32:35], s56 offen offset:2048 sc1 lds
    v_exp_f32 v28, v28
    v_mfma_f32_16x16x32_bf16 v[48:51], a[204:207], v[172:175], v[48:51]
    buffer_load_dwordx4 v248, s[32:35], s56 offen offset:3072 sc1 lds
    v_mfma_f32_16x16x32_bf16 v[56:59], a[192:195], v[176:179], v[108:111]
    s_add_u32 m0, s55, 0
    v_exp_f32 v29, v29
    v_mfma_f32_16x16x32_bf16 v[56:59], a[196:199], v[180:183], v[56:59]
    s_add_u32 s56, s10, 24576
    ds_read_b128 a[248:251], v232 offset:14336
    v_cvt_pk_bf16_f32 v78, v28, v29
    v_mfma_f32_16x16x32_bf16 v[56:59], a[200:203], v[184:187], v[56:59]
    buffer_load_dwordx4 v248, s[32:35], s56 offen offset:0 sc1 lds
    v_exp_f32 v30, v30
    v_mfma_f32_16x16x32_bf16 v[56:59], a[204:207], v[188:191], v[56:59]
    buffer_load_dwordx4 v248, s[32:35], s56 offen offset:1024 sc1 lds
    v_mfma_f32_16x16x32_bf16 v[36:39], a[208:211], v[128:131], v[112:115]
    buffer_load_dwordx4 v248, s[32:35], s56 offen offset:2048 sc1 lds
    v_exp_f32 v31, v31
    v_mfma_f32_16x16x32_bf16 v[36:39], a[212:215], v[132:135], v[36:39]
    ds_read_b128 a[252:255], v232 offset:15360
    buffer_load_dwordx4 v248, s[32:35], s56 offen offset:3072 sc1 lds
    v_cvt_pk_bf16_f32 v79, v30, v31
    v_mfma_f32_16x16x32_bf16 v[36:39], a[216:219], v[136:139], v[36:39]
    s_add_u32 s67, s67, 0x4000
    v_mfma_f32_16x16x32_bf16 v[36:39], a[220:223], v[140:143], v[36:39]
    v_mfma_f32_16x16x32_bf16 v[44:47], a[208:211], v[144:147], v[116:119]
    v_mfma_f32_16x16x32_bf16 v[44:47], a[212:215], v[148:151], v[44:47]
    v_bfi_b32 v232, v233, s67, v232
    v_mfma_f32_16x16x32_bf16 v[44:47], a[216:219], v[152:155], v[44:47]
    v_exp_f32 v32, v32
    v_mfma_f32_16x16x32_bf16 v[44:47], a[220:223], v[156:159], v[44:47]
    v_mfma_f32_16x16x32_bf16 v[52:55], a[208:211], v[160:163], v[120:123]
    v_exp_f32 v33, v33
    v_mfma_f32_16x16x32_bf16 v[52:55], a[212:215], v[164:167], v[52:55]
    v_cvt_pk_bf16_f32 v80, v32, v33
    v_mfma_f32_16x16x32_bf16 v[52:55], a[216:219], v[168:171], v[52:55]
    v_exp_f32 v34, v34
    v_mfma_f32_16x16x32_bf16 v[52:55], a[220:223], v[172:175], v[52:55]
    v_mfma_f32_16x16x32_bf16 v[60:63], a[208:211], v[176:179], v[124:127]
    v_exp_f32 v35, v35
    v_mfma_f32_16x16x32_bf16 v[60:63], a[212:215], v[180:183], v[60:63]
    v_cvt_pk_bf16_f32 v81, v34, v35
    v_mfma_f32_16x16x32_bf16 v[60:63], a[216:219], v[184:187], v[60:63]
    v_exp_f32 v40, v40
    v_mfma_f32_16x16x32_bf16 v[60:63], a[220:223], v[188:191], v[60:63]
    s_waitcnt vmcnt(24) lgkmcnt(0)
    s_barrier
    v_mfma_f32_16x16x32_bf16 a[0:3], a[224:227], v[64:67], a[0:3]
    v_exp_f32 v41, v41
    v_mfma_f32_16x16x32_bf16 a[4:7], a[224:227], v[68:71], a[4:7]
    s_add_u32 s56, s10, 0
    v_cvt_pk_bf16_f32 v84, v40, v41
    v_mfma_f32_16x16x32_bf16 a[8:11], a[224:227], v[72:75], a[8:11]
    v_exp_f32 v42, v42
    v_mfma_f32_16x16x32_bf16 a[12:15], a[224:227], v[76:79], a[12:15]
    buffer_load_dwordx4 a[192:195], v248, s[32:35], s56 offen offset:0 sc1
    v_mfma_f32_16x16x32_bf16 a[16:19], a[228:231], v[64:67], a[16:19]
    v_exp_f32 v43, v43
    v_mfma_f32_16x16x32_bf16 a[20:23], a[228:231], v[68:71], a[20:23]
    buffer_load_dwordx4 a[196:199], v248, s[32:35], s56 offen offset:1024 sc1
    v_cvt_pk_bf16_f32 v85, v42, v43
    v_mfma_f32_16x16x32_bf16 a[24:27], a[228:231], v[72:75], a[24:27]
    v_exp_f32 v48, v48
    v_mfma_f32_16x16x32_bf16 a[28:31], a[228:231], v[76:79], a[28:31]
    buffer_load_dwordx4 a[200:203], v248, s[32:35], s56 offen offset:2048 sc1
    v_mfma_f32_16x16x32_bf16 a[32:35], a[232:235], v[64:67], a[32:35]
    v_exp_f32 v49, v49
    v_mfma_f32_16x16x32_bf16 a[36:39], a[232:235], v[68:71], a[36:39]
    buffer_load_dwordx4 a[204:207], v248, s[32:35], s56 offen offset:3072 sc1
    v_cvt_pk_bf16_f32 v88, v48, v49
    v_mfma_f32_16x16x32_bf16 a[40:43], a[232:235], v[72:75], a[40:43]
    v_exp_f32 v50, v50
    v_mfma_f32_16x16x32_bf16 a[44:47], a[232:235], v[76:79], a[44:47]
    s_add_u32 s56, s10, 4096
    v_mfma_f32_16x16x32_bf16 a[48:51], a[236:239], v[64:67], a[48:51]
    v_exp_f32 v51, v51
    v_mfma_f32_16x16x32_bf16 a[52:55], a[236:239], v[68:71], a[52:55]
    buffer_load_dwordx4 a[208:211], v248, s[32:35], s56 offen offset:0 sc1
    v_cvt_pk_bf16_f32 v89, v50, v51
    v_mfma_f32_16x16x32_bf16 a[56:59], a[236:239], v[72:75], a[56:59]
    v_exp_f32 v56, v56
    v_mfma_f32_16x16x32_bf16 a[60:63], a[236:239], v[76:79], a[60:63]
    buffer_load_dwordx4 a[212:215], v248, s[32:35], s56 offen offset:1024 sc1
    v_mfma_f32_16x16x32_bf16 v[192:195], v[208:211], v[64:67], v[192:195]
    v_exp_f32 v57, v57
    v_mfma_f32_16x16x32_bf16 v[196:199], v[208:211], v[68:71], v[196:199]
    buffer_load_dwordx4 a[216:219], v248, s[32:35], s56 offen offset:2048 sc1
    v_cvt_pk_bf16_f32 v92, v56, v57
    v_mfma_f32_16x16x32_bf16 v[200:203], v[208:211], v[72:75], v[200:203]
    v_exp_f32 v58, v58
    v_mfma_f32_16x16x32_bf16 v[204:207], v[208:211], v[76:79], v[204:207]
    buffer_load_dwordx4 a[220:223], v248, s[32:35], s56 offen offset:3072 sc1
    v_mfma_f32_16x16x32_bf16 a[64:67], a[240:243], v[64:67], a[64:67]
    v_exp_f32 v59, v59
    v_mfma_f32_16x16x32_bf16 a[68:71], a[240:243], v[68:71], a[68:71]
    v_cvt_pk_bf16_f32 v93, v58, v59
    v_mfma_f32_16x16x32_bf16 a[72:75], a[240:243], v[72:75], a[72:75]
    v_exp_f32 v36, v36
    v_mfma_f32_16x16x32_bf16 a[76:79], a[240:243], v[76:79], a[76:79]
    v_min_u32 v231, 7, v249
    v_lshlrev_b32 v231, 2, v231
    buffer_load_dword v230, v231, s[32:35], s95 offen offset:128 sc1
    v_mfma_f32_16x16x32_bf16 a[80:83], a[244:247], v[64:67], a[80:83]
    v_exp_f32 v37, v37
    v_mfma_f32_16x16x32_bf16 a[84:87], a[244:247], v[68:71], a[84:87]
    ds_read_b128 a[224:227], v232 offset:8192
    v_cvt_pk_bf16_f32 v82, v36, v37
    v_mfma_f32_16x16x32_bf16 a[88:91], a[244:247], v[72:75], a[88:91]
    v_exp_f32 v38, v38
    v_mfma_f32_16x16x32_bf16 a[92:95], a[244:247], v[76:79], a[92:95]
    v_mfma_f32_16x16x32_bf16 a[96:99], a[248:251], v[64:67], a[96:99]
    v_exp_f32 v39, v39
    v_mfma_f32_16x16x32_bf16 a[100:103], a[248:251], v[68:71], a[100:103]
    ds_read_b128 a[228:231], v232 offset:9216
    v_cvt_pk_bf16_f32 v83, v38, v39
    v_mfma_f32_16x16x32_bf16 a[104:107], a[248:251], v[72:75], a[104:107]
    v_exp_f32 v44, v44
    v_mfma_f32_16x16x32_bf16 a[108:111], a[248:251], v[76:79], a[108:111]
    v_mfma_f32_16x16x32_bf16 a[112:115], a[252:255], v[64:67], a[112:115]
    v_exp_f32 v45, v45
    v_mfma_f32_16x16x32_bf16 a[116:119], a[252:255], v[68:71], a[116:119]
    v_cvt_pk_bf16_f32 v86, v44, v45
    v_mfma_f32_16x16x32_bf16 a[120:123], a[252:255], v[72:75], a[120:123]
    v_exp_f32 v46, v46
    v_mfma_f32_16x16x32_bf16 a[124:127], a[252:255], v[76:79], a[124:127]
    s_branch F_drain
.p2align 6
F_X0:
    s_waitcnt lgkmcnt(2)
    v_mfma_f32_16x16x32_bf16 v[32:35], a[192:195], v[128:131], v[96:99]
    v_exp_f32 v15, v15
    v_mfma_f32_16x16x32_bf16 v[32:35], a[196:199], v[132:135], v[32:35]
    ds_read_b128 a[232:235], v232 offset:10240
    v_cvt_pk_bf16_f32 v71, v14, v15
    v_mfma_f32_16x16x32_bf16 v[32:35], a[200:203], v[136:139], v[32:35]
    v_exp_f32 v20, v20
    v_mfma_f32_16x16x32_bf16 v[32:35], a[204:207], v[140:143], v[32:35]
    s_add_u32 m0, s66, 0x10000
    ds_read_b128 a[236:239], v232 offset:11264
    v_mfma_f32_16x16x32_bf16 v[40:43], a[192:195], v[144:147], v[100:103]
    v_exp_f32 v21, v21
    v_mfma_f32_16x16x32_bf16 v[40:43], a[196:199], v[148:151], v[40:43]
    ds_read_b128 a[240:243], v232 offset:12288
    v_cvt_pk_bf16_f32 v74, v20, v21
    v_mfma_f32_16x16x32_bf16 v[40:43], a[200:203], v[152:155], v[40:43]
    v_exp_f32 v22, v22
    v_mfma_f32_16x16x32_bf16 v[40:43], a[204:207], v[156:159], v[40:43]
    buffer_load_dwordx4 v248, s[40:43], s65 offen offset:0 sc1 lds
    v_mfma_f32_16x16x32_bf16 v[48:51], a[192:195], v[160:163], v[104:107]
    v_exp_f32 v23, v23
    v_mfma_f32_16x16x32_bf16 v[48:51], a[196:199], v[164:167], v[48:51]
    ds_read_b128 a[244:247], v232 offset:13312
    v_cvt_pk_bf16_f32 v75, v22, v23
    v_mfma_f32_16x16x32_bf16 v[48:51], a[200:203], v[168:171], v[48:51]
    v_exp_f32 v28, v28
    v_mfma_f32_16x16x32_bf16 v[48:51], a[204:207], v[172:175], v[48:51]
    buffer_load_dwordx4 v248, s[40:43], s65 offen offset:1024 sc1 lds
    v_mfma_f32_16x16x32_bf16 v[56:59], a[192:195], v[176:179], v[108:111]
    v_exp_f32 v29, v29
    v_mfma_f32_16x16x32_bf16 v[56:59], a[196:199], v[180:183], v[56:59]
    ds_read_b128 a[248:251], v232 offset:14336
    v_cvt_pk_bf16_f32 v78, v28, v29
    v_mfma_f32_16x16x32_bf16 v[56:59], a[200:203], v[184:187], v[56:59]
    v_exp_f32 v30, v30
    v_mfma_f32_16x16x32_bf16 v[56:59], a[204:207], v[188:191], v[56:59]
    buffer_load_dwordx4 v248, s[40:43], s65 offen offset:2048 sc1 lds
    v_mfma_f32_16x16x32_bf16 v[36:39], a[208:211], v[128:131], v[112:115]
    v_exp_f32 v31, v31
    v_mfma_f32_16x16x32_bf16 v[36:39], a[212:215], v[132:135], v[36:39]
    ds_read_b128 a[252:255], v232 offset:15360
    v_cvt_pk_bf16_f32 v79, v30, v31
    v_mfma_f32_16x16x32_bf16 v[36:39], a[216:219], v[136:139], v[36:39]
    s_add_u32 s67, s67, 0x4000
    v_add_f32 v96, v212, v216
    v_add_f32 v97, v212, v217
    v_mfma_f32_16x16x32_bf16 v[36:39], a[220:223], v[140:143], v[36:39]
    buffer_load_dwordx4 v248, s[40:43], s65 offen offset:3072 sc1 lds
    v_add_f32 v98, v212, v218
    v_mfma_f32_16x16x32_bf16 v[44:47], a[208:211], v[144:147], v[116:119]
    s_sub_u32 s65, s65, 8192
    v_add_f32 v99, v212, v219
    v_mfma_f32_16x16x32_bf16 v[44:47], a[212:215], v[148:151], v[44:47]
    v_bfi_b32 v232, v233, s67, v232
    v_mfma_f32_16x16x32_bf16 v[44:47], a[216:219], v[152:155], v[44:47]
    v_exp_f32 v32, v32
    v_mfma_f32_16x16x32_bf16 v[44:47], a[220:223], v[156:159], v[44:47]
    s_mov_b32 m0, s66
    v_mfma_f32_16x16x32_bf16 v[52:55], a[208:211], v[160:163], v[120:123]
    v_exp_f32 v33, v33
    v_mfma_f32_16x16x32_bf16 v[52:55], a[212:215], v[164:167], v[52:55]
    v_cvt_pk_bf16_f32 v80, v32, v33
    v_mfma_f32_16x16x32_bf16 v[52:55], a[216:219], v[168:171], v[52:55]
    v_exp_f32 v34, v34
    v_mfma_f32_16x16x32_bf16 v[52:55], a[220:223], v[172:175], v[52:55]
    v_mfma_f32_16x16x32_bf16 v[60:63], a[208:211], v[176:179], v[124:127]
    v_exp_f32 v35, v35
    v_mfma_f32_16x16x32_bf16 v[60:63], a[212:215], v[180:183], v[60:63]
    v_cvt_pk_bf16_f32 v81, v34, v35
    v_mfma_f32_16x16x32_bf16 v[60:63], a[216:219], v[184:187], v[60:63]
    v_exp_f32 v40, v40
    v_mfma_f32_16x16x32_bf16 v[60:63], a[220:223], v[188:191], v[60:63]
    s_waitcnt vmcnt(16) lgkmcnt(0)
    s_barrier
    v_mfma_f32_16x16x32_bf16 a[0:3], a[224:227], v[64:67], a[0:3]
    v_exp_f32 v41, v41
    v_mfma_f32_16x16x32_bf16 a[4:7], a[224:227], v[68:71], a[4:7]
    ds_read_b128 a[192:195], v232 offset:0
    v_cvt_pk_bf16_f32 v84, v40, v41
    v_mfma_f32_16x16x32_bf16 a[8:11], a[224:227], v[72:75], a[8:11]
    v_exp_f32 v42, v42
    v_mfma_f32_16x16x32_bf16 a[12:15], a[224:227], v[76:79], a[12:15]
    ds_read_b128 a[196:199], v232 offset:1024
    v_mov_b32 v112, 0xf149f2ca
    v_mfma_f32_16x16x32_bf16 a[16:19], a[228:231], v[64:67], a[16:19]
    v_exp_f32 v43, v43
    v_mfma_f32_16x16x32_bf16 a[20:23], a[228:231], v[68:71], a[20:23]
    ds_read_b128 a[200:203], v232 offset:2048
    v_cvt_pk_bf16_f32 v85, v42, v43
    v_mfma_f32_16x16x32_bf16 a[24:27], a[228:231], v[72:75], a[24:27]
    v_exp_f32 v48, v48
    v_mfma_f32_16x16x32_bf16 a[28:31], a[228:231], v[76:79], a[28:31]
    ds_read_b128 a[204:207], v232 offset:3072
    v_mov_b32 v113, 0xf149f2ca
    v_mfma_f32_16x16x32_bf16 a[32:35], a[232:235], v[64:67], a[32:35]
    v_exp_f32 v49, v49
    v_mfma_f32_16x16x32_bf16 a[36:39], a[232:235], v[68:71], a[36:39]
    ds_read_b128 a[208:211], v232 offset:4096
    v_cvt_pk_bf16_f32 v88, v48, v49
    v_mfma_f32_16x16x32_bf16 a[40:43], a[232:235], v[72:75], a[40:43]
    v_exp_f32 v50, v50
    v_mfma_f32_16x16x32_bf16 a[44:47], a[232:235], v[76:79], a[44:47]
    buffer_load_dwordx4 v248, s[40:43], s64 offen offset:0 sc1 lds
    v_mov_b32 v114, 0xf149f2ca
    v_mfma_f32_16x16x32_bf16 a[48:51], a[236:239], v[64:67], a[48:51]
    v_exp_f32 v51, v51
    v_mfma_f32_16x16x32_bf16 a[52:55], a[236:239], v[68:71], a[52:55]
    ds_read_b128 a[212:215], v232 offset:5120
    v_cvt_pk_bf16_f32 v89, v50, v51
    v_mfma_f32_16x16x32_bf16 a[56:59], a[236:239], v[72:75], a[56:59]
    v_exp_f32 v56, v56
    v_mfma_f32_16x16x32_bf16 a[60:63], a[236:239], v[76:79], a[60:63]
    buffer_load_dwordx4 v248, s[40:43], s64 offen offset:1024 sc1 lds
    v_mov_b32 v115, 0xf149f2ca
    v_mfma_f32_16x16x32_bf16 v[192:195], v[208:211], v[64:67], v[192:195]
    v_exp_f32 v57, v57
    v_mfma_f32_16x16x32_bf16 v[196:199], v[208:211], v[68:71], v[196:199]
    ds_read_b128 a[216:219], v232 offset:6144
    v_cvt_pk_bf16_f32 v92, v56, v57
    v_mfma_f32_16x16x32_bf16 v[200:203], v[208:211], v[72:75], v[200:203]
    v_exp_f32 v58, v58
    v_mfma_f32_16x16x32_bf16 v[204:207], v[208:211], v[76:79], v[204:207]
    buffer_load_dwordx4 v248, s[40:43], s64 offen offset:2048 sc1 lds
    v_add_f32 v116, v213, v216
    v_mfma_f32_16x16x32_bf16 a[64:67], a[240:243], v[64:67], a[64:67]
    v_exp_f32 v59, v59
    v_mfma_f32_16x16x32_bf16 a[68:71], a[240:243], v[68:71], a[68:71]
    ds_read_b128 a[220:223], v232 offset:7168
    v_cvt_pk_bf16_f32 v93, v58, v59
    v_mfma_f32_16x16x32_bf16 a[72:75], a[240:243], v[72:75], a[72:75]
    v_exp_f32 v36, v36
    v_mfma_f32_16x16x32_bf16 a[76:79], a[240:243], v[76:79], a[76:79]
    buffer_load_dwordx4 v248, s[40:43], s64 offen offset:3072 sc1 lds
    v_add_f32 v117, v213, v217
    v_mfma_f32_16x16x32_bf16 a[80:83], a[244:247], v[64:67], a[80:83]
    v_exp_f32 v37, v37
    v_mfma_f32_16x16x32_bf16 a[84:87], a[244:247], v[68:71], a[84:87]
    ds_read_b128 a[224:227], v232 offset:8192
    v_cvt_pk_bf16_f32 v82, v36, v37
    v_mfma_f32_16x16x32_bf16 a[88:91], a[244:247], v[72:75], a[88:91]
    s_add_u32 s64, s64, 8192
    v_exp_f32 v38, v38
    v_mfma_f32_16x16x32_bf16 a[92:95], a[244:247], v[76:79], a[92:95]
    s_add_u32 s66, s66, 0x4000
    v_add_f32 v118, v213, v218
    v_add_f32 v119, v213, v219
    v_mfma_f32_16x16x32_bf16 a[96:99], a[248:251], v[64:67], a[96:99]
    s_and_b32 s66, s66, 0xffff
    v_exp_f32 v39, v39
    v_mfma_f32_16x16x32_bf16 a[100:103], a[248:251], v[68:71], a[100:103]
    ds_read_b128 a[228:231], v232 offset:9216
    v_cvt_pk_bf16_f32 v83, v38, v39
    v_mfma_f32_16x16x32_bf16 a[104:107], a[248:251], v[72:75], a[104:107]
    v_exp_f32 v44, v44
    v_mfma_f32_16x16x32_bf16 a[108:111], a[248:251], v[76:79], a[108:111]
    v_mfma_f32_16x16x32_bf16 a[112:115], a[252:255], v[64:67], a[112:115]
    v_exp_f32 v45, v45
    v_mfma_f32_16x16x32_bf16 a[116:119], a[252:255], v[68:71], a[116:119]
    v_cvt_pk_bf16_f32 v86, v44, v45
    v_mfma_f32_16x16x32_bf16 a[120:123], a[252:255], v[72:75], a[120:123]
    v_exp_f32 v46, v46
    v_mfma_f32_16x16x32_bf16 a[124:127], a[252:255], v[76:79], a[124:127]
    s_waitcnt lgkmcnt(2)
    v_mfma_f32_16x16x32_bf16 v[0:3], a[192:195], v[128:131], v[96:99]
    v_exp_f32 v47, v47
    v_mfma_f32_16x16x32_bf16 v[0:3], a[196:199], v[132:135], v[0:3]
    ds_read_b128 a[232:235], v232 offset:10240
    v_cvt_pk_bf16_f32 v87, v46, v47
    v_mfma_f32_16x16x32_bf16 v[0:3], a[200:203], v[136:139], v[0:3]
    v_exp_f32 v52, v52
    v_mfma_f32_16x16x32_bf16 v[0:3], a[204:207], v[140:143], v[0:3]
    s_add_u32 m0, s66, 0x10000
    ds_read_b128 a[236:239], v232 offset:11264
    v_mfma_f32_16x16x32_bf16 v[8:11], a[192:195], v[144:147], v[100:103]
    v_exp_f32 v53, v53
    v_mfma_f32_16x16x32_bf16 v[8:11], a[196:199], v[148:151], v[8:11]
    ds_read_b128 a[240:243], v232 offset:12288
    v_cvt_pk_bf16_f32 v90, v52, v53
    v_mfma_f32_16x16x32_bf16 v[8:11], a[200:203], v[152:155], v[8:11]
    v_exp_f32 v54, v54
    v_mfma_f32_16x16x32_bf16 v[8:11], a[204:207], v[156:159], v[8:11]
    buffer_load_dwordx4 v248, s[40:43], s65 offen offset:0 sc1 lds
    v_mfma_f32_16x16x32_bf16 v[16:19], a[192:195], v[160:163], v[104:107]
    v_exp_f32 v55, v55
    v_mfma_f32_16x16x32_bf16 v[16:19], a[196:199], v[164:167], v[16:19]
    ds_read_b128 a[244:247], v232 offset:13312
    v_cvt_pk_bf16_f32 v91, v54, v55
    v_mfma_f32_16x16x32_bf16 v[16:19], a[200:203], v[168:171], v[16:19]
    v_exp_f32 v60, v60
    v_mfma_f32_16x16x32_bf16 v[16:19], a[204:207], v[172:175], v[16:19]
    buffer_load_dwordx4 v248, s[40:43], s65 offen offset:1024 sc1 lds
    v_mfma_f32_16x16x32_bf16 v[24:27], a[192:195], v[176:179], v[108:111]
    v_exp_f32 v61, v61
    v_mfma_f32_16x16x32_bf16 v[24:27], a[196:199], v[180:183], v[24:27]
    ds_read_b128 a[248:251], v232 offset:14336
    v_cvt_pk_bf16_f32 v94, v60, v61
    v_mfma_f32_16x16x32_bf16 v[24:27], a[200:203], v[184:187], v[24:27]
    v_exp_f32 v62, v62
    v_mfma_f32_16x16x32_bf16 v[24:27], a[204:207], v[188:191], v[24:27]
    buffer_load_dwordx4 v248, s[40:43], s65 offen offset:2048 sc1 lds
    v_mfma_f32_16x16x32_bf16 v[4:7], a[208:211], v[128:131], v[112:115]
    v_exp_f32 v63, v63
    v_mfma_f32_16x16x32_bf16 v[4:7], a[212:215], v[132:135], v[4:7]
    ds_read_b128 a[252:255], v232 offset:15360
    v_cvt_pk_bf16_f32 v95, v62, v63
    v_mfma_f32_16x16x32_bf16 v[4:7], a[216:219], v[136:139], v[4:7]
    s_add_u32 s67, s67, 0x4000
    v_mov_b32 v96, 0xf149f2ca
    v_mov_b32 v97, 0xf149f2ca
    v_mfma_f32_16x16x32_bf16 v[4:7], a[220:223], v[140:143], v[4:7]
    buffer_load_dwordx4 v248, s[40:43], s65 offen offset:3072 sc1 lds
    v_mov_b32 v98, 0xf149f2ca
    v_mfma_f32_16x16x32_bf16 v[12:15], a[208:211], v[144:147], v[116:119]
    s_sub_u32 s65, s65, 8192
    v_mov_b32 v99, 0xf149f2ca
    v_mov_b32 v100, 0xf149f2ca
    v_mfma_f32_16x16x32_bf16 v[12:15], a[212:215], v[148:151], v[12:15]
    v_bfi_b32 v232, v233, s67, v232
    v_mov_b32 v101, 0xf149f2ca
    v_mfma_f32_16x16x32_bf16 v[12:15], a[216:219], v[152:155], v[12:15]
    v_exp_f32 v0, v0
    v_mfma_f32_16x16x32_bf16 v[12:15], a[220:223], v[156:159], v[12:15]
    s_mov_b32 m0, s66
    v_mov_b32 v102, 0xf149f2ca
    v_mov_b32 v103, 0xf149f2ca
    v_mfma_f32_16x16x32_bf16 v[20:23], a[208:211], v[160:163], v[120:123]
    v_exp_f32 v1, v1
    v_mfma_f32_16x16x32_bf16 v[20:23], a[212:215], v[164:167], v[20:23]
    v_cvt_pk_bf16_f32 v64, v0, v1
    v_add_f32 v104, v214, v216
    v_mfma_f32_16x16x32_bf16 v[20:23], a[216:219], v[168:171], v[20:23]
    v_exp_f32 v2, v2
    v_mfma_f32_16x16x32_bf16 v[20:23], a[220:223], v[172:175], v[20:23]
    v_add_f32 v105, v214, v217
    v_add_f32 v106, v214, v218
    v_mfma_f32_16x16x32_bf16 v[28:31], a[208:211], v[176:179], v[124:127]
    v_exp_f32 v3, v3
    v_mfma_f32_16x16x32_bf16 v[28:31], a[212:215], v[180:183], v[28:31]
    v_cvt_pk_bf16_f32 v65, v2, v3
    v_add_f32 v107, v214, v219
    v_mfma_f32_16x16x32_bf16 v[28:31], a[216:219], v[184:187], v[28:31]
    v_exp_f32 v8, v8
    v_mfma_f32_16x16x32_bf16 v[28:31], a[220:223], v[188:191], v[28:31]
    s_waitcnt vmcnt(16) lgkmcnt(0)
    s_barrier
    v_mfma_f32_16x16x32_bf16 a[0:3], a[224:227], v[80:83], a[0:3]
    v_exp_f32 v9, v9
    v_mfma_f32_16x16x32_bf16 a[4:7], a[224:227], v[84:87], a[4:7]
    ds_read_b128 a[192:195], v232 offset:0
    v_cvt_pk_bf16_f32 v68, v8, v9
    v_mfma_f32_16x16x32_bf16 a[8:11], a[224:227], v[88:91], a[8:11]
    v_exp_f32 v10, v10
    v_mfma_f32_16x16x32_bf16 a[12:15], a[224:227], v[92:95], a[12:15]
    ds_read_b128 a[196:199], v232 offset:1024
    v_mov_b32 v116, 0xf149f2ca
    v_mfma_f32_16x16x32_bf16 a[16:19], a[228:231], v[80:83], a[16:19]
    v_exp_f32 v11, v11
    v_mfma_f32_16x16x32_bf16 a[20:23], a[228:231], v[84:87], a[20:23]
    ds_read_b128 a[200:203], v232 offset:2048
    v_cvt_pk_bf16_f32 v69, v10, v11
    v_mfma_f32_16x16x32_bf16 a[24:27], a[228:231], v[88:91], a[24:27]
    v_exp_f32 v16, v16
    v_mfma_f32_16x16x32_bf16 a[28:31], a[228:231], v[92:95], a[28:31]
    ds_read_b128 a[204:207], v232 offset:3072
    v_mov_b32 v117, 0xf149f2ca
    v_mfma_f32_16x16x32_bf16 a[32:35], a[232:235], v[80:83], a[32:35]
    v_exp_f32 v17, v17
    v_mfma_f32_16x16x32_bf16 a[36:39], a[232:235], v[84:87], a[36:39]
    ds_read_b128 a[208:211], v232 offset:4096
    v_cvt_pk_bf16_f32 v72, v16, v17
    v_mfma_f32_16x16x32_bf16 a[40:43], a[232:235], v[88:91], a[40:43]
    v_exp_f32 v18, v18
    v_mfma_f32_16x16x32_bf16 a[44:47], a[232:235], v[92:95], a[44:47]
    buffer_load_dwordx4 v248, s[40:43], s64 offen offset:0 sc1 lds
    v_mov_b32 v118, 0xf149f2ca
    v_mfma_f32_16x16x32_bf16 a[48:51], a[236:239], v[80:83], a[48:51]
    v_exp_f32 v19, v19
    v_mfma_f32_16x16x32_bf16 a[52:55], a[236:239], v[84:87], a[52:55]
    ds_read_b128 a[212:215], v232 offset:5120
    v_cvt_pk_bf16_f32 v73, v18, v19
    v_mfma_f32_16x16x32_bf16 a[56:59], a[236:239], v[88:91], a[56:59]
    v_exp_f32 v24, v24
    v_mfma_f32_16x16x32_bf16 a[60:63], a[236:239], v[92:95], a[60:63]
    buffer_load_dwordx4 v248, s[40:43], s64 offen offset:1024 sc1 lds
    v_mov_b32 v119, 0xf149f2ca
    v_mfma_f32_16x16x32_bf16 v[192:195], v[208:211], v[80:83], v[192:195]
    v_exp_f32 v25, v25
    v_mfma_f32_16x16x32_bf16 v[196:199], v[208:211], v[84:87], v[196:199]
    ds_read_b128 a[216:219], v232 offset:6144
    v_cvt_pk_bf16_f32 v76, v24, v25
    v_mfma_f32_16x16x32_bf16 v[200:203], v[208:211], v[88:91], v[200:203]
    v_exp_f32 v26, v26
    v_mfma_f32_16x16x32_bf16 v[204:207], v[208:211], v[92:95], v[204:207]
    buffer_load_dwordx4 v248, s[40:43], s64 offen offset:2048 sc1 lds
    v_mov_b32 v120, 0xf149f2ca
    v_mfma_f32_16x16x32_bf16 a[64:67], a[240:243], v[80:83], a[64:67]
    v_exp_f32 v27, v27
    v_mfma_f32_16x16x32_bf16 a[68:71], a[240:243], v[84:87], a[68:71]
    ds_read_b128 a[220:223], v232 offset:7168
    v_cvt_pk_bf16_f32 v77, v26, v27
    v_mfma_f32_16x16x32_bf16 a[72:75], a[240:243], v[88:91], a[72:75]
    v_exp_f32 v4, v4
    v_mfma_f32_16x16x32_bf16 a[76:79], a[240:243], v[92:95], a[76:79]
    buffer_load_dwordx4 v248, s[40:43], s64 offen offset:3072 sc1 lds
    v_mov_b32 v121, 0xf149f2ca
    v_mfma_f32_16x16x32_bf16 a[80:83], a[244:247], v[80:83], a[80:83]
    v_exp_f32 v5, v5
    v_mfma_f32_16x16x32_bf16 a[84:87], a[244:247], v[84:87], a[84:87]
    ds_read_b128 a[224:227], v232 offset:8192
    v_cvt_pk_bf16_f32 v66, v4, v5
    v_mfma_f32_16x16x32_bf16 a[88:91], a[244:247], v[88:91], a[88:91]
    s_add_u32 s64, s64, 8192
    v_exp_f32 v6, v6
    v_mfma_f32_16x16x32_bf16 a[92:95], a[244:247], v[92:95], a[92:95]
    s_add_u32 s66, s66, 0x4000
    v_mov_b32 v122, 0xf149f2ca
    v_mov_b32 v123, 0xf149f2ca
    v_mfma_f32_16x16x32_bf16 a[96:99], a[248:251], v[80:83], a[96:99]
    s_and_b32 s66, s66, 0xffff
    v_exp_f32 v7, v7
    v_mfma_f32_16x16x32_bf16 a[100:103], a[248:251], v[84:87], a[100:103]
    ds_read_b128 a[228:231], v232 offset:9216
    v_cvt_pk_bf16_f32 v67, v6, v7
    v_mfma_f32_16x16x32_bf16 a[104:107], a[248:251], v[88:91], a[104:107]
    v_exp_f32 v12, v12
    v_mfma_f32_16x16x32_bf16 a[108:111], a[248:251], v[92:95], a[108:111]
    v_add_f32 v124, v215, v216
    v_add_f32 v125, v215, v217
    v_mfma_f32_16x16x32_bf16 a[112:115], a[252:255], v[80:83], a[112:115]
    v_exp_f32 v13, v13
    v_mfma_f32_16x16x32_bf16 a[116:119], a[252:255], v[84:87], a[116:119]
    v_cvt_pk_bf16_f32 v70, v12, v13
    v_add_f32 v126, v215, v218
    v_mfma_f32_16x16x32_bf16 a[120:123], a[252:255], v[88:91], a[120:123]
    v_exp_f32 v14, v14
    v_mfma_f32_16x16x32_bf16 a[124:127], a[252:255], v[92:95], a[124:127]
    v_add_f32 v127, v215, v219
    s_nop 0
F_X2:
    s_waitcnt lgkmcnt(2)
    v_mfma_f32_16x16x32_bf16 v[32:35], a[192:195], v[128:131], v[96:99]
    v_exp_f32 v15, v15
    v_mfma_f32_16x16x32_bf16 v[32:35], a[196:199], v[132:135], v[32:35]
    ds_read_b128 a[232:235], v232 offset:10240
    v_cvt_pk_bf16_f32 v71, v14, v15
    v_mfma_f32_16x16x32_bf16 v[32:35], a[200:203], v[136:139], v[32:35]
    v_exp_f32 v20, v20
    v_mfma_f32_16x16x32_bf16 v[32:35], a[204:207], v[140:143], v[32:35]
    s_add_u32 m0, s66, 0x10000
    ds_read_b128 a[236:239], v232 offset:11264
    v_mfma_f32_16x16x32_bf16 v[40:43], a[192:195], v[144:147], v[100:103]
    v_exp_f32 v21, v21
    v_mfma_f32_16x16x32_bf16 v[40:43], a[196:199], v[148:151], v[40:43]
    ds_read_b128 a[240:243], v232 offset:12288
    v_cvt_pk_bf16_f32 v74, v20, v21
    v_mfma_f32_16x16x32_bf16 v[40:43], a[200:203], v[152:155], v[40:43]
    v_exp_f32 v22, v22
    v_mfma_f32_16x16x32_bf16 v[40:43], a[204:207], v[156:159], v[40:43]
    buffer_load_dwordx4 v248, s[40:43], s65 offen offset:0 sc1 lds
    v_mfma_f32_16x16x32_bf16 v[48:51], a[192:195], v[160:163], v[104:107]
    v_exp_f32 v23, v23
    v_mfma_f32_16x16x32_bf16 v[48:51], a[196:199], v[164:167], v[48:51]
    ds_read_b128 a[244:247], v232 offset:13312
    v_cvt_pk_bf16_f32 v75, v22, v23
    v_mfma_f32_16x16x32_bf16 v[48:51], a[200:203], v[168:171], v[48:51]
    v_exp_f32 v28, v28
    v_mfma_f32_16x16x32_bf16 v[48:51], a[204:207], v[172:175], v[48:51]
    buffer_load_dwordx4 v248, s[40:43], s65 offen offset:1024 sc1 lds
    v_mfma_f32_16x16x32_bf16 v[56:59], a[192:195], v[176:179], v[108:111]
    v_exp_f32 v29, v29
    v_mfma_f32_16x16x32_bf16 v[56:59], a[196:199], v[180:183], v[56:59]
    ds_read_b128 a[248:251], v232 offset:14336
    v_cvt_pk_bf16_f32 v78, v28, v29
    v_mfma_f32_16x16x32_bf16 v[56:59], a[200:203], v[184:187], v[56:59]
    v_exp_f32 v30, v30
    v_mfma_f32_16x16x32_bf16 v[56:59], a[204:207], v[188:191], v[56:59]
    buffer_load_dwordx4 v248, s[40:43], s65 offen offset:2048 sc1 lds
    v_mfma_f32_16x16x32_bf16 v[36:39], a[208:211], v[128:131], v[112:115]
    v_exp_f32 v31, v31
    v_mfma_f32_16x16x32_bf16 v[36:39], a[212:215], v[132:135], v[36:39]
    ds_read_b128 a[252:255], v232 offset:15360
    v_cvt_pk_bf16_f32 v79, v30, v31
    v_mfma_f32_16x16x32_bf16 v[36:39], a[216:219], v[136:139], v[36:39]
    s_add_u32 s67, s67, 0x4000
    v_mfma_f32_16x16x32_bf16 v[36:39], a[220:223], v[140:143], v[36:39]
    buffer_load_dwordx4 v248, s[40:43], s65 offen offset:3072 sc1 lds
    v_mfma_f32_16x16x32_bf16 v[44:47], a[208:211], v[144:147], v[116:119]
    s_sub_u32 s65, s65, 8192
    v_mfma_f32_16x16x32_bf16 v[44:47], a[212:215], v[148:151], v[44:47]
    v_bfi_b32 v232, v233, s67, v232
    v_mfma_f32_16x16x32_bf16 v[44:47], a[216:219], v[152:155], v[44:47]
    v_exp_f32 v32, v32
    v_mfma_f32_16x16x32_bf16 v[44:47], a[220:223], v[156:159], v[44:47]
    s_mov_b32 m0, s66
    v_mfma_f32_16x16x32_bf16 v[52:55], a[208:211], v[160:163], v[120:123]
    v_exp_f32 v33, v33
    v_mfma_f32_16x16x32_bf16 v[52:55], a[212:215], v[164:167], v[52:55]
    v_cvt_pk_bf16_f32 v80, v32, v33
    v_mfma_f32_16x16x32_bf16 v[52:55], a[216:219], v[168:171], v[52:55]
    v_exp_f32 v34, v34
    v_mfma_f32_16x16x32_bf16 v[52:55], a[220:223], v[172:175], v[52:55]
    v_mfma_f32_16x16x32_bf16 v[60:63], a[208:211], v[176:179], v[124:127]
    v_exp_f32 v35, v35
    v_mfma_f32_16x16x32_bf16 v[60:63], a[212:215], v[180:183], v[60:63]
    v_cvt_pk_bf16_f32 v81, v34, v35
    v_mfma_f32_16x16x32_bf16 v[60:63], a[216:219], v[184:187], v[60:63]
    v_exp_f32 v40, v40
    v_mfma_f32_16x16x32_bf16 v[60:63], a[220:223], v[188:191], v[60:63]
    s_waitcnt vmcnt(16) lgkmcnt(0)
    s_barrier
    v_mfma_f32_16x16x32_bf16 a[0:3], a[224:227], v[64:67], a[0:3]
    v_exp_f32 v41, v41
    v_mfma_f32_16x16x32_bf16 a[4:7], a[224:227], v[68:71], a[4:7]
    ds_read_b128 a[192:195], v232 offset:0
    v_cvt_pk_bf16_f32 v84, v40, v41
    v_mfma_f32_16x16x32_bf16 a[8:11], a[224:227], v[72:75], a[8:11]
    v_exp_f32 v42, v42
    v_mfma_f32_16x16x32_bf16 a[12:15], a[224:227], v[76:79], a[12:15]
    ds_read_b128 a[196:199], v232 offset:1024
    buffer_load_dwordx4 v[220:223], v248, s[32:35], s98 offen sc1
    v_mfma_f32_16x16x32_bf16 a[16:19], a[228:231], v[64:67], a[16:19]
    v_exp_f32 v43, v43
    v_mfma_f32_16x16x32_bf16 a[20:23], a[228:231], v[68:71], a[20:23]
    ds_read_b128 a[200:203], v232 offset:2048
    v_cvt_pk_bf16_f32 v85, v42, v43
    v_mfma_f32_16x16x32_bf16 a[24:27], a[228:231], v[72:75], a[24:27]
    v_exp_f32 v48, v48
    v_mfma_f32_16x16x32_bf16 a[28:31], a[228:231], v[76:79], a[28:31]
    ds_read_b128 a[204:207], v232 offset:3072
    v_mfma_f32_16x16x32_bf16 a[32:35], a[232:235], v[64:67], a[32:35]
    v_exp_f32 v49, v49
    v_mfma_f32_16x16x32_bf16 a[36:39], a[232:235], v[68:71], a[36:39]
    ds_read_b128 a[208:211], v232 offset:4096
    v_cvt_pk_bf16_f32 v88, v48, v49
    v_mfma_f32_16x16x32_bf16 a[40:43], a[232:235], v[72:75], a[40:43]
    v_exp_f32 v50, v50
    v_mfma_f32_16x16x32_bf16 a[44:47], a[232:235], v[76:79], a[44:47]
    buffer_load_dwordx4 v248, s[40:43], s64 offen offset:0 sc1 lds
    v_mfma_f32_16x16x32_bf16 a[48:51], a[236:239], v[64:67], a[48:51]
    v_exp_f32 v51, v51
    v_mfma_f32_16x16x32_bf16 a[52:55], a[236:239], v[68:71], a[52:55]
    ds_read_b128 a[212:215], v232 offset:5120
    v_cvt_pk_bf16_f32 v89, v50, v51
    v_mfma_f32_16x16x32_bf16 a[56:59], a[236:239], v[72:75], a[56:59]
    v_exp_f32 v56, v56
    v_mfma_f32_16x16x32_bf16 a[60:63], a[236:239], v[76:79], a[60:63]
    buffer_load_dwordx4 v248, s[40:43], s64 offen offset:1024 sc1 lds
    v_mfma_f32_16x16x32_bf16 v[192:195], v[208:211], v[64:67], v[192:195]
    v_exp_f32 v57, v57
    v_mfma_f32_16x16x32_bf16 v[196:199], v[208:211], v[68:71], v[196:199]
    ds_read_b128 a[216:219], v232 offset:6144
    v_cvt_pk_bf16_f32 v92, v56, v57
    v_mfma_f32_16x16x32_bf16 v[200:203], v[208:211], v[72:75], v[200:203]
    v_exp_f32 v58, v58
    v_mfma_f32_16x16x32_bf16 v[204:207], v[208:211], v[76:79], v[204:207]
    buffer_load_dwordx4 v248, s[40:43], s64 offen offset:2048 sc1 lds
    v_mfma_f32_16x16x32_bf16 a[64:67], a[240:243], v[64:67], a[64:67]
    v_exp_f32 v59, v59
    v_mfma_f32_16x16x32_bf16 a[68:71], a[240:243], v[68:71], a[68:71]
    ds_read_b128 a[220:223], v232 offset:7168
    v_cvt_pk_bf16_f32 v93, v58, v59
    v_mfma_f32_16x16x32_bf16 a[72:75], a[240:243], v[72:75], a[72:75]
    v_exp_f32 v36, v36
    v_mfma_f32_16x16x32_bf16 a[76:79], a[240:243], v[76:79], a[76:79]
    buffer_load_dwordx4 v248, s[40:43], s64 offen offset:3072 sc1 lds
    v_mfma_f32_16x16x32_bf16 a[80:83], a[244:247], v[64:67], a[80:83]
    v_exp_f32 v37, v37
    v_mfma_f32_16x16x32_bf16 a[84:87], a[244:247], v[68:71], a[84:87]
    ds_read_b128 a[224:227], v232 offset:8192
    v_cvt_pk_bf16_f32 v82, v36, v37
    v_mfma_f32_16x16x32_bf16 a[88:91], a[244:247], v[72:75], a[88:91]
    s_add_u32 s64, s64, 8192
    v_exp_f32 v38, v38
    v_mfma_f32_16x16x32_bf16 a[92:95], a[244:247], v[76:79], a[92:95]
    s_add_u32 s66, s66, 0x4000
    v_mfma_f32_16x16x32_bf16 a[96:99], a[248:251], v[64:67], a[96:99]
    s_and_b32 s66, s66, 0xffff
    v_exp_f32 v39, v39
    v_mfma_f32_16x16x32_bf16 a[100:103], a[248:251], v[68:71], a[100:103]
    ds_read_b128 a[228:231], v232 offset:9216
    v_cvt_pk_bf16_f32 v83, v38, v39
    v_mfma_f32_16x16x32_bf16 a[104:107], a[248:251], v[72:75], a[104:107]
    v_exp_f32 v44, v44
    v_mfma_f32_16x16x32_bf16 a[108:111], a[248:251], v[76:79], a[108:111]
    v_mfma_f32_16x16x32_bf16 a[112:115], a[252:255], v[64:67], a[112:115]
    v_exp_f32 v45, v45
    v_mfma_f32_16x16x32_bf16 a[116:119], a[252:255], v[68:71], a[116:119]
    v_cvt_pk_bf16_f32 v86, v44, v45
    v_mfma_f32_16x16x32_bf16 a[120:123], a[252:255], v[72:75], a[120:123]
    v_exp_f32 v46, v46
    v_mfma_f32_16x16x32_bf16 a[124:127], a[252:255], v[76:79], a[124:127]
F_drain:
    ds_read_b128 a[232:235], v232 offset:10240
    ds_read_b128 a[236:239], v232 offset:11264
    ds_read_b128 a[240:243], v232 offset:12288
    ds_read_b128 a[244:247], v232 offset:13312
    ds_read_b128 a[248:251], v232 offset:14336
    ds_read_b128 a[252:255], v232 offset:15360
    v_exp_f32 v47, v47
    v_exp_f32 v52, v52
    v_exp_f32 v53, v53
    v_exp_f32 v54, v54
    v_exp_f32 v55, v55
    v_exp_f32 v60, v60
    v_exp_f32 v61, v61
    v_exp_f32 v62, v62
    v_exp_f32 v63, v63
    s_nop 0
    v_cvt_pk_bf16_f32 v87, v46, v47
    v_cvt_pk_bf16_f32 v90, v52, v53
    v_cvt_pk_bf16_f32 v91, v54, v55
    v_cvt_pk_bf16_f32 v94, v60, v61
    v_cvt_pk_bf16_f32 v95, v62, v63
    s_cmp_eq_u32 s75, 34
    s_cbranch_scc1 F_final
    v_mfma_f32_16x16x32_bf16 v[192:195], v[208:211], v[80:83], v[192:195]
    v_mfma_f32_16x16x32_bf16 v[196:199], v[208:211], v[84:87], v[196:199]
    v_mfma_f32_16x16x32_bf16 v[200:203], v[208:211], v[88:91], v[200:203]
    v_mfma_f32_16x16x32_bf16 v[204:207], v[208:211], v[92:95], v[204:207]
    s_add_u32 m0, s66, 0x10000
    s_nop 0
    buffer_load_dwordx4 v248, s[40:43], s65 offen offset:0 sc1 lds
    buffer_load_dwordx4 v248, s[40:43], s65 offen offset:1024 sc1 lds
    buffer_load_dwordx4 v248, s[40:43], s65 offen offset:2048 sc1 lds
    buffer_load_dwordx4 v248, s[40:43], s65 offen offset:3072 sc1 lds
    s_sub_u32 s65, s65, 8192
    s_add_u32 s67, s67, 0x4000
    v_bfi_b32 v232, v233, s67, v232
    v_add_f32 v241, v192, v196
    v_add_f32 v240, v200, v204
    v_add_f32 v240, v240, v241
    v_mov_b32 v241, 0x5d800000
    v_cmp_nlt_f32 vcc, v240, v241
    s_nop 4
    s_cbranch_vccz F_dr_ok
    s_lshl_b32 s96, s62, 1
    s_add_u32 s96, s96, 2
    s_call_b64 s[100:101], F_slow
F_dr_ok:
    v_rcp_f32 v236, v192
    v_rcp_f32 v237, v196
    v_rcp_f32 v238, v200
    v_rcp_f32 v239, v204
    s_sub_u32 s56, 3, s52
    s_lshl_b32 s56, s56, 14
    s_add_u32 s56, s56, 131072
    v_add_u32 v250, s56, v248
    ds_read_b128 v[128:131], v250 offset:0
    ds_read_b128 v[132:135], v250 offset:1024
    ds_read_b128 v[136:139], v250 offset:2048
    ds_read_b128 v[140:143], v250 offset:3072
    ds_read_b128 v[144:147], v250 offset:4096
    ds_read_b128 v[148:151], v250 offset:5120
    ds_read_b128 v[152:155], v250 offset:6144
    ds_read_b128 v[156:159], v250 offset:7168
    ds_read_b128 v[160:163], v250 offset:8192
    ds_read_b128 v[164:167], v250 offset:9216
    ds_read_b128 v[168:171], v250 offset:10240
    ds_read_b128 v[172:175], v250 offset:11264
    ds_read_b128 v[176:179], v250 offset:12288
    ds_read_b128 v[180:183], v250 offset:13312
    ds_read_b128 v[184:187], v250 offset:14336
    ds_read_b128 v[188:191], v250 offset:15360
    v_mov_b32 v192, 0
    v_mov_b32 v193, 0
    v_mov_b32 v194, 0
    v_mov_b32 v195, 0
    v_mov_b32 v196, 0
    v_mov_b32 v197, 0
    v_mov_b32 v198, 0
    v_mov_b32 v199, 0
    v_mov_b32 v200, 0
    v_mov_b32 v201, 0
    v_mov_b32 v202, 0
    v_mov_b32 v203, 0
    v_mov_b32 v204, 0
    v_mov_b32 v205, 0
    v_mov_b32 v206, 0
    v_mov_b32 v207, 0
    s_waitcnt vmcnt(8)
    v_mov_b32 v212, v220
    v_mov_b32 v213, v221
    v_mov_b32 v214, v222
    v_mov_b32 v215, v223
    v_add_f32 v104, v214, v216
    v_add_f32 v105, v214, v217
    v_add_f32 v106, v214, v218
    v_add_f32 v107, v214, v219
    v_mov_b32 v108, v215
    v_mov_b32 v109, v215
    v_mov_b32 v110, v215
    v_mov_b32 v111, v215
    v_add_f32 v124, v215, v216
    v_add_f32 v125, v215, v217
    v_add_f32 v126, v215, v218
    v_add_f32 v127, v215, v219
    s_lshl_b32 s56, s53, 14
    s_add_u32 s56, s56, 0x3200000
    s_mul_i32 s62, s62, 529408
    s_add_u32 s62, s62, s56
    s_waitcnt vmcnt(16) lgkmcnt(0)
    s_barrier
    v_mfma_f32_16x16x32_bf16 a[0:3], a[224:227], v[80:83], a[0:3]
    s_mov_b32 m0, s66
    v_mfma_f32_16x16x32_bf16 a[4:7], a[224:227], v[84:87], a[4:7]
    s_nop 0
    v_mfma_f32_16x16x32_bf16 a[8:11], a[224:227], v[88:91], a[8:11]
    buffer_load_dwordx4 v248, s[40:43], s64 offen offset:0 sc1 lds
    v_mfma_f32_16x16x32_bf16 a[12:15], a[224:227], v[92:95], a[12:15]
    buffer_load_dwordx4 v248, s[40:43], s64 offen offset:1024 sc1 lds
    v_mfma_f32_16x16x32_bf16 a[16:19], a[228:231], v[80:83], a[16:19]
    buffer_load_dwordx4 v248, s[40:43], s64 offen offset:2048 sc1 lds
    v_mfma_f32_16x16x32_bf16 a[20:23], a[228:231], v[84:87], a[20:23]
    buffer_load_dwordx4 v248, s[40:43], s64 offen offset:3072 sc1 lds
    v_mfma_f32_16x16x32_bf16 a[24:27], a[228:231], v[88:91], a[24:27]
    s_add_u32 s64, s64, 8192
    v_mfma_f32_16x16x32_bf16 a[28:31], a[228:231], v[92:95], a[28:31]
    s_add_u32 s66, s66, 0x4000
    v_mfma_f32_16x16x32_bf16 a[32:35], a[232:235], v[80:83], a[32:35]
    s_and_b32 s66, s66, 0xffff
    v_mfma_f32_16x16x32_bf16 a[36:39], a[232:235], v[84:87], a[36:39]
    v_mfma_f32_16x16x32_bf16 a[40:43], a[232:235], v[88:91], a[40:43]
    v_mfma_f32_16x16x32_bf16 a[44:47], a[232:235], v[92:95], a[44:47]
    v_mfma_f32_16x16x32_bf16 a[48:51], a[236:239], v[80:83], a[48:51]
    v_mfma_f32_16x16x32_bf16 a[52:55], a[236:239], v[84:87], a[52:55]
    v_accvgpr_read_b32 v32, a0
    v_accvgpr_read_b32 v33, a1
    v_mfma_f32_16x16x32_bf16 a[56:59], a[236:239], v[88:91], a[56:59]
    v_accvgpr_read_b32 v34, a2
    v_accvgpr_read_b32 v35, a3
    v_mfma_f32_16x16x32_bf16 a[60:63], a[236:239], v[92:95], a[60:63]
    v_accvgpr_read_b32 v36, a16
    v_accvgpr_read_b32 v37, a17
    v_mfma_f32_16x16x32_bf16 a[64:67], a[240:243], v[80:83], a[64:67]
    v_accvgpr_read_b32 v38, a18
    v_accvgpr_read_b32 v39, a19
    v_mfma_f32_16x16x32_bf16 a[68:71], a[240:243], v[84:87], a[68:71]
    v_mul_f32 v32, v32, v236
    v_mul_f32 v33, v33, v236
    v_mfma_f32_16x16x32_bf16 a[72:75], a[240:243], v[88:91], a[72:75]
    v_mul_f32 v34, v34, v236
    v_mul_f32 v35, v35, v236
    v_mfma_f32_16x16x32_bf16 a[76:79], a[240:243], v[92:95], a[76:79]
    v_mul_f32 v36, v36, v236
    v_mul_f32 v37, v37, v236
    v_mfma_f32_16x16x32_bf16 a[80:83], a[244:247], v[80:83], a[80:83]
    v_mul_f32 v38, v38, v236
    v_mul_f32 v39, v39, v236
    v_mfma_f32_16x16x32_bf16 a[84:87], a[244:247], v[84:87], a[84:87]
    v_cvt_pk_bf16_f32 v32, v32, v33
    v_cvt_pk_bf16_f32 v33, v34, v35
    v_mfma_f32_16x16x32_bf16 a[88:91], a[244:247], v[88:91], a[88:91]
    v_cvt_pk_bf16_f32 v34, v36, v37
    v_cvt_pk_bf16_f32 v35, v38, v39
    v_mfma_f32_16x16x32_bf16 a[92:95], a[244:247], v[92:95], a[92:95]
    s_add_u32 s58, s62, 0
    buffer_store_dwordx4 v[32:35], v248, s[32:35], s58 offen offset:0 sc1
    v_accvgpr_read_b32 v40, a4
    v_mfma_f32_16x16x32_bf16 a[96:99], a[248:251], v[80:83], a[96:99]
    v_accvgpr_read_b32 v41, a5
    v_accvgpr_read_b32 v42, a6
    v_mfma_f32_16x16x32_bf16 a[100:103], a[248:251], v[84:87], a[100:103]
    v_accvgpr_read_b32 v43, a7
    v_accvgpr_read_b32 v44, a20
    v_mfma_f32_16x16x32_bf16 a[104:107], a[248:251], v[88:91], a[104:107]
    v_accvgpr_read_b32 v45, a21
    v_accvgpr_read_b32 v46, a22
    v_mfma_f32_16x16x32_bf16 a[108:111], a[248:251], v[92:95], a[108:111]
    v_accvgpr_read_b32 v47, a23
    v_mul_f32 v40, v40, v237
    v_mfma_f32_16x16x32_bf16 a[112:115], a[252:255], v[80:83], a[112:115]
    v_mul_f32 v41, v41, v237
    v_mul_f32 v42, v42, v237
    v_mfma_f32_16x16x32_bf16 a[116:119], a[252:255], v[84:87], a[116:119]
    v_mul_f32 v43, v43, v237
    v_mul_f32 v44, v44, v237
    v_mfma_f32_16x16x32_bf16 a[120:123], a[252:255], v[88:91], a[120:123]
    v_mul_f32 v45, v45, v237
    v_mul_f32 v46, v46, v237
    v_mfma_f32_16x16x32_bf16 a[124:127], a[252:255], v[92:95], a[124:127]
    v_mul_f32 v47, v47, v237
    v_cvt_pk_bf16_f32 v40, v40, v41
    v_cvt_pk_bf16_f32 v41, v42, v43
    v_cvt_pk_bf16_f32 v42, v44, v45
    v_cvt_pk_bf16_f32 v43, v46, v47
    buffer_store_dwordx4 v[40:43], v248, s[32:35], s58 offen offset:1024 sc1
    v_accvgpr_read_b32 v48, a8
    v_accvgpr_read_b32 v49, a9
    v_accvgpr_read_b32 v50, a10
    v_accvgpr_read_b32 v51, a11
    v_accvgpr_read_b32 v52, a24
    v_accvgpr_read_b32 v53, a25
    v_accvgpr_read_b32 v54, a26
    v_accvgpr_read_b32 v55, a27
    v_mul_f32 v48, v48, v238
    v_mul_f32 v49, v49, v238
    v_mul_f32 v50, v50, v238
    v_mul_f32 v51, v51, v238
    v_mul_f32 v52, v52, v238
    v_mul_f32 v53, v53, v238
    v_mul_f32 v54, v54, v238
    v_mul_f32 v55, v55, v238
    v_cvt_pk_bf16_f32 v48, v48, v49
    v_cvt_pk_bf16_f32 v49, v50, v51
    v_cvt_pk_bf16_f32 v50, v52, v53
    v_cvt_pk_bf16_f32 v51, v54, v55
    buffer_store_dwordx4 v[48:51], v248, s[32:35], s58 offen offset:2048 sc1
    v_accvgpr_read_b32 v56, a12
    v_accvgpr_read_b32 v57, a13
    v_accvgpr_read_b32 v58, a14
    v_accvgpr_read_b32 v59, a15
    v_accvgpr_read_b32 v60, a28
    v_accvgpr_read_b32 v61, a29
    v_accvgpr_read_b32 v62, a30
    v_accvgpr_read_b32 v63, a31
    v_mul_f32 v56, v56, v239
    v_mul_f32 v57, v57, v239
    v_mul_f32 v58, v58, v239
    v_mul_f32 v59, v59, v239
    v_mul_f32 v60, v60, v239
    v_mul_f32 v61, v61, v239
    v_mul_f32 v62, v62, v239
    v_mul_f32 v63, v63, v239
    v_cvt_pk_bf16_f32 v56, v56, v57
    v_cvt_pk_bf16_f32 v57, v58, v59
    v_cvt_pk_bf16_f32 v58, v60, v61
    v_cvt_pk_bf16_f32 v59, v62, v63
    buffer_store_dwordx4 v[56:59], v248, s[32:35], s58 offen offset:3072 sc1
    v_accvgpr_read_b32 v32, a32
    v_accvgpr_read_b32 v33, a33
    v_accvgpr_read_b32 v34, a34
    v_accvgpr_read_b32 v35, a35
    v_accvgpr_read_b32 v36, a48
    v_accvgpr_read_b32 v37, a49
    v_accvgpr_read_b32 v38, a50
    v_accvgpr_read_b32 v39, a51
    v_mul_f32 v32, v32, v236
    v_mul_f32 v33, v33, v236
    v_mul_f32 v34, v34, v236
    v_mul_f32 v35, v35, v236
    v_mul_f32 v36, v36, v236
    v_mul_f32 v37, v37, v236
    v_mul_f32 v38, v38, v236
    v_mul_f32 v39, v39, v236
    v_cvt_pk_bf16_f32 v32, v32, v33
    v_cvt_pk_bf16_f32 v33, v34, v35
    v_cvt_pk_bf16_f32 v34, v36, v37
    v_cvt_pk_bf16_f32 v35, v38, v39
    s_add_u32 s58, s62, 4096
    buffer_store_dwordx4 v[32:35], v248, s[32:35], s58 offen offset:0 sc1
    v_accvgpr_read_b32 v40, a36
    v_accvgpr_read_b32 v41, a37
    v_accvgpr_read_b32 v42, a38
    v_accvgpr_read_b32 v43, a39
    v_accvgpr_read_b32 v44, a52
    v_accvgpr_read_b32 v45, a53
    v_accvgpr_read_b32 v46, a54
    v_accvgpr_read_b32 v47, a55
    v_mul_f32 v40, v40, v237
    v_mul_f32 v41, v41, v237
    v_mul_f32 v42, v42, v237
    v_mul_f32 v43, v43, v237
    v_mul_f32 v44, v44, v237
    v_mul_f32 v45, v45, v237
    v_mul_f32 v46, v46, v237
    v_mul_f32 v47, v47, v237
    v_cvt_pk_bf16_f32 v40, v40, v41
    v_cvt_pk_bf16_f32 v41, v42, v43
    v_cvt_pk_bf16_f32 v42, v44, v45
    v_cvt_pk_bf16_f32 v43, v46, v47
    buffer_store_dwordx4 v[40:43], v248, s[32:35], s58 offen offset:1024 sc1
    v_accvgpr_read_b32 v48, a40
    v_accvgpr_read_b32 v49, a41
    v_accvgpr_read_b32 v50, a42
    v_accvgpr_read_b32 v51, a43
    v_accvgpr_read_b32 v52, a56
    v_accvgpr_read_b32 v53, a57
    v_accvgpr_read_b32 v54, a58
    v_accvgpr_read_b32 v55, a59
    v_mul_f32 v48, v48, v238
    v_mul_f32 v49, v49, v238
    v_mul_f32 v50, v50, v238
    v_mul_f32 v51, v51, v238
    v_mul_f32 v52, v52, v238
    v_mul_f32 v53, v53, v238
    v_mul_f32 v54, v54, v238
    v_mul_f32 v55, v55, v238
    v_cvt_pk_bf16_f32 v48, v48, v49
    v_cvt_pk_bf16_f32 v49, v50, v51
    v_cvt_pk_bf16_f32 v50, v52, v53
    v_cvt_pk_bf16_f32 v51, v54, v55
    buffer_store_dwordx4 v[48:51], v248, s[32:35], s58 offen offset:2048 sc1
    s_add_u32 m0, s66, 0x10000
    s_nop 0
    buffer_load_dwordx4 v248, s[40:43], s65 offen offset:0 sc1 lds
    buffer_load_dwordx4 v248, s[40:43], s65 offen offset:1024 sc1 lds
    buffer_load_dwordx4 v248, s[40:43], s65 offen offset:2048 sc1 lds
    buffer_load_dwordx4 v248, s[40:43], s65 offen offset:3072 sc1 lds
    s_sub_u32 s65, s65, 8192
    v_or_b32 v232, 0x10000, v232
    s_add_u32 s67, s67, 0x4000
    s_add_u32 s67, s67, 0x4000
    v_bfi_b32 v232, v233, s67, v232
    s_waitcnt vmcnt(16) lgkmcnt(0)
    s_barrier
    ds_read_b128 a[192:195], v232 offset:0
    ds_read_b128 a[196:199], v232 offset:1024
    ds_read_b128 a[200:203], v232 offset:2048
    ds_read_b128 a[204:207], v232 offset:3072
    ds_read_b128 a[208:211], v232 offset:4096
    ds_read_b128 a[212:215], v232 offset:5120
    ds_read_b128 a[216:219], v232 offset:6144
    ds_read_b128 a[220:223], v232 offset:7168
    s_mov_b32 m0, s66
    s_nop 0
    buffer_load_dwordx4 v248, s[40:43], s64 offen offset:0 sc1 lds
    buffer_load_dwordx4 v248, s[40:43], s64 offen offset:1024 sc1 lds
    buffer_load_dwordx4 v248, s[40:43], s64 offen offset:2048 sc1 lds
    buffer_load_dwordx4 v248, s[40:43], s64 offen offset:3072 sc1 lds
    s_add_u32 s64, s64, 8192
    s_add_u32 s66, s66, 0x4000
    s_and_b32 s66, s66, 0xffff
    v_accvgpr_read_b32 v56, a44
    v_accvgpr_read_b32 v57, a45
    v_accvgpr_read_b32 v58, a46
    v_accvgpr_read_b32 v59, a47
    v_accvgpr_read_b32 v60, a60
    v_accvgpr_read_b32 v61, a61
    v_accvgpr_read_b32 v62, a62
    v_accvgpr_read_b32 v63, a63
    v_mul_f32 v56, v56, v239
    v_mul_f32 v57, v57, v239
    v_mul_f32 v58, v58, v239
    v_mul_f32 v59, v59, v239
    v_mul_f32 v60, v60, v239
    v_mul_f32 v61, v61, v239
    v_mul_f32 v62, v62, v239
    v_mul_f32 v63, v63, v239
    v_cvt_pk_bf16_f32 v56, v56, v57
    v_cvt_pk_bf16_f32 v57, v58, v59
    v_cvt_pk_bf16_f32 v58, v60, v61
    v_cvt_pk_bf16_f32 v59, v62, v63
    buffer_store_dwordx4 v[56:59], v248, s[32:35], s58 offen offset:3072 sc1
    v_accvgpr_read_b32 v32, a64
    v_accvgpr_read_b32 v33, a65
    v_accvgpr_read_b32 v34, a66
    v_accvgpr_read_b32 v35, a67
    v_accvgpr_read_b32 v36, a80
    v_accvgpr_read_b32 v37, a81
    v_accvgpr_read_b32 v38, a82
    v_accvgpr_read_b32 v39, a83
    v_mul_f32 v32, v32, v236
    v_mul_f32 v33, v33, v236
    v_mul_f32 v34, v34, v236
    v_mul_f32 v35, v35, v236
    v_mul_f32 v36, v36, v236
    v_mul_f32 v37, v37, v236
    v_mul_f32 v38, v38, v236
    v_mul_f32 v39, v39, v236
    v_cvt_pk_bf16_f32 v32, v32, v33
    v_cvt_pk_bf16_f32 v33, v34, v35
    v_cvt_pk_bf16_f32 v34, v36, v37
    v_cvt_pk_bf16_f32 v35, v38, v39
    s_add_u32 s58, s62, 8192
    buffer_store_dwordx4 v[32:35], v248, s[32:35], s58 offen offset:0 sc1
    v_accvgpr_read_b32 v40, a68
    v_accvgpr_read_b32 v41, a69
    v_accvgpr_read_b32 v42, a70
    v_accvgpr_read_b32 v43, a71
    v_accvgpr_read_b32 v44, a84
    v_accvgpr_read_b32 v45, a85
    v_accvgpr_read_b32 v46, a86
    v_accvgpr_read_b32 v47, a87
    v_mul_f32 v40, v40, v237
    v_mul_f32 v41, v41, v237
    v_mul_f32 v42, v42, v237
    v_mul_f32 v43, v43, v237
    v_mul_f32 v44, v44, v237
    v_mul_f32 v45, v45, v237
    v_mul_f32 v46, v46, v237
    v_mul_f32 v47, v47, v237
    v_cvt_pk_bf16_f32 v40, v40, v41
    v_cvt_pk_bf16_f32 v41, v42, v43
    v_cvt_pk_bf16_f32 v42, v44, v45
    v_cvt_pk_bf16_f32 v43, v46, v47
    buffer_store_dwordx4 v[40:43], v248, s[32:35], s58 offen offset:1024 sc1
    s_sub_u32 s68, 28, s75
    s_mov_b32 s69, 32
    s_cmp_eq_u32 s75, 32
    s_mov_b32 s75, 34
    s_cbranch_scc1 F_idle34
    s_add_u32 m0, s66, 0x10000
    s_nop 0
    buffer_load_dwordx4 v248, s[40:43], s65 offen offset:0 sc1 lds
    buffer_load_dwordx4 v248, s[40:43], s65 offen offset:1024 sc1 lds
    buffer_load_dwordx4 v248, s[40:43], s65 offen offset:2048 sc1 lds
    buffer_load_dwordx4 v248, s[40:43], s65 offen offset:3072 sc1 lds
    s_sub_u32 s65, s65, 8192
    s_waitcnt lgkmcnt(0)
    v_mfma_f32_16x16x32_bf16 v[0:3], a[192:195], v[128:131], v[96:99]
    v_accvgpr_read_b32 v48, a72
    v_accvgpr_read_b32 v49, a73
    v_mfma_f32_16x16x32_bf16 v[0:3], a[196:199], v[132:135], v[0:3]
    v_accvgpr_read_b32 v50, a74
    v_accvgpr_read_b32 v51, a75
    v_mfma_f32_16x16x32_bf16 v[0:3], a[200:203], v[136:139], v[0:3]
    v_accvgpr_read_b32 v52, a88
    v_accvgpr_read_b32 v53, a89
    v_mfma_f32_16x16x32_bf16 v[0:3], a[204:207], v[140:143], v[0:3]
    v_accvgpr_read_b32 v54, a90
    v_accvgpr_read_b32 v55, a91
    v_mfma_f32_16x16x32_bf16 v[8:11], a[192:195], v[144:147], v[100:103]
    v_mul_f32 v48, v48, v238
    v_mul_f32 v49, v49, v238
    v_mfma_f32_16x16x32_bf16 v[8:11], a[196:199], v[148:151], v[8:11]
    v_mul_f32 v50, v50, v238
    v_mul_f32 v51, v51, v238
    v_mfma_f32_16x16x32_bf16 v[8:11], a[200:203], v[152:155], v[8:11]
    v_mul_f32 v52, v52, v238
    v_mul_f32 v53, v53, v238
    v_mfma_f32_16x16x32_bf16 v[8:11], a[204:207], v[156:159], v[8:11]
    v_mul_f32 v54, v54, v238
    v_mul_f32 v55, v55, v238
    v_mfma_f32_16x16x32_bf16 v[16:19], a[192:195], v[160:163], v[104:107]
    v_cvt_pk_bf16_f32 v48, v48, v49
    v_cvt_pk_bf16_f32 v49, v50, v51
    v_mfma_f32_16x16x32_bf16 v[16:19], a[196:199], v[164:167], v[16:19]
    v_cvt_pk_bf16_f32 v50, v52, v53
    v_cvt_pk_bf16_f32 v51, v54, v55
    v_mfma_f32_16x16x32_bf16 v[16:19], a[200:203], v[168:171], v[16:19]
    buffer_store_dwordx4 v[48:51], v248, s[32:35], s58 offen offset:2048 sc1
    v_accvgpr_read_b32 v56, a76
    v_mfma_f32_16x16x32_bf16 v[16:19], a[204:207], v[172:175], v[16:19]
    v_accvgpr_read_b32 v57, a77
    v_accvgpr_read_b32 v58, a78
    v_mfma_f32_16x16x32_bf16 v[24:27], a[192:195], v[176:179], v[108:111]
    v_accvgpr_read_b32 v59, a79
    v_accvgpr_read_b32 v60, a92
    v_mfma_f32_16x16x32_bf16 v[24:27], a[196:199], v[180:183], v[24:27]
    v_accvgpr_read_b32 v61, a93
    v_accvgpr_read_b32 v62, a94
    v_mfma_f32_16x16x32_bf16 v[24:27], a[200:203], v[184:187], v[24:27]
    v_accvgpr_read_b32 v63, a95
    v_mul_f32 v56, v56, v239
    v_mfma_f32_16x16x32_bf16 v[24:27], a[204:207], v[188:191], v[24:27]
    v_mul_f32 v57, v57, v239
    v_mul_f32 v58, v58, v239
    v_mfma_f32_16x16x32_bf16 v[4:7], a[208:211], v[128:131], v[112:115]
    v_mul_f32 v59, v59, v239
    v_mul_f32 v60, v60, v239
    v_mfma_f32_16x16x32_bf16 v[4:7], a[212:215], v[132:135], v[4:7]
    v_mul_f32 v61, v61, v239
    v_mul_f32 v62, v62, v239
    v_mfma_f32_16x16x32_bf16 v[4:7], a[216:219], v[136:139], v[4:7]
    v_mul_f32 v63, v63, v239
    v_cvt_pk_bf16_f32 v56, v56, v57
    v_mfma_f32_16x16x32_bf16 v[4:7], a[220:223], v[140:143], v[4:7]
    v_cvt_pk_bf16_f32 v57, v58, v59
    v_cvt_pk_bf16_f32 v58, v60, v61
    v_mfma_f32_16x16x32_bf16 v[12:15], a[208:211], v[144:147], v[116:119]
    v_cvt_pk_bf16_f32 v59, v62, v63
    v_add_f32 v96, v212, v216
    v_mfma_f32_16x16x32_bf16 v[12:15], a[212:215], v[148:151], v[12:15]
    buffer_store_dwordx4 v[56:59], v248, s[32:35], s58 offen offset:3072 sc1
    v_add_f32 v97, v212, v217
    v_mfma_f32_16x16x32_bf16 v[12:15], a[216:219], v[152:155], v[12:15]
    v_add_f32 v98, v212, v218
    v_add_f32 v99, v212, v219
    v_mfma_f32_16x16x32_bf16 v[12:15], a[220:223], v[156:159], v[12:15]
    v_mov_b32 v100, v213
    v_mov_b32 v101, v213
    v_mfma_f32_16x16x32_bf16 v[20:23], a[208:211], v[160:163], v[120:123]
    v_mov_b32 v102, v213
    v_mov_b32 v103, v213
    v_mfma_f32_16x16x32_bf16 v[20:23], a[212:215], v[164:167], v[20:23]
    v_mov_b32 v104, v214
    v_mov_b32 v105, v214
    v_mfma_f32_16x16x32_bf16 v[20:23], a[216:219], v[168:171], v[20:23]
    v_mov_b32 v106, v214
    v_mov_b32 v107, v214
    v_mfma_f32_16x16x32_bf16 v[20:23], a[220:223], v[172:175], v[20:23]
    v_mfma_f32_16x16x32_bf16 v[28:31], a[208:211], v[176:179], v[124:127]
    v_mfma_f32_16x16x32_bf16 v[28:31], a[212:215], v[180:183], v[28:31]
    v_mfma_f32_16x16x32_bf16 v[28:31], a[216:219], v[184:187], v[28:31]
    v_mfma_f32_16x16x32_bf16 v[28:31], a[220:223], v[188:191], v[28:31]
    s_nop 1
    v_add_f32 v116, v213, v216
    v_add_f32 v117, v213, v217
    v_add_f32 v118, v213, v218
    v_add_f32 v119, v213, v219
    v_mov_b32 v120, v214
    v_mov_b32 v121, v214
    v_mov_b32 v122, v214
    v_mov_b32 v123, v214
    v_mov_b32 v124, v215
    v_mov_b32 v125, v215
    v_mov_b32 v126, v215
    v_mov_b32 v127, v215
    s_add_u32 s67, s67, 0x4000
    v_bfi_b32 v232, v233, s67, v232
    s_waitcnt vmcnt(16) lgkmcnt(0)
    s_barrier
    ds_read_b128 a[192:195], v232 offset:0
    ds_read_b128 a[196:199], v232 offset:1024
    ds_read_b128 a[200:203], v232 offset:2048
    ds_read_b128 a[204:207], v232 offset:3072
    ds_read_b128 a[208:211], v232 offset:4096
    ds_read_b128 a[212:215], v232 offset:5120
    ds_read_b128 a[216:219], v232 offset:6144
    ds_read_b128 a[220:223], v232 offset:7168
    ds_read_b128 a[224:227], v232 offset:8192
    ds_read_b128 a[228:231], v232 offset:9216
    s_mov_b32 m0, s66
    s_nop 0
    buffer_load_dwordx4 v248, s[40:43], s64 offen offset:0 sc1 lds
    buffer_load_dwordx4 v248, s[40:43], s64 offen offset:1024 sc1 lds
    buffer_load_dwordx4 v248, s[40:43], s64 offen offset:2048 sc1 lds
    buffer_load_dwordx4 v248, s[40:43], s64 offen offset:3072 sc1 lds
    s_add_u32 s64, s64, 8192
    s_add_u32 s66, s66, 0x4000
    s_and_b32 s66, s66, 0xffff
    v_accvgpr_read_b32 v32, a96
    v_accvgpr_read_b32 v33, a97
    v_accvgpr_read_b32 v34, a98
    v_accvgpr_read_b32 v35, a99
    v_accvgpr_read_b32 v36, a112
    v_accvgpr_read_b32 v37, a113
    v_accvgpr_read_b32 v38, a114
    v_accvgpr_read_b32 v39, a115
    v_mul_f32 v32, v32, v236
    v_mul_f32 v33, v33, v236
    v_mul_f32 v34, v34, v236
    v_mul_f32 v35, v35, v236
    v_mul_f32 v36, v36, v236
    v_mul_f32 v37, v37, v236
    v_mul_f32 v38, v38, v236
    v_mul_f32 v39, v39, v236
    v_cvt_pk_bf16_f32 v32, v32, v33
    v_cvt_pk_bf16_f32 v33, v34, v35
    v_cvt_pk_bf16_f32 v34, v36, v37
    v_cvt_pk_bf16_f32 v35, v38, v39
    s_add_u32 s58, s62, 12288
    buffer_store_dwordx4 v[32:35], v248, s[32:35], s58 offen offset:0 sc1
    v_accvgpr_read_b32 v40, a100
    v_accvgpr_read_b32 v41, a101
    v_accvgpr_read_b32 v42, a102
    v_accvgpr_read_b32 v43, a103
    v_accvgpr_read_b32 v44, a116
    v_accvgpr_read_b32 v45, a117
    v_accvgpr_read_b32 v46, a118
    v_accvgpr_read_b32 v47, a119
    v_mul_f32 v40, v40, v237
    v_mul_f32 v41, v41, v237
    v_mul_f32 v42, v42, v237
    v_mul_f32 v43, v43, v237
    v_mul_f32 v44, v44, v237
    v_mul_f32 v45, v45, v237
    v_mul_f32 v46, v46, v237
    v_mul_f32 v47, v47, v237
    v_cvt_pk_bf16_f32 v40, v40, v41
    v_cvt_pk_bf16_f32 v41, v42, v43
    v_cvt_pk_bf16_f32 v42, v44, v45
    v_cvt_pk_bf16_f32 v43, v46, v47
    buffer_store_dwordx4 v[40:43], v248, s[32:35], s58 offen offset:1024 sc1
    v_accvgpr_read_b32 v48, a104
    v_accvgpr_read_b32 v49, a105
    v_accvgpr_read_b32 v50, a106
    v_accvgpr_read_b32 v51, a107
    v_accvgpr_read_b32 v52, a120
    v_accvgpr_read_b32 v53, a121
    v_accvgpr_read_b32 v54, a122
    v_accvgpr_read_b32 v55, a123
    v_mul_f32 v48, v48, v238
    v_mul_f32 v49, v49, v238
    v_mul_f32 v50, v50, v238
    v_mul_f32 v51, v51, v238
    v_mul_f32 v52, v52, v238
    v_mul_f32 v53, v53, v238
    v_mul_f32 v54, v54, v238
    v_mul_f32 v55, v55, v238
    v_cvt_pk_bf16_f32 v48, v48, v49
    v_cvt_pk_bf16_f32 v49, v50, v51
    v_cvt_pk_bf16_f32 v50, v52, v53
    v_cvt_pk_bf16_f32 v51, v54, v55
    buffer_store_dwordx4 v[48:51], v248, s[32:35], s58 offen offset:2048 sc1
    v_accvgpr_read_b32 v56, a108
    v_accvgpr_read_b32 v57, a109
    v_accvgpr_read_b32 v58, a110
    v_accvgpr_read_b32 v59, a111
    v_accvgpr_read_b32 v60, a124
    v_accvgpr_read_b32 v61, a125
    v_accvgpr_read_b32 v62, a126
    v_accvgpr_read_b32 v63, a127
    v_mul_f32 v56, v56, v239
    v_mul_f32 v57, v57, v239
    v_mul_f32 v58, v58, v239
    v_mul_f32 v59, v59, v239
    v_mul_f32 v60, v60, v239
    v_mul_f32 v61, v61, v239
    v_mul_f32 v62, v62, v239
    v_mul_f32 v63, v63, v239
    v_cvt_pk_bf16_f32 v56, v56, v57
    v_cvt_pk_bf16_f32 v57, v58, v59
    v_cvt_pk_bf16_f32 v58, v60, v61
    v_cvt_pk_bf16_f32 v59, v62, v63
    buffer_store_dwordx4 v[56:59], v248, s[32:35], s58 offen offset:3072 sc1
    v_mfma_f32_32x32x16_bf16 a[0:15], v[244:247], v[244:247], 0
    v_exp_f32 v0, v0
    v_exp_f32 v1, v1
    v_exp_f32 v2, v2
    v_mfma_f32_32x32x16_bf16 a[16:31], v[244:247], v[244:247], 0
    v_exp_f32 v3, v3
    v_exp_f32 v8, v8
    v_exp_f32 v9, v9
    v_mfma_f32_32x32x16_bf16 a[32:47], v[244:247], v[244:247], 0
    v_exp_f32 v10, v10
    v_exp_f32 v11, v11
    v_exp_f32 v16, v16
    v_mfma_f32_32x32x16_bf16 a[48:63], v[244:247], v[244:247], 0
    v_exp_f32 v17, v17
    v_exp_f32 v18, v18
    v_exp_f32 v19, v19
    v_mfma_f32_32x32x16_bf16 a[64:79], v[244:247], v[244:247], 0
    v_exp_f32 v24, v24
    v_exp_f32 v25, v25
    v_exp_f32 v26, v26
    v_mfma_f32_32x32x16_bf16 a[80:95], v[244:247], v[244:247], 0
    v_exp_f32 v27, v27
    v_exp_f32 v4, v4
    v_exp_f32 v5, v5
    v_mfma_f32_32x32x16_bf16 a[96:111], v[244:247], v[244:247], 0
    v_exp_f32 v6, v6
    v_exp_f32 v7, v7
    v_exp_f32 v12, v12
    v_mfma_f32_32x32x16_bf16 a[112:127], v[244:247], v[244:247], 0
    v_exp_f32 v13, v13
    v_exp_f32 v14, v14
    s_nop 0
    v_cvt_pk_bf16_f32 v64, v0, v1
    v_cvt_pk_bf16_f32 v65, v2, v3
    v_cvt_pk_bf16_f32 v68, v8, v9
    v_cvt_pk_bf16_f32 v69, v10, v11
    v_cvt_pk_bf16_f32 v72, v16, v17
    v_cvt_pk_bf16_f32 v73, v18, v19
    v_cvt_pk_bf16_f32 v76, v24, v25
    v_cvt_pk_bf16_f32 v77, v26, v27
    v_cvt_pk_bf16_f32 v66, v4, v5
    v_cvt_pk_bf16_f32 v67, v6, v7
    v_cvt_pk_bf16_f32 v70, v12, v13
    s_cmp_eq_u32 s54, 7
    s_cbranch_scc1 F_p7w2
    s_waitcnt lgkmcnt(2)
    v_mfma_f32_16x16x32_bf16 v[32:35], a[192:195], v[128:131], v[96:99]
    v_exp_f32 v15, v15
    v_mfma_f32_16x16x32_bf16 v[32:35], a[196:199], v[132:135], v[32:35]
    ds_read_b128 a[232:235], v232 offset:10240
    v_cvt_pk_bf16_f32 v71, v14, v15
    v_mfma_f32_16x16x32_bf16 v[32:35], a[200:203], v[136:139], v[32:35]
    v_exp_f32 v20, v20
    v_mfma_f32_16x16x32_bf16 v[32:35], a[204:207], v[140:143], v[32:35]
    s_add_u32 m0, s66, 0x10000
    ds_read_b128 a[236:239], v232 offset:11264
    v_mfma_f32_16x16x32_bf16 v[40:43], a[192:195], v[144:147], v[100:103]
    v_exp_f32 v21, v21
    v_mfma_f32_16x16x32_bf16 v[40:43], a[196:199], v[148:151], v[40:43]
    ds_read_b128 a[240:243], v232 offset:12288
    v_cvt_pk_bf16_f32 v74, v20, v21
    v_mfma_f32_16x16x32_bf16 v[40:43], a[200:203], v[152:155], v[40:43]
    v_exp_f32 v22, v22
    v_mfma_f32_16x16x32_bf16 v[40:43], a[204:207], v[156:159], v[40:43]
    buffer_load_dwordx4 v248, s[40:43], s65 offen offset:0 sc1 lds
    v_mfma_f32_16x16x32_bf16 v[48:51], a[192:195], v[160:163], v[104:107]
    v_exp_f32 v23, v23
    v_mfma_f32_16x16x32_bf16 v[48:51], a[196:199], v[164:167], v[48:51]
    ds_read_b128 a[244:247], v232 offset:13312
    v_cvt_pk_bf16_f32 v75, v22, v23
    v_mfma_f32_16x16x32_bf16 v[48:51], a[200:203], v[168:171], v[48:51]
    v_exp_f32 v28, v28
    v_mfma_f32_16x16x32_bf16 v[48:51], a[204:207], v[172:175], v[48:51]
    buffer_load_dwordx4 v248, s[40:43], s65 offen offset:1024 sc1 lds
    v_mfma_f32_16x16x32_bf16 v[56:59], a[192:195], v[176:179], v[108:111]
    v_exp_f32 v29, v29
    v_mfma_f32_16x16x32_bf16 v[56:59], a[196:199], v[180:183], v[56:59]
    ds_read_b128 a[248:251], v232 offset:14336
    v_cvt_pk_bf16_f32 v78, v28, v29
    v_mfma_f32_16x16x32_bf16 v[56:59], a[200:203], v[184:187], v[56:59]
    v_exp_f32 v30, v30
    v_mfma_f32_16x16x32_bf16 v[56:59], a[204:207], v[188:191], v[56:59]
    buffer_load_dwordx4 v248, s[40:43], s65 offen offset:2048 sc1 lds
    v_mfma_f32_16x16x32_bf16 v[36:39], a[208:211], v[128:131], v[112:115]
    v_exp_f32 v31, v31
    v_mfma_f32_16x16x32_bf16 v[36:39], a[212:215], v[132:135], v[36:39]
    ds_read_b128 a[252:255], v232 offset:15360
    v_cvt_pk_bf16_f32 v79, v30, v31
    v_mfma_f32_16x16x32_bf16 v[36:39], a[216:219], v[136:139], v[36:39]
    s_add_u32 s67, s67, 0x4000
    v_mov_b32 v96, v212
    v_mov_b32 v97, v212
    v_mfma_f32_16x16x32_bf16 v[36:39], a[220:223], v[140:143], v[36:39]
    buffer_load_dwordx4 v248, s[40:43], s65 offen offset:3072 sc1 lds
    v_mov_b32 v98, v212
    v_mfma_f32_16x16x32_bf16 v[44:47], a[208:211], v[144:147], v[116:119]
    s_sub_u32 s65, s65, 8192
    v_mov_b32 v99, v212
    v_mfma_f32_16x16x32_bf16 v[44:47], a[212:215], v[148:151], v[44:47]
    v_bfi_b32 v232, v233, s67, v232
    v_mfma_f32_16x16x32_bf16 v[44:47], a[216:219], v[152:155], v[44:47]
    v_exp_f32 v32, v32
    v_mfma_f32_16x16x32_bf16 v[44:47], a[220:223], v[156:159], v[44:47]
    s_mov_b32 m0, s66
    v_mfma_f32_16x16x32_bf16 v[52:55], a[208:211], v[160:163], v[120:123]
    v_exp_f32 v33, v33
    v_mfma_f32_16x16x32_bf16 v[52:55], a[212:215], v[164:167], v[52:55]
    v_cvt_pk_bf16_f32 v80, v32, v33
    v_mfma_f32_16x16x32_bf16 v[52:55], a[216:219], v[168:171], v[52:55]
    v_exp_f32 v34, v34
    v_mfma_f32_16x16x32_bf16 v[52:55], a[220:223], v[172:175], v[52:55]
    v_mfma_f32_16x16x32_bf16 v[60:63], a[208:211], v[176:179], v[124:127]
    v_exp_f32 v35, v35
    v_mfma_f32_16x16x32_bf16 v[60:63], a[212:215], v[180:183], v[60:63]
    v_cvt_pk_bf16_f32 v81, v34, v35
    v_mfma_f32_16x16x32_bf16 v[60:63], a[216:219], v[184:187], v[60:63]
    v_exp_f32 v40, v40
    v_mfma_f32_16x16x32_bf16 v[60:63], a[220:223], v[188:191], v[60:63]
    s_waitcnt vmcnt(16) lgkmcnt(0)
    s_barrier
    v_mfma_f32_16x16x32_bf16 a[0:3], a[224:227], v[64:67], a[0:3]
    v_exp_f32 v41, v41
    v_mfma_f32_16x16x32_bf16 a[4:7], a[224:227], v[68:71], a[4:7]
    ds_read_b128 a[192:195], v232 offset:0
    v_cvt_pk_bf16_f32 v84, v40, v41
    v_mfma_f32_16x16x32_bf16 a[8:11], a[224:227], v[72:75], a[8:11]
    v_exp_f32 v42, v42
    v_mfma_f32_16x16x32_bf16 a[12:15], a[224:227], v[76:79], a[12:15]
    ds_read_b128 a[196:199], v232 offset:1024
    v_mov_b32 v112, v212
    v_mfma_f32_16x16x32_bf16 a[16:19], a[228:231], v[64:67], a[16:19]
    v_exp_f32 v43, v43
    v_mfma_f32_16x16x32_bf16 a[20:23], a[228:231], v[68:71], a[20:23]
    ds_read_b128 a[200:203], v232 offset:2048
    v_cvt_pk_bf16_f32 v85, v42, v43
    v_mfma_f32_16x16x32_bf16 a[24:27], a[228:231], v[72:75], a[24:27]
    v_exp_f32 v48, v48
    v_mfma_f32_16x16x32_bf16 a[28:31], a[228:231], v[76:79], a[28:31]
    ds_read_b128 a[204:207], v232 offset:3072
    v_mov_b32 v113, v212
    v_mfma_f32_16x16x32_bf16 a[32:35], a[232:235], v[64:67], a[32:35]
    v_exp_f32 v49, v49
    v_mfma_f32_16x16x32_bf16 a[36:39], a[232:235], v[68:71], a[36:39]
    ds_read_b128 a[208:211], v232 offset:4096
    v_cvt_pk_bf16_f32 v88, v48, v49
    v_mfma_f32_16x16x32_bf16 a[40:43], a[232:235], v[72:75], a[40:43]
    v_exp_f32 v50, v50
    v_mfma_f32_16x16x32_bf16 a[44:47], a[232:235], v[76:79], a[44:47]
    buffer_load_dwordx4 v248, s[40:43], s64 offen offset:0 sc1 lds
    v_mov_b32 v114, v212
    v_mfma_f32_16x16x32_bf16 a[48:51], a[236:239], v[64:67], a[48:51]
    v_exp_f32 v51, v51
    v_mfma_f32_16x16x32_bf16 a[52:55], a[236:239], v[68:71], a[52:55]
    ds_read_b128 a[212:215], v232 offset:5120
    v_cvt_pk_bf16_f32 v89, v50, v51
    v_mfma_f32_16x16x32_bf16 a[56:59], a[236:239], v[72:75], a[56:59]
    v_exp_f32 v56, v56
    v_mfma_f32_16x16x32_bf16 a[60:63], a[236:239], v[76:79], a[60:63]
    buffer_load_dwordx4 v248, s[40:43], s64 offen offset:1024 sc1 lds
    v_mov_b32 v115, v212
    v_mfma_f32_16x16x32_bf16 v[192:195], v[208:211], v[64:67], v[192:195]
    v_exp_f32 v57, v57
    v_mfma_f32_16x16x32_bf16 v[196:199], v[208:211], v[68:71], v[196:199]
    ds_read_b128 a[216:219], v232 offset:6144
    v_cvt_pk_bf16_f32 v92, v56, v57
    v_mfma_f32_16x16x32_bf16 v[200:203], v[208:211], v[72:75], v[200:203]
    v_exp_f32 v58, v58
    v_mfma_f32_16x16x32_bf16 v[204:207], v[208:211], v[76:79], v[204:207]
    buffer_load_dwordx4 v248, s[40:43], s64 offen offset:2048 sc1 lds
    v_mov_b32 v116, v213
    v_mfma_f32_16x16x32_bf16 a[64:67], a[240:243], v[64:67], a[64:67]
    v_exp_f32 v59, v59
    v_mfma_f32_16x16x32_bf16 a[68:71], a[240:243], v[68:71], a[68:71]
    ds_read_b128 a[220:223], v232 offset:7168
    v_cvt_pk_bf16_f32 v93, v58, v59
    v_mfma_f32_16x16x32_bf16 a[72:75], a[240:243], v[72:75], a[72:75]
    v_exp_f32 v36, v36
    v_mfma_f32_16x16x32_bf16 a[76:79], a[240:243], v[76:79], a[76:79]
    buffer_load_dwordx4 v248, s[40:43], s64 offen offset:3072 sc1 lds
    v_mov_b32 v117, v213
    v_mfma_f32_16x16x32_bf16 a[80:83], a[244:247], v[64:67], a[80:83]
    v_exp_f32 v37, v37
    v_mfma_f32_16x16x32_bf16 a[84:87], a[244:247], v[68:71], a[84:87]
    ds_read_b128 a[224:227], v232 offset:8192
    v_cvt_pk_bf16_f32 v82, v36, v37
    v_mfma_f32_16x16x32_bf16 a[88:91], a[244:247], v[72:75], a[88:91]
    s_add_u32 s64, s64, 8192
    v_exp_f32 v38, v38
    v_mfma_f32_16x16x32_bf16 a[92:95], a[244:247], v[76:79], a[92:95]
    s_add_u32 s66, s66, 0x4000
    v_mov_b32 v118, v213
    v_mov_b32 v119, v213
    v_mfma_f32_16x16x32_bf16 a[96:99], a[248:251], v[64:67], a[96:99]
    s_and_b32 s66, s66, 0xffff
    v_exp_f32 v39, v39
    v_mfma_f32_16x16x32_bf16 a[100:103], a[248:251], v[68:71], a[100:103]
    ds_read_b128 a[228:231], v232 offset:9216
    v_cvt_pk_bf16_f32 v83, v38, v39
    v_mfma_f32_16x16x32_bf16 a[104:107], a[248:251], v[72:75], a[104:107]
    v_exp_f32 v44, v44
    v_mfma_f32_16x16x32_bf16 a[108:111], a[248:251], v[76:79], a[108:111]
    s_sub_u32 s68, s68, 1
    v_mfma_f32_16x16x32_bf16 a[112:115], a[252:255], v[64:67], a[112:115]
    v_exp_f32 v45, v45
    v_mfma_f32_16x16x32_bf16 a[116:119], a[252:255], v[68:71], a[116:119]
    v_cvt_pk_bf16_f32 v86, v44, v45
    v_mfma_f32_16x16x32_bf16 a[120:123], a[252:255], v[72:75], a[120:123]
    v_exp_f32 v46, v46
    v_mfma_f32_16x16x32_bf16 a[124:127], a[252:255], v[76:79], a[124:127]
    s_cbranch_scc1 F_event
    s_branch F_E2
F_p7w2:
    buffer_load_dwordx4 v[236:239], v228, s[32:35], 0 offen sc1
    s_add_u32 s56, s9, 1
    s_and_b32 s56, s56, 3
    s_lshl_b32 s56, s56, 10
    s_add_u32 s56, s56, 4096
    v_add_u32 v224, s56, v248
    s_add_u32 s56, s9, 2
    s_and_b32 s56, s56, 3
    s_lshl_b32 s56, s56, 10
    s_add_u32 s56, s56, 3072
    v_add_u32 v225, s56, v248
    s_add_u32 s56, s9, 3
    s_and_b32 s56, s56, 3
    s_lshl_b32 s56, s56, 10
    s_add_u32 s56, s56, 2048
    v_add_u32 v226, s56, v248
    v_and_b32 v229, 1, v249
    v_lshrrev_b32 v230, 1, v249
    v_lshl_add_u32 v229, v230, 6, v229
    s_and_b32 s56, s2, 0x3e
    s_lshl_b32 s56, s56, 9
    s_and_b32 s57, s53, 7
    s_lshl_b32 s57, s57, 2
    s_add_u32 s56, s56, s57
    s_add_u32 s56, s56, 128
    v_lshl_add_u32 v229, v229, 9, s56
    v_cmp_gt_u32 vcc, 8, v249
    v_mov_b32 v230, 0x40000000
    s_nop 1
    v_cndmask_b32 v229, v230, v229, vcc
    s_waitcnt vmcnt(0)
    s_mov_b32 s16, 100000
F_pl7:
    v_xor_b32 v236, s94, v236
    v_xor_b32 v237, s94, v237
    v_xor_b32 v238, s94, v238
    v_xor_b32 v239, s94, v239
    v_or3_b32 v236, v236, v237, v238
    v_or_b32 v236, v236, v239
    v_cmp_ne_u32 vcc, 0, v236
    s_nop 4
    s_cbranch_vccz F_pd7
    s_sleep 8
    buffer_load_dwordx4 v[236:239], v228, s[32:35], 0 offen sc1
    s_sub_u32 s16, s16, 1
    s_waitcnt vmcnt(0)
    s_cbranch_scc0 F_pl7
F_pd7:
    s_add_u32 m0, s55, 49152
    s_add_u32 s56, s10, 8192
    buffer_load_dwordx4 v248, s[32:35], s56 offen offset:0 sc1 lds
    buffer_load_dwordx4 v248, s[32:35], s56 offen offset:1024 sc1 lds
    buffer_load_dwordx4 v248, s[32:35], s56 offen offset:2048 sc1 lds
    buffer_load_dwordx4 v248, s[32:35], s56 offen offset:3072 sc1 lds
    s_add_u32 m0, s55, 65536
    s_add_u32 s56, s10, 12288
    buffer_load_dwordx4 v248, s[32:35], s56 offen offset:0 sc1 lds
    buffer_load_dwordx4 v248, s[32:35], s56 offen offset:1024 sc1 lds
    buffer_load_dwordx4 v248, s[32:35], s56 offen offset:2048 sc1 lds
    buffer_load_dwordx4 v248, s[32:35], s56 offen offset:3072 sc1 lds
    s_branch F_T33
F_idle34:
    v_accvgpr_read_b32 v48, a72
    v_accvgpr_read_b32 v49, a73
    v_accvgpr_read_b32 v50, a74
    v_accvgpr_read_b32 v51, a75
    v_accvgpr_read_b32 v52, a88
    v_accvgpr_read_b32 v53, a89
    v_accvgpr_read_b32 v54, a90
    v_accvgpr_read_b32 v55, a91
    v_mul_f32 v48, v48, v238
    v_mul_f32 v49, v49, v238
    v_mul_f32 v50, v50, v238
    v_mul_f32 v51, v51, v238
    v_mul_f32 v52, v52, v238
    v_mul_f32 v53, v53, v238
    v_mul_f32 v54, v54, v238
    v_mul_f32 v55, v55, v238
    v_cvt_pk_bf16_f32 v48, v48, v49
    v_cvt_pk_bf16_f32 v49, v50, v51
    v_cvt_pk_bf16_f32 v50, v52, v53
    v_cvt_pk_bf16_f32 v51, v54, v55
    buffer_store_dwordx4 v[48:51], v248, s[32:35], s58 offen offset:2048 sc1
    v_accvgpr_read_b32 v56, a76
    v_accvgpr_read_b32 v57, a77
    v_accvgpr_read_b32 v58, a78
    v_accvgpr_read_b32 v59, a79
    v_accvgpr_read_b32 v60, a92
    v_accvgpr_read_b32 v61, a93
    v_accvgpr_read_b32 v62, a94
    v_accvgpr_read_b32 v63, a95
    v_mul_f32 v56, v56, v239
    v_mul_f32 v57, v57, v239
    v_mul_f32 v58, v58, v239
    v_mul_f32 v59, v59, v239
    v_mul_f32 v60, v60, v239
    v_mul_f32 v61, v61, v239
    v_mul_f32 v62, v62, v239
    v_mul_f32 v63, v63, v239
    v_cvt_pk_bf16_f32 v56, v56, v57
    v_cvt_pk_bf16_f32 v57, v58, v59
    v_cvt_pk_bf16_f32 v58, v60, v61
    v_cvt_pk_bf16_f32 v59, v62, v63
    buffer_store_dwordx4 v[56:59], v248, s[32:35], s58 offen offset:3072 sc1
    v_accvgpr_read_b32 v32, a96
    v_accvgpr_read_b32 v33, a97
    v_accvgpr_read_b32 v34, a98
    v_accvgpr_read_b32 v35, a99
    v_accvgpr_read_b32 v36, a112
    v_accvgpr_read_b32 v37, a113
    v_accvgpr_read_b32 v38, a114
    v_accvgpr_read_b32 v39, a115
    v_mul_f32 v32, v32, v236
    v_mul_f32 v33, v33, v236
    v_mul_f32 v34, v34, v236
    v_mul_f32 v35, v35, v236
    v_mul_f32 v36, v36, v236
    v_mul_f32 v37, v37, v236
    v_mul_f32 v38, v38, v236
    v_mul_f32 v39, v39, v236
    v_cvt_pk_bf16_f32 v32, v32, v33
    v_cvt_pk_bf16_f32 v33, v34, v35
    v_cvt_pk_bf16_f32 v34, v36, v37
    v_cvt_pk_bf16_f32 v35, v38, v39
    s_add_u32 s58, s62, 12288
    buffer_store_dwordx4 v[32:35], v248, s[32:35], s58 offen offset:0 sc1
    v_accvgpr_read_b32 v40, a100
    v_accvgpr_read_b32 v41, a101
    v_accvgpr_read_b32 v42, a102
    v_accvgpr_read_b32 v43, a103
    v_accvgpr_read_b32 v44, a116
    v_accvgpr_read_b32 v45, a117
    v_accvgpr_read_b32 v46, a118
    v_accvgpr_read_b32 v47, a119
    v_mul_f32 v40, v40, v237
    v_mul_f32 v41, v41, v237
    v_mul_f32 v42, v42, v237
    v_mul_f32 v43, v43, v237
    v_mul_f32 v44, v44, v237
    v_mul_f32 v45, v45, v237
    v_mul_f32 v46, v46, v237
    v_mul_f32 v47, v47, v237
    v_cvt_pk_bf16_f32 v40, v40, v41
    v_cvt_pk_bf16_f32 v41, v42, v43
    v_cvt_pk_bf16_f32 v42, v44, v45
    v_cvt_pk_bf16_f32 v43, v46, v47
    buffer_store_dwordx4 v[40:43], v248, s[32:35], s58 offen offset:1024 sc1
    v_accvgpr_read_b32 v48, a104
    v_accvgpr_read_b32 v49, a105
    v_accvgpr_read_b32 v50, a106
    v_accvgpr_read_b32 v51, a107
    v_accvgpr_read_b32 v52, a120
    v_accvgpr_read_b32 v53, a121
    v_accvgpr_read_b32 v54, a122
    v_accvgpr_read_b32 v55, a123
    v_mul_f32 v48, v48, v238
    v_mul_f32 v49, v49, v238
    v_mul_f32 v50, v50, v238
    v_mul_f32 v51, v51, v238
    v_mul_f32 v52, v52, v238
    v_mul_f32 v53, v53, v238
    v_mul_f32 v54, v54, v238
    v_mul_f32 v55, v55, v238
    v_cvt_pk_bf16_f32 v48, v48, v49
    v_cvt_pk_bf16_f32 v49, v50, v51
    v_cvt_pk_bf16_f32 v50, v52, v53
    v_cvt_pk_bf16_f32 v51, v54, v55
    buffer_store_dwordx4 v[48:51], v248, s[32:35], s58 offen offset:2048 sc1
    v_accvgpr_read_b32 v56, a108
    v_accvgpr_read_b32 v57, a109
    v_accvgpr_read_b32 v58, a110
    v_accvgpr_read_b32 v59, a111
    v_accvgpr_read_b32 v60, a124
    v_accvgpr_read_b32 v61, a125
    v_accvgpr_read_b32 v62, a126
    v_accvgpr_read_b32 v63, a127
    v_mul_f32 v56, v56, v239
    v_mul_f32 v57, v57, v239
    v_mul_f32 v58, v58, v239
    v_mul_f32 v59, v59, v239
    v_mul_f32 v60, v60, v239
    v_mul_f32 v61, v61, v239
    v_mul_f32 v62, v62, v239
    v_mul_f32 v63, v63, v239
    v_cvt_pk_bf16_f32 v56, v56, v57
    v_cvt_pk_bf16_f32 v57, v58, v59
    v_cvt_pk_bf16_f32 v58, v60, v61
    v_cvt_pk_bf16_f32 v59, v62, v63
    buffer_store_dwordx4 v[56:59], v248, s[32:35], s58 offen offset:3072 sc1
    s_waitcnt lgkmcnt(0)
    s_add_u32 s56, s9, 1
    s_and_b32 s56, s56, 3
    s_lshl_b32 s56, s56, 10
    s_add_u32 s56, s56, 4096
    v_add_u32 v224, s56, v248
    s_add_u32 s56, s9, 2
    s_and_b32 s56, s56, 3
    s_lshl_b32 s56, s56, 10
    s_add_u32 s56, s56, 3072
    v_add_u32 v225, s56, v248
    s_add_u32 s56, s9, 3
    s_and_b32 s56, s56, 3
    s_lshl_b32 s56, s56, 10
    s_add_u32 s56, s56, 2048
    v_add_u32 v226, s56, v248
    v_and_b32 v229, 1, v249
    v_lshrrev_b32 v230, 1, v249
    v_lshl_add_u32 v229, v230, 6, v229
    s_and_b32 s56, s2, 0x3e
    s_lshl_b32 s56, s56, 9
    s_and_b32 s57, s53, 7
    s_lshl_b32 s57, s57, 2
    s_add_u32 s56, s56, s57
    s_add_u32 s56, s56, 128
    v_lshl_add_u32 v229, v229, 9, s56
    v_cmp_gt_u32 vcc, 8, v249
    v_mov_b32 v230, 0x40000000
    s_nop 1
    v_cndmask_b32 v229, v230, v229, vcc
    s_add_u32 m0, s55, 49152
    s_add_u32 s56, s10, 8192
    buffer_load_dwordx4 v248, s[32:35], s56 offen offset:0 sc1 lds
    buffer_load_dwordx4 v248, s[32:35], s56 offen offset:1024 sc1 lds
    buffer_load_dwordx4 v248, s[32:35], s56 offen offset:2048 sc1 lds
    buffer_load_dwordx4 v248, s[32:35], s56 offen offset:3072 sc1 lds
    s_add_u32 m0, s55, 65536
    s_add_u32 s56, s10, 12288
    buffer_load_dwordx4 v248, s[32:35], s56 offen offset:0 sc1 lds
    buffer_load_dwordx4 v248, s[32:35], s56 offen offset:1024 sc1 lds
    buffer_load_dwordx4 v248, s[32:35], s56 offen offset:2048 sc1 lds
    buffer_load_dwordx4 v248, s[32:35], s56 offen offset:3072 sc1 lds
    s_add_u32 m0, s55, 131072
    s_add_u32 s56, s10, 16384
    buffer_load_dwordx4 v248, s[32:35], s56 offen offset:0 sc1 lds
    buffer_load_dwordx4 v248, s[32:35], s56 offen offset:1024 sc1 lds
    buffer_load_dwordx4 v248, s[32:35], s56 offen offset:2048 sc1 lds
    buffer_load_dwordx4 v248, s[32:35], s56 offen offset:3072 sc1 lds
    s_add_u32 m0, s55, 147456
    s_add_u32 s56, s10, 20480
    buffer_load_dwordx4 v248, s[32:35], s56 offen offset:0 sc1 lds
    buffer_load_dwordx4 v248, s[32:35], s56 offen offset:1024 sc1 lds
    buffer_load_dwordx4 v248, s[32:35], s56 offen offset:2048 sc1 lds
    buffer_load_dwordx4 v248, s[32:35], s56 offen offset:3072 sc1 lds
    s_add_u32 m0, s55, 0
    s_add_u32 s56, s10, 24576
    buffer_load_dwordx4 v248, s[32:35], s56 offen offset:0 sc1 lds
    buffer_load_dwordx4 v248, s[32:35], s56 offen offset:1024 sc1 lds
    buffer_load_dwordx4 v248, s[32:35], s56 offen offset:2048 sc1 lds
    buffer_load_dwordx4 v248, s[32:35], s56 offen offset:3072 sc1 lds
    s_add_u32 s56, s10, 0
    buffer_load_dwordx4 a[192:195], v248, s[32:35], s56 offen offset:0 sc1
    buffer_load_dwordx4 a[196:199], v248, s[32:35], s56 offen offset:1024 sc1
    buffer_load_dwordx4 a[200:203], v248, s[32:35], s56 offen offset:2048 sc1
    buffer_load_dwordx4 a[204:207], v248, s[32:35], s56 offen offset:3072 sc1
    s_add_u32 s56, s10, 4096
    buffer_load_dwordx4 a[208:211], v248, s[32:35], s56 offen offset:0 sc1
    buffer_load_dwordx4 a[212:215], v248, s[32:35], s56 offen offset:1024 sc1
    buffer_load_dwordx4 a[216:219], v248, s[32:35], s56 offen offset:2048 sc1
    buffer_load_dwordx4 a[220:223], v248, s[32:35], s56 offen offset:3072 sc1
    v_min_u32 v231, 7, v249
    v_lshlrev_b32 v231, 2, v231
    buffer_load_dword v230, v231, s[32:35], s95 offen offset:128 sc1
    v_mfma_f32_32x32x16_bf16 a[0:15], v[244:247], v[244:247], 0
    v_mfma_f32_32x32x16_bf16 a[16:31], v[244:247], v[244:247], 0
    v_mfma_f32_32x32x16_bf16 a[32:47], v[244:247], v[244:247], 0
    v_mfma_f32_32x32x16_bf16 a[48:63], v[244:247], v[244:247], 0
    v_mfma_f32_32x32x16_bf16 a[64:79], v[244:247], v[244:247], 0
    v_mfma_f32_32x32x16_bf16 a[80:95], v[244:247], v[244:247], 0
    v_mfma_f32_32x32x16_bf16 a[96:111], v[244:247], v[244:247], 0
    v_mfma_f32_32x32x16_bf16 a[112:127], v[244:247], v[244:247], 0
    v_mov_b32 v80, 0
    v_mov_b32 v81, 0
    v_mov_b32 v82, 0
    v_mov_b32 v83, 0
    v_mov_b32 v84, 0
    v_mov_b32 v85, 0
    v_mov_b32 v86, 0
    v_mov_b32 v87, 0
    v_mov_b32 v88, 0
    v_mov_b32 v89, 0
    v_mov_b32 v90, 0
    v_mov_b32 v91, 0
    v_mov_b32 v92, 0
    v_mov_b32 v93, 0
    v_mov_b32 v94, 0
    v_mov_b32 v95, 0
    s_nop 7
F_final:
    v_mfma_f32_16x16x32_bf16 v[192:195], v[208:211], v[80:83], v[192:195]
    v_mfma_f32_16x16x32_bf16 v[196:199], v[208:211], v[84:87], v[196:199]
    v_mfma_f32_16x16x32_bf16 v[200:203], v[208:211], v[88:91], v[200:203]
    v_mfma_f32_16x16x32_bf16 v[204:207], v[208:211], v[92:95], v[204:207]
    s_lshr_b32 s57, s52, 1
    s_lshl_b32 s57, s57, 15
    s_lshl_b32 s56, s52, 14
    s_add_u32 s56, s56, s57
    s_add_u32 s56, s56, 16384
    v_add_u32 v250, s56, v248
    s_sub_u32 s56, 114688, s56
    v_add_u32 v251, s56, v248
    s_lshl_b32 s56, s52, 10
    s_add_u32 s57, s56, 114688
    v_add_u32 v252, s57, v248
    s_sub_u32 s57, 117760, s56
    v_add_u32 v253, s57, v248
    s_lshl_b32 s96, s63, 1
    s_add_u32 s96, s96, 2
    s_lshl_b32 s56, s53, 14
    s_add_u32 s56, s56, 0x3200000
    s_mul_i32 s63, s63, 529408
    s_add_u32 s63, s63, s56
    v_mov_b32 v212, v192
    v_mov_b32 v213, v196
    v_mov_b32 v214, v200
    v_mov_b32 v215, v204
    v_add_u32 v232, s55, v248
    v_add_u32 v233, 0x10000, v232
    v_add_u32 v254, 0x20000, v232
    s_waitcnt vmcnt(29) lgkmcnt(0)
    s_barrier
    v_mov_b32 v240, s94
    s_cmp_eq_u32 s52, 0
    s_mov_b32 s58, 0x7fff0000
    s_cselect_b32 s58, 0x3a0000, s58
    buffer_store_dword v240, v229, s[32:35], s58 offen sc1
    ds_write_b128 v252, v[212:215]
    s_cmp_ge_u32 s52, 2
    s_cbranch_scc1 F_merge_hi
    v_mfma_f32_16x16x32_bf16 a[64:67], a[240:243], v[80:83], a[64:67]
    s_lshl_b32 s57, s99, 15
    v_mfma_f32_16x16x32_bf16 a[68:71], a[240:243], v[84:87], a[68:71]
    s_add_u32 s57, s57, s55
    v_mfma_f32_16x16x32_bf16 a[72:75], a[240:243], v[88:91], a[72:75]
    s_add_u32 s57, s57, 0x800000
    v_mfma_f32_16x16x32_bf16 a[76:79], a[240:243], v[92:95], a[76:79]
    s_add_u32 s57, s57, s17
    v_mfma_f32_16x16x32_bf16 a[80:83], a[244:247], v[80:83], a[80:83]
    buffer_load_dwordx4 a[144:147], v248, s[32:35], s57 offen offset:0 sc1
    v_mfma_f32_16x16x32_bf16 a[84:87], a[244:247], v[84:87], a[84:87]
    buffer_load_dwordx4 a[148:151], v248, s[32:35], s57 offen offset:1024 sc1
    v_mfma_f32_16x16x32_bf16 a[88:91], a[244:247], v[88:91], a[88:91]
    buffer_load_dwordx4 a[152:155], v248, s[32:35], s57 offen offset:2048 sc1
    v_mfma_f32_16x16x32_bf16 a[92:95], a[244:247], v[92:95], a[92:95]
    buffer_load_dwordx4 a[156:159], v248, s[32:35], s57 offen offset:3072 sc1
    v_mfma_f32_16x16x32_bf16 a[96:99], a[248:251], v[80:83], a[96:99]
    s_add_u32 s57, s57, 16384
    v_mfma_f32_16x16x32_bf16 a[100:103], a[248:251], v[84:87], a[100:103]
    ds_write_b128 v250, a[64:67] offset:0
    buffer_load_dwordx4 a[160:163], v248, s[32:35], s57 offen offset:0 sc1
    v_mfma_f32_16x16x32_bf16 a[104:107], a[248:251], v[88:91], a[104:107]
    ds_write_b128 v250, a[68:71] offset:1024
    buffer_load_dwordx4 a[164:167], v248, s[32:35], s57 offen offset:1024 sc1
    v_mfma_f32_16x16x32_bf16 a[108:111], a[248:251], v[92:95], a[108:111]
    buffer_load_dwordx4 a[168:171], v248, s[32:35], s57 offen offset:2048 sc1
    v_mfma_f32_16x16x32_bf16 a[112:115], a[252:255], v[80:83], a[112:115]
    ds_write_b128 v250, a[72:75] offset:2048
    buffer_load_dwordx4 a[172:175], v248, s[32:35], s57 offen offset:3072 sc1
    v_mfma_f32_16x16x32_bf16 a[116:119], a[252:255], v[84:87], a[116:119]
    s_lshl_b32 s57, s52, 14
    ds_write_b128 v250, a[76:79] offset:3072
    v_mfma_f32_16x16x32_bf16 a[120:123], a[252:255], v[88:91], a[120:123]
    s_add_u32 s57, s57, s17
    v_mfma_f32_16x16x32_bf16 a[124:127], a[252:255], v[92:95], a[124:127]
    s_add_u32 s57, s57, 0xb00000
    ds_write_b128 v250, a[80:83] offset:4096
    v_mfma_f32_16x16x32_bf16 a[0:3], a[224:227], v[80:83], a[0:3]
    ds_write_b128 v250, a[84:87] offset:5120
    buffer_load_dwordx4 a[128:131], v235, s[32:35], s57 offen sc1
    v_mfma_f32_16x16x32_bf16 a[4:7], a[224:227], v[84:87], a[4:7]
    s_add_u32 s57, s57, 4096
    v_mfma_f32_16x16x32_bf16 a[8:11], a[224:227], v[88:91], a[8:11]
    ds_write_b128 v250, a[88:91] offset:6144
    buffer_load_dwordx4 a[132:135], v235, s[32:35], s57 offen sc1
    v_mfma_f32_16x16x32_bf16 a[12:15], a[224:227], v[92:95], a[12:15]
    s_add_u32 s57, s57, 4096
    ds_write_b128 v250, a[92:95] offset:7168
    v_mfma_f32_16x16x32_bf16 a[16:19], a[228:231], v[80:83], a[16:19]
    buffer_load_dwordx4 a[136:139], v235, s[32:35], s57 offen sc1
    v_mfma_f32_16x16x32_bf16 a[20:23], a[228:231], v[84:87], a[20:23]
    s_add_u32 s57, s57, 4096
    ds_write_b128 v250, a[96:99] offset:8192
    v_mfma_f32_16x16x32_bf16 a[24:27], a[228:231], v[88:91], a[24:27]
    ds_write_b128 v250, a[100:103] offset:9216
    buffer_load_dwordx4 a[140:143], v235, s[32:35], s57 offen sc1
    v_mfma_f32_16x16x32_bf16 a[28:31], a[228:231], v[92:95], a[28:31]
    v_mfma_f32_16x16x32_bf16 a[32:35], a[232:235], v[80:83], a[32:35]
    ds_write_b128 v250, a[104:107] offset:10240
    v_mfma_f32_16x16x32_bf16 a[36:39], a[232:235], v[84:87], a[36:39]
    ds_write_b128 v250, a[108:111] offset:11264
    v_mfma_f32_16x16x32_bf16 a[40:43], a[232:235], v[88:91], a[40:43]
    v_mfma_f32_16x16x32_bf16 a[44:47], a[232:235], v[92:95], a[44:47]
    ds_write_b128 v250, a[112:115] offset:12288
    v_mfma_f32_16x16x32_bf16 a[48:51], a[236:239], v[80:83], a[48:51]
    ds_write_b128 v250, a[116:119] offset:13312
    v_mfma_f32_16x16x32_bf16 a[52:55], a[236:239], v[84:87], a[52:55]
    v_mfma_f32_16x16x32_bf16 a[56:59], a[236:239], v[88:91], a[56:59]
    ds_write_b128 v250, a[120:123] offset:14336
    v_mfma_f32_16x16x32_bf16 a[60:63], a[236:239], v[92:95], a[60:63]
    ds_write_b128 v250, a[124:127] offset:15360
    s_waitcnt lgkmcnt(0)
    s_barrier
    ds_read_b128 v[220:223], v253
    ds_read_b128 v[0:3], v251 offset:0
    ds_read_b128 v[4:7], v251 offset:1024
    ds_read_b128 v[8:11], v251 offset:2048
    ds_read_b128 v[12:15], v251 offset:3072
    ds_read_b128 v[16:19], v251 offset:4096
    ds_read_b128 v[20:23], v251 offset:5120
    ds_read_b128 v[24:27], v251 offset:6144
    ds_read_b128 v[28:31], v251 offset:7168
    ds_read_b128 v[32:35], v251 offset:8192
    ds_read_b128 v[36:39], v251 offset:9216
    ds_read_b128 v[40:43], v251 offset:10240
    ds_read_b128 v[44:47], v251 offset:11264
    ds_read_b128 v[48:51], v251 offset:12288
    ds_read_b128 v[52:55], v251 offset:13312
    ds_read_b128 v[56:59], v251 offset:14336
    ds_read_b128 v[60:63], v251 offset:15360
F_mrd0:
    v_accvgpr_read_b32 v64, a0
    v_accvgpr_read_b32 v65, a1
    v_accvgpr_read_b32 v66, a2
    v_accvgpr_read_b32 v67, a3
    v_accvgpr_read_b32 v68, a16
    v_accvgpr_read_b32 v69, a17
    v_accvgpr_read_b32 v70, a18
    v_accvgpr_read_b32 v71, a19
    v_accvgpr_read_b32 v72, a4
    v_accvgpr_read_b32 v73, a5
    v_accvgpr_read_b32 v74, a6
    v_accvgpr_read_b32 v75, a7
    v_accvgpr_read_b32 v76, a20
    v_accvgpr_read_b32 v77, a21
    v_accvgpr_read_b32 v78, a22
    v_accvgpr_read_b32 v79, a23
    v_accvgpr_read_b32 v80, a8
    v_accvgpr_read_b32 v81, a9
    v_accvgpr_read_b32 v82, a10
    v_accvgpr_read_b32 v83, a11
    v_accvgpr_read_b32 v84, a24
    v_accvgpr_read_b32 v85, a25
    v_accvgpr_read_b32 v86, a26
    v_accvgpr_read_b32 v87, a27
    v_accvgpr_read_b32 v88, a12
    v_accvgpr_read_b32 v89, a13
    v_accvgpr_read_b32 v90, a14
    v_accvgpr_read_b32 v91, a15
    v_accvgpr_read_b32 v92, a28
    v_accvgpr_read_b32 v93, a29
    v_accvgpr_read_b32 v94, a30
    v_accvgpr_read_b32 v95, a31
    v_accvgpr_read_b32 v96, a32
    v_accvgpr_read_b32 v97, a33
    v_accvgpr_read_b32 v98, a34
    v_accvgpr_read_b32 v99, a35
    v_accvgpr_read_b32 v100, a48
    v_accvgpr_read_b32 v101, a49
    v_accvgpr_read_b32 v102, a50
    v_accvgpr_read_b32 v103, a51
    v_accvgpr_read_b32 v104, a36
    v_accvgpr_read_b32 v105, a37
    v_accvgpr_read_b32 v106, a38
    v_accvgpr_read_b32 v107, a39
    v_accvgpr_read_b32 v108, a52
    v_accvgpr_read_b32 v109, a53
    v_accvgpr_read_b32 v110, a54
    v_accvgpr_read_b32 v111, a55
    v_accvgpr_read_b32 v112, a40
    v_accvgpr_read_b32 v113, a41
    v_accvgpr_read_b32 v114, a42
    v_accvgpr_read_b32 v115, a43
    v_accvgpr_read_b32 v116, a56
    v_accvgpr_read_b32 v117, a57
    v_accvgpr_read_b32 v118, a58
    v_accvgpr_read_b32 v119, a59
    v_accvgpr_read_b32 v120, a44
    v_accvgpr_read_b32 v121, a45
    v_accvgpr_read_b32 v122, a46
    v_accvgpr_read_b32 v123, a47
    v_accvgpr_read_b32 v124, a60
    v_accvgpr_read_b32 v125, a61
    v_accvgpr_read_b32 v126, a62
    v_accvgpr_read_b32 v127, a63
    s_waitcnt lgkmcnt(0)
    v_add_f32 v192, v212, v220
    v_add_f32 v196, v213, v221
    v_add_f32 v200, v214, v222
    v_add_f32 v204, v215, v223
    v_add_f32 v241, v192, v196
    v_add_f32 v240, v200, v204
    v_add_f32 v240, v240, v241
    v_mov_b32 v241, 0x5d800000
    v_cmp_nlt_f32 vcc, v240, v241
    s_nop 4
    s_cbranch_vccz F_mok0
    s_cmp_eq_u32 s96, 0
    s_cbranch_scc1 F_mok0
    s_call_b64 s[100:101], F_slow
    v_mov_b32 v0, 0
    v_mov_b32 v1, 0
    v_mov_b32 v2, 0
    v_mov_b32 v3, 0
    v_mov_b32 v4, 0
    v_mov_b32 v5, 0
    v_mov_b32 v6, 0
    v_mov_b32 v7, 0
    v_mov_b32 v8, 0
    v_mov_b32 v9, 0
    v_mov_b32 v10, 0
    v_mov_b32 v11, 0
    v_mov_b32 v12, 0
    v_mov_b32 v13, 0
    v_mov_b32 v14, 0
    v_mov_b32 v15, 0
    v_mov_b32 v16, 0
    v_mov_b32 v17, 0
    v_mov_b32 v18, 0
    v_mov_b32 v19, 0
    v_mov_b32 v20, 0
    v_mov_b32 v21, 0
    v_mov_b32 v22, 0
    v_mov_b32 v23, 0
    v_mov_b32 v24, 0
    v_mov_b32 v25, 0
    v_mov_b32 v26, 0
    v_mov_b32 v27, 0
    v_mov_b32 v28, 0
    v_mov_b32 v29, 0
    v_mov_b32 v30, 0
    v_mov_b32 v31, 0
    v_mov_b32 v32, 0
    v_mov_b32 v33, 0
    v_mov_b32 v34, 0
    v_mov_b32 v35, 0
    v_mov_b32 v36, 0
    v_mov_b32 v37, 0
    v_mov_b32 v38, 0
    v_mov_b32 v39, 0
    v_mov_b32 v40, 0
    v_mov_b32 v41, 0
    v_mov_b32 v42, 0
    v_mov_b32 v43, 0
    v_mov_b32 v44, 0
    v_mov_b32 v45, 0
    v_mov_b32 v46, 0
    v_mov_b32 v47, 0
    v_mov_b32 v48, 0
    v_mov_b32 v49, 0
    v_mov_b32 v50, 0
    v_mov_b32 v51, 0
    v_mov_b32 v52, 0
    v_mov_b32 v53, 0
    v_mov_b32 v54, 0
    v_mov_b32 v55, 0
    v_mov_b32 v56, 0
    v_mov_b32 v57, 0
    v_mov_b32 v58, 0
    v_mov_b32 v59, 0
    v_mov_b32 v60, 0
    v_mov_b32 v61, 0
    v_mov_b32 v62, 0
    v_mov_b32 v63, 0
    v_mov_b32 v212, v192
    v_mov_b32 v213, v196
    v_mov_b32 v214, v200
    v_mov_b32 v215, v204
    v_mov_b32 v220, 0
    v_mov_b32 v221, 0
    v_mov_b32 v222, 0
    v_mov_b32 v223, 0
    s_add_u32 s56, s10, 0
    buffer_load_dwordx4 a[192:195], v248, s[32:35], s56 offen offset:0 sc1
    buffer_load_dwordx4 a[196:199], v248, s[32:35], s56 offen offset:1024 sc1
    buffer_load_dwordx4 a[200:203], v248, s[32:35], s56 offen offset:2048 sc1
    buffer_load_dwordx4 a[204:207], v248, s[32:35], s56 offen offset:3072 sc1
    s_add_u32 s56, s10, 4096
    buffer_load_dwordx4 a[208:211], v248, s[32:35], s56 offen offset:0 sc1
    buffer_load_dwordx4 a[212:215], v248, s[32:35], s56 offen offset:1024 sc1
    buffer_load_dwordx4 a[216:219], v248, s[32:35], s56 offen offset:2048 sc1
    buffer_load_dwordx4 a[220:223], v248, s[32:35], s56 offen offset:3072 sc1
    s_waitcnt vmcnt(0)
    s_mov_b32 s96, 0
    s_branch F_mrd0
F_mok0:
    v_rcp_f32 v236, v192
    v_rcp_f32 v237, v196
    v_rcp_f32 v238, v200
    v_rcp_f32 v239, v204
    v_pk_add_f32 v[64:65], v[64:65], v[0:1]
    v_pk_add_f32 v[66:67], v[66:67], v[2:3]
    v_pk_add_f32 v[68:69], v[68:69], v[16:17]
    v_pk_add_f32 v[70:71], v[70:71], v[18:19]
    v_pk_mul_f32 v[64:65], v[64:65], v[236:237] op_sel:[0,0] op_sel_hi:[1,0]
    v_pk_mul_f32 v[66:67], v[66:67], v[236:237] op_sel:[0,0] op_sel_hi:[1,0]
    v_pk_mul_f32 v[68:69], v[68:69], v[236:237] op_sel:[0,0] op_sel_hi:[1,0]
    v_pk_mul_f32 v[70:71], v[70:71], v[236:237] op_sel:[0,0] op_sel_hi:[1,0]
    v_cvt_pk_bf16_f32 v64, v64, v65
    v_cvt_pk_bf16_f32 v65, v66, v67
    v_cvt_pk_bf16_f32 v66, v68, v69
    v_cvt_pk_bf16_f32 v67, v70, v71
    s_add_u32 s58, s63, 0
    buffer_store_dwordx4 v[64:67], v248, s[32:35], s58 offen offset:0 sc1
    v_pk_add_f32 v[72:73], v[72:73], v[4:5]
    v_pk_add_f32 v[74:75], v[74:75], v[6:7]
    v_pk_add_f32 v[76:77], v[76:77], v[20:21]
    v_pk_add_f32 v[78:79], v[78:79], v[22:23]
    v_pk_mul_f32 v[72:73], v[72:73], v[236:237] op_sel:[0,1] op_sel_hi:[1,1]
    v_pk_mul_f32 v[74:75], v[74:75], v[236:237] op_sel:[0,1] op_sel_hi:[1,1]
    v_pk_mul_f32 v[76:77], v[76:77], v[236:237] op_sel:[0,1] op_sel_hi:[1,1]
    v_pk_mul_f32 v[78:79], v[78:79], v[236:237] op_sel:[0,1] op_sel_hi:[1,1]
    v_cvt_pk_bf16_f32 v72, v72, v73
    v_cvt_pk_bf16_f32 v73, v74, v75
    v_cvt_pk_bf16_f32 v74, v76, v77
    v_cvt_pk_bf16_f32 v75, v78, v79
    buffer_store_dwordx4 v[72:75], v248, s[32:35], s58 offen offset:1024 sc1
    v_pk_add_f32 v[80:81], v[80:81], v[8:9]
    v_pk_add_f32 v[82:83], v[82:83], v[10:11]
    v_pk_add_f32 v[84:85], v[84:85], v[24:25]
    v_pk_add_f32 v[86:87], v[86:87], v[26:27]
    v_pk_mul_f32 v[80:81], v[80:81], v[238:239] op_sel:[0,0] op_sel_hi:[1,0]
    v_pk_mul_f32 v[82:83], v[82:83], v[238:239] op_sel:[0,0] op_sel_hi:[1,0]
    v_pk_mul_f32 v[84:85], v[84:85], v[238:239] op_sel:[0,0] op_sel_hi:[1,0]
    v_pk_mul_f32 v[86:87], v[86:87], v[238:239] op_sel:[0,0] op_sel_hi:[1,0]
    v_cvt_pk_bf16_f32 v80, v80, v81
    v_cvt_pk_bf16_f32 v81, v82, v83
    v_cvt_pk_bf16_f32 v82, v84, v85
    v_cvt_pk_bf16_f32 v83, v86, v87
    buffer_store_dwordx4 v[80:83], v248, s[32:35], s58 offen offset:2048 sc1
    v_pk_add_f32 v[88:89], v[88:89], v[12:13]
    v_pk_add_f32 v[90:91], v[90:91], v[14:15]
    v_pk_add_f32 v[92:93], v[92:93], v[28:29]
    v_pk_add_f32 v[94:95], v[94:95], v[30:31]
    v_pk_mul_f32 v[88:89], v[88:89], v[238:239] op_sel:[0,1] op_sel_hi:[1,1]
    v_pk_mul_f32 v[90:91], v[90:91], v[238:239] op_sel:[0,1] op_sel_hi:[1,1]
    v_pk_mul_f32 v[92:93], v[92:93], v[238:239] op_sel:[0,1] op_sel_hi:[1,1]
    v_pk_mul_f32 v[94:95], v[94:95], v[238:239] op_sel:[0,1] op_sel_hi:[1,1]
    v_cvt_pk_bf16_f32 v88, v88, v89
    v_cvt_pk_bf16_f32 v89, v90, v91
    v_cvt_pk_bf16_f32 v90, v92, v93
    v_cvt_pk_bf16_f32 v91, v94, v95
    buffer_store_dwordx4 v[88:91], v248, s[32:35], s58 offen offset:3072 sc1
    v_pk_add_f32 v[96:97], v[96:97], v[32:33]
    v_pk_add_f32 v[98:99], v[98:99], v[34:35]
    v_pk_add_f32 v[100:101], v[100:101], v[48:49]
    v_pk_add_f32 v[102:103], v[102:103], v[50:51]
    v_pk_mul_f32 v[96:97], v[96:97], v[236:237] op_sel:[0,0] op_sel_hi:[1,0]
    v_pk_mul_f32 v[98:99], v[98:99], v[236:237] op_sel:[0,0] op_sel_hi:[1,0]
    v_pk_mul_f32 v[100:101], v[100:101], v[236:237] op_sel:[0,0] op_sel_hi:[1,0]
    v_pk_mul_f32 v[102:103], v[102:103], v[236:237] op_sel:[0,0] op_sel_hi:[1,0]
    v_cvt_pk_bf16_f32 v96, v96, v97
    v_cvt_pk_bf16_f32 v97, v98, v99
    v_cvt_pk_bf16_f32 v98, v100, v101
    v_cvt_pk_bf16_f32 v99, v102, v103
    s_add_u32 s58, s63, 4096
    buffer_store_dwordx4 v[96:99], v248, s[32:35], s58 offen offset:0 sc1
    v_pk_add_f32 v[104:105], v[104:105], v[36:37]
    v_pk_add_f32 v[106:107], v[106:107], v[38:39]
    v_pk_add_f32 v[108:109], v[108:109], v[52:53]
    v_pk_add_f32 v[110:111], v[110:111], v[54:55]
    v_pk_mul_f32 v[104:105], v[104:105], v[236:237] op_sel:[0,1] op_sel_hi:[1,1]
    v_pk_mul_f32 v[106:107], v[106:107], v[236:237] op_sel:[0,1] op_sel_hi:[1,1]
    v_pk_mul_f32 v[108:109], v[108:109], v[236:237] op_sel:[0,1] op_sel_hi:[1,1]
    v_pk_mul_f32 v[110:111], v[110:111], v[236:237] op_sel:[0,1] op_sel_hi:[1,1]
    v_cvt_pk_bf16_f32 v104, v104, v105
    v_cvt_pk_bf16_f32 v105, v106, v107
    v_cvt_pk_bf16_f32 v106, v108, v109
    v_cvt_pk_bf16_f32 v107, v110, v111
    buffer_store_dwordx4 v[104:107], v248, s[32:35], s58 offen offset:1024 sc1
    v_pk_add_f32 v[112:113], v[112:113], v[40:41]
    v_pk_add_f32 v[114:115], v[114:115], v[42:43]
    v_pk_add_f32 v[116:117], v[116:117], v[56:57]
    v_pk_add_f32 v[118:119], v[118:119], v[58:59]
    v_pk_mul_f32 v[112:113], v[112:113], v[238:239] op_sel:[0,0] op_sel_hi:[1,0]
    v_pk_mul_f32 v[114:115], v[114:115], v[238:239] op_sel:[0,0] op_sel_hi:[1,0]
    v_pk_mul_f32 v[116:117], v[116:117], v[238:239] op_sel:[0,0] op_sel_hi:[1,0]
    v_pk_mul_f32 v[118:119], v[118:119], v[238:239] op_sel:[0,0] op_sel_hi:[1,0]
    v_cvt_pk_bf16_f32 v112, v112, v113
    v_cvt_pk_bf16_f32 v113, v114, v115
    v_cvt_pk_bf16_f32 v114, v116, v117
    v_cvt_pk_bf16_f32 v115, v118, v119
    buffer_store_dwordx4 v[112:115], v248, s[32:35], s58 offen offset:2048 sc1
    v_pk_add_f32 v[120:121], v[120:121], v[44:45]
    v_pk_add_f32 v[122:123], v[122:123], v[46:47]
    v_pk_add_f32 v[124:125], v[124:125], v[60:61]
    v_pk_add_f32 v[126:127], v[126:127], v[62:63]
    v_pk_mul_f32 v[120:121], v[120:121], v[238:239] op_sel:[0,1] op_sel_hi:[1,1]
    v_pk_mul_f32 v[122:123], v[122:123], v[238:239] op_sel:[0,1] op_sel_hi:[1,1]
    v_pk_mul_f32 v[124:125], v[124:125], v[238:239] op_sel:[0,1] op_sel_hi:[1,1]
    v_pk_mul_f32 v[126:127], v[126:127], v[238:239] op_sel:[0,1] op_sel_hi:[1,1]
    v_cvt_pk_bf16_f32 v120, v120, v121
    v_cvt_pk_bf16_f32 v121, v122, v123
    v_cvt_pk_bf16_f32 v122, v124, v125
    v_cvt_pk_bf16_f32 v123, v126, v127
    buffer_store_dwordx4 v[120:123], v248, s[32:35], s58 offen offset:3072 sc1
    s_branch F_phaseD
F_merge_hi:
    v_mfma_f32_16x16x32_bf16 a[0:3], a[224:227], v[80:83], a[0:3]
    s_lshl_b32 s57, s99, 15
    v_mfma_f32_16x16x32_bf16 a[4:7], a[224:227], v[84:87], a[4:7]
    s_add_u32 s57, s57, s55
    v_mfma_f32_16x16x32_bf16 a[8:11], a[224:227], v[88:91], a[8:11]
    s_add_u32 s57, s57, 0x800000
    v_mfma_f32_16x16x32_bf16 a[12:15], a[224:227], v[92:95], a[12:15]
    s_add_u32 s57, s57, s17
    v_mfma_f32_16x16x32_bf16 a[16:19], a[228:231], v[80:83], a[16:19]
    buffer_load_dwordx4 a[144:147], v248, s[32:35], s57 offen offset:0 sc1
    v_mfma_f32_16x16x32_bf16 a[20:23], a[228:231], v[84:87], a[20:23]
    buffer_load_dwordx4 a[148:151], v248, s[32:35], s57 offen offset:1024 sc1
    v_mfma_f32_16x16x32_bf16 a[24:27], a[228:231], v[88:91], a[24:27]
    buffer_load_dwordx4 a[152:155], v248, s[32:35], s57 offen offset:2048 sc1
    v_mfma_f32_16x16x32_bf16 a[28:31], a[228:231], v[92:95], a[28:31]
    buffer_load_dwordx4 a[156:159], v248, s[32:35], s57 offen offset:3072 sc1
    v_mfma_f32_16x16x32_bf16 a[32:35], a[232:235], v[80:83], a[32:35]
    s_add_u32 s57, s57, 16384
    v_mfma_f32_16x16x32_bf16 a[36:39], a[232:235], v[84:87], a[36:39]
    ds_write_b128 v250, a[0:3] offset:0
    buffer_load_dwordx4 a[160:163], v248, s[32:35], s57 offen offset:0 sc1
    v_mfma_f32_16x16x32_bf16 a[40:43], a[232:235], v[88:91], a[40:43]
    ds_write_b128 v250, a[4:7] offset:1024
    buffer_load_dwordx4 a[164:167], v248, s[32:35], s57 offen offset:1024 sc1
    v_mfma_f32_16x16x32_bf16 a[44:47], a[232:235], v[92:95], a[44:47]
    buffer_load_dwordx4 a[168:171], v248, s[32:35], s57 offen offset:2048 sc1
    v_mfma_f32_16x16x32_bf16 a[48:51], a[236:239], v[80:83], a[48:51]
    ds_write_b128 v250, a[8:11] offset:2048
    buffer_load_dwordx4 a[172:175], v248, s[32:35], s57 offen offset:3072 sc1
    v_mfma_f32_16x16x32_bf16 a[52:55], a[236:239], v[84:87], a[52:55]
    s_lshl_b32 s57, s52, 14
    ds_write_b128 v250, a[12:15] offset:3072
    v_mfma_f32_16x16x32_bf16 a[56:59], a[236:239], v[88:91], a[56:59]
    s_add_u32 s57, s57, s17
    v_mfma_f32_16x16x32_bf16 a[60:63], a[236:239], v[92:95], a[60:63]
    s_add_u32 s57, s57, 0xb00000
    ds_write_b128 v250, a[16:19] offset:4096
    v_mfma_f32_16x16x32_bf16 a[64:67], a[240:243], v[80:83], a[64:67]
    ds_write_b128 v250, a[20:23] offset:5120
    buffer_load_dwordx4 a[128:131], v235, s[32:35], s57 offen sc1
    v_mfma_f32_16x16x32_bf16 a[68:71], a[240:243], v[84:87], a[68:71]
    s_add_u32 s57, s57, 4096
    v_mfma_f32_16x16x32_bf16 a[72:75], a[240:243], v[88:91], a[72:75]
    ds_write_b128 v250, a[24:27] offset:6144
    buffer_load_dwordx4 a[132:135], v235, s[32:35], s57 offen sc1
    v_mfma_f32_16x16x32_bf16 a[76:79], a[240:243], v[92:95], a[76:79]
    s_add_u32 s57, s57, 4096
    ds_write_b128 v250, a[28:31] offset:7168
    v_mfma_f32_16x16x32_bf16 a[80:83], a[244:247], v[80:83], a[80:83]
    buffer_load_dwordx4 a[136:139], v235, s[32:35], s57 offen sc1
    v_mfma_f32_16x16x32_bf16 a[84:87], a[244:247], v[84:87], a[84:87]
    s_add_u32 s57, s57, 4096
    ds_write_b128 v250, a[32:35] offset:8192
    v_mfma_f32_16x16x32_bf16 a[88:91], a[244:247], v[88:91], a[88:91]
    ds_write_b128 v250, a[36:39] offset:9216
    buffer_load_dwordx4 a[140:143], v235, s[32:35], s57 offen sc1
    v_mfma_f32_16x16x32_bf16 a[92:95], a[244:247], v[92:95], a[92:95]
    v_mfma_f32_16x16x32_bf16 a[96:99], a[248:251], v[80:83], a[96:99]
    ds_write_b128 v250, a[40:43] offset:10240
    v_mfma_f32_16x16x32_bf16 a[100:103], a[248:251], v[84:87], a[100:103]
    ds_write_b128 v250, a[44:47] offset:11264
    v_mfma_f32_16x16x32_bf16 a[104:107], a[248:251], v[88:91], a[104:107]
    v_mfma_f32_16x16x32_bf16 a[108:111], a[248:251], v[92:95], a[108:111]
    ds_write_b128 v250, a[48:51] offset:12288
    v_mfma_f32_16x16x32_bf16 a[112:115], a[252:255], v[80:83], a[112:115]
    ds_write_b128 v250, a[52:55] offset:13312
    v_mfma_f32_16x16x32_bf16 a[116:119], a[252:255], v[84:87], a[116:119]
    v_mfma_f32_16x16x32_bf16 a[120:123], a[252:255], v[88:91], a[120:123]
    ds_write_b128 v250, a[56:59] offset:14336
    v_mfma_f32_16x16x32_bf16 a[124:127], a[252:255], v[92:95], a[124:127]
    ds_write_b128 v250, a[60:63] offset:15360
    s_waitcnt lgkmcnt(0)
    s_barrier
    ds_read_b128 v[220:223], v253
    ds_read_b128 v[0:3], v251 offset:0
    ds_read_b128 v[4:7], v251 offset:1024
    ds_read_b128 v[8:11], v251 offset:2048
    ds_read_b128 v[12:15], v251 offset:3072
    ds_read_b128 v[16:19], v251 offset:4096
    ds_read_b128 v[20:23], v251 offset:5120
    ds_read_b128 v[24:27], v251 offset:6144
    ds_read_b128 v[28:31], v251 offset:7168
    ds_read_b128 v[32:35], v251 offset:8192
    ds_read_b128 v[36:39], v251 offset:9216
    ds_read_b128 v[40:43], v251 offset:10240
    ds_read_b128 v[44:47], v251 offset:11264
    ds_read_b128 v[48:51], v251 offset:12288
    ds_read_b128 v[52:55], v251 offset:13312
    ds_read_b128 v[56:59], v251 offset:14336
    ds_read_b128 v[60:63], v251 offset:15360
F_mrd1:
    v_accvgpr_read_b32 v64, a64
    v_accvgpr_read_b32 v65, a65
    v_accvgpr_read_b32 v66, a66
    v_accvgpr_read_b32 v67, a67
    v_accvgpr_read_b32 v68, a80
    v_accvgpr_read_b32 v69, a81
    v_accvgpr_read_b32 v70, a82
    v_accvgpr_read_b32 v71, a83
    v_accvgpr_read_b32 v72, a68
    v_accvgpr_read_b32 v73, a69
    v_accvgpr_read_b32 v74, a70
    v_accvgpr_read_b32 v75, a71
    v_accvgpr_read_b32 v76, a84
    v_accvgpr_read_b32 v77, a85
    v_accvgpr_read_b32 v78, a86
    v_accvgpr_read_b32 v79, a87
    v_accvgpr_read_b32 v80, a72
    v_accvgpr_read_b32 v81, a73
    v_accvgpr_read_b32 v82, a74
    v_accvgpr_read_b32 v83, a75
    v_accvgpr_read_b32 v84, a88
    v_accvgpr_read_b32 v85, a89
    v_accvgpr_read_b32 v86, a90
    v_accvgpr_read_b32 v87, a91
    v_accvgpr_read_b32 v88, a76
    v_accvgpr_read_b32 v89, a77
    v_accvgpr_read_b32 v90, a78
    v_accvgpr_read_b32 v91, a79
    v_accvgpr_read_b32 v92, a92
    v_accvgpr_read_b32 v93, a93
    v_accvgpr_read_b32 v94, a94
    v_accvgpr_read_b32 v95, a95
    v_accvgpr_read_b32 v96, a96
    v_accvgpr_read_b32 v97, a97
    v_accvgpr_read_b32 v98, a98
    v_accvgpr_read_b32 v99, a99
    v_accvgpr_read_b32 v100, a112
    v_accvgpr_read_b32 v101, a113
    v_accvgpr_read_b32 v102, a114
    v_accvgpr_read_b32 v103, a115
    v_accvgpr_read_b32 v104, a100
    v_accvgpr_read_b32 v105, a101
    v_accvgpr_read_b32 v106, a102
    v_accvgpr_read_b32 v107, a103
    v_accvgpr_read_b32 v108, a116
    v_accvgpr_read_b32 v109, a117
    v_accvgpr_read_b32 v110, a118
    v_accvgpr_read_b32 v111, a119
    v_accvgpr_read_b32 v112, a104
    v_accvgpr_read_b32 v113, a105
    v_accvgpr_read_b32 v114, a106
    v_accvgpr_read_b32 v115, a107
    v_accvgpr_read_b32 v116, a120
    v_accvgpr_read_b32 v117, a121
    v_accvgpr_read_b32 v118, a122
    v_accvgpr_read_b32 v119, a123
    v_accvgpr_read_b32 v120, a108
    v_accvgpr_read_b32 v121, a109
    v_accvgpr_read_b32 v122, a110
    v_accvgpr_read_b32 v123, a111
    v_accvgpr_read_b32 v124, a124
    v_accvgpr_read_b32 v125, a125
    v_accvgpr_read_b32 v126, a126
    v_accvgpr_read_b32 v127, a127
    s_waitcnt lgkmcnt(0)
    v_add_f32 v192, v212, v220
    v_add_f32 v196, v213, v221
    v_add_f32 v200, v214, v222
    v_add_f32 v204, v215, v223
    v_add_f32 v241, v192, v196
    v_add_f32 v240, v200, v204
    v_add_f32 v240, v240, v241
    v_mov_b32 v241, 0x5d800000
    v_cmp_nlt_f32 vcc, v240, v241
    s_nop 4
    s_cbranch_vccz F_mok1
    s_cmp_eq_u32 s96, 0
    s_cbranch_scc1 F_mok1
    s_call_b64 s[100:101], F_slow
    v_mov_b32 v0, 0
    v_mov_b32 v1, 0
    v_mov_b32 v2, 0
    v_mov_b32 v3, 0
    v_mov_b32 v4, 0
    v_mov_b32 v5, 0
    v_mov_b32 v6, 0
    v_mov_b32 v7, 0
    v_mov_b32 v8, 0
    v_mov_b32 v9, 0
    v_mov_b32 v10, 0
    v_mov_b32 v11, 0
    v_mov_b32 v12, 0
    v_mov_b32 v13, 0
    v_mov_b32 v14, 0
    v_mov_b32 v15, 0
    v_mov_b32 v16, 0
    v_mov_b32 v17, 0
    v_mov_b32 v18, 0
    v_mov_b32 v19, 0
    v_mov_b32 v20, 0
    v_mov_b32 v21, 0
    v_mov_b32 v22, 0
    v_mov_b32 v23, 0
    v_mov_b32 v24, 0
    v_mov_b32 v25, 0
    v_mov_b32 v26, 0
    v_mov_b32 v27, 0
    v_mov_b32 v28, 0
    v_mov_b32 v29, 0
    v_mov_b32 v30, 0
    v_mov_b32 v31, 0
    v_mov_b32 v32, 0
    v_mov_b32 v33, 0
    v_mov_b32 v34, 0
    v_mov_b32 v35, 0
    v_mov_b32 v36, 0
    v_mov_b32 v37, 0
    v_mov_b32 v38, 0
    v_mov_b32 v39, 0
    v_mov_b32 v40, 0
    v_mov_b32 v41, 0
    v_mov_b32 v42, 0
    v_mov_b32 v43, 0
    v_mov_b32 v44, 0
    v_mov_b32 v45, 0
    v_mov_b32 v46, 0
    v_mov_b32 v47, 0
    v_mov_b32 v48, 0
    v_mov_b32 v49, 0
    v_mov_b32 v50, 0
    v_mov_b32 v51, 0
    v_mov_b32 v52, 0
    v_mov_b32 v53, 0
    v_mov_b32 v54, 0
    v_mov_b32 v55, 0
    v_mov_b32 v56, 0
    v_mov_b32 v57, 0
    v_mov_b32 v58, 0
    v_mov_b32 v59, 0
    v_mov_b32 v60, 0
    v_mov_b32 v61, 0
    v_mov_b32 v62, 0
    v_mov_b32 v63, 0
    v_mov_b32 v212, v192
    v_mov_b32 v213, v196
    v_mov_b32 v214, v200
    v_mov_b32 v215, v204
    v_mov_b32 v220, 0
    v_mov_b32 v221, 0
    v_mov_b32 v222, 0
    v_mov_b32 v223, 0
    s_add_u32 s56, s10, 0
    buffer_load_dwordx4 a[192:195], v248, s[32:35], s56 offen offset:0 sc1
    buffer_load_dwordx4 a[196:199], v248, s[32:35], s56 offen offset:1024 sc1
    buffer_load_dwordx4 a[200:203], v248, s[32:35], s56 offen offset:2048 sc1
    buffer_load_dwordx4 a[204:207], v248, s[32:35], s56 offen offset:3072 sc1
    s_add_u32 s56, s10, 4096
    buffer_load_dwordx4 a[208:211], v248, s[32:35], s56 offen offset:0 sc1
    buffer_load_dwordx4 a[212:215], v248, s[32:35], s56 offen offset:1024 sc1
    buffer_load_dwordx4 a[216:219], v248, s[32:35], s56 offen offset:2048 sc1
    buffer_load_dwordx4 a[220:223], v248, s[32:35], s56 offen offset:3072 sc1
    s_waitcnt vmcnt(0)
    s_mov_b32 s96, 0
    s_branch F_mrd1
F_mok1:
    v_rcp_f32 v236, v192
    v_rcp_f32 v237, v196
    v_rcp_f32 v238, v200
    v_rcp_f32 v239, v204
    v_pk_add_f32 v[64:65], v[64:65], v[0:1]
    v_pk_add_f32 v[66:67], v[66:67], v[2:3]
    v_pk_add_f32 v[68:69], v[68:69], v[16:17]
    v_pk_add_f32 v[70:71], v[70:71], v[18:19]
    v_pk_mul_f32 v[64:65], v[64:65], v[236:237] op_sel:[0,0] op_sel_hi:[1,0]
    v_pk_mul_f32 v[66:67], v[66:67], v[236:237] op_sel:[0,0] op_sel_hi:[1,0]
    v_pk_mul_f32 v[68:69], v[68:69], v[236:237] op_sel:[0,0] op_sel_hi:[1,0]
    v_pk_mul_f32 v[70:71], v[70:71], v[236:237] op_sel:[0,0] op_sel_hi:[1,0]
    v_cvt_pk_bf16_f32 v64, v64, v65
    v_cvt_pk_bf16_f32 v65, v66, v67
    v_cvt_pk_bf16_f32 v66, v68, v69
    v_cvt_pk_bf16_f32 v67, v70, v71
    s_add_u32 s58, s63, 8192
    buffer_store_dwordx4 v[64:67], v248, s[32:35], s58 offen offset:0 sc1
    v_pk_add_f32 v[72:73], v[72:73], v[4:5]
    v_pk_add_f32 v[74:75], v[74:75], v[6:7]
    v_pk_add_f32 v[76:77], v[76:77], v[20:21]
    v_pk_add_f32 v[78:79], v[78:79], v[22:23]
    v_pk_mul_f32 v[72:73], v[72:73], v[236:237] op_sel:[0,1] op_sel_hi:[1,1]
    v_pk_mul_f32 v[74:75], v[74:75], v[236:237] op_sel:[0,1] op_sel_hi:[1,1]
    v_pk_mul_f32 v[76:77], v[76:77], v[236:237] op_sel:[0,1] op_sel_hi:[1,1]
    v_pk_mul_f32 v[78:79], v[78:79], v[236:237] op_sel:[0,1] op_sel_hi:[1,1]
    v_cvt_pk_bf16_f32 v72, v72, v73
    v_cvt_pk_bf16_f32 v73, v74, v75
    v_cvt_pk_bf16_f32 v74, v76, v77
    v_cvt_pk_bf16_f32 v75, v78, v79
    buffer_store_dwordx4 v[72:75], v248, s[32:35], s58 offen offset:1024 sc1
    v_pk_add_f32 v[80:81], v[80:81], v[8:9]
    v_pk_add_f32 v[82:83], v[82:83], v[10:11]
    v_pk_add_f32 v[84:85], v[84:85], v[24:25]
    v_pk_add_f32 v[86:87], v[86:87], v[26:27]
    v_pk_mul_f32 v[80:81], v[80:81], v[238:239] op_sel:[0,0] op_sel_hi:[1,0]
    v_pk_mul_f32 v[82:83], v[82:83], v[238:239] op_sel:[0,0] op_sel_hi:[1,0]
    v_pk_mul_f32 v[84:85], v[84:85], v[238:239] op_sel:[0,0] op_sel_hi:[1,0]
    v_pk_mul_f32 v[86:87], v[86:87], v[238:239] op_sel:[0,0] op_sel_hi:[1,0]
    v_cvt_pk_bf16_f32 v80, v80, v81
    v_cvt_pk_bf16_f32 v81, v82, v83
    v_cvt_pk_bf16_f32 v82, v84, v85
    v_cvt_pk_bf16_f32 v83, v86, v87
    buffer_store_dwordx4 v[80:83], v248, s[32:35], s58 offen offset:2048 sc1
    v_pk_add_f32 v[88:89], v[88:89], v[12:13]
    v_pk_add_f32 v[90:91], v[90:91], v[14:15]
    v_pk_add_f32 v[92:93], v[92:93], v[28:29]
    v_pk_add_f32 v[94:95], v[94:95], v[30:31]
    v_pk_mul_f32 v[88:89], v[88:89], v[238:239] op_sel:[0,1] op_sel_hi:[1,1]
    v_pk_mul_f32 v[90:91], v[90:91], v[238:239] op_sel:[0,1] op_sel_hi:[1,1]
    v_pk_mul_f32 v[92:93], v[92:93], v[238:239] op_sel:[0,1] op_sel_hi:[1,1]
    v_pk_mul_f32 v[94:95], v[94:95], v[238:239] op_sel:[0,1] op_sel_hi:[1,1]
    v_cvt_pk_bf16_f32 v88, v88, v89
    v_cvt_pk_bf16_f32 v89, v90, v91
    v_cvt_pk_bf16_f32 v90, v92, v93
    v_cvt_pk_bf16_f32 v91, v94, v95
    buffer_store_dwordx4 v[88:91], v248, s[32:35], s58 offen offset:3072 sc1
    v_pk_add_f32 v[96:97], v[96:97], v[32:33]
    v_pk_add_f32 v[98:99], v[98:99], v[34:35]
    v_pk_add_f32 v[100:101], v[100:101], v[48:49]
    v_pk_add_f32 v[102:103], v[102:103], v[50:51]
    v_pk_mul_f32 v[96:97], v[96:97], v[236:237] op_sel:[0,0] op_sel_hi:[1,0]
    v_pk_mul_f32 v[98:99], v[98:99], v[236:237] op_sel:[0,0] op_sel_hi:[1,0]
    v_pk_mul_f32 v[100:101], v[100:101], v[236:237] op_sel:[0,0] op_sel_hi:[1,0]
    v_pk_mul_f32 v[102:103], v[102:103], v[236:237] op_sel:[0,0] op_sel_hi:[1,0]
    v_cvt_pk_bf16_f32 v96, v96, v97
    v_cvt_pk_bf16_f32 v97, v98, v99
    v_cvt_pk_bf16_f32 v98, v100, v101
    v_cvt_pk_bf16_f32 v99, v102, v103
    s_add_u32 s58, s63, 12288
    buffer_store_dwordx4 v[96:99], v248, s[32:35], s58 offen offset:0 sc1
    v_pk_add_f32 v[104:105], v[104:105], v[36:37]
    v_pk_add_f32 v[106:107], v[106:107], v[38:39]
    v_pk_add_f32 v[108:109], v[108:109], v[52:53]
    v_pk_add_f32 v[110:111], v[110:111], v[54:55]
    v_pk_mul_f32 v[104:105], v[104:105], v[236:237] op_sel:[0,1] op_sel_hi:[1,1]
    v_pk_mul_f32 v[106:107], v[106:107], v[236:237] op_sel:[0,1] op_sel_hi:[1,1]
    v_pk_mul_f32 v[108:109], v[108:109], v[236:237] op_sel:[0,1] op_sel_hi:[1,1]
    v_pk_mul_f32 v[110:111], v[110:111], v[236:237] op_sel:[0,1] op_sel_hi:[1,1]
    v_cvt_pk_bf16_f32 v104, v104, v105
    v_cvt_pk_bf16_f32 v105, v106, v107
    v_cvt_pk_bf16_f32 v106, v108, v109
    v_cvt_pk_bf16_f32 v107, v110, v111
    buffer_store_dwordx4 v[104:107], v248, s[32:35], s58 offen offset:1024 sc1
    v_pk_add_f32 v[112:113], v[112:113], v[40:41]
    v_pk_add_f32 v[114:115], v[114:115], v[42:43]
    v_pk_add_f32 v[116:117], v[116:117], v[56:57]
    v_pk_add_f32 v[118:119], v[118:119], v[58:59]
    v_pk_mul_f32 v[112:113], v[112:113], v[238:239] op_sel:[0,0] op_sel_hi:[1,0]
    v_pk_mul_f32 v[114:115], v[114:115], v[238:239] op_sel:[0,0] op_sel_hi:[1,0]
    v_pk_mul_f32 v[116:117], v[116:117], v[238:239] op_sel:[0,0] op_sel_hi:[1,0]
    v_pk_mul_f32 v[118:119], v[118:119], v[238:239] op_sel:[0,0] op_sel_hi:[1,0]
    v_cvt_pk_bf16_f32 v112, v112, v113
    v_cvt_pk_bf16_f32 v113, v114, v115
    v_cvt_pk_bf16_f32 v114, v116, v117
    v_cvt_pk_bf16_f32 v115, v118, v119
    buffer_store_dwordx4 v[112:115], v248, s[32:35], s58 offen offset:2048 sc1
    v_pk_add_f32 v[120:121], v[120:121], v[44:45]
    v_pk_add_f32 v[122:123], v[122:123], v[46:47]
    v_pk_add_f32 v[124:125], v[124:125], v[60:61]
    v_pk_add_f32 v[126:127], v[126:127], v[62:63]
    v_pk_mul_f32 v[120:121], v[120:121], v[238:239] op_sel:[0,1] op_sel_hi:[1,1]
    v_pk_mul_f32 v[122:123], v[122:123], v[238:239] op_sel:[0,1] op_sel_hi:[1,1]
    v_pk_mul_f32 v[124:125], v[124:125], v[238:239] op_sel:[0,1] op_sel_hi:[1,1]
    v_pk_mul_f32 v[126:127], v[126:127], v[238:239] op_sel:[0,1] op_sel_hi:[1,1]
    v_cvt_pk_bf16_f32 v120, v120, v121
    v_cvt_pk_bf16_f32 v121, v122, v123
    v_cvt_pk_bf16_f32 v122, v124, v125
    v_cvt_pk_bf16_f32 v123, v126, v127
    buffer_store_dwordx4 v[120:123], v248, s[32:35], s58 offen offset:3072 sc1
F_phaseD:
    s_waitcnt vmcnt(21)
    s_mov_b32 s16, 100000
F_pl8:
    v_cmp_ne_u32 vcc, s94, v230
    s_nop 4
    s_cbranch_vccz F_pd8
    s_sleep 4
    buffer_load_dword v230, v231, s[32:35], s95 offen offset:128 sc1
    s_sub_u32 s16, s16, 1
    s_waitcnt vmcnt(0)
    s_cbranch_scc0 F_pl8
F_pd8:
    s_barrier
    s_add_u32 m0, s13, 16384
    s_add_u32 s57, s11, 0
    buffer_load_dwordx4 v224, s[32:35], s57 offen offset:0 sc1 lds
    buffer_load_dwordx4 v225, s[32:35], s57 offen offset:1024 sc1 lds
    buffer_load_dwordx4 v226, s[32:35], s57 offen offset:2048 sc1 lds
    s_add_u32 m0, s13, 20480
    s_add_u32 s57, s11, 4096
    buffer_load_dwordx4 v224, s[32:35], s57 offen offset:0 sc1 lds
    buffer_load_dwordx4 v225, s[32:35], s57 offen offset:1024 sc1 lds
    buffer_load_dwordx4 v226, s[32:35], s57 offen offset:2048 sc1 lds
    ds_read_b128 a[224:227], v232 offset:49152
    ds_read_b128 a[228:231], v232 offset:50176
    ds_read_b128 a[232:235], v232 offset:51200
    ds_read_b128 a[236:239], v232 offset:52224
    ds_read_b128 a[240:243], v233 offset:0
    ds_read_b128 a[244:247], v233 offset:1024
    ds_read_b128 a[248:251], v233 offset:2048
    ds_read_b128 a[252:255], v233 offset:3072
    ds_read_b128 a[0:3], v254 offset:0
    ds_read_b128 a[4:7], v254 offset:1024
    ds_read_b128 a[8:11], v254 offset:2048
    ds_read_b128 a[12:15], v254 offset:3072
    ds_read_b128 a[16:19], v254 offset:16384
    ds_read_b128 a[20:23], v254 offset:17408
    ds_read_b128 a[24:27], v254 offset:18432
    ds_read_b128 a[28:31], v254 offset:19456
    ds_read_b128 a[32:35], v232 offset:0
    ds_read_b128 a[36:39], v232 offset:1024
    ds_read_b128 a[40:43], v232 offset:2048
    ds_read_b128 a[44:47], v232 offset:3072
    s_add_u32 s56, s10, 28672
    buffer_load_dwordx4 a[48:51], v248, s[32:35], s56 offen offset:0 sc1
    buffer_load_dwordx4 a[52:55], v248, s[32:35], s56 offen offset:1024 sc1
    buffer_load_dwordx4 a[56:59], v248, s[32:35], s56 offen offset:2048 sc1
    buffer_load_dwordx4 a[60:63], v248, s[32:35], s56 offen offset:3072 sc1
    v_mov_b32 v236, v248
    v_add_u32 v237, 0x10000, v248
    v_add_u32 v238, 0x20000, v248
    s_add_u32 s56, s52, 1
    s_bfe_u32 s56, s56, 0x10001
    s_xor_b32 s56, s56, 1
    s_and_b32 s57, s2, 0x3e
    s_or_b32 s56, s56, s57
    s_lshl_b32 s56, s56, 9
    s_and_b32 s57, s53, 7
    s_lshl_b32 s57, s57, 3
    s_add_u32 s56, s56, s57
    s_lshr_b32 s57, s52, 1
    s_lshl_b32 s57, s57, 2
    s_add_u32 s56, s56, s57
    s_add_u32 s56, s56, 384
    v_lshl_add_u32 v229, v249, 15, s56
    v_cmp_gt_u32 vcc, 4, v249
    v_mov_b32 v240, 0x40000000
    s_nop 1
    v_cndmask_b32 v229, v240, v229, vcc
    s_waitcnt vmcnt(10)
    v_mov_b32 v240, s94
    s_mov_b32 s58, 0x3a0000
    buffer_store_dword v240, v229, s[32:35], s58 offen sc1
    s_add_u32 m0, s13, 81920
    s_add_u32 s57, s11, 32768
    buffer_load_dwordx4 v224, s[32:35], s57 offen offset:0 sc1 lds
    buffer_load_dwordx4 v225, s[32:35], s57 offen offset:1024 sc1 lds
    buffer_load_dwordx4 v226, s[32:35], s57 offen offset:2048 sc1 lds
    s_add_u32 m0, s13, 86016
    s_add_u32 s57, s11, 36864
    buffer_load_dwordx4 v224, s[32:35], s57 offen offset:0 sc1 lds
    buffer_load_dwordx4 v225, s[32:35], s57 offen offset:1024 sc1 lds
    buffer_load_dwordx4 v226, s[32:35], s57 offen offset:2048 sc1 lds
    s_waitcnt vmcnt(11)
    s_waitcnt lgkmcnt(0)
    s_barrier
    ds_read_b128 v[64:67], v236 offset:16384
    ds_read_b128 v[68:71], v236 offset:20480
    ds_read_b128 v[72:75], v236 offset:24576
    ds_read_b128 v[76:79], v236 offset:28672
    ds_read_b128 v[80:83], v236 offset:17408
    ds_read_b128 v[84:87], v236 offset:21504
    ds_read_b128 v[88:91], v236 offset:25600
    ds_read_b128 v[92:95], v236 offset:29696
    s_waitcnt lgkmcnt(3)
    v_mfma_f32_16x16x32_bf16 v[16:19], a[192:195], v[64:67], 0
    s_add_u32 s56, s10, 32768
    s_lshl_b32 s70, s52, 11
    s_add_u32 s70, s70, 155648
    ds_read_b128 v[96:99], v236 offset:18432
    v_add_u32 v243, s70, v248
    v_mfma_f32_16x16x32_bf16 v[16:19], a[200:203], v[68:71], v[16:19]
    ds_read_b128 v[100:103], v236 offset:22528
    buffer_load_dwordx4 a[64:67], v248, s[32:35], s56 offen offset:0 sc1
    v_add_u32 v244, 155648, v248
    v_mfma_f32_16x16x32_bf16 v[16:19], a[208:211], v[72:75], v[16:19]
    ds_read_b128 v[104:107], v236 offset:26624
    buffer_load_dwordx4 a[68:71], v248, s[32:35], s56 offen offset:1024 sc1
    v_mfma_f32_16x16x32_bf16 v[112:115], a[144:147], a[128:131], 0
    v_mfma_f32_16x16x32_bf16 v[16:19], a[216:219], v[76:79], v[16:19]
    ds_read_b128 v[108:111], v236 offset:30720
    buffer_load_dwordx4 a[72:75], v248, s[32:35], s56 offen offset:2048 sc1
    v_mfma_f32_16x16x32_bf16 v[116:119], a[160:163], a[128:131], 0
    v_mfma_f32_16x16x32_bf16 v[20:23], a[196:199], v[64:67], 0
    buffer_load_dwordx4 a[76:79], v248, s[32:35], s56 offen offset:3072 sc1
    v_mfma_f32_16x16x32_bf16 v[112:115], a[148:151], a[132:135], v[112:115]
    v_mfma_f32_16x16x32_bf16 v[20:23], a[204:207], v[68:71], v[20:23]
    s_add_u32 s56, s10, 36864
    v_mfma_f32_16x16x32_bf16 v[116:119], a[164:167], a[132:135], v[116:119]
    v_mfma_f32_16x16x32_bf16 v[112:115], a[152:155], a[136:139], v[112:115]
    v_mfma_f32_16x16x32_bf16 v[20:23], a[212:215], v[72:75], v[20:23]
    buffer_load_dwordx4 a[80:83], v248, s[32:35], s56 offen offset:0 sc1
    v_mfma_f32_16x16x32_bf16 v[116:119], a[168:171], a[136:139], v[116:119]
    v_mfma_f32_16x16x32_bf16 v[20:23], a[220:223], v[76:79], v[20:23]
    buffer_load_dwordx4 a[84:87], v248, s[32:35], s56 offen offset:1024 sc1
    v_mfma_f32_16x16x32_bf16 v[112:115], a[156:159], a[140:143], v[112:115]
    v_mfma_f32_16x16x32_bf16 v[24:27], a[192:195], v[80:83], 0
    s_waitcnt lgkmcnt(2)
    ds_read_b128 v[64:67], v236 offset:32768
    buffer_load_dwordx4 a[88:91], v248, s[32:35], s56 offen offset:2048 sc1
    v_mfma_f32_16x16x32_bf16 v[116:119], a[172:175], a[140:143], v[116:119]
    v_mfma_f32_16x16x32_bf16 v[24:27], a[200:203], v[84:87], v[24:27]
    ds_read_b128 v[68:71], v236 offset:36864
    buffer_load_dwordx4 a[92:95], v248, s[32:35], s56 offen offset:3072 sc1
    v_mfma_f32_16x16x32_bf16 v[24:27], a[208:211], v[88:91], v[24:27]
    s_add_u32 s56, s10, 40960
    ds_read_b128 v[72:75], v236 offset:40960
    v_mfma_f32_16x16x32_bf16 v[24:27], a[216:219], v[92:95], v[24:27]
    ds_read_b128 v[76:79], v236 offset:45056
    buffer_load_dwordx4 a[96:99], v248, s[32:35], s56 offen offset:0 sc1
    v_mfma_f32_16x16x32_bf16 v[28:31], a[196:199], v[80:83], 0
    buffer_load_dwordx4 a[100:103], v248, s[32:35], s56 offen offset:1024 sc1
    v_mfma_f32_16x16x32_bf16 v[28:31], a[204:207], v[84:87], v[28:31]
    buffer_load_dwordx4 a[104:107], v248, s[32:35], s56 offen offset:2048 sc1
    v_mfma_f32_16x16x32_bf16 v[28:31], a[212:215], v[88:91], v[28:31]
    buffer_load_dwordx4 a[108:111], v248, s[32:35], s56 offen offset:3072 sc1
    v_mfma_f32_16x16x32_bf16 v[28:31], a[220:223], v[92:95], v[28:31]
    s_add_u32 s56, s10, 45056
    v_mfma_f32_16x16x32_bf16 v[32:35], a[192:195], v[96:99], 0
    ds_read_b128 v[80:83], v236 offset:33792
    buffer_load_dwordx4 a[112:115], v248, s[32:35], s56 offen offset:0 sc1
    ds_write_b128 v243, v[112:115]
    ds_write_b128 v243, v[116:119] offset:1024
    v_mfma_f32_16x16x32_bf16 v[32:35], a[200:203], v[100:103], v[32:35]
    s_waitcnt lgkmcnt(4)
    ds_read_b128 v[84:87], v236 offset:37888
    buffer_load_dwordx4 a[116:119], v248, s[32:35], s56 offen offset:1024 sc1
    v_mfma_f32_16x16x32_bf16 v[32:35], a[208:211], v[104:107], v[32:35]
    ds_read_b128 v[88:91], v236 offset:41984
    buffer_load_dwordx4 a[120:123], v248, s[32:35], s56 offen offset:2048 sc1
    v_mfma_f32_16x16x32_bf16 v[32:35], a[216:219], v[108:111], v[32:35]
    ds_read_b128 v[92:95], v236 offset:46080
    buffer_load_dwordx4 a[124:127], v248, s[32:35], s56 offen offset:3072 sc1
    v_mfma_f32_16x16x32_bf16 v[36:39], a[196:199], v[96:99], 0
    s_add_u32 m0, s13, 49152
    v_mfma_f32_16x16x32_bf16 v[36:39], a[204:207], v[100:103], v[36:39]
    s_add_u32 s57, s11, 65536
    v_mfma_f32_16x16x32_bf16 v[36:39], a[212:215], v[104:107], v[36:39]
    buffer_load_dwordx4 v224, s[32:35], s57 offen offset:0 sc1 lds
    v_mfma_f32_16x16x32_bf16 v[36:39], a[220:223], v[108:111], v[36:39]
    buffer_load_dwordx4 v225, s[32:35], s57 offen offset:1024 sc1 lds
    v_mfma_f32_16x16x32_bf16 v[16:19], a[224:227], v[64:67], v[16:19]
    ds_read_b128 v[96:99], v236 offset:34816
    buffer_load_dwordx4 v226, s[32:35], s57 offen offset:2048 sc1 lds
    v_mfma_f32_16x16x32_bf16 v[16:19], a[232:235], v[68:71], v[16:19]
    s_add_u32 m0, s13, 53248
    ds_read_b128 v[100:103], v236 offset:38912
    v_mfma_f32_16x16x32_bf16 v[16:19], a[240:243], v[72:75], v[16:19]
    s_waitcnt lgkmcnt(2)
    s_add_u32 s57, s11, 69632
    ds_read_b128 v[104:107], v236 offset:43008
    v_mfma_f32_16x16x32_bf16 v[16:19], a[248:251], v[76:79], v[16:19]
    ds_read_b128 v[108:111], v236 offset:47104
    buffer_load_dwordx4 v224, s[32:35], s57 offen offset:0 sc1 lds
    v_mfma_f32_16x16x32_bf16 v[20:23], a[228:231], v[64:67], v[20:23]
    buffer_load_dwordx4 v225, s[32:35], s57 offen offset:1024 sc1 lds
    v_mfma_f32_16x16x32_bf16 v[20:23], a[236:239], v[68:71], v[20:23]
    buffer_load_dwordx4 v226, s[32:35], s57 offen offset:2048 sc1 lds
    v_mfma_f32_16x16x32_bf16 v[20:23], a[244:247], v[72:75], v[20:23]
    s_add_u32 s56, s10, 49152
    v_mfma_f32_16x16x32_bf16 v[20:23], a[252:255], v[76:79], v[20:23]
    buffer_load_dwordx4 v[128:131], v248, s[32:35], s56 offen offset:0 sc1
    v_mfma_f32_16x16x32_bf16 v[24:27], a[224:227], v[80:83], v[24:27]
    buffer_load_dwordx4 v[132:135], v248, s[32:35], s56 offen offset:1024 sc1
    v_mfma_f32_16x16x32_bf16 v[24:27], a[232:235], v[84:87], v[24:27]
    buffer_load_dwordx4 v[136:139], v248, s[32:35], s56 offen offset:2048 sc1
    v_mfma_f32_16x16x32_bf16 v[24:27], a[240:243], v[88:91], v[24:27]
    buffer_load_dwordx4 v[140:143], v248, s[32:35], s56 offen offset:3072 sc1
    v_mfma_f32_16x16x32_bf16 v[24:27], a[248:251], v[92:95], v[24:27]
    s_add_u32 s56, s10, 53248
    v_mfma_f32_16x16x32_bf16 v[28:31], a[228:231], v[80:83], v[28:31]
    s_waitcnt vmcnt(26)
    s_waitcnt lgkmcnt(0)
    s_barrier
    ds_read_b128 v[64:67], v237 offset:16384
    buffer_load_dwordx4 v[144:147], v248, s[32:35], s56 offen offset:0 sc1
    v_mfma_f32_16x16x32_bf16 v[28:31], a[236:239], v[84:87], v[28:31]
    ds_read_b128 v[68:71], v237 offset:20480
    buffer_load_dwordx4 v[148:151], v248, s[32:35], s56 offen offset:1024 sc1
    ds_read_b128 v[40:43], v244 offset:0
    v_mfma_f32_16x16x32_bf16 v[28:31], a[244:247], v[88:91], v[28:31]
    ds_read_b128 v[72:75], v237 offset:24576
    buffer_load_dwordx4 v[152:155], v248, s[32:35], s56 offen offset:2048 sc1
    ds_read_b128 v[44:47], v244 offset:1024
    v_mfma_f32_16x16x32_bf16 v[28:31], a[252:255], v[92:95], v[28:31]
    ds_read_b128 v[76:79], v237 offset:28672
    buffer_load_dwordx4 v[156:159], v248, s[32:35], s56 offen offset:3072 sc1
    ds_read_b128 v[48:51], v244 offset:2048
    v_mfma_f32_16x16x32_bf16 v[32:35], a[224:227], v[96:99], v[32:35]
    s_add_u32 s56, s10, 57344
    ds_read_b128 v[80:83], v237 offset:17408
    ds_read_b128 v[52:55], v244 offset:3072
    ds_read_b128 v[208:211], v244 offset:4096
    v_mfma_f32_16x16x32_bf16 v[32:35], a[232:235], v[100:103], v[32:35]
    ds_read_b128 v[84:87], v237 offset:21504
    buffer_load_dwordx4 v[160:163], v248, s[32:35], s56 offen offset:0 sc1
    ds_read_b128 v[212:215], v244 offset:5120
    v_mfma_f32_16x16x32_bf16 v[32:35], a[240:243], v[104:107], v[32:35]
    ds_read_b128 v[88:91], v237 offset:25600
    buffer_load_dwordx4 v[164:167], v248, s[32:35], s56 offen offset:1024 sc1
    ds_read_b128 v[216:219], v244 offset:6144
    v_mfma_f32_16x16x32_bf16 v[32:35], a[248:251], v[108:111], v[32:35]
    ds_read_b128 v[92:95], v237 offset:29696
    buffer_load_dwordx4 v[168:171], v248, s[32:35], s56 offen offset:2048 sc1
    ds_read_b128 v[220:223], v244 offset:7168
    v_mfma_f32_16x16x32_bf16 v[36:39], a[228:231], v[96:99], v[36:39]
    buffer_load_dwordx4 v[172:175], v248, s[32:35], s56 offen offset:3072 sc1
    v_mfma_f32_16x16x32_bf16 v[36:39], a[236:239], v[100:103], v[36:39]
    s_add_u32 s56, s10, 61440
    v_mfma_f32_16x16x32_bf16 v[36:39], a[244:247], v[104:107], v[36:39]
    buffer_load_dwordx4 v[176:179], v248, s[32:35], s56 offen offset:0 sc1
    v_mfma_f32_16x16x32_bf16 v[36:39], a[252:255], v[108:111], v[36:39]
    s_waitcnt lgkmcnt(8)
    buffer_load_dwordx4 v[180:183], v248, s[32:35], s56 offen offset:1024 sc1
    v_mfma_f32_16x16x32_bf16 v[16:19], a[0:3], v[64:67], v[16:19]
    ds_read_b128 v[96:99], v237 offset:18432
    buffer_load_dwordx4 v[184:187], v248, s[32:35], s56 offen offset:2048 sc1
    v_mfma_f32_16x16x32_bf16 v[16:19], a[8:11], v[68:71], v[16:19]
    ds_read_b128 v[100:103], v237 offset:22528
    buffer_load_dwordx4 v[188:191], v248, s[32:35], s56 offen offset:3072 sc1
    v_mfma_f32_16x16x32_bf16 v[16:19], a[16:19], v[72:75], v[16:19]
    s_add_u32 m0, s13, 114688
    ds_read_b128 v[104:107], v237 offset:26624
    v_mfma_f32_16x16x32_bf16 v[16:19], a[24:27], v[76:79], v[16:19]
    s_add_u32 s57, s11, 98304
    s_waitcnt lgkmcnt(3)
    ds_read_b128 v[108:111], v237 offset:30720
    v_add_f32 v40, v40, v48
    v_mfma_f32_16x16x32_bf16 v[20:23], a[4:7], v[64:67], v[20:23]
    buffer_load_dwordx4 v224, s[32:35], s57 offen offset:0 sc1 lds
    v_add_f32 v41, v41, v49
    v_add_f32 v42, v42, v50
    v_mfma_f32_16x16x32_bf16 v[20:23], a[12:15], v[68:71], v[20:23]
    buffer_load_dwordx4 v225, s[32:35], s57 offen offset:1024 sc1 lds
    v_add_f32 v43, v43, v51
    v_add_f32 v44, v44, v52
    v_mfma_f32_16x16x32_bf16 v[20:23], a[20:23], v[72:75], v[20:23]
    buffer_load_dwordx4 v226, s[32:35], s57 offen offset:2048 sc1 lds
    v_add_f32 v45, v45, v53
    v_add_f32 v46, v46, v54
    v_mfma_f32_16x16x32_bf16 v[20:23], a[28:31], v[76:79], v[20:23]
    s_add_u32 m0, s13, 118784
    v_add_f32 v47, v47, v55
    v_add_f32 v208, v208, v216
    v_add_f32 v209, v209, v217
    v_mfma_f32_16x16x32_bf16 v[24:27], a[0:3], v[80:83], v[24:27]
    s_waitcnt lgkmcnt(2)
    s_add_u32 s57, s11, 102400
    ds_read_b128 v[64:67], v237 offset:32768
    v_add_f32 v210, v210, v218
    v_mfma_f32_16x16x32_bf16 v[24:27], a[8:11], v[84:87], v[24:27]
    ds_read_b128 v[68:71], v237 offset:36864
    buffer_load_dwordx4 v224, s[32:35], s57 offen offset:0 sc1 lds
    v_add_f32 v211, v211, v219
    v_mfma_f32_16x16x32_bf16 v[24:27], a[16:19], v[88:91], v[24:27]
    ds_read_b128 v[72:75], v237 offset:40960
    buffer_load_dwordx4 v225, s[32:35], s57 offen offset:1024 sc1 lds
    v_add_f32 v212, v212, v220
    v_mfma_f32_16x16x32_bf16 v[24:27], a[24:27], v[92:95], v[24:27]
    ds_read_b128 v[76:79], v237 offset:45056
    buffer_load_dwordx4 v226, s[32:35], s57 offen offset:2048 sc1 lds
    v_add_f32 v213, v213, v221
    v_mfma_f32_16x16x32_bf16 v[28:31], a[4:7], v[80:83], v[28:31]
    v_add_f32 v214, v214, v222
    v_add_f32 v215, v215, v223
    v_add_f32 v40, v40, v208
    v_mfma_f32_16x16x32_bf16 v[28:31], a[12:15], v[84:87], v[28:31]
    v_add_u32 v224, 0, v248
    v_add_u32 v225, 3072, v248
    v_add_f32 v41, v41, v209
    v_mfma_f32_16x16x32_bf16 v[28:31], a[20:23], v[88:91], v[28:31]
    v_add_u32 v226, 6144, v248
    v_add_u32 v227, 9216, v248
    v_add_f32 v42, v42, v210
    v_mfma_f32_16x16x32_bf16 v[28:31], a[28:31], v[92:95], v[28:31]
    v_add_f32 v43, v43, v211
    v_add_f32 v44, v44, v212
    v_add_f32 v45, v45, v213
    v_mfma_f32_16x16x32_bf16 v[32:35], a[0:3], v[96:99], v[32:35]
    ds_read_b128 v[80:83], v237 offset:33792
    v_add_f32 v46, v46, v214
    v_add_f32 v47, v47, v215
    v_mfma_f32_16x16x32_bf16 v[32:35], a[8:11], v[100:103], v[32:35]
    s_waitcnt lgkmcnt(2)
    ds_read_b128 v[84:87], v237 offset:37888
    v_cvt_pk_bf16_f32 v48, v40, v44
    v_cvt_pk_bf16_f32 v49, v41, v45
    v_mfma_f32_16x16x32_bf16 v[32:35], a[16:19], v[104:107], v[32:35]
    ds_read_b128 v[88:91], v237 offset:41984
    v_cvt_pk_bf16_f32 v50, v42, v46
    v_cvt_pk_bf16_f32 v51, v43, v47
    v_mfma_f32_16x16x32_bf16 v[32:35], a[24:27], v[108:111], v[32:35]
    ds_read_b128 v[92:95], v237 offset:46080
    v_lshlrev_b32 v40, 16, v48
    v_and_b32 v44, 0xffff0000, v48
    v_mfma_f32_16x16x32_bf16 v[36:39], a[4:7], v[96:99], v[36:39]
    v_lshlrev_b32 v41, 16, v49
    v_and_b32 v45, 0xffff0000, v49
    v_lshlrev_b32 v42, 16, v50
    v_mfma_f32_16x16x32_bf16 v[36:39], a[12:15], v[100:103], v[36:39]
    v_and_b32 v46, 0xffff0000, v50
    v_lshlrev_b32 v43, 16, v51
    v_and_b32 v47, 0xffff0000, v51
    v_mfma_f32_16x16x32_bf16 v[36:39], a[20:23], v[104:107], v[36:39]
    v_mul_f32 v48, 0xbfb8aa3b, v40
    v_mul_f32 v49, 0xbfb8aa3b, v41
    v_mul_f32 v50, 0xbfb8aa3b, v42
    v_mfma_f32_16x16x32_bf16 v[36:39], a[28:31], v[108:111], v[36:39]
    v_mul_f32 v51, 0xbfb8aa3b, v43
    v_exp_f32 v48, v48
    v_mfma_f32_16x16x32_bf16 v[16:19], a[32:35], v[64:67], v[16:19]
    ds_read_b128 v[96:99], v237 offset:34816
    v_exp_f32 v49, v49
    v_mfma_f32_16x16x32_bf16 v[16:19], a[40:43], v[68:71], v[16:19]
    ds_read_b128 v[100:103], v237 offset:38912
    v_exp_f32 v50, v50
    v_mfma_f32_16x16x32_bf16 v[16:19], a[48:51], v[72:75], v[16:19]
    s_waitcnt lgkmcnt(2)
    ds_read_b128 v[104:107], v237 offset:43008
    v_exp_f32 v51, v51
    v_mfma_f32_16x16x32_bf16 v[16:19], a[56:59], v[76:79], v[16:19]
    ds_read_b128 v[108:111], v237 offset:47104
    v_add_f32 v48, 1.0, v48
    v_add_f32 v49, 1.0, v49
    v_mfma_f32_16x16x32_bf16 v[20:23], a[36:39], v[64:67], v[20:23]
    v_add_f32 v50, 1.0, v50
    v_add_f32 v51, 1.0, v51
    v_mfma_f32_16x16x32_bf16 v[20:23], a[44:47], v[68:71], v[20:23]
    v_rcp_f32 v48, v48
    v_mfma_f32_16x16x32_bf16 v[20:23], a[52:55], v[72:75], v[20:23]
    v_rcp_f32 v49, v49
    v_mfma_f32_16x16x32_bf16 v[20:23], a[60:63], v[76:79], v[20:23]
    v_rcp_f32 v50, v50
    v_mfma_f32_16x16x32_bf16 v[24:27], a[32:35], v[80:83], v[24:27]
    v_min_u32 v247, 15, v249
    v_lshlrev_b32 v247, 2, v247
    buffer_load_dword v246, v247, s[32:35], s95 offen offset:384 sc1
    v_mfma_f32_16x16x32_bf16 v[24:27], a[40:43], v[84:87], v[24:27]
    v_rcp_f32 v51, v51
    v_mul_f32 v40, v40, v48
    v_mfma_f32_16x16x32_bf16 v[24:27], a[48:51], v[88:91], v[24:27]
    v_mul_f32 v41, v41, v49
    v_mul_f32 v42, v42, v50
    v_mul_f32 v43, v43, v51
    v_mfma_f32_16x16x32_bf16 v[24:27], a[56:59], v[92:95], v[24:27]
    v_cvt_pk_bf16_f32 v48, v40, v41
    v_cvt_pk_bf16_f32 v49, v42, v43
    v_lshlrev_b32 v40, 16, v48
    v_mfma_f32_16x16x32_bf16 v[28:31], a[36:39], v[80:83], v[28:31]
    s_waitcnt vmcnt(23)
    s_waitcnt lgkmcnt(0)
    s_barrier
    ds_read_b128 v[64:67], v236 offset:49152
    v_and_b32 v41, 0xffff0000, v48
    v_lshlrev_b32 v42, 16, v49
    v_mfma_f32_16x16x32_bf16 v[28:31], a[44:47], v[84:87], v[28:31]
    ds_read_b128 v[68:71], v236 offset:53248
    v_and_b32 v43, 0xffff0000, v49
    v_mul_f32 v40, v40, v44
    v_mfma_f32_16x16x32_bf16 v[28:31], a[52:55], v[88:91], v[28:31]
    ds_read_b128 v[72:75], v236 offset:57344
    v_mul_f32 v41, v41, v45
    v_mul_f32 v42, v42, v46
    v_mfma_f32_16x16x32_bf16 v[28:31], a[60:63], v[92:95], v[28:31]
    ds_read_b128 v[76:79], v236 offset:61440
    v_mul_f32 v43, v43, v47
    v_cvt_pk_bf16_f32 v52, v40, v41
    v_mfma_f32_16x16x32_bf16 v[32:35], a[32:35], v[96:99], v[32:35]
    ds_read_b128 v[80:83], v236 offset:50176
    v_cvt_pk_bf16_f32 v53, v42, v43
    v_and_b32 v243, 7, v249
    v_mfma_f32_16x16x32_bf16 v[32:35], a[40:43], v[100:103], v[32:35]
    ds_read_b128 v[84:87], v236 offset:54272
    v_lshlrev_b32 v243, 11, v243
    v_lshrrev_b32 v244, 4, v249
    v_mfma_f32_16x16x32_bf16 v[32:35], a[48:51], v[104:107], v[32:35]
    ds_read_b128 v[88:91], v236 offset:58368
    v_lshl_add_u32 v243, v244, 4, v243
    v_bfe_u32 v244, v249, 3, 1
    v_mfma_f32_16x16x32_bf16 v[32:35], a[56:59], v[108:111], v[32:35]
    ds_read_b128 v[92:95], v236 offset:62464
    v_lshl_add_u32 v243, v244, 6, v243
    v_cmp_eq_u32 s[0:1], 1, v244
    v_mfma_f32_16x16x32_bf16 v[36:39], a[36:39], v[96:99], v[36:39]
    s_lshl_b32 s70, s99, 14
    s_lshl_b32 s69, s52, 9
    s_add_u32 s70, s70, s69
    s_add_u32 s70, s70, 0x220000
    v_mfma_f32_16x16x32_bf16 v[36:39], a[44:47], v[100:103], v[36:39]
    s_add_u32 s70, s70, s17
    v_mfma_f32_16x16x16_bf16 v[112:115], a[176:177], v[52:53], 0
    v_mfma_f32_16x16x32_bf16 v[36:39], a[52:55], v[104:107], v[36:39]
    v_mfma_f32_16x16x16_bf16 v[116:119], a[178:179], v[52:53], 0
    v_mfma_f32_16x16x32_bf16 v[36:39], a[60:63], v[108:111], v[36:39]
    s_waitcnt lgkmcnt(3)
    v_mfma_f32_16x16x16_bf16 v[120:123], a[180:181], v[52:53], 0
    v_mfma_f32_16x16x32_bf16 v[16:19], a[64:67], v[64:67], v[16:19]
    ds_read_b128 v[96:99], v236 offset:51200
    v_mfma_f32_16x16x16_bf16 v[124:127], a[182:183], v[52:53], 0
    v_mfma_f32_16x16x32_bf16 v[16:19], a[72:75], v[68:71], v[16:19]
    ds_read_b128 v[100:103], v236 offset:55296
    v_mfma_f32_16x16x16_bf16 v[208:211], a[184:185], v[52:53], 0
    v_mfma_f32_16x16x32_bf16 v[16:19], a[80:83], v[72:75], v[16:19]
    ds_read_b128 v[104:107], v236 offset:59392
    v_mfma_f32_16x16x16_bf16 v[212:215], a[186:187], v[52:53], 0
    v_mfma_f32_16x16x32_bf16 v[16:19], a[88:91], v[76:79], v[16:19]
    ds_read_b128 v[108:111], v236 offset:63488
    v_mfma_f32_16x16x16_bf16 v[216:219], a[188:189], v[52:53], 0
    v_mfma_f32_16x16x32_bf16 v[20:23], a[68:71], v[64:67], v[20:23]
    v_mfma_f32_16x16x16_bf16 v[220:223], a[190:191], v[52:53], 0
    v_mfma_f32_16x16x32_bf16 v[20:23], a[76:79], v[68:71], v[20:23]
    v_mfma_f32_16x16x32_bf16 v[20:23], a[84:87], v[72:75], v[20:23]
    v_mfma_f32_16x16x32_bf16 v[20:23], a[92:95], v[76:79], v[20:23]
    v_mfma_f32_16x16x32_bf16 v[24:27], a[64:67], v[80:83], v[24:27]
    s_waitcnt lgkmcnt(2)
    ds_read_b128 v[64:67], v237 offset:0
    v_cndmask_b32 v112, v112, v116, s[0:1]
    v_cndmask_b32 v113, v113, v117, s[0:1]
    v_mfma_f32_16x16x32_bf16 v[24:27], a[72:75], v[84:87], v[24:27]
    ds_read_b128 v[68:71], v237 offset:4096
    v_cndmask_b32 v114, v114, v118, s[0:1]
    v_cndmask_b32 v115, v115, v119, s[0:1]
    v_mfma_f32_16x16x32_bf16 v[24:27], a[80:83], v[88:91], v[24:27]
    ds_read_b128 v[72:75], v237 offset:8192
    buffer_store_dwordx4 v[112:115], v243, s[32:35], s70 offen offset:0 sc1
    v_mfma_f32_16x16x32_bf16 v[24:27], a[88:91], v[92:95], v[24:27]
    ds_read_b128 v[76:79], v237 offset:12288
    v_mfma_f32_16x16x32_bf16 v[28:31], a[68:71], v[80:83], v[28:31]
    v_mfma_f32_16x16x32_bf16 v[28:31], a[76:79], v[84:87], v[28:31]
    v_cndmask_b32 v120, v120, v124, s[0:1]
    v_cndmask_b32 v121, v121, v125, s[0:1]
    v_cndmask_b32 v122, v122, v126, s[0:1]
    v_mfma_f32_16x16x32_bf16 v[28:31], a[84:87], v[88:91], v[28:31]
    v_cndmask_b32 v123, v123, v127, s[0:1]
    v_mfma_f32_16x16x32_bf16 v[28:31], a[92:95], v[92:95], v[28:31]
    buffer_store_dwordx4 v[120:123], v243, s[32:35], s70 offen offset:128 sc1
    v_mfma_f32_16x16x32_bf16 v[32:35], a[64:67], v[96:99], v[32:35]
    ds_read_b128 v[80:83], v237 offset:1024
    v_mfma_f32_16x16x32_bf16 v[32:35], a[72:75], v[100:103], v[32:35]
    s_waitcnt lgkmcnt(2)
    ds_read_b128 v[84:87], v237 offset:5120
    v_mfma_f32_16x16x32_bf16 v[32:35], a[80:83], v[104:107], v[32:35]
    ds_read_b128 v[88:91], v237 offset:9216
    v_cndmask_b32 v208, v208, v212, s[0:1]
    v_cndmask_b32 v209, v209, v213, s[0:1]
    v_mfma_f32_16x16x32_bf16 v[32:35], a[88:91], v[108:111], v[32:35]
    ds_read_b128 v[92:95], v237 offset:13312
    v_cndmask_b32 v210, v210, v214, s[0:1]
    v_cndmask_b32 v211, v211, v215, s[0:1]
    v_mfma_f32_16x16x32_bf16 v[36:39], a[68:71], v[96:99], v[36:39]
    buffer_store_dwordx4 v[208:211], v243, s[32:35], s70 offen offset:256 sc1
    v_mfma_f32_16x16x32_bf16 v[36:39], a[76:79], v[100:103], v[36:39]
    v_mfma_f32_16x16x32_bf16 v[36:39], a[84:87], v[104:107], v[36:39]
    v_mfma_f32_16x16x32_bf16 v[36:39], a[92:95], v[108:111], v[36:39]
    v_cndmask_b32 v216, v216, v220, s[0:1]
    v_cndmask_b32 v217, v217, v221, s[0:1]
    v_cndmask_b32 v218, v218, v222, s[0:1]
    v_mfma_f32_16x16x32_bf16 v[16:19], a[96:99], v[64:67], v[16:19]
    ds_read_b128 v[96:99], v237 offset:2048
    v_cndmask_b32 v219, v219, v223, s[0:1]
    v_mfma_f32_16x16x32_bf16 v[16:19], a[104:107], v[68:71], v[16:19]
    ds_read_b128 v[100:103], v237 offset:6144
    buffer_store_dwordx4 v[216:219], v243, s[32:35], s70 offen offset:384 sc1
    v_mfma_f32_16x16x32_bf16 v[16:19], a[112:115], v[72:75], v[16:19]
    s_waitcnt lgkmcnt(2)
    ds_read_b128 v[104:107], v237 offset:10240
    v_mfma_f32_16x16x32_bf16 v[16:19], a[120:123], v[76:79], v[16:19]
    ds_read_b128 v[108:111], v237 offset:14336
    v_mfma_f32_16x16x32_bf16 v[20:23], a[100:103], v[64:67], v[20:23]
    s_waitcnt vmcnt(4)
    s_mov_b32 s16, 100000
F_pl9:
    v_cmp_ne_u32 vcc, s94, v246
    s_nop 4
    s_cbranch_vccz F_pd9
    s_sleep 4
    buffer_load_dword v246, v247, s[32:35], s95 offen offset:384 sc1
    s_sub_u32 s16, s16, 1
    s_waitcnt vmcnt(0)
    s_cbranch_scc0 F_pl9
F_pd9:
    v_mfma_f32_16x16x32_bf16 v[20:23], a[108:111], v[68:71], v[20:23]
    s_add_u32 s73, s9, 1
    v_mfma_f32_16x16x32_bf16 v[20:23], a[116:119], v[72:75], v[20:23]
    s_and_b32 s73, s73, 3
    v_mfma_f32_16x16x32_bf16 v[20:23], a[124:127], v[76:79], v[20:23]
    s_lshl_b32 s73, s73, 10
    v_mfma_f32_16x16x32_bf16 v[24:27], a[96:99], v[80:83], v[24:27]
    s_add_u32 s73, s73, s12
    v_mfma_f32_16x16x32_bf16 v[24:27], a[104:107], v[84:87], v[24:27]
    s_add_u32 m0, s13, 16384
    v_mfma_f32_16x16x32_bf16 v[24:27], a[112:115], v[88:91], v[24:27]
    s_add_u32 s57, s73, 0
    v_mfma_f32_16x16x32_bf16 v[24:27], a[120:123], v[92:95], v[24:27]
    buffer_load_dwordx4 v224, s[32:35], s57 offen offset:0 sc1 lds
    v_mfma_f32_16x16x32_bf16 v[28:31], a[100:103], v[80:83], v[28:31]
    s_waitcnt lgkmcnt(0)
    s_barrier
    ds_read_b128 v[64:67], v237 offset:49152
    buffer_load_dwordx4 v225, s[32:35], s57 offen offset:1024 sc1 lds
    v_mfma_f32_16x16x32_bf16 v[28:31], a[108:111], v[84:87], v[28:31]
    ds_read_b128 v[68:71], v237 offset:53248
    buffer_load_dwordx4 v226, s[32:35], s57 offen offset:2048 sc1 lds
    v_mfma_f32_16x16x32_bf16 v[28:31], a[116:119], v[88:91], v[28:31]
    ds_read_b128 v[72:75], v237 offset:57344
    buffer_load_dwordx4 v227, s[32:35], s57 offen offset:3072 sc1 lds
    v_mfma_f32_16x16x32_bf16 v[28:31], a[124:127], v[92:95], v[28:31]
    s_add_u32 m0, s13, 20480
    ds_read_b128 v[76:79], v237 offset:61440
    v_mfma_f32_16x16x32_bf16 v[32:35], a[96:99], v[96:99], v[32:35]
    s_add_u32 s57, s73, 16384
    ds_read_b128 v[80:83], v237 offset:50176
    v_mfma_f32_16x16x32_bf16 v[32:35], a[104:107], v[100:103], v[32:35]
    ds_read_b128 v[84:87], v237 offset:54272
    buffer_load_dwordx4 v224, s[32:35], s57 offen offset:0 sc1 lds
    v_mfma_f32_16x16x32_bf16 v[32:35], a[112:115], v[104:107], v[32:35]
    ds_read_b128 v[88:91], v237 offset:58368
    buffer_load_dwordx4 v225, s[32:35], s57 offen offset:1024 sc1 lds
    v_mfma_f32_16x16x32_bf16 v[32:35], a[120:123], v[108:111], v[32:35]
    ds_read_b128 v[92:95], v237 offset:62464
    buffer_load_dwordx4 v226, s[32:35], s57 offen offset:2048 sc1 lds
    v_mfma_f32_16x16x32_bf16 v[36:39], a[100:103], v[96:99], v[36:39]
    buffer_load_dwordx4 v227, s[32:35], s57 offen offset:3072 sc1 lds
    v_mfma_f32_16x16x32_bf16 v[36:39], a[108:111], v[100:103], v[36:39]
    v_mfma_f32_16x16x32_bf16 v[36:39], a[116:119], v[104:107], v[36:39]
    s_add_u32 s73, s9, 2
    v_mfma_f32_16x16x32_bf16 v[36:39], a[124:127], v[108:111], v[36:39]
    s_waitcnt lgkmcnt(3)
    v_mfma_f32_16x16x32_bf16 v[16:19], v[128:131], v[64:67], v[16:19]
    s_and_b32 s73, s73, 3
    ds_read_b128 v[96:99], v237 offset:51200
    v_mfma_f32_16x16x32_bf16 v[16:19], v[136:139], v[68:71], v[16:19]
    ds_read_b128 v[100:103], v237 offset:55296
    v_mfma_f32_16x16x32_bf16 v[16:19], v[144:147], v[72:75], v[16:19]
    s_lshl_b32 s73, s73, 10
    ds_read_b128 v[104:107], v237 offset:59392
    v_mfma_f32_16x16x32_bf16 v[16:19], v[152:155], v[76:79], v[16:19]
    ds_read_b128 v[108:111], v237 offset:63488
    v_mfma_f32_16x16x32_bf16 v[20:23], v[132:135], v[64:67], v[20:23]
    s_add_u32 s73, s73, s12
    v_mfma_f32_16x16x32_bf16 v[20:23], v[140:143], v[68:71], v[20:23]
    v_mfma_f32_16x16x32_bf16 v[20:23], v[148:151], v[72:75], v[20:23]
    s_add_u32 m0, s13, 81920
    v_mfma_f32_16x16x32_bf16 v[20:23], v[156:159], v[76:79], v[20:23]
    v_mfma_f32_16x16x32_bf16 v[24:27], v[128:131], v[80:83], v[24:27]
    s_waitcnt lgkmcnt(2)
    s_add_u32 s57, s73, 0
    ds_read_b128 v[64:67], v238 offset:0
    v_mfma_f32_16x16x32_bf16 v[24:27], v[136:139], v[84:87], v[24:27]
    ds_read_b128 v[68:71], v238 offset:4096
    v_mfma_f32_16x16x32_bf16 v[24:27], v[144:147], v[88:91], v[24:27]
    ds_read_b128 v[72:75], v238 offset:8192
    buffer_load_dwordx4 v224, s[32:35], s57 offen offset:0 sc1 lds
    v_mfma_f32_16x16x32_bf16 v[24:27], v[152:155], v[92:95], v[24:27]
    ds_read_b128 v[76:79], v238 offset:12288
    v_mfma_f32_16x16x32_bf16 v[28:31], v[132:135], v[80:83], v[28:31]
    buffer_load_dwordx4 v225, s[32:35], s57 offen offset:1024 sc1 lds
    v_mfma_f32_16x16x32_bf16 v[28:31], v[140:143], v[84:87], v[28:31]
    v_mfma_f32_16x16x32_bf16 v[28:31], v[148:151], v[88:91], v[28:31]
    buffer_load_dwordx4 v226, s[32:35], s57 offen offset:2048 sc1 lds
    v_mfma_f32_16x16x32_bf16 v[28:31], v[156:159], v[92:95], v[28:31]
    v_mfma_f32_16x16x32_bf16 v[32:35], v[128:131], v[96:99], v[32:35]
    ds_read_b128 v[80:83], v238 offset:1024
    buffer_load_dwordx4 v227, s[32:35], s57 offen offset:3072 sc1 lds
    v_mfma_f32_16x16x32_bf16 v[32:35], v[136:139], v[100:103], v[32:35]
    s_waitcnt lgkmcnt(2)
    ds_read_b128 v[84:87], v238 offset:5120
    v_mfma_f32_16x16x32_bf16 v[32:35], v[144:147], v[104:107], v[32:35]
    s_add_u32 m0, s13, 86016
    ds_read_b128 v[88:91], v238 offset:9216
    v_mfma_f32_16x16x32_bf16 v[32:35], v[152:155], v[108:111], v[32:35]
    ds_read_b128 v[92:95], v238 offset:13312
    v_mfma_f32_16x16x32_bf16 v[36:39], v[132:135], v[96:99], v[36:39]
    s_add_u32 s57, s73, 16384
    v_mfma_f32_16x16x32_bf16 v[36:39], v[140:143], v[100:103], v[36:39]
    v_mfma_f32_16x16x32_bf16 v[36:39], v[148:151], v[104:107], v[36:39]
    buffer_load_dwordx4 v224, s[32:35], s57 offen offset:0 sc1 lds
    v_mfma_f32_16x16x32_bf16 v[36:39], v[156:159], v[108:111], v[36:39]
    v_mfma_f32_16x16x32_bf16 v[16:19], v[160:163], v[64:67], v[16:19]
    ds_read_b128 v[96:99], v238 offset:2048
    buffer_load_dwordx4 v225, s[32:35], s57 offen offset:1024 sc1 lds
    v_mfma_f32_16x16x32_bf16 v[16:19], v[168:171], v[68:71], v[16:19]
    ds_read_b128 v[100:103], v238 offset:6144
    v_mfma_f32_16x16x32_bf16 v[16:19], v[176:179], v[72:75], v[16:19]
    s_waitcnt lgkmcnt(2)
    ds_read_b128 v[104:107], v238 offset:10240
    buffer_load_dwordx4 v226, s[32:35], s57 offen offset:2048 sc1 lds
    v_mfma_f32_16x16x32_bf16 v[16:19], v[184:187], v[76:79], v[16:19]
    ds_read_b128 v[108:111], v238 offset:14336
    v_mfma_f32_16x16x32_bf16 v[20:23], v[164:167], v[64:67], v[20:23]
    buffer_load_dwordx4 v227, s[32:35], s57 offen offset:3072 sc1 lds
    v_mfma_f32_16x16x32_bf16 v[20:23], v[172:175], v[68:71], v[20:23]
    v_mfma_f32_16x16x32_bf16 v[20:23], v[180:183], v[72:75], v[20:23]
    v_mfma_f32_16x16x32_bf16 v[20:23], v[188:191], v[76:79], v[20:23]
    s_add_u32 s73, s9, 3
    v_mfma_f32_16x16x32_bf16 v[24:27], v[160:163], v[80:83], v[24:27]
    v_mfma_f32_16x16x32_bf16 v[24:27], v[168:171], v[84:87], v[24:27]
    s_and_b32 s73, s73, 3
    v_mfma_f32_16x16x32_bf16 v[24:27], v[176:179], v[88:91], v[24:27]
    v_mfma_f32_16x16x32_bf16 v[24:27], v[184:187], v[92:95], v[24:27]
    s_lshl_b32 s73, s73, 10
    v_mfma_f32_16x16x32_bf16 v[28:31], v[164:167], v[80:83], v[28:31]
    s_waitcnt vmcnt(8)
    s_waitcnt lgkmcnt(0)
    s_barrier
    ds_read_b128 v[64:67], v236 offset:16384
    v_mfma_f32_16x16x32_bf16 v[28:31], v[172:175], v[84:87], v[28:31]
    s_add_u32 s73, s73, s12
    ds_read_b128 v[68:71], v236 offset:17408
    v_mov_b32 v244, s94
    s_lshr_b32 s58, s2, 3
    s_mul_i32 s58, s58, 96
    s_lshl_b32 s16, s2, 2
    s_add_u32 s58, s58, s16
    s_add_u32 s58, s58, 0x3c2000
    s_cmp_eq_u32 s52, 0
    s_cselect_b32 s58, s58, 0x7fff0000
    v_min_u32 v243, 1, v249
    v_lshlrev_b32 v243, 30, v243
    buffer_store_dword v244, v243, s[32:35], s58 offen sc1
    v_mfma_f32_16x16x32_bf16 v[28:31], v[180:183], v[88:91], v[28:31]
    ds_read_b128 v[72:75], v236 offset:18432
    v_mfma_f32_16x16x32_bf16 v[28:31], v[188:191], v[92:95], v[28:31]
    s_add_u32 m0, s13, 49152
    ds_read_b128 v[76:79], v236 offset:19456
    v_mfma_f32_16x16x32_bf16 v[32:35], v[160:163], v[96:99], v[32:35]
    ds_read_b128 v[80:83], v236 offset:20480
    v_mfma_f32_16x16x32_bf16 v[32:35], v[168:171], v[100:103], v[32:35]
    s_add_u32 s57, s73, 0
    ds_read_b128 v[84:87], v236 offset:21504
    v_mfma_f32_16x16x32_bf16 v[32:35], v[176:179], v[104:107], v[32:35]
    ds_read_b128 v[88:91], v236 offset:22528
    v_mfma_f32_16x16x32_bf16 v[32:35], v[184:187], v[108:111], v[32:35]
    ds_read_b128 v[92:95], v236 offset:23552
    buffer_load_dwordx4 v224, s[32:35], s57 offen offset:0 sc1 lds
    v_mfma_f32_16x16x32_bf16 v[36:39], v[164:167], v[96:99], v[36:39]
    v_mfma_f32_16x16x32_bf16 v[36:39], v[172:175], v[100:103], v[36:39]
    buffer_load_dwordx4 v225, s[32:35], s57 offen offset:1024 sc1 lds
    v_mfma_f32_16x16x32_bf16 v[36:39], v[180:183], v[104:107], v[36:39]
    v_mfma_f32_16x16x32_bf16 v[36:39], v[188:191], v[108:111], v[36:39]
    s_waitcnt lgkmcnt(3)
    buffer_load_dwordx4 v226, s[32:35], s57 offen offset:2048 sc1 lds
    v_mfma_f32_16x16x32_bf16 v[40:43], a[192:195], v[64:67], 0
    ds_read_b128 v[96:99], v236 offset:24576
    v_mfma_f32_16x16x32_bf16 v[40:43], a[200:203], v[68:71], v[40:43]
    s_mul_i32 s56, s2, 50176
    ds_read_b128 v[100:103], v236 offset:25600
    buffer_load_dwordx4 v227, s[32:35], s57 offen offset:3072 sc1 lds
    v_mfma_f32_16x16x32_bf16 v[40:43], a[208:211], v[72:75], v[40:43]
    s_mul_i32 s10, s52, 12288
    s_add_u32 s56, s56, s10
    ds_read_b128 v[104:107], v236 offset:26624
    v_mfma_f32_16x16x32_bf16 v[40:43], a[216:219], v[76:79], v[40:43]
    s_add_u32 m0, s13, 53248
    s_add_u32 s10, s56, 0x4400000
    ds_read_b128 v[108:111], v236 offset:27648
    v_mfma_f32_16x16x32_bf16 v[44:47], a[196:199], v[64:67], 0
    v_mfma_f32_16x16x32_bf16 v[44:47], a[204:207], v[68:71], v[44:47]
    s_add_u32 s57, s73, 16384
    v_mfma_f32_16x16x32_bf16 v[44:47], a[212:215], v[72:75], v[44:47]
    v_mfma_f32_16x16x32_bf16 v[44:47], a[220:223], v[76:79], v[44:47]
    buffer_load_dwordx4 v224, s[32:35], s57 offen offset:0 sc1 lds
    buffer_store_dwordx4 v[16:19], v248, s[32:35], s10 offen offset:0 sc1
    v_mfma_f32_16x16x32_bf16 v[40:43], a[224:227], v[80:83], v[40:43]
    s_waitcnt lgkmcnt(2)
    ds_read_b128 v[64:67], v236 offset:28672
    v_mfma_f32_16x16x32_bf16 v[40:43], a[232:235], v[84:87], v[40:43]
    ds_read_b128 v[68:71], v236 offset:29696
    buffer_load_dwordx4 v225, s[32:35], s57 offen offset:1024 sc1 lds
    v_mfma_f32_16x16x32_bf16 v[40:43], a[240:243], v[88:91], v[40:43]
    ds_read_b128 v[72:75], v236 offset:30720
    v_mfma_f32_16x16x32_bf16 v[40:43], a[248:251], v[92:95], v[40:43]
    ds_read_b128 v[76:79], v236 offset:31744
    buffer_load_dwordx4 v226, s[32:35], s57 offen offset:2048 sc1 lds
    v_mfma_f32_16x16x32_bf16 v[44:47], a[228:231], v[80:83], v[44:47]
    v_mfma_f32_16x16x32_bf16 v[44:47], a[236:239], v[84:87], v[44:47]
    buffer_load_dwordx4 v227, s[32:35], s57 offen offset:3072 sc1 lds
    v_mfma_f32_16x16x32_bf16 v[44:47], a[244:247], v[88:91], v[44:47]
    v_mfma_f32_16x16x32_bf16 v[44:47], a[252:255], v[92:95], v[44:47]
    v_mfma_f32_16x16x32_bf16 v[40:43], a[0:3], v[96:99], v[40:43]
    s_add_u32 s73, s9, 4
    ds_read_b128 v[80:83], v236 offset:32768
    v_mfma_f32_16x16x32_bf16 v[40:43], a[8:11], v[100:103], v[40:43]
    s_waitcnt lgkmcnt(2)
    ds_read_b128 v[84:87], v236 offset:33792
    v_mfma_f32_16x16x32_bf16 v[40:43], a[16:19], v[104:107], v[40:43]
    s_and_b32 s73, s73, 3
    ds_read_b128 v[88:91], v236 offset:34816
    v_mfma_f32_16x16x32_bf16 v[40:43], a[24:27], v[108:111], v[40:43]
    ds_read_b128 v[92:95], v236 offset:35840
    buffer_store_dwordx4 v[20:23], v248, s[32:35], s10 offen offset:1024 sc1
    v_mfma_f32_16x16x32_bf16 v[44:47], a[4:7], v[96:99], v[44:47]
    s_lshl_b32 s73, s73, 10
    v_mfma_f32_16x16x32_bf16 v[44:47], a[12:15], v[100:103], v[44:47]
    v_mfma_f32_16x16x32_bf16 v[44:47], a[20:23], v[104:107], v[44:47]
    s_add_u32 s73, s73, s12
    v_mfma_f32_16x16x32_bf16 v[44:47], a[28:31], v[108:111], v[44:47]
    v_mfma_f32_16x16x32_bf16 v[40:43], a[32:35], v[64:67], v[40:43]
    s_add_u32 m0, s13, 114688
    ds_read_b128 v[96:99], v236 offset:36864
    v_mfma_f32_16x16x32_bf16 v[40:43], a[40:43], v[68:71], v[40:43]
    ds_read_b128 v[100:103], v236 offset:37888
    v_mfma_f32_16x16x32_bf16 v[40:43], a[48:51], v[72:75], v[40:43]
    s_waitcnt lgkmcnt(2)
    s_add_u32 s57, s73, 0
    ds_read_b128 v[104:107], v236 offset:38912
    v_mfma_f32_16x16x32_bf16 v[40:43], a[56:59], v[76:79], v[40:43]
    ds_read_b128 v[108:111], v236 offset:39936
    v_mfma_f32_16x16x32_bf16 v[44:47], a[36:39], v[64:67], v[44:47]
    buffer_load_dwordx4 v224, s[32:35], s57 offen offset:0 sc1 lds
    v_mfma_f32_16x16x32_bf16 v[44:47], a[44:47], v[68:71], v[44:47]
    v_mfma_f32_16x16x32_bf16 v[44:47], a[52:55], v[72:75], v[44:47]
    buffer_load_dwordx4 v225, s[32:35], s57 offen offset:1024 sc1 lds
    v_mfma_f32_16x16x32_bf16 v[44:47], a[60:63], v[76:79], v[44:47]
    v_mfma_f32_16x16x32_bf16 v[40:43], a[64:67], v[80:83], v[40:43]
    ds_read_b128 v[64:67], v236 offset:40960
    buffer_load_dwordx4 v226, s[32:35], s57 offen offset:2048 sc1 lds
    v_mfma_f32_16x16x32_bf16 v[40:43], a[72:75], v[84:87], v[40:43]
    ds_read_b128 v[68:71], v236 offset:41984
    v_mfma_f32_16x16x32_bf16 v[40:43], a[80:83], v[88:91], v[40:43]
    ds_read_b128 v[72:75], v236 offset:43008
    buffer_load_dwordx4 v227, s[32:35], s57 offen offset:3072 sc1 lds
    v_mfma_f32_16x16x32_bf16 v[40:43], a[88:91], v[92:95], v[40:43]
    ds_read_b128 v[76:79], v236 offset:44032
    v_mfma_f32_16x16x32_bf16 v[44:47], a[68:71], v[80:83], v[44:47]
    s_add_u32 m0, s13, 118784
    v_mfma_f32_16x16x32_bf16 v[44:47], a[76:79], v[84:87], v[44:47]
    v_mfma_f32_16x16x32_bf16 v[44:47], a[84:87], v[88:91], v[44:47]
    s_add_u32 s57, s73, 16384
    v_mfma_f32_16x16x32_bf16 v[44:47], a[92:95], v[92:95], v[44:47]
    s_waitcnt lgkmcnt(3)
    v_mfma_f32_16x16x32_bf16 v[40:43], a[96:99], v[96:99], v[40:43]
    ds_read_b128 v[80:83], v236 offset:45056
    buffer_load_dwordx4 v224, s[32:35], s57 offen offset:0 sc1 lds
    v_mfma_f32_16x16x32_bf16 v[40:43], a[104:107], v[100:103], v[40:43]
    ds_read_b128 v[84:87], v236 offset:46080
    v_mfma_f32_16x16x32_bf16 v[40:43], a[112:115], v[104:107], v[40:43]
    ds_read_b128 v[88:91], v236 offset:47104
    buffer_load_dwordx4 v225, s[32:35], s57 offen offset:1024 sc1 lds
    v_mfma_f32_16x16x32_bf16 v[40:43], a[120:123], v[108:111], v[40:43]
    ds_read_b128 v[92:95], v236 offset:48128
    v_mfma_f32_16x16x32_bf16 v[44:47], a[100:103], v[96:99], v[44:47]
    buffer_load_dwordx4 v226, s[32:35], s57 offen offset:2048 sc1 lds
    v_mfma_f32_16x16x32_bf16 v[44:47], a[108:111], v[100:103], v[44:47]
    v_mfma_f32_16x16x32_bf16 v[44:47], a[116:119], v[104:107], v[44:47]
    buffer_load_dwordx4 v227, s[32:35], s57 offen offset:3072 sc1 lds
    v_mfma_f32_16x16x32_bf16 v[44:47], a[124:127], v[108:111], v[44:47]
    v_mfma_f32_16x16x32_bf16 v[40:43], v[128:131], v[64:67], v[40:43]
    s_waitcnt lgkmcnt(2)
    v_mfma_f32_16x16x32_bf16 v[40:43], v[136:139], v[68:71], v[40:43]
    v_mfma_f32_16x16x32_bf16 v[40:43], v[144:147], v[72:75], v[40:43]
    v_mfma_f32_16x16x32_bf16 v[40:43], v[152:155], v[76:79], v[40:43]
    v_mfma_f32_16x16x32_bf16 v[44:47], v[132:135], v[64:67], v[44:47]
    s_waitcnt vmcnt(19)
    s_waitcnt lgkmcnt(0)
    s_barrier
    ds_read_b128 v[96:99], v237 offset:16384
    v_mfma_f32_16x16x32_bf16 v[44:47], v[140:143], v[68:71], v[44:47]
    s_add_u32 s73, s9, 4
    ds_read_b128 v[100:103], v237 offset:17408
    v_mfma_f32_16x16x32_bf16 v[44:47], v[148:151], v[72:75], v[44:47]
    ds_read_b128 v[104:107], v237 offset:18432
    v_mfma_f32_16x16x32_bf16 v[44:47], v[156:159], v[76:79], v[44:47]
    s_and_b32 s73, s73, 3
    ds_read_b128 v[108:111], v237 offset:19456
    v_mfma_f32_16x16x32_bf16 v[40:43], v[160:163], v[80:83], v[40:43]
    ds_read_b128 v[64:67], v237 offset:20480
    v_mfma_f32_16x16x32_bf16 v[40:43], v[168:171], v[84:87], v[40:43]
    s_lshl_b32 s73, s73, 10
    ds_read_b128 v[68:71], v237 offset:21504
    v_mfma_f32_16x16x32_bf16 v[40:43], v[176:179], v[88:91], v[40:43]
    ds_read_b128 v[72:75], v237 offset:22528
    v_mfma_f32_16x16x32_bf16 v[40:43], v[184:187], v[92:95], v[40:43]
    s_add_u32 s73, s73, s11
    ds_read_b128 v[76:79], v237 offset:23552
    v_mfma_f32_16x16x32_bf16 v[44:47], v[164:167], v[80:83], v[44:47]
    v_mfma_f32_16x16x32_bf16 v[44:47], v[172:175], v[84:87], v[44:47]
    s_mul_i32 s57, s13, 3
    v_mfma_f32_16x16x32_bf16 v[44:47], v[180:183], v[88:91], v[44:47]
    v_mfma_f32_16x16x32_bf16 v[44:47], v[188:191], v[92:95], v[44:47]
    s_waitcnt lgkmcnt(3)
    s_add_u32 s73, s73, s57
    v_mfma_f32_16x16x32_bf16 v[48:51], a[192:195], v[96:99], 0
    ds_read_b128 v[80:83], v237 offset:24576
    v_mfma_f32_16x16x32_bf16 v[48:51], a[200:203], v[100:103], v[48:51]
    s_add_u32 s73, s73, 4096
    ds_read_b128 v[84:87], v237 offset:25600
    v_mfma_f32_16x16x32_bf16 v[48:51], a[208:211], v[104:107], v[48:51]
    ds_read_b128 v[88:91], v237 offset:26624
    v_mfma_f32_16x16x32_bf16 v[48:51], a[216:219], v[108:111], v[48:51]
    s_add_u32 m0, s13, 16384
    ds_read_b128 v[92:95], v237 offset:27648
    v_mfma_f32_16x16x32_bf16 v[52:55], a[196:199], v[96:99], 0
    v_mfma_f32_16x16x32_bf16 v[52:55], a[204:207], v[100:103], v[52:55]
    s_add_u32 s57, s73, 0
    v_mfma_f32_16x16x32_bf16 v[52:55], a[212:215], v[104:107], v[52:55]
    v_mfma_f32_16x16x32_bf16 v[52:55], a[220:223], v[108:111], v[52:55]
    buffer_load_dwordx4 v224, s[32:35], s57 offen offset:0 sc1 lds
    v_mfma_f32_16x16x32_bf16 v[48:51], a[224:227], v[64:67], v[48:51]
    s_waitcnt lgkmcnt(2)
    ds_read_b128 v[96:99], v237 offset:28672
    buffer_store_dwordx4 v[40:43], v248, s[32:35], s10 offen offset:2048 sc1
    v_mfma_f32_16x16x32_bf16 v[48:51], a[232:235], v[68:71], v[48:51]
    ds_read_b128 v[100:103], v237 offset:29696
    buffer_load_dwordx4 v225, s[32:35], s57 offen offset:1024 sc1 lds
    v_mfma_f32_16x16x32_bf16 v[48:51], a[240:243], v[72:75], v[48:51]
    ds_read_b128 v[104:107], v237 offset:30720
    v_mfma_f32_16x16x32_bf16 v[48:51], a[248:251], v[76:79], v[48:51]
    ds_read_b128 v[108:111], v237 offset:31744
    buffer_load_dwordx4 v226, s[32:35], s57 offen offset:2048 sc1 lds
    v_mfma_f32_16x16x32_bf16 v[52:55], a[228:231], v[64:67], v[52:55]
    v_mfma_f32_16x16x32_bf16 v[52:55], a[236:239], v[68:71], v[52:55]
    buffer_load_dwordx4 v227, s[32:35], s57 offen offset:3072 sc1 lds
    v_mfma_f32_16x16x32_bf16 v[52:55], a[244:247], v[72:75], v[52:55]
    v_mfma_f32_16x16x32_bf16 v[52:55], a[252:255], v[76:79], v[52:55]
    s_add_u32 m0, s13, 20480
    v_mfma_f32_16x16x32_bf16 v[48:51], a[0:3], v[80:83], v[48:51]
    ds_read_b128 v[64:67], v237 offset:32768
    v_mfma_f32_16x16x32_bf16 v[48:51], a[8:11], v[84:87], v[48:51]
    s_waitcnt lgkmcnt(2)
    s_add_u32 s57, s73, 16384
    ds_read_b128 v[68:71], v237 offset:33792
    v_mfma_f32_16x16x32_bf16 v[48:51], a[16:19], v[88:91], v[48:51]
    ds_read_b128 v[72:75], v237 offset:34816
    v_mfma_f32_16x16x32_bf16 v[48:51], a[24:27], v[92:95], v[48:51]
    ds_read_b128 v[76:79], v237 offset:35840
    buffer_load_dwordx4 v224, s[32:35], s57 offen offset:0 sc1 lds
    v_mfma_f32_16x16x32_bf16 v[52:55], a[4:7], v[80:83], v[52:55]
    buffer_store_dwordx4 v[44:47], v248, s[32:35], s10 offen offset:3072 sc1
    v_mfma_f32_16x16x32_bf16 v[52:55], a[12:15], v[84:87], v[52:55]
    buffer_load_dwordx4 v225, s[32:35], s57 offen offset:1024 sc1 lds
    v_mfma_f32_16x16x32_bf16 v[52:55], a[20:23], v[88:91], v[52:55]
    v_mfma_f32_16x16x32_bf16 v[52:55], a[28:31], v[92:95], v[52:55]
    buffer_load_dwordx4 v226, s[32:35], s57 offen offset:2048 sc1 lds
    v_mfma_f32_16x16x32_bf16 v[48:51], a[32:35], v[96:99], v[48:51]
    ds_read_b128 v[80:83], v237 offset:36864
    v_mfma_f32_16x16x32_bf16 v[48:51], a[40:43], v[100:103], v[48:51]
    ds_read_b128 v[84:87], v237 offset:37888
    buffer_load_dwordx4 v227, s[32:35], s57 offen offset:3072 sc1 lds
    v_mfma_f32_16x16x32_bf16 v[48:51], a[48:51], v[104:107], v[48:51]
    s_waitcnt lgkmcnt(2)
    ds_read_b128 v[88:91], v237 offset:38912
    v_mfma_f32_16x16x32_bf16 v[48:51], a[56:59], v[108:111], v[48:51]
    ds_read_b128 v[92:95], v237 offset:39936
    v_mfma_f32_16x16x32_bf16 v[52:55], a[36:39], v[96:99], v[52:55]
    v_mfma_f32_16x16x32_bf16 v[52:55], a[44:47], v[100:103], v[52:55]
    v_mfma_f32_16x16x32_bf16 v[52:55], a[52:55], v[104:107], v[52:55]
    s_mul_i32 s56, s2, 50176
    s_mul_i32 s10, s52, 12288
    s_add_u32 s56, s56, s10
    v_and_b32 v240, 15, v249
    v_lshlrev_b32 v241, 10, v240
    v_lshrrev_b32 v242, 4, v249
    v_lshl_add_u32 v241, v242, 4, v241
    s_lshl_b32 s69, s9, 14
    s_lshl_b32 s72, s8, 8
    s_add_u32 s69, s69, s72
    s_lshl_b32 s72, s52, 6
    s_add_u32 s69, s69, s72
    s_lshl_b32 s73, s7, 16
    s_sub_u32 s74, 2031616, s73
    s_lshl_b32 s72, s8, 14
    s_add_u32 s72, s72, s55
    s_lshl_b32 s71, s9, 10
    s_add_u32 s72, s72, s71
    s_add_u32 s72, s72, 0xb00000
    s_mul_i32 s58, s7, 70656
    s_add_u32 s71, s72, s58
    s_add_u32 s72, s72, 2190336
    s_sub_u32 s72, s72, s58
    s_add_u32 s73, s73, s69
    s_add_u32 s74, s74, s69
    s_mov_b32 s36, s4
    s_and_b32 s37, s5, 0xffff
    s_mov_b32 s38, 0x200000
    s_mov_b32 s39, 0x20000
    buffer_load_dwordx4 v[192:195], v241, s[36:39], s73 offen
    buffer_load_dwordx4 v[196:199], v241, s[36:39], s74 offen
    buffer_load_dwordx4 v[200:203], v248, s[32:35], s71 offen sc1
    buffer_load_dwordx4 v[204:207], v248, s[32:35], s72 offen sc1
    v_mfma_f32_16x16x32_bf16 v[52:55], a[60:63], v[108:111], v[52:55]
    s_add_u32 s10, s56, 0x4401000
    s_add_u32 s70, s9, 1
    v_add_u32 v243, s70, v249
    v_mfma_f32_16x16x32_bf16 v[48:51], a[64:67], v[64:67], v[48:51]
    ds_read_b128 v[96:99], v237 offset:40960
    v_and_b32 v243, 3, v243
    v_mfma_f32_16x16x32_bf16 v[48:51], a[72:75], v[68:71], v[48:51]
    ds_read_b128 v[100:103], v237 offset:41984
    v_lshlrev_b32 v243, 10, v243
    v_mfma_f32_16x16x32_bf16 v[48:51], a[80:83], v[72:75], v[48:51]
    ds_read_b128 v[104:107], v237 offset:43008
    v_lshl_add_u32 v243, v249, 4, v243
    v_mfma_f32_16x16x32_bf16 v[48:51], a[88:91], v[76:79], v[48:51]
    s_and_b32 s70, s2, 0xf9
    ds_read_b128 v[108:111], v237 offset:44032
    buffer_store_dwordx4 v[24:27], v248, s[32:35], s10 offen offset:0 sc1
    v_mfma_f32_16x16x32_bf16 v[52:55], a[68:71], v[64:67], v[52:55]
    s_lshl_b32 s70, s70, 9
    s_add_u32 s70, s70, 256
    v_add_u32 v243, s70, v243
    v_mfma_f32_16x16x32_bf16 v[52:55], a[76:79], v[68:71], v[52:55]
    s_lshl_b32 s70, s52, 2
    v_add_u32 v243, s70, v243
    v_min_u32 v247, 2, v249
    v_mfma_f32_16x16x32_bf16 v[52:55], a[84:87], v[72:75], v[52:55]
    v_lshl_add_u32 v247, v247, 4, s70
    v_cmp_gt_u32 vcc, 3, v249
    v_mfma_f32_16x16x32_bf16 v[52:55], a[92:95], v[76:79], v[52:55]
    s_waitcnt lgkmcnt(3)
    v_mov_b32 v244, 0x40000000
    v_mfma_f32_16x16x32_bf16 v[48:51], a[96:99], v[80:83], v[48:51]
    ds_read_b128 v[64:67], v237 offset:45056
    v_mfma_f32_16x16x32_bf16 v[48:51], a[104:107], v[84:87], v[48:51]
    ds_read_b128 v[68:71], v237 offset:46080
    v_cndmask_b32 v243, v244, v243, vcc
    v_mfma_f32_16x16x32_bf16 v[48:51], a[112:115], v[88:91], v[48:51]
    ds_read_b128 v[72:75], v237 offset:47104
    v_mfma_f32_16x16x32_bf16 v[48:51], a[120:123], v[92:95], v[48:51]
    ds_read_b128 v[76:79], v237 offset:48128
    v_mfma_f32_16x16x32_bf16 v[52:55], a[100:103], v[80:83], v[52:55]
    v_mfma_f32_16x16x32_bf16 v[52:55], a[108:111], v[84:87], v[52:55]
    v_mfma_f32_16x16x32_bf16 v[52:55], a[116:119], v[88:91], v[52:55]
    v_mfma_f32_16x16x32_bf16 v[52:55], a[124:127], v[92:95], v[52:55]
    buffer_store_dwordx4 v[28:31], v248, s[32:35], s10 offen offset:1024 sc1
    v_mfma_f32_16x16x32_bf16 v[48:51], v[128:131], v[96:99], v[48:51]
    s_waitcnt lgkmcnt(2)
    v_mfma_f32_16x16x32_bf16 v[48:51], v[136:139], v[100:103], v[48:51]
    v_mfma_f32_16x16x32_bf16 v[48:51], v[144:147], v[104:107], v[48:51]
    v_mfma_f32_16x16x32_bf16 v[48:51], v[152:155], v[108:111], v[48:51]
    v_mfma_f32_16x16x32_bf16 v[52:55], v[132:135], v[96:99], v[52:55]
    s_waitcnt vmcnt(25)
    s_waitcnt lgkmcnt(0)
    s_barrier
    ds_read_b128 v[80:83], v236 offset:49152
    v_mfma_f32_16x16x32_bf16 v[52:55], v[140:143], v[100:103], v[52:55]
    ds_read_b128 v[84:87], v236 offset:50176
    v_mfma_f32_16x16x32_bf16 v[52:55], v[148:151], v[104:107], v[52:55]
    ds_read_b128 v[88:91], v236 offset:51200
    v_mfma_f32_16x16x32_bf16 v[52:55], v[156:159], v[108:111], v[52:55]
    ds_read_b128 v[92:95], v236 offset:52224
    v_mfma_f32_16x16x32_bf16 v[48:51], v[160:163], v[64:67], v[48:51]
    ds_read_b128 v[96:99], v236 offset:53248
    v_mfma_f32_16x16x32_bf16 v[48:51], v[168:171], v[68:71], v[48:51]
    ds_read_b128 v[100:103], v236 offset:54272
    v_mfma_f32_16x16x32_bf16 v[48:51], v[176:179], v[72:75], v[48:51]
    ds_read_b128 v[104:107], v236 offset:55296
    v_mfma_f32_16x16x32_bf16 v[48:51], v[184:187], v[76:79], v[48:51]
    ds_read_b128 v[108:111], v236 offset:56320
    v_mfma_f32_16x16x32_bf16 v[52:55], v[164:167], v[64:67], v[52:55]
    v_mfma_f32_16x16x32_bf16 v[52:55], v[172:175], v[68:71], v[52:55]
    v_mfma_f32_16x16x32_bf16 v[52:55], v[180:183], v[72:75], v[52:55]
    v_mfma_f32_16x16x32_bf16 v[52:55], v[188:191], v[76:79], v[52:55]
    s_waitcnt lgkmcnt(3)
    v_mfma_f32_16x16x32_bf16 v[56:59], a[192:195], v[80:83], 0
    ds_read_b128 v[64:67], v236 offset:57344
    v_mfma_f32_16x16x32_bf16 v[56:59], a[200:203], v[84:87], v[56:59]
    ds_read_b128 v[68:71], v236 offset:58368
    v_mfma_f32_16x16x32_bf16 v[56:59], a[208:211], v[88:91], v[56:59]
    ds_read_b128 v[72:75], v236 offset:59392
    v_mfma_f32_16x16x32_bf16 v[56:59], a[216:219], v[92:95], v[56:59]
    ds_read_b128 v[76:79], v236 offset:60416
    v_mfma_f32_16x16x32_bf16 v[60:63], a[196:199], v[80:83], 0
    v_mfma_f32_16x16x32_bf16 v[60:63], a[204:207], v[84:87], v[60:63]
    v_mfma_f32_16x16x32_bf16 v[60:63], a[212:215], v[88:91], v[60:63]
    v_mfma_f32_16x16x32_bf16 v[60:63], a[220:223], v[92:95], v[60:63]
    v_mfma_f32_16x16x32_bf16 v[56:59], a[224:227], v[96:99], v[56:59]
    s_waitcnt lgkmcnt(2)
    ds_read_b128 v[80:83], v236 offset:61440
    buffer_store_dwordx4 v[48:51], v248, s[32:35], s10 offen offset:2048 sc1
    v_mfma_f32_16x16x32_bf16 v[56:59], a[232:235], v[100:103], v[56:59]
    ds_read_b128 v[84:87], v236 offset:62464
    v_mfma_f32_16x16x32_bf16 v[56:59], a[240:243], v[104:107], v[56:59]
    ds_read_b128 v[88:91], v236 offset:63488
    v_mfma_f32_16x16x32_bf16 v[56:59], a[248:251], v[108:111], v[56:59]
    ds_read_b128 v[92:95], v236 offset:64512
    v_mfma_f32_16x16x32_bf16 v[60:63], a[228:231], v[96:99], v[60:63]
    v_mfma_f32_16x16x32_bf16 v[60:63], a[236:239], v[100:103], v[60:63]
    v_mfma_f32_16x16x32_bf16 v[60:63], a[244:247], v[104:107], v[60:63]
    v_mfma_f32_16x16x32_bf16 v[60:63], a[252:255], v[108:111], v[60:63]
    v_mfma_f32_16x16x32_bf16 v[56:59], a[0:3], v[64:67], v[56:59]
    ds_read_b128 v[96:99], v237 offset:0
    v_mfma_f32_16x16x32_bf16 v[56:59], a[8:11], v[68:71], v[56:59]
    s_waitcnt lgkmcnt(2)
    ds_read_b128 v[100:103], v237 offset:1024
    v_mfma_f32_16x16x32_bf16 v[56:59], a[16:19], v[72:75], v[56:59]
    ds_read_b128 v[104:107], v237 offset:2048
    v_mfma_f32_16x16x32_bf16 v[56:59], a[24:27], v[76:79], v[56:59]
    ds_read_b128 v[108:111], v237 offset:3072
    v_mfma_f32_16x16x32_bf16 v[60:63], a[4:7], v[64:67], v[60:63]
    buffer_store_dwordx4 v[52:55], v248, s[32:35], s10 offen offset:3072 sc1
    v_mfma_f32_16x16x32_bf16 v[60:63], a[12:15], v[68:71], v[60:63]
    v_mfma_f32_16x16x32_bf16 v[60:63], a[20:23], v[72:75], v[60:63]
    v_mfma_f32_16x16x32_bf16 v[60:63], a[28:31], v[76:79], v[60:63]
    v_mfma_f32_16x16x32_bf16 v[56:59], a[32:35], v[80:83], v[56:59]
    ds_read_b128 v[64:67], v237 offset:4096
    v_mfma_f32_16x16x32_bf16 v[56:59], a[40:43], v[84:87], v[56:59]
    ds_read_b128 v[68:71], v237 offset:5120
    v_mfma_f32_16x16x32_bf16 v[56:59], a[48:51], v[88:91], v[56:59]
    s_waitcnt lgkmcnt(2)
    ds_read_b128 v[72:75], v237 offset:6144
    v_mfma_f32_16x16x32_bf16 v[56:59], a[56:59], v[92:95], v[56:59]
    ds_read_b128 v[76:79], v237 offset:7168
    v_mfma_f32_16x16x32_bf16 v[60:63], a[36:39], v[80:83], v[60:63]
    v_mfma_f32_16x16x32_bf16 v[60:63], a[44:47], v[84:87], v[60:63]
    v_mfma_f32_16x16x32_bf16 v[60:63], a[52:55], v[88:91], v[60:63]
    s_mul_i32 s56, s2, 50176
    s_mul_i32 s10, s52, 12288
    s_add_u32 s56, s56, s10
    v_mfma_f32_16x16x32_bf16 v[60:63], a[60:63], v[92:95], v[60:63]
    s_add_u32 s10, s56, 0x4402000
    v_mfma_f32_16x16x32_bf16 v[56:59], a[64:67], v[96:99], v[56:59]
    ds_read_b128 v[80:83], v237 offset:8192
    v_mfma_f32_16x16x32_bf16 v[56:59], a[72:75], v[100:103], v[56:59]
    ds_read_b128 v[84:87], v237 offset:9216
    v_mfma_f32_16x16x32_bf16 v[56:59], a[80:83], v[104:107], v[56:59]
    ds_read_b128 v[88:91], v237 offset:10240
    v_mfma_f32_16x16x32_bf16 v[56:59], a[88:91], v[108:111], v[56:59]
    ds_read_b128 v[92:95], v237 offset:11264
    buffer_store_dwordx4 v[32:35], v248, s[32:35], s10 offen offset:0 sc1
    v_mfma_f32_16x16x32_bf16 v[60:63], a[68:71], v[96:99], v[60:63]
    v_mfma_f32_16x16x32_bf16 v[60:63], a[76:79], v[100:103], v[60:63]
    v_mfma_f32_16x16x32_bf16 v[60:63], a[84:87], v[104:107], v[60:63]
    v_mfma_f32_16x16x32_bf16 v[60:63], a[92:95], v[108:111], v[60:63]
    s_waitcnt lgkmcnt(3)
    v_mfma_f32_16x16x32_bf16 v[56:59], a[96:99], v[64:67], v[56:59]
    ds_read_b128 v[96:99], v237 offset:12288
    v_mfma_f32_16x16x32_bf16 v[56:59], a[104:107], v[68:71], v[56:59]
    ds_read_b128 v[100:103], v237 offset:13312
    v_mfma_f32_16x16x32_bf16 v[56:59], a[112:115], v[72:75], v[56:59]
    ds_read_b128 v[104:107], v237 offset:14336
    v_mfma_f32_16x16x32_bf16 v[56:59], a[120:123], v[76:79], v[56:59]
    ds_read_b128 v[108:111], v237 offset:15360
    v_mfma_f32_16x16x32_bf16 v[60:63], a[100:103], v[64:67], v[60:63]
    v_mfma_f32_16x16x32_bf16 v[60:63], a[108:111], v[68:71], v[60:63]
    v_mfma_f32_16x16x32_bf16 v[60:63], a[116:119], v[72:75], v[60:63]
    v_mfma_f32_16x16x32_bf16 v[60:63], a[124:127], v[76:79], v[60:63]
    buffer_store_dwordx4 v[36:39], v248, s[32:35], s10 offen offset:1024 sc1
    v_mfma_f32_16x16x32_bf16 v[56:59], v[128:131], v[80:83], v[56:59]
    s_waitcnt lgkmcnt(2)
    v_mfma_f32_16x16x32_bf16 v[56:59], v[136:139], v[84:87], v[56:59]
    v_mfma_f32_16x16x32_bf16 v[56:59], v[144:147], v[88:91], v[56:59]
    v_mfma_f32_16x16x32_bf16 v[56:59], v[152:155], v[92:95], v[56:59]
    v_mfma_f32_16x16x32_bf16 v[60:63], v[132:135], v[80:83], v[60:63]
    s_waitcnt vmcnt(20)
    s_waitcnt lgkmcnt(0)
    s_barrier
    ds_read_b128 v[64:67], v237 offset:49152
    v_mfma_f32_16x16x32_bf16 v[60:63], v[140:143], v[84:87], v[60:63]
    ds_read_b128 v[68:71], v237 offset:50176
    v_mfma_f32_16x16x32_bf16 v[60:63], v[148:151], v[88:91], v[60:63]
    ds_read_b128 v[72:75], v237 offset:51200
    s_mov_b32 s71, 0
    s_mov_b32 s98, 0
F_fm10:
    s_cmp_ge_u32 s71, 8
    s_cbranch_scc1 F_em_none
    v_readlane_b32 s69, v234, s71
    s_add_u32 s71, s71, 1
    s_nop 1
    s_and_b32 s72, s69, 0x7ff
    s_sub_u32 s72, 2047, s72
    s_bfe_u32 s70, s72, 0x20004
    s_cmp_lg_u32 s70, s9
    s_cbranch_scc1 F_fm10
    s_lshr_b32 s70, s72, 6
    s_sub_u32 s58, 31, s70
    s_min_u32 s58, s70, s58
    s_cmp_lg_u32 s58, s7
    s_cbranch_scc1 F_fm10
    v_lshrrev_b32 v228, 1, v249
    v_and_b32 v212, 7, v228
    v_med3_u32 v212, v212, 2, 5
    v_and_b32 v228, 24, v228
    v_or_b32 v228, v228, v212
    v_lshlrev_b32 v228, 7, v228
    v_and_b32 v212, 1, v249
    v_lshl_add_u32 v228, v212, 4, v228
    v_add_u32 v228, 0x3c2000, v228
    buffer_load_dwordx4 v[212:215], v228, s[32:35], 0 offen sc1
    s_mov_b32 s98, 1
F_em_none:
    v_mfma_f32_16x16x32_bf16 v[60:63], v[156:159], v[92:95], v[60:63]
    ds_read_b128 v[76:79], v237 offset:52224
    v_mfma_f32_16x16x32_bf16 v[56:59], v[160:163], v[96:99], v[56:59]
    ds_read_b128 v[80:83], v237 offset:53248
    v_mfma_f32_16x16x32_bf16 v[56:59], v[168:171], v[100:103], v[56:59]
    ds_read_b128 v[84:87], v237 offset:54272
    v_mfma_f32_16x16x32_bf16 v[56:59], v[176:179], v[104:107], v[56:59]
    ds_read_b128 v[88:91], v237 offset:55296
    v_mfma_f32_16x16x32_bf16 v[56:59], v[184:187], v[108:111], v[56:59]
    ds_read_b128 v[92:95], v237 offset:56320
    v_mfma_f32_16x16x32_bf16 v[60:63], v[164:167], v[96:99], v[60:63]
    v_mfma_f32_16x16x32_bf16 v[60:63], v[172:175], v[100:103], v[60:63]
    v_mfma_f32_16x16x32_bf16 v[60:63], v[180:183], v[104:107], v[60:63]
    v_mfma_f32_16x16x32_bf16 v[60:63], v[188:191], v[108:111], v[60:63]
    s_waitcnt lgkmcnt(3)
    v_mfma_f32_16x16x32_bf16 v[8:11], a[192:195], v[64:67], 0
    ds_read_b128 v[96:99], v237 offset:57344
    v_mfma_f32_16x16x32_bf16 v[8:11], a[200:203], v[68:71], v[8:11]
    ds_read_b128 v[100:103], v237 offset:58368
    v_mfma_f32_16x16x32_bf16 v[8:11], a[208:211], v[72:75], v[8:11]
    ds_read_b128 v[104:107], v237 offset:59392
    v_mfma_f32_16x16x32_bf16 v[8:11], a[216:219], v[76:79], v[8:11]
    ds_read_b128 v[108:111], v237 offset:60416
    v_mfma_f32_16x16x32_bf16 v[12:15], a[196:199], v[64:67], 0
    v_mfma_f32_16x16x32_bf16 v[12:15], a[204:207], v[68:71], v[12:15]
    v_mfma_f32_16x16x32_bf16 v[12:15], a[212:215], v[72:75], v[12:15]
    v_mfma_f32_16x16x32_bf16 v[12:15], a[220:223], v[76:79], v[12:15]
    v_mfma_f32_16x16x32_bf16 v[8:11], a[224:227], v[80:83], v[8:11]
    s_waitcnt lgkmcnt(2)
    ds_read_b128 v[64:67], v237 offset:61440
    buffer_store_dwordx4 v[56:59], v248, s[32:35], s10 offen offset:2048 sc1
    v_mfma_f32_16x16x32_bf16 v[8:11], a[232:235], v[84:87], v[8:11]
    ds_read_b128 v[68:71], v237 offset:62464
    buffer_store_dwordx4 v[60:63], v248, s[32:35], s10 offen offset:3072 sc1
    v_mfma_f32_16x16x32_bf16 v[8:11], a[240:243], v[88:91], v[8:11]
    ds_read_b128 v[72:75], v237 offset:63488
    v_mfma_f32_16x16x32_bf16 v[8:11], a[248:251], v[92:95], v[8:11]
    ds_read_b128 v[76:79], v237 offset:64512
    v_mfma_f32_16x16x32_bf16 v[12:15], a[228:231], v[80:83], v[12:15]
    v_mfma_f32_16x16x32_bf16 v[12:15], a[236:239], v[84:87], v[12:15]
    v_mfma_f32_16x16x32_bf16 v[12:15], a[244:247], v[88:91], v[12:15]
    v_mfma_f32_16x16x32_bf16 v[12:15], a[252:255], v[92:95], v[12:15]
    v_mfma_f32_16x16x32_bf16 v[8:11], a[0:3], v[96:99], v[8:11]
    ds_read_b128 v[80:83], v238 offset:0
    v_mfma_f32_16x16x32_bf16 v[8:11], a[8:11], v[100:103], v[8:11]
    s_waitcnt lgkmcnt(2)
    ds_read_b128 v[84:87], v238 offset:1024
    v_mfma_f32_16x16x32_bf16 v[8:11], a[16:19], v[104:107], v[8:11]
    ds_read_b128 v[88:91], v238 offset:2048
    v_mfma_f32_16x16x32_bf16 v[8:11], a[24:27], v[108:111], v[8:11]
    ds_read_b128 v[92:95], v238 offset:3072
    v_mfma_f32_16x16x32_bf16 v[12:15], a[4:7], v[96:99], v[12:15]
    v_mfma_f32_16x16x32_bf16 v[12:15], a[12:15], v[100:103], v[12:15]
    v_mfma_f32_16x16x32_bf16 v[12:15], a[20:23], v[104:107], v[12:15]
    v_mfma_f32_16x16x32_bf16 v[12:15], a[28:31], v[108:111], v[12:15]
    v_mfma_f32_16x16x32_bf16 v[8:11], a[32:35], v[64:67], v[8:11]
    ds_read_b128 v[96:99], v238 offset:4096
    v_mfma_f32_16x16x32_bf16 v[8:11], a[40:43], v[68:71], v[8:11]
    ds_read_b128 v[100:103], v238 offset:5120
    v_mfma_f32_16x16x32_bf16 v[8:11], a[48:51], v[72:75], v[8:11]
    s_waitcnt lgkmcnt(2)
    ds_read_b128 v[104:107], v238 offset:6144
    v_mfma_f32_16x16x32_bf16 v[8:11], a[56:59], v[76:79], v[8:11]
    ds_read_b128 v[108:111], v238 offset:7168
    v_mfma_f32_16x16x32_bf16 v[12:15], a[36:39], v[64:67], v[12:15]
    v_mfma_f32_16x16x32_bf16 v[12:15], a[44:47], v[68:71], v[12:15]
    v_mfma_f32_16x16x32_bf16 v[12:15], a[52:55], v[72:75], v[12:15]
    v_mfma_f32_16x16x32_bf16 v[12:15], a[60:63], v[76:79], v[12:15]
    v_mfma_f32_16x16x32_bf16 v[8:11], a[64:67], v[80:83], v[8:11]
    ds_read_b128 v[64:67], v238 offset:8192
    v_mfma_f32_16x16x32_bf16 v[8:11], a[72:75], v[84:87], v[8:11]
    ds_read_b128 v[68:71], v238 offset:9216
    v_mfma_f32_16x16x32_bf16 v[8:11], a[80:83], v[88:91], v[8:11]
    ds_read_b128 v[72:75], v238 offset:10240
    v_mfma_f32_16x16x32_bf16 v[8:11], a[88:91], v[92:95], v[8:11]
    ds_read_b128 v[76:79], v238 offset:11264
    v_mfma_f32_16x16x32_bf16 v[12:15], a[68:71], v[80:83], v[12:15]
    v_mfma_f32_16x16x32_bf16 v[12:15], a[76:79], v[84:87], v[12:15]
    v_mfma_f32_16x16x32_bf16 v[12:15], a[84:87], v[88:91], v[12:15]
    v_mfma_f32_16x16x32_bf16 v[12:15], a[92:95], v[92:95], v[12:15]
    s_waitcnt lgkmcnt(3)
    v_mfma_f32_16x16x32_bf16 v[8:11], a[96:99], v[96:99], v[8:11]
    ds_read_b128 v[80:83], v238 offset:12288
    v_mfma_f32_16x16x32_bf16 v[8:11], a[104:107], v[100:103], v[8:11]
    ds_read_b128 v[84:87], v238 offset:13312
    v_mfma_f32_16x16x32_bf16 v[8:11], a[112:115], v[104:107], v[8:11]
    ds_read_b128 v[88:91], v238 offset:14336
    v_mfma_f32_16x16x32_bf16 v[8:11], a[120:123], v[108:111], v[8:11]
    ds_read_b128 v[92:95], v238 offset:15360
    v_mfma_f32_16x16x32_bf16 v[12:15], a[100:103], v[96:99], v[12:15]
    v_mfma_f32_16x16x32_bf16 v[12:15], a[108:111], v[100:103], v[12:15]
    v_mfma_f32_16x16x32_bf16 v[12:15], a[116:119], v[104:107], v[12:15]
    v_mfma_f32_16x16x32_bf16 v[12:15], a[124:127], v[108:111], v[12:15]
    v_mfma_f32_16x16x32_bf16 v[8:11], v[128:131], v[64:67], v[8:11]
    s_waitcnt lgkmcnt(2)
    v_mfma_f32_16x16x32_bf16 v[8:11], v[136:139], v[68:71], v[8:11]
    v_mfma_f32_16x16x32_bf16 v[8:11], v[144:147], v[72:75], v[8:11]
    s_waitcnt vmcnt(0)
    v_mov_b32 v244, s94
    s_mov_b32 s58, 0x3a0000
    buffer_store_dword v244, v243, s[32:35], s58 offen sc1
    v_mfma_f32_16x16x32_bf16 v[8:11], v[152:155], v[76:79], v[8:11]
    v_mfma_f32_16x16x32_bf16 v[12:15], v[132:135], v[64:67], v[12:15]
    s_waitcnt lgkmcnt(0)
    s_barrier
    ds_read_b128 v[96:99], v236 offset:16384
    v_mfma_f32_16x16x32_bf16 v[12:15], v[140:143], v[68:71], v[12:15]
    ds_read_b128 v[100:103], v236 offset:17408
    s_cmp_eq_u32 s98, 0
    s_cbranch_scc1 F_ty
    v_xor_b32 v216, s94, v212
    v_xor_b32 v217, s94, v213
    v_xor_b32 v218, s94, v214
    v_xor_b32 v219, s94, v215
    v_or3_b32 v216, v216, v217, v218
    v_or_b32 v216, v216, v219
    v_cmp_ne_u32 vcc, 0, v216
    s_nop 4
    s_cbranch_vccnz F_ty
    s_add_u32 s44, s30, 0x220000
    s_addc_u32 s45, s31, 0
    s_and_b32 s45, s45, 0xffff
    s_mov_b32 s46, 1409024
    s_mov_b32 s47, 0x20000
    v_lshlrev_b32 v245, 14, v240
    v_lshl_add_u32 v245, v242, 5, v245
    s_sub_u32 s70, s71, 1
    s_lshl_b32 s70, s70, 11
    s_lshl_b32 s58, s8, 9
    s_add_u32 s70, s70, s58
    s_lshl_b32 s58, s52, 7
    s_add_u32 s70, s70, s58
    buffer_load_dwordx4 a[128:131], v245, s[44:47], s70 offen sc1
    buffer_load_dwordx4 a[132:135], v245, s[44:47], s70 offen offset:16 sc1
    s_add_u32 s70, s70, 262144
    buffer_load_dwordx4 a[136:139], v245, s[44:47], s70 offen sc1
    buffer_load_dwordx4 a[140:143], v245, s[44:47], s70 offen offset:16 sc1
    s_add_u32 s70, s70, 262144
    buffer_load_dwordx4 a[144:147], v245, s[44:47], s70 offen sc1
    buffer_load_dwordx4 a[148:151], v245, s[44:47], s70 offen offset:16 sc1
    s_add_u32 s70, s70, 262144
    buffer_load_dwordx4 a[152:155], v245, s[44:47], s70 offen sc1
    buffer_load_dwordx4 a[156:159], v245, s[44:47], s70 offen offset:16 sc1
    s_add_u32 s70, s70, 262144
    buffer_load_dwordx4 a[160:163], v245, s[44:47], s70 offen sc1
    buffer_load_dwordx4 a[164:167], v245, s[44:47], s70 offen offset:16 sc1
    s_add_u32 s70, s70, 262144
    buffer_load_dwordx4 a[168:171], v245, s[44:47], s70 offen sc1
    buffer_load_dwordx4 a[172:175], v245, s[44:47], s70 offen offset:16 sc1
    s_add_u32 s70, s70, 262144
    s_mov_b32 s98, 2
F_ty:
    v_mfma_f32_16x16x32_bf16 v[12:15], v[148:151], v[72:75], v[12:15]
    ds_read_b128 v[104:107], v236 offset:18432
    buffer_load_dword v246, v247, s[32:35], s95 offen offset:256 sc1
    v_mfma_f32_16x16x32_bf16 v[12:15], v[156:159], v[76:79], v[12:15]
    ds_read_b128 v[108:111], v236 offset:19456
    v_mfma_f32_16x16x32_bf16 v[8:11], v[160:163], v[80:83], v[8:11]
    ds_read_b128 v[64:67], v236 offset:20480
    v_mfma_f32_16x16x32_bf16 v[8:11], v[168:171], v[84:87], v[8:11]
    ds_read_b128 v[68:71], v236 offset:21504
    v_mfma_f32_16x16x32_bf16 v[8:11], v[176:179], v[88:91], v[8:11]
    ds_read_b128 v[72:75], v236 offset:22528
    v_mfma_f32_16x16x32_bf16 v[8:11], v[184:187], v[92:95], v[8:11]
    ds_read_b128 v[76:79], v236 offset:23552
    v_mfma_f32_16x16x32_bf16 v[12:15], v[164:167], v[80:83], v[12:15]
    v_mfma_f32_16x16x32_bf16 v[12:15], v[172:175], v[84:87], v[12:15]
    v_mfma_f32_16x16x32_bf16 v[12:15], v[180:183], v[88:91], v[12:15]
    v_mfma_f32_16x16x32_bf16 v[12:15], v[188:191], v[92:95], v[12:15]
    s_waitcnt lgkmcnt(3)
    v_mfma_f32_16x16x32_bf16 v[0:3], a[192:195], v[96:99], 0
    ds_read_b128 v[80:83], v236 offset:24576
    v_mfma_f32_16x16x32_bf16 v[0:3], a[200:203], v[100:103], v[0:3]
    ds_read_b128 v[84:87], v236 offset:25600
    v_mfma_f32_16x16x32_bf16 v[0:3], a[208:211], v[104:107], v[0:3]
    ds_read_b128 v[88:91], v236 offset:26624
    v_mfma_f32_16x16x32_bf16 v[0:3], a[216:219], v[108:111], v[0:3]
    ds_read_b128 v[92:95], v236 offset:27648
    v_mfma_f32_16x16x32_bf16 v[4:7], a[196:199], v[96:99], 0
    v_mfma_f32_16x16x32_bf16 v[4:7], a[204:207], v[100:103], v[4:7]
    v_mfma_f32_16x16x32_bf16 v[4:7], a[212:215], v[104:107], v[4:7]
    v_mfma_f32_16x16x32_bf16 v[4:7], a[220:223], v[108:111], v[4:7]
    v_mfma_f32_16x16x32_bf16 v[0:3], a[224:227], v[64:67], v[0:3]
    s_waitcnt lgkmcnt(2)
    ds_read_b128 v[96:99], v236 offset:28672
    v_mfma_f32_16x16x32_bf16 v[0:3], a[232:235], v[68:71], v[0:3]
    ds_read_b128 v[100:103], v236 offset:29696
    v_mfma_f32_16x16x32_bf16 v[0:3], a[240:243], v[72:75], v[0:3]
    ds_read_b128 v[104:107], v236 offset:30720
    v_mfma_f32_16x16x32_bf16 v[0:3], a[248:251], v[76:79], v[0:3]
    ds_read_b128 v[108:111], v236 offset:31744
    v_mfma_f32_16x16x32_bf16 v[4:7], a[228:231], v[64:67], v[4:7]
    v_mfma_f32_16x16x32_bf16 v[4:7], a[236:239], v[68:71], v[4:7]
    v_mfma_f32_16x16x32_bf16 v[4:7], a[244:247], v[72:75], v[4:7]
    v_mfma_f32_16x16x32_bf16 v[4:7], a[252:255], v[76:79], v[4:7]
    v_mfma_f32_16x16x32_bf16 v[0:3], a[0:3], v[80:83], v[0:3]
    ds_read_b128 v[64:67], v236 offset:32768
    v_mfma_f32_16x16x32_bf16 v[0:3], a[8:11], v[84:87], v[0:3]
    s_waitcnt lgkmcnt(2)
    ds_read_b128 v[68:71], v236 offset:33792
    v_mfma_f32_16x16x32_bf16 v[0:3], a[16:19], v[88:91], v[0:3]
    ds_read_b128 v[72:75], v236 offset:34816
    v_mfma_f32_16x16x32_bf16 v[0:3], a[24:27], v[92:95], v[0:3]
    ds_read_b128 v[76:79], v236 offset:35840
    v_mfma_f32_16x16x32_bf16 v[4:7], a[4:7], v[80:83], v[4:7]
    v_mfma_f32_16x16x32_bf16 v[4:7], a[12:15], v[84:87], v[4:7]
    v_mfma_f32_16x16x32_bf16 v[4:7], a[20:23], v[88:91], v[4:7]
    v_mfma_f32_16x16x32_bf16 v[4:7], a[28:31], v[92:95], v[4:7]
    v_mfma_f32_16x16x32_bf16 v[0:3], a[32:35], v[96:99], v[0:3]
    ds_read_b128 v[80:83], v236 offset:36864
    v_mfma_f32_16x16x32_bf16 v[0:3], a[40:43], v[100:103], v[0:3]
    ds_read_b128 v[84:87], v236 offset:37888
    v_mfma_f32_16x16x32_bf16 v[0:3], a[48:51], v[104:107], v[0:3]
    s_waitcnt lgkmcnt(2)
    ds_read_b128 v[88:91], v236 offset:38912
    v_mfma_f32_16x16x32_bf16 v[0:3], a[56:59], v[108:111], v[0:3]
    ds_read_b128 v[92:95], v236 offset:39936
    v_mfma_f32_16x16x32_bf16 v[4:7], a[36:39], v[96:99], v[4:7]
    v_mfma_f32_16x16x32_bf16 v[4:7], a[44:47], v[100:103], v[4:7]
    v_mfma_f32_16x16x32_bf16 v[4:7], a[52:55], v[104:107], v[4:7]
    v_mfma_f32_16x16x32_bf16 v[4:7], a[60:63], v[108:111], v[4:7]
    v_mfma_f32_16x16x32_bf16 v[0:3], a[64:67], v[64:67], v[0:3]
    ds_read_b128 v[96:99], v236 offset:40960
    v_mfma_f32_16x16x32_bf16 v[0:3], a[72:75], v[68:71], v[0:3]
    ds_read_b128 v[100:103], v236 offset:41984
    v_mfma_f32_16x16x32_bf16 v[0:3], a[80:83], v[72:75], v[0:3]
    ds_read_b128 v[104:107], v236 offset:43008
    v_mfma_f32_16x16x32_bf16 v[0:3], a[88:91], v[76:79], v[0:3]
    ds_read_b128 v[108:111], v236 offset:44032
    v_mfma_f32_16x16x32_bf16 v[4:7], a[68:71], v[64:67], v[4:7]
    v_mfma_f32_16x16x32_bf16 v[4:7], a[76:79], v[68:71], v[4:7]
    v_mfma_f32_16x16x32_bf16 v[4:7], a[84:87], v[72:75], v[4:7]
    v_mfma_f32_16x16x32_bf16 v[4:7], a[92:95], v[76:79], v[4:7]
    s_waitcnt lgkmcnt(3)
    v_mfma_f32_16x16x32_bf16 v[0:3], a[96:99], v[80:83], v[0:3]
    ds_read_b128 v[64:67], v236 offset:45056
    s_waitcnt vmcnt(0)
    s_mov_b32 s96, 0
    v_cmp_ne_u32 vcc, s94, v246
    s_nop 4
    s_cbranch_vccnz F_tp
    s_sub_u32 s11, s9, 1
    s_and_b32 s11, s11, 3
    s_lshl_b32 s11, s11, 1
    s_and_b32 s12, s2, 0xf9
    s_or_b32 s11, s11, s12
    s_mul_i32 s11, s11, 50176
    s_mul_i32 s12, s52, 12288
    s_add_u32 s11, s11, s12
    s_add_u32 s11, s11, 0x4400000
    buffer_load_dwordx4 v[16:19], v248, s[32:35], s11 offen offset:0 sc1
    buffer_load_dwordx4 v[20:23], v248, s[32:35], s11 offen offset:1024 sc1
    buffer_load_dwordx4 v[24:27], v248, s[32:35], s11 offen offset:2048 sc1
    buffer_load_dwordx4 v[28:31], v248, s[32:35], s11 offen offset:3072 sc1
    s_sub_u32 s11, s9, 2
    s_and_b32 s11, s11, 3
    s_lshl_b32 s11, s11, 1
    s_and_b32 s12, s2, 0xf9
    s_or_b32 s11, s11, s12
    s_mul_i32 s11, s11, 50176
    s_mul_i32 s12, s52, 12288
    s_add_u32 s11, s11, s12
    s_add_u32 s11, s11, 0x4401000
    buffer_load_dwordx4 v[32:35], v248, s[32:35], s11 offen offset:0 sc1
    buffer_load_dwordx4 v[36:39], v248, s[32:35], s11 offen offset:1024 sc1
    buffer_load_dwordx4 v[40:43], v248, s[32:35], s11 offen offset:2048 sc1
    buffer_load_dwordx4 v[44:47], v248, s[32:35], s11 offen offset:3072 sc1
    s_sub_u32 s11, s9, 3
    s_and_b32 s11, s11, 3
    s_lshl_b32 s11, s11, 1
    s_and_b32 s12, s2, 0xf9
    s_or_b32 s11, s11, s12
    s_mul_i32 s11, s11, 50176
    s_mul_i32 s12, s52, 12288
    s_add_u32 s11, s11, s12
    s_add_u32 s11, s11, 0x4402000
    buffer_load_dwordx4 v[48:51], v248, s[32:35], s11 offen offset:0 sc1
    buffer_load_dwordx4 v[52:55], v248, s[32:35], s11 offen offset:1024 sc1
    buffer_load_dwordx4 v[56:59], v248, s[32:35], s11 offen offset:2048 sc1
    buffer_load_dwordx4 v[60:63], v248, s[32:35], s11 offen offset:3072 sc1
    s_mov_b32 s96, 1
F_tp:
    v_mfma_f32_16x16x32_bf16 v[0:3], a[104:107], v[84:87], v[0:3]
    ds_read_b128 v[68:71], v236 offset:46080
    v_mfma_f32_16x16x32_bf16 v[0:3], a[112:115], v[88:91], v[0:3]
    ds_read_b128 v[72:75], v236 offset:47104
    v_mfma_f32_16x16x32_bf16 v[0:3], a[120:123], v[92:95], v[0:3]
    ds_read_b128 v[76:79], v236 offset:48128
    v_mfma_f32_16x16x32_bf16 v[4:7], a[100:103], v[80:83], v[4:7]
    v_mfma_f32_16x16x32_bf16 v[4:7], a[108:111], v[84:87], v[4:7]
    v_mfma_f32_16x16x32_bf16 v[4:7], a[116:119], v[88:91], v[4:7]
    v_mfma_f32_16x16x32_bf16 v[4:7], a[124:127], v[92:95], v[4:7]
    v_mfma_f32_16x16x32_bf16 v[0:3], v[128:131], v[96:99], v[0:3]
    s_waitcnt lgkmcnt(2)
    v_mfma_f32_16x16x32_bf16 v[0:3], v[136:139], v[100:103], v[0:3]
    v_mfma_f32_16x16x32_bf16 v[0:3], v[144:147], v[104:107], v[0:3]
    v_mfma_f32_16x16x32_bf16 v[0:3], v[152:155], v[108:111], v[0:3]
    v_mfma_f32_16x16x32_bf16 v[4:7], v[132:135], v[96:99], v[4:7]
    v_mfma_f32_16x16x32_bf16 v[4:7], v[140:143], v[100:103], v[4:7]
    v_mfma_f32_16x16x32_bf16 v[4:7], v[148:151], v[104:107], v[4:7]
    v_mfma_f32_16x16x32_bf16 v[4:7], v[156:159], v[108:111], v[4:7]
    v_mfma_f32_16x16x32_bf16 v[0:3], v[160:163], v[64:67], v[0:3]
    v_mfma_f32_16x16x32_bf16 v[0:3], v[168:171], v[68:71], v[0:3]
    s_waitcnt lgkmcnt(0)
    v_mfma_f32_16x16x32_bf16 v[0:3], v[176:179], v[72:75], v[0:3]
    v_mfma_f32_16x16x32_bf16 v[0:3], v[184:187], v[76:79], v[0:3]
    v_mfma_f32_16x16x32_bf16 v[4:7], v[164:167], v[64:67], v[4:7]
    v_mfma_f32_16x16x32_bf16 v[4:7], v[172:175], v[68:71], v[4:7]
    v_mfma_f32_16x16x32_bf16 v[4:7], v[180:183], v[72:75], v[4:7]
    v_mfma_f32_16x16x32_bf16 v[4:7], v[188:191], v[76:79], v[4:7]
    s_cmp_lg_u32 s98, 1
    s_cbranch_scc1 F_em2
    s_mov_b32 s16, 100000
F_pl11:
    v_xor_b32 v212, s94, v212
    v_xor_b32 v213, s94, v213
    v_xor_b32 v214, s94, v214
    v_xor_b32 v215, s94, v215
    v_or3_b32 v212, v212, v213, v214
    v_or_b32 v212, v212, v215
    v_cmp_ne_u32 vcc, 0, v212
    s_nop 4
    s_cbranch_vccz F_pd11
    s_sleep 8
    buffer_load_dwordx4 v[212:215], v228, s[32:35], 0 offen sc1
    s_sub_u32 s16, s16, 1
    s_waitcnt vmcnt(0)
    s_cbranch_scc0 F_pl11
F_pd11:
    s_add_u32 s44, s30, 0x220000
    s_addc_u32 s45, s31, 0
    s_and_b32 s45, s45, 0xffff
    s_mov_b32 s46, 1409024
    s_mov_b32 s47, 0x20000
    v_lshlrev_b32 v245, 14, v240
    v_lshl_add_u32 v245, v242, 5, v245
    s_sub_u32 s70, s71, 1
    s_lshl_b32 s70, s70, 11
    s_lshl_b32 s58, s8, 9
    s_add_u32 s70, s70, s58
    s_lshl_b32 s58, s52, 7
    s_add_u32 s70, s70, s58
    buffer_load_dwordx4 a[128:131], v245, s[44:47], s70 offen sc1
    buffer_load_dwordx4 a[132:135], v245, s[44:47], s70 offen offset:16 sc1
    s_add_u32 s70, s70, 262144
    buffer_load_dwordx4 a[136:139], v245, s[44:47], s70 offen sc1
    buffer_load_dwordx4 a[140:143], v245, s[44:47], s70 offen offset:16 sc1
    s_add_u32 s70, s70, 262144
    buffer_load_dwordx4 a[144:147], v245, s[44:47], s70 offen sc1
    buffer_load_dwordx4 a[148:151], v245, s[44:47], s70 offen offset:16 sc1
    s_add_u32 s70, s70, 262144
    buffer_load_dwordx4 a[152:155], v245, s[44:47], s70 offen sc1
    buffer_load_dwordx4 a[156:159], v245, s[44:47], s70 offen offset:16 sc1
    s_add_u32 s70, s70, 262144
    buffer_load_dwordx4 a[160:163], v245, s[44:47], s70 offen sc1
    buffer_load_dwordx4 a[164:167], v245, s[44:47], s70 offen offset:16 sc1
    s_add_u32 s70, s70, 262144
    buffer_load_dwordx4 a[168:171], v245, s[44:47], s70 offen sc1
    buffer_load_dwordx4 a[172:175], v245, s[44:47], s70 offen offset:16 sc1
    s_add_u32 s70, s70, 262144
F_em2:
    v_mov_b32 v64, 0
    v_mov_b32 v65, 0
    v_mov_b32 v66, 0
    v_mov_b32 v67, 0
    v_mov_b32 v68, 0
    v_mov_b32 v69, 0
    v_mov_b32 v70, 0
    v_mov_b32 v71, 0
    v_mov_b32 v72, 0
    v_mov_b32 v73, 0
    v_mov_b32 v74, 0
    v_mov_b32 v75, 0
    v_mov_b32 v76, 0
    v_mov_b32 v77, 0
    v_mov_b32 v78, 0
    v_mov_b32 v79, 0
    s_cmp_eq_u32 s98, 0
    s_cbranch_scc1 F_noupd
    s_add_u32 s56, s98, s96
    s_cmp_eq_u32 s56, 3
    s_cbranch_scc1 F_upd2
F_upd:
    s_waitcnt vmcnt(0)
F_upd2:
    s_and_b32 s57, s69, 0xffff0000
    v_mov_b32 v80, s57
    v_ashrrev_i32 v81, 31, v80
    v_not_b32 v81, v81
    v_or_b32 v81, 0x80000000, v81
    v_xor_b32 v80, v80, v81
    v_and_b32 v80, 0xffff0000, v80
    v_mul_f32 v80, 0xbfb8aa3b, v80
    v_exp_f32 v80, v80
    s_nop 0
    v_add_f32 v80, 1.0, v80
    v_rcp_f32 v80, v80
    s_nop 0
    v_cvt_pk_bf16_f32 v80, v80, v80
    v_lshlrev_b32 v80, 16, v80
    s_waitcnt vmcnt(12)
    v_accvgpr_read_b32 v128, a128
    v_accvgpr_read_b32 v129, a129
    v_accvgpr_read_b32 v130, a130
    v_accvgpr_read_b32 v131, a131
    v_accvgpr_read_b32 v132, a132
    v_accvgpr_read_b32 v133, a133
    v_accvgpr_read_b32 v134, a134
    v_accvgpr_read_b32 v135, a135
    v_accvgpr_read_b32 v136, a136
    v_accvgpr_read_b32 v137, a137
    v_accvgpr_read_b32 v138, a138
    v_accvgpr_read_b32 v139, a139
    v_accvgpr_read_b32 v140, a140
    v_accvgpr_read_b32 v141, a141
    v_accvgpr_read_b32 v142, a142
    v_accvgpr_read_b32 v143, a143
    v_accvgpr_read_b32 v144, a144
    v_accvgpr_read_b32 v145, a145
    v_accvgpr_read_b32 v146, a146
    v_accvgpr_read_b32 v147, a147
    v_accvgpr_read_b32 v148, a148
    v_accvgpr_read_b32 v149, a149
    v_accvgpr_read_b32 v150, a150
    v_accvgpr_read_b32 v151, a151
    v_accvgpr_read_b32 v152, a152
    v_accvgpr_read_b32 v153, a153
    v_accvgpr_read_b32 v154, a154
    v_accvgpr_read_b32 v155, a155
    v_accvgpr_read_b32 v156, a156
    v_accvgpr_read_b32 v157, a157
    v_accvgpr_read_b32 v158, a158
    v_accvgpr_read_b32 v159, a159
    v_accvgpr_read_b32 v160, a160
    v_accvgpr_read_b32 v161, a161
    v_accvgpr_read_b32 v162, a162
    v_accvgpr_read_b32 v163, a163
    v_accvgpr_read_b32 v164, a164
    v_accvgpr_read_b32 v165, a165
    v_accvgpr_read_b32 v166, a166
    v_accvgpr_read_b32 v167, a167
    v_accvgpr_read_b32 v168, a168
    v_accvgpr_read_b32 v169, a169
    v_accvgpr_read_b32 v170, a170
    v_accvgpr_read_b32 v171, a171
    v_accvgpr_read_b32 v172, a172
    v_accvgpr_read_b32 v173, a173
    v_accvgpr_read_b32 v174, a174
    v_accvgpr_read_b32 v175, a175
    v_add_f32 v128, v128, v136
    v_add_f32 v129, v129, v137
    v_add_f32 v130, v130, v138
    v_add_f32 v131, v131, v139
    v_add_f32 v132, v132, v140
    v_add_f32 v133, v133, v141
    v_add_f32 v134, v134, v142
    v_add_f32 v135, v135, v143
    v_add_f32 v128, v128, v144
    v_add_f32 v129, v129, v145
    v_add_f32 v130, v130, v146
    v_add_f32 v131, v131, v147
    v_add_f32 v132, v132, v148
    v_add_f32 v133, v133, v149
    v_add_f32 v134, v134, v150
    v_add_f32 v135, v135, v151
    v_add_f32 v128, v128, v152
    v_add_f32 v129, v129, v153
    v_add_f32 v130, v130, v154
    v_add_f32 v131, v131, v155
    v_add_f32 v132, v132, v156
    v_add_f32 v133, v133, v157
    v_add_f32 v134, v134, v158
    v_add_f32 v135, v135, v159
    v_add_f32 v128, v128, v160
    v_add_f32 v129, v129, v161
    v_add_f32 v130, v130, v162
    v_add_f32 v131, v131, v163
    v_add_f32 v132, v132, v164
    v_add_f32 v133, v133, v165
    v_add_f32 v134, v134, v166
    v_add_f32 v135, v135, v167
    v_add_f32 v128, v128, v168
    v_add_f32 v129, v129, v169
    v_add_f32 v130, v130, v170
    v_add_f32 v131, v131, v171
    v_add_f32 v132, v132, v172
    v_add_f32 v133, v133, v173
    v_add_f32 v134, v134, v174
    v_add_f32 v135, v135, v175
    v_add_f32_dpp v128, v128, v128 quad_perm:[1,0,3,2] row_mask:0xf bank_mask:0xf
    v_add_f32_dpp v129, v129, v129 quad_perm:[1,0,3,2] row_mask:0xf bank_mask:0xf
    v_add_f32_dpp v130, v130, v130 quad_perm:[1,0,3,2] row_mask:0xf bank_mask:0xf
    v_add_f32_dpp v131, v131, v131 quad_perm:[1,0,3,2] row_mask:0xf bank_mask:0xf
    v_add_f32_dpp v132, v132, v132 quad_perm:[1,0,3,2] row_mask:0xf bank_mask:0xf
    v_add_f32_dpp v133, v133, v133 quad_perm:[1,0,3,2] row_mask:0xf bank_mask:0xf
    v_add_f32_dpp v134, v134, v134 quad_perm:[1,0,3,2] row_mask:0xf bank_mask:0xf
    v_add_f32_dpp v135, v135, v135 quad_perm:[1,0,3,2] row_mask:0xf bank_mask:0xf
    v_add_f32_dpp v128, v128, v128 quad_perm:[2,3,0,1] row_mask:0xf bank_mask:0xf
    v_add_f32_dpp v129, v129, v129 quad_perm:[2,3,0,1] row_mask:0xf bank_mask:0xf
    v_add_f32_dpp v130, v130, v130 quad_perm:[2,3,0,1] row_mask:0xf bank_mask:0xf
    v_add_f32_dpp v131, v131, v131 quad_perm:[2,3,0,1] row_mask:0xf bank_mask:0xf
    v_add_f32_dpp v132, v132, v132 quad_perm:[2,3,0,1] row_mask:0xf bank_mask:0xf
    v_add_f32_dpp v133, v133, v133 quad_perm:[2,3,0,1] row_mask:0xf bank_mask:0xf
    v_add_f32_dpp v134, v134, v134 quad_perm:[2,3,0,1] row_mask:0xf bank_mask:0xf
    v_add_f32_dpp v135, v135, v135 quad_perm:[2,3,0,1] row_mask:0xf bank_mask:0xf
    v_add_f32_dpp v128, v128, v128 row_half_mirror row_mask:0xf bank_mask:0xf
    v_add_f32_dpp v129, v129, v129 row_half_mirror row_mask:0xf bank_mask:0xf
    v_add_f32_dpp v130, v130, v130 row_half_mirror row_mask:0xf bank_mask:0xf
    v_add_f32_dpp v131, v131, v131 row_half_mirror row_mask:0xf bank_mask:0xf
    v_add_f32_dpp v132, v132, v132 row_half_mirror row_mask:0xf bank_mask:0xf
    v_add_f32_dpp v133, v133, v133 row_half_mirror row_mask:0xf bank_mask:0xf
    v_add_f32_dpp v134, v134, v134 row_half_mirror row_mask:0xf bank_mask:0xf
    v_add_f32_dpp v135, v135, v135 row_half_mirror row_mask:0xf bank_mask:0xf
    v_add_f32_dpp v128, v128, v128 row_mirror row_mask:0xf bank_mask:0xf
    v_add_f32_dpp v129, v129, v129 row_mirror row_mask:0xf bank_mask:0xf
    v_add_f32_dpp v130, v130, v130 row_mirror row_mask:0xf bank_mask:0xf
    v_add_f32_dpp v131, v131, v131 row_mirror row_mask:0xf bank_mask:0xf
    v_add_f32_dpp v132, v132, v132 row_mirror row_mask:0xf bank_mask:0xf
    v_add_f32_dpp v133, v133, v133 row_mirror row_mask:0xf bank_mask:0xf
    v_add_f32_dpp v134, v134, v134 row_mirror row_mask:0xf bank_mask:0xf
    v_add_f32_dpp v135, v135, v135 row_mirror row_mask:0xf bank_mask:0xf
    v_cvt_pk_bf16_f32 v136, v128, v129
    v_cvt_pk_bf16_f32 v137, v130, v131
    v_cvt_pk_bf16_f32 v138, v132, v133
    v_cvt_pk_bf16_f32 v139, v134, v135
    v_lshlrev_b32 v128, 16, v136
    v_and_b32 v129, 0xffff0000, v136
    v_lshlrev_b32 v130, 16, v137
    v_and_b32 v131, 0xffff0000, v137
    v_lshlrev_b32 v132, 16, v138
    v_and_b32 v133, 0xffff0000, v138
    v_lshlrev_b32 v134, 16, v139
    v_and_b32 v135, 0xffff0000, v139
    v_mul_f32 v128, v128, v80
    v_mul_f32 v129, v129, v80
    v_mul_f32 v130, v130, v80
    v_mul_f32 v131, v131, v80
    v_mul_f32 v132, v132, v80
    v_mul_f32 v133, v133, v80
    v_mul_f32 v134, v134, v80
    v_mul_f32 v135, v135, v80
    v_cvt_pk_bf16_f32 v136, v128, v129
    v_cvt_pk_bf16_f32 v137, v130, v131
    v_cvt_pk_bf16_f32 v138, v132, v133
    v_cvt_pk_bf16_f32 v139, v134, v135
    v_lshlrev_b32 v128, 16, v136
    v_and_b32 v129, 0xffff0000, v136
    v_lshlrev_b32 v130, 16, v137
    v_and_b32 v131, 0xffff0000, v137
    v_lshlrev_b32 v132, 16, v138
    v_and_b32 v133, 0xffff0000, v138
    v_lshlrev_b32 v134, 16, v139
    v_and_b32 v135, 0xffff0000, v139
    s_and_b32 s56, s72, 0x40f
    s_sub_u32 s56, s56, 0
    v_cmp_eq_u32 vcc, s56, v240
    s_nop 1
    v_cndmask_b32 v64, v64, v128, vcc
    v_cndmask_b32 v65, v65, v129, vcc
    v_cndmask_b32 v66, v66, v130, vcc
    v_cndmask_b32 v67, v67, v131, vcc
    v_cndmask_b32 v68, v68, v132, vcc
    v_cndmask_b32 v69, v69, v133, vcc
    v_cndmask_b32 v70, v70, v134, vcc
    v_cndmask_b32 v71, v71, v135, vcc
    s_and_b32 s56, s72, 0x40f
    s_sub_u32 s56, s56, 1024
    v_cmp_eq_u32 vcc, s56, v240
    s_nop 1
    v_cndmask_b32 v72, v72, v128, vcc
    v_cndmask_b32 v73, v73, v129, vcc
    v_cndmask_b32 v74, v74, v130, vcc
    v_cndmask_b32 v75, v75, v131, vcc
    v_cndmask_b32 v76, v76, v132, vcc
    v_cndmask_b32 v77, v77, v133, vcc
    v_cndmask_b32 v78, v78, v134, vcc
    v_cndmask_b32 v79, v79, v135, vcc
F_fm12:
    s_cmp_ge_u32 s71, 8
    s_cbranch_scc1 F_noupd
    v_readlane_b32 s69, v234, s71
    s_add_u32 s71, s71, 1
    s_nop 1
    s_and_b32 s72, s69, 0x7ff
    s_sub_u32 s72, 2047, s72
    s_bfe_u32 s70, s72, 0x20004
    s_cmp_lg_u32 s70, s9
    s_cbranch_scc1 F_fm12
    s_lshr_b32 s70, s72, 6
    s_sub_u32 s58, 31, s70
    s_min_u32 s58, s70, s58
    s_cmp_lg_u32 s58, s7
    s_cbranch_scc1 F_fm12
    s_add_u32 s44, s30, 0x220000
    s_addc_u32 s45, s31, 0
    s_and_b32 s45, s45, 0xffff
    s_mov_b32 s46, 1409024
    s_mov_b32 s47, 0x20000
    v_lshlrev_b32 v245, 14, v240
    v_lshl_add_u32 v245, v242, 5, v245
    s_sub_u32 s70, s71, 1
    s_lshl_b32 s70, s70, 11
    s_lshl_b32 s58, s8, 9
    s_add_u32 s70, s70, s58
    s_lshl_b32 s58, s52, 7
    s_add_u32 s70, s70, s58
    buffer_load_dwordx4 a[128:131], v245, s[44:47], s70 offen sc1
    buffer_load_dwordx4 a[132:135], v245, s[44:47], s70 offen offset:16 sc1
    s_add_u32 s70, s70, 262144
    buffer_load_dwordx4 a[136:139], v245, s[44:47], s70 offen sc1
    buffer_load_dwordx4 a[140:143], v245, s[44:47], s70 offen offset:16 sc1
    s_add_u32 s70, s70, 262144
    buffer_load_dwordx4 a[144:147], v245, s[44:47], s70 offen sc1
    buffer_load_dwordx4 a[148:151], v245, s[44:47], s70 offen offset:16 sc1
    s_add_u32 s70, s70, 262144
    buffer_load_dwordx4 a[152:155], v245, s[44:47], s70 offen sc1
    buffer_load_dwordx4 a[156:159], v245, s[44:47], s70 offen offset:16 sc1
    s_add_u32 s70, s70, 262144
    buffer_load_dwordx4 a[160:163], v245, s[44:47], s70 offen sc1
    buffer_load_dwordx4 a[164:167], v245, s[44:47], s70 offen offset:16 sc1
    s_add_u32 s70, s70, 262144
    buffer_load_dwordx4 a[168:171], v245, s[44:47], s70 offen sc1
    buffer_load_dwordx4 a[172:175], v245, s[44:47], s70 offen offset:16 sc1
    s_add_u32 s70, s70, 262144
    s_branch F_upd
F_noupd:
    s_cmp_eq_u32 s96, 1
    s_cbranch_scc1 F_havept
    s_mov_b32 s16, 100000
F_pl13:
    v_cmp_ne_u32 vcc, s94, v246
    s_nop 4
    s_cbranch_vccz F_pd13
    s_sleep 4
    buffer_load_dword v246, v247, s[32:35], s95 offen offset:256 sc1
    s_sub_u32 s16, s16, 1
    s_waitcnt vmcnt(0)
    s_cbranch_scc0 F_pl13
F_pd13:
    s_sub_u32 s11, s9, 1
    s_and_b32 s11, s11, 3
    s_lshl_b32 s11, s11, 1
    s_and_b32 s12, s2, 0xf9
    s_or_b32 s11, s11, s12
    s_mul_i32 s11, s11, 50176
    s_mul_i32 s12, s52, 12288
    s_add_u32 s11, s11, s12
    s_add_u32 s11, s11, 0x4400000
    buffer_load_dwordx4 v[16:19], v248, s[32:35], s11 offen offset:0 sc1
    buffer_load_dwordx4 v[20:23], v248, s[32:35], s11 offen offset:1024 sc1
    buffer_load_dwordx4 v[24:27], v248, s[32:35], s11 offen offset:2048 sc1
    buffer_load_dwordx4 v[28:31], v248, s[32:35], s11 offen offset:3072 sc1
    s_sub_u32 s11, s9, 2
    s_and_b32 s11, s11, 3
    s_lshl_b32 s11, s11, 1
    s_and_b32 s12, s2, 0xf9
    s_or_b32 s11, s11, s12
    s_mul_i32 s11, s11, 50176
    s_mul_i32 s12, s52, 12288
    s_add_u32 s11, s11, s12
    s_add_u32 s11, s11, 0x4401000
    buffer_load_dwordx4 v[32:35], v248, s[32:35], s11 offen offset:0 sc1
    buffer_load_dwordx4 v[36:39], v248, s[32:35], s11 offen offset:1024 sc1
    buffer_load_dwordx4 v[40:43], v248, s[32:35], s11 offen offset:2048 sc1
    buffer_load_dwordx4 v[44:47], v248, s[32:35], s11 offen offset:3072 sc1
    s_sub_u32 s11, s9, 3
    s_and_b32 s11, s11, 3
    s_lshl_b32 s11, s11, 1
    s_and_b32 s12, s2, 0xf9
    s_or_b32 s11, s11, s12
    s_mul_i32 s11, s11, 50176
    s_mul_i32 s12, s52, 12288
    s_add_u32 s11, s11, s12
    s_add_u32 s11, s11, 0x4402000
    buffer_load_dwordx4 v[48:51], v248, s[32:35], s11 offen offset:0 sc1
    buffer_load_dwordx4 v[52:55], v248, s[32:35], s11 offen offset:1024 sc1
    buffer_load_dwordx4 v[56:59], v248, s[32:35], s11 offen offset:2048 sc1
    buffer_load_dwordx4 v[60:63], v248, s[32:35], s11 offen offset:3072 sc1
F_havept:
    s_mov_b32 s36, s26
    s_and_b32 s37, s27, 0xffff
    s_mov_b32 s38, 0x200000
    s_mov_b32 s39, 0x20000
    v_lshlrev_b32 v84, 16, v192
    v_and_b32 v85, 0xffff0000, v192
    v_lshlrev_b32 v92, 16, v200
    v_and_b32 v93, 0xffff0000, v200
    v_lshlrev_b32 v86, 16, v193
    v_and_b32 v87, 0xffff0000, v193
    v_lshlrev_b32 v94, 16, v201
    v_and_b32 v95, 0xffff0000, v201
    v_lshlrev_b32 v88, 16, v194
    v_and_b32 v89, 0xffff0000, v194
    v_lshlrev_b32 v96, 16, v202
    v_and_b32 v97, 0xffff0000, v202
    v_lshlrev_b32 v90, 16, v195
    v_and_b32 v91, 0xffff0000, v195
    v_lshlrev_b32 v98, 16, v203
    v_and_b32 v99, 0xffff0000, v203
    v_add_f32 v92, v92, v64
    v_add_f32 v93, v93, v65
    v_add_f32 v94, v94, v66
    v_add_f32 v95, v95, v67
    v_add_f32 v96, v96, v68
    v_add_f32 v97, v97, v69
    v_add_f32 v98, v98, v70
    v_add_f32 v99, v99, v71
    v_cvt_pk_bf16_f32 v116, v92, v93
    v_cvt_pk_bf16_f32 v117, v94, v95
    v_cvt_pk_bf16_f32 v118, v96, v97
    v_cvt_pk_bf16_f32 v119, v98, v99
    v_lshlrev_b32 v92, 16, v116
    v_and_b32 v93, 0xffff0000, v116
    v_lshlrev_b32 v94, 16, v117
    v_and_b32 v95, 0xffff0000, v117
    v_lshlrev_b32 v96, 16, v118
    v_and_b32 v97, 0xffff0000, v118
    v_lshlrev_b32 v98, 16, v119
    v_and_b32 v99, 0xffff0000, v119
    v_lshlrev_b32 v100, 16, v196
    v_and_b32 v101, 0xffff0000, v196
    v_lshlrev_b32 v108, 16, v204
    v_and_b32 v109, 0xffff0000, v204
    v_lshlrev_b32 v102, 16, v197
    v_and_b32 v103, 0xffff0000, v197
    v_lshlrev_b32 v110, 16, v205
    v_and_b32 v111, 0xffff0000, v205
    v_lshlrev_b32 v104, 16, v198
    v_and_b32 v105, 0xffff0000, v198
    v_lshlrev_b32 v112, 16, v206
    v_and_b32 v113, 0xffff0000, v206
    v_lshlrev_b32 v106, 16, v199
    v_and_b32 v107, 0xffff0000, v199
    v_lshlrev_b32 v114, 16, v207
    v_and_b32 v115, 0xffff0000, v207
    v_add_f32 v108, v108, v72
    v_add_f32 v109, v109, v73
    v_add_f32 v110, v110, v74
    v_add_f32 v111, v111, v75
    v_add_f32 v112, v112, v76
    v_add_f32 v113, v113, v77
    v_add_f32 v114, v114, v78
    v_add_f32 v115, v115, v79
    v_cvt_pk_bf16_f32 v116, v108, v109
    v_cvt_pk_bf16_f32 v117, v110, v111
    v_cvt_pk_bf16_f32 v118, v112, v113
    v_cvt_pk_bf16_f32 v119, v114, v115
    v_lshlrev_b32 v108, 16, v116
    v_and_b32 v109, 0xffff0000, v116
    v_lshlrev_b32 v110, 16, v117
    v_and_b32 v111, 0xffff0000, v117
    v_lshlrev_b32 v112, 16, v118
    v_and_b32 v113, 0xffff0000, v118
    v_lshlrev_b32 v114, 16, v119
    v_and_b32 v115, 0xffff0000, v119
    s_waitcnt vmcnt(8)
    v_pk_add_f32 v[0:1], v[0:1], v[16:17]
    v_pk_add_f32 v[2:3], v[2:3], v[18:19]
    v_pk_add_f32 v[4:5], v[4:5], v[20:21]
    v_pk_add_f32 v[6:7], v[6:7], v[22:23]
    v_pk_add_f32 v[8:9], v[8:9], v[24:25]
    v_pk_add_f32 v[10:11], v[10:11], v[26:27]
    v_pk_add_f32 v[12:13], v[12:13], v[28:29]
    v_pk_add_f32 v[14:15], v[14:15], v[30:31]
    s_waitcnt vmcnt(4)
    v_pk_add_f32 v[0:1], v[0:1], v[32:33]
    v_pk_add_f32 v[2:3], v[2:3], v[34:35]
    v_pk_add_f32 v[4:5], v[4:5], v[36:37]
    v_pk_add_f32 v[6:7], v[6:7], v[38:39]
    v_pk_add_f32 v[8:9], v[8:9], v[40:41]
    v_pk_add_f32 v[10:11], v[10:11], v[42:43]
    v_pk_add_f32 v[12:13], v[12:13], v[44:45]
    v_pk_add_f32 v[14:15], v[14:15], v[46:47]
    s_waitcnt vmcnt(0)
    v_pk_add_f32 v[0:1], v[0:1], v[48:49]
    v_pk_add_f32 v[2:3], v[2:3], v[50:51]
    v_pk_add_f32 v[4:5], v[4:5], v[52:53]
    v_pk_add_f32 v[6:7], v[6:7], v[54:55]
    v_pk_add_f32 v[8:9], v[8:9], v[56:57]
    v_pk_add_f32 v[10:11], v[10:11], v[58:59]
    v_pk_add_f32 v[12:13], v[12:13], v[60:61]
    v_pk_add_f32 v[14:15], v[14:15], v[62:63]
    v_cvt_pk_bf16_f32 v16, v0, v1
    v_cvt_pk_bf16_f32 v17, v2, v3
    v_cvt_pk_bf16_f32 v18, v4, v5
    v_cvt_pk_bf16_f32 v19, v6, v7
    v_lshlrev_b32 v0, 16, v16
    v_and_b32 v1, 0xffff0000, v16
    v_lshlrev_b32 v2, 16, v17
    v_and_b32 v3, 0xffff0000, v17
    v_lshlrev_b32 v4, 16, v18
    v_and_b32 v5, 0xffff0000, v18
    v_lshlrev_b32 v6, 16, v19
    v_and_b32 v7, 0xffff0000, v19
    v_add_f32 v0, v0, v84
    v_add_f32 v1, v1, v85
    v_add_f32 v2, v2, v86
    v_add_f32 v3, v3, v87
    v_add_f32 v4, v4, v88
    v_add_f32 v5, v5, v89
    v_add_f32 v6, v6, v90
    v_add_f32 v7, v7, v91
    v_cvt_pk_bf16_f32 v16, v0, v1
    v_cvt_pk_bf16_f32 v17, v2, v3
    v_cvt_pk_bf16_f32 v18, v4, v5
    v_cvt_pk_bf16_f32 v19, v6, v7
    v_lshlrev_b32 v0, 16, v16
    v_and_b32 v1, 0xffff0000, v16
    v_lshlrev_b32 v2, 16, v17
    v_and_b32 v3, 0xffff0000, v17
    v_lshlrev_b32 v4, 16, v18
    v_and_b32 v5, 0xffff0000, v18
    v_lshlrev_b32 v6, 16, v19
    v_and_b32 v7, 0xffff0000, v19
    v_add_f32 v0, v0, v92
    v_add_f32 v1, v1, v93
    v_add_f32 v2, v2, v94
    v_add_f32 v3, v3, v95
    v_add_f32 v4, v4, v96
    v_add_f32 v5, v5, v97
    v_add_f32 v6, v6, v98
    v_add_f32 v7, v7, v99
    v_cvt_pk_bf16_f32 v20, v0, v1
    v_cvt_pk_bf16_f32 v21, v2, v3
    v_cvt_pk_bf16_f32 v22, v4, v5
    v_cvt_pk_bf16_f32 v23, v6, v7
    buffer_store_dwordx4 v[20:23], v241, s[36:39], s73 offen sc1
    v_cvt_pk_bf16_f32 v16, v8, v9
    v_cvt_pk_bf16_f32 v17, v10, v11
    v_cvt_pk_bf16_f32 v18, v12, v13
    v_cvt_pk_bf16_f32 v19, v14, v15
    v_lshlrev_b32 v8, 16, v16
    v_and_b32 v9, 0xffff0000, v16
    v_lshlrev_b32 v10, 16, v17
    v_and_b32 v11, 0xffff0000, v17
    v_lshlrev_b32 v12, 16, v18
    v_and_b32 v13, 0xffff0000, v18
    v_lshlrev_b32 v14, 16, v19
    v_and_b32 v15, 0xffff0000, v19
    v_add_f32 v8, v8, v100
    v_add_f32 v9, v9, v101
    v_add_f32 v10, v10, v102
    v_add_f32 v11, v11, v103
    v_add_f32 v12, v12, v104
    v_add_f32 v13, v13, v105
    v_add_f32 v14, v14, v106
    v_add_f32 v15, v15, v107
    v_cvt_pk_bf16_f32 v16, v8, v9
    v_cvt_pk_bf16_f32 v17, v10, v11
    v_cvt_pk_bf16_f32 v18, v12, v13
    v_cvt_pk_bf16_f32 v19, v14, v15
    v_lshlrev_b32 v8, 16, v16
    v_and_b32 v9, 0xffff0000, v16
    v_lshlrev_b32 v10, 16, v17
    v_and_b32 v11, 0xffff0000, v17
    v_lshlrev_b32 v12, 16, v18
    v_and_b32 v13, 0xffff0000, v18
    v_lshlrev_b32 v14, 16, v19
    v_and_b32 v15, 0xffff0000, v19
    v_add_f32 v8, v8, v108
    v_add_f32 v9, v9, v109
    v_add_f32 v10, v10, v110
    v_add_f32 v11, v11, v111
    v_add_f32 v12, v12, v112
    v_add_f32 v13, v13, v113
    v_add_f32 v14, v14, v114
    v_add_f32 v15, v15, v115
    v_cvt_pk_bf16_f32 v24, v8, v9
    v_cvt_pk_bf16_f32 v25, v10, v11
    v_cvt_pk_bf16_f32 v26, v12, v13
    v_cvt_pk_bf16_f32 v27, v14, v15
    buffer_store_dwordx4 v[24:27], v241, s[36:39], s74 offen sc1
F_end:
    s_endpgm
.section .rodata,"a"
.p2align 6
.amdhsa_kernel parallel_sum__compressed_kv_cla__moe_arch_mod__prompt_kernel
  .amdhsa_next_free_vgpr 512
  .amdhsa_next_free_sgpr 102
  .amdhsa_accum_offset 256
  .amdhsa_group_segment_fixed_size 0
  .amdhsa_kernarg_size 112
  .amdhsa_user_sgpr_count 2
  .amdhsa_user_sgpr_kernarg_segment_ptr 1
  .amdhsa_system_sgpr_workgroup_id_x 1
  .amdhsa_float_denorm_mode_32 3
  .amdhsa_float_denorm_mode_16_64 3
.end_amdhsa_kernel
```
